```python
import torch

def _softmax(x, axis=-1):
    return torch.softmax(x, dim=axis)

def _gelu(x):
    return torch.nn.functional.gelu(x, approximate='tanh')

def _silu(x):
    return torch.nn.functional.silu(x)

def _sigmoid(x):
    return torch.sigmoid(x)

def _layernorm(x, axis=-1, eps=1e-05):
    m = x.mean(dim=axis, keepdim=True)
    v = x.var(dim=axis, keepdim=True, unbiased=False)
    return (x - m) / torch.sqrt(v + eps)

def _scatter_add(tgt, idx, src, axis=0):
    return tgt.clone().index_add_(axis, idx, src)

def _segment_sum(src, seg, n):
    out = torch.zeros((n,) + src.shape[1:], dtype=src.dtype)
    return out.index_add_(0, seg, src)

def _pad(x, pw):
    flat = tuple((v for pair in reversed(pw) for v in pair))
    return torch.nn.functional.pad(x, flat)
kernel_name = 'interleave_layers__linear_attn_block__mixer_gmlp__prompt'

def setup_inputs():

    _w = lambda a: (lambda t: t.to(torch.bfloat16) if t.is_floating_point() else t)(torch.as_tensor(a))

    def _A_setup():
        B, S, D = (1, 2048, 576)
        return {'x': _w((lambda *s: torch.randn(*s, dtype=torch.bfloat16) * 0.05)(B, S, D)), 'wqkv': _w((lambda *s: torch.randn(*s, dtype=torch.bfloat16) * 0.1)(D, 3 * D)), 'wo': _w((lambda *s: torch.randn(*s, dtype=torch.bfloat16) * 0.05)(D, D))}
    _A_in = _A_setup()

    def _B_setup():
        B, S, D, F = (1, 2048, 576, 4608)
        Fh = F // 2
        return {'x': _w((lambda *s: torch.randn(*s, dtype=torch.bfloat16) * 0.05)(B, S, D)), 'w_in': _w((lambda *s: torch.randn(*s, dtype=torch.bfloat16) * 0.2)(D, 2 * Fh)), 'w_sp': _w(0.01 * (lambda *s: torch.randn(*s, dtype=torch.bfloat16) * 0.2)(S, S)), 'b_sp': _w(1.0 + 0.01 * (lambda *s: torch.randn(*s, dtype=torch.bfloat16) * 0.05)(S)), 'w_out': _w((lambda *s: torch.randn(*s, dtype=torch.bfloat16) * 0.05)(Fh, D))}
    _B_in = _B_setup()
    return {'A_x': _A_in['x'], 'A_wqkv': _A_in['wqkv'], 'A_wo': _A_in['wo'], 'B_x': _B_in['x'], 'B_w_in': _B_in['w_in'], 'B_w_sp': _B_in['w_sp'], 'B_b_sp': _B_in['b_sp'], 'B_w_out': _B_in['w_out']}

def reference(A_x, A_wqkv, A_wo, B_x, B_w_in, B_w_sp, B_b_sp, B_w_out):

    def _A_ref(x, wqkv, wo):
        B, S, D = x.shape
        H = 32
        Dh = D // H
        qkv = (lambda x, *d: x.permute(*d))((x @ wqkv).reshape(B, S, 3, H, Dh), 2, 0, 3, 1, 4)
        q, k, v = (qkv[0], qkv[1], qkv[2])
        phi = lambda t: torch.where(t > 0, t + 1, torch.exp(t)) + 1e-06
        pq, pk = (phi(q), phi(k))
        kv = torch.einsum('bhsd,bhse->bhde', pk, v)
        z = torch.einsum('bhsd->bhd', pk)
        num = torch.einsum('bhqd,bhde->bhqe', pq, kv)
        den = torch.einsum('bhqd,bhd->bhq', pq, z)[..., None] + 1e-06
        o = num / den
        return (lambda x, *d: x.permute(*d))(o, 0, 2, 1, 3).reshape(B, S, D) @ wo

    def _B_ref(x, w_in, w_sp, b_sp, w_out):
        B, S, D = x.shape
        F = w_in.shape[-1]
        Fh = F // 2
        z = _gelu(torch.einsum('bsd,df->bsf', x, w_in))
        z1 = z[..., :Fh].clone()
        z2 = _layernorm(z[..., Fh:], axis=-1)
        g = torch.einsum('ts,bsf->btf', w_sp, z2) + b_sp[None, :, None]
        return torch.einsum('bsf,fd->bsd', z1 * g, w_out)
    x = A_x
    x = x + _A_ref(_layernorm(x, axis=-1), A_wqkv, A_wo)
    x = x + _B_ref(_layernorm(x, axis=-1), B_w_in, B_w_sp, B_b_sp, B_w_out)
    x = x + _A_ref(_layernorm(x, axis=-1), A_wqkv, A_wo)
    x = x + _B_ref(_layernorm(x, axis=-1), B_w_in, B_w_sp, B_b_sp, B_w_out)
    return x
```

```asm
; @launch kernel=k0_kernel grid=(1820,1,1) block=(64,1,1) lds=10240
; @launch kernel=mega_kernel grid=(256,1,1) block=(256,1,1) lds=163840
.amdgcn_target "amdgcn-amd-amdhsa--gfx950"
.text
.globl k0_kernel
.p2align 8
.type k0_kernel,@function
k0_kernel:
    s_cmp_ge_u32 s2, 1820
    s_cbranch_scc1 k0_kernel_end1
    v_and_b32 v1, 63, v0
    v_lshrrev_b32 v2, 6, v0
    s_nop 0
    v_readfirstlane_b32 s4, v2
    s_load_dwordx2 s[6:7], s[0:1], 0
    s_load_dwordx2 s[8:9], s[0:1], 8
    s_load_dwordx2 s[10:11], s[0:1], 16
    s_load_dwordx2 s[12:13], s[0:1], 32
    s_load_dwordx2 s[14:15], s[0:1], 40
    s_load_dwordx2 s[16:17], s[0:1], 56
    s_load_dwordx2 s[18:19], s[0:1], 80
    v_and_b32 v3, 15, v1
    v_lshrrev_b32 v4, 4, v1
    s_mul_i32 s20, s2, 1
    s_add_u32 s20, s20, s4
    s_mul_i32 s26, s4, 10240
    v_lshlrev_b32 v8, 4, v1
    v_lshlrev_b32 v9, 3, v4
    v_lshrrev_b32 v5, 2, v3
    v_add_u32 v9, v9, v5
    v_and_b32 v10, 3, v3
    v_lshlrev_b32 v10, 3, v10
    v_mov_b32 v12, 0x3f803f80
    v_mov_b32 v13, 0x3f803f80
    v_mov_b32 v14, 0x3f803f80
    v_mov_b32 v15, 0x3f803f80
    s_waitcnt lgkmcnt(0)
    s_mov_b32 s36, s18
    s_and_b32 s37, s19, 0xffff
    s_mov_b32 s38, 68845568
    s_mov_b32 s39, 0x20000
    s_cmp_ge_u32 s20, 1608
    s_cbranch_scc1 k0_kernel_clr7
    s_cmp_ge_u32 s20, 1320
    s_cbranch_scc1 k0_kernel_out5
    s_cmp_ge_u32 s20, 672
    s_cbranch_scc1 k0_kernel_in4
    s_cmp_ge_u32 s20, 416
    s_cbranch_scc1 k0_kernel_wo3
    s_cmp_ge_u32 s20, 128
    s_cbranch_scc1 k0_kernel_wq2
    s_mov_b32 s32, s6
    s_and_b32 s33, s7, 0xffff
    s_mov_b32 s34, 2359296
    s_mov_b32 s35, 0x20000
    s_lshr_b32 s21, s20, 1
    s_lshl_b32 s21, s21, 5
    s_and_b32 s22, s20, 1
    s_lshl_b32 s22, s22, 2
    s_add_u32 s21, s21, s22
    s_mul_i32 s21, s21, 1152
    v_lshrrev_b32 v5, 2, v3
    v_lshlrev_b32 v5, 3, v5
    v_and_b32 v6, 3, v3
    v_add_u32 v5, v5, v6
    v_mul_u32_u24 v5, 1152, v5
    v_lshlrev_b32 v6, 4, v4
    v_add_u32 v5, v5, v6
    buffer_load_dwordx4 v[16:19], v5, s[32:35], s21 offen offset:0
    buffer_load_dwordx4 v[20:23], v5, s[32:35], s21 offen offset:64
    buffer_load_dwordx4 v[24:27], v5, s[32:35], s21 offen offset:128
    buffer_load_dwordx4 v[28:31], v5, s[32:35], s21 offen offset:192
    buffer_load_dwordx4 v[32:35], v5, s[32:35], s21 offen offset:256
    buffer_load_dwordx4 v[36:39], v5, s[32:35], s21 offen offset:320
    buffer_load_dwordx4 v[40:43], v5, s[32:35], s21 offen offset:384
    buffer_load_dwordx4 v[44:47], v5, s[32:35], s21 offen offset:448
    buffer_load_dwordx4 v[48:51], v5, s[32:35], s21 offen offset:512
    buffer_load_dwordx4 v[52:55], v5, s[32:35], s21 offen offset:576
    buffer_load_dwordx4 v[56:59], v5, s[32:35], s21 offen offset:640
    buffer_load_dwordx4 v[60:63], v5, s[32:35], s21 offen offset:704
    buffer_load_dwordx4 v[64:67], v5, s[32:35], s21 offen offset:768
    buffer_load_dwordx4 v[68:71], v5, s[32:35], s21 offen offset:832
    buffer_load_dwordx4 v[72:75], v5, s[32:35], s21 offen offset:896
    buffer_load_dwordx4 v[76:79], v5, s[32:35], s21 offen offset:960
    buffer_load_dwordx4 v[80:83], v5, s[32:35], s21 offen offset:1024
    buffer_load_dwordx4 v[84:87], v5, s[32:35], s21 offen offset:1088
    s_mul_i32 s22, s20, 18432
    s_add_u32 s22, s22, 13246464
    s_waitcnt vmcnt(17)
    buffer_store_dwordx4 v[16:19], v8, s[36:39], s22 offen offset:0 sc1
    v_mfma_f32_16x16x32_bf16 v[88:91], v[12:15], v[16:19], 0
    v_mfma_f32_16x16x32_bf16 v[92:95], v[16:19], v[16:19], 0
    s_waitcnt vmcnt(17)
    buffer_store_dwordx4 v[20:23], v8, s[36:39], s22 offen offset:1024 sc1
    v_mfma_f32_16x16x32_bf16 v[88:91], v[12:15], v[20:23], v[88:91]
    v_mfma_f32_16x16x32_bf16 v[92:95], v[20:23], v[20:23], v[92:95]
    s_waitcnt vmcnt(17)
    buffer_store_dwordx4 v[24:27], v8, s[36:39], s22 offen offset:2048 sc1
    v_mfma_f32_16x16x32_bf16 v[88:91], v[12:15], v[24:27], v[88:91]
    v_mfma_f32_16x16x32_bf16 v[92:95], v[24:27], v[24:27], v[92:95]
    s_waitcnt vmcnt(17)
    buffer_store_dwordx4 v[28:31], v8, s[36:39], s22 offen offset:3072 sc1
    v_mfma_f32_16x16x32_bf16 v[88:91], v[12:15], v[28:31], v[88:91]
    v_mfma_f32_16x16x32_bf16 v[92:95], v[28:31], v[28:31], v[92:95]
    s_waitcnt vmcnt(17)
    s_add_u32 s22, s22, 4096
    buffer_store_dwordx4 v[32:35], v8, s[36:39], s22 offen offset:0 sc1
    v_mfma_f32_16x16x32_bf16 v[88:91], v[12:15], v[32:35], v[88:91]
    v_mfma_f32_16x16x32_bf16 v[92:95], v[32:35], v[32:35], v[92:95]
    s_waitcnt vmcnt(17)
    buffer_store_dwordx4 v[36:39], v8, s[36:39], s22 offen offset:1024 sc1
    v_mfma_f32_16x16x32_bf16 v[88:91], v[12:15], v[36:39], v[88:91]
    v_mfma_f32_16x16x32_bf16 v[92:95], v[36:39], v[36:39], v[92:95]
    s_waitcnt vmcnt(17)
    buffer_store_dwordx4 v[40:43], v8, s[36:39], s22 offen offset:2048 sc1
    v_mfma_f32_16x16x32_bf16 v[88:91], v[12:15], v[40:43], v[88:91]
    v_mfma_f32_16x16x32_bf16 v[92:95], v[40:43], v[40:43], v[92:95]
    s_waitcnt vmcnt(17)
    buffer_store_dwordx4 v[44:47], v8, s[36:39], s22 offen offset:3072 sc1
    v_mfma_f32_16x16x32_bf16 v[88:91], v[12:15], v[44:47], v[88:91]
    v_mfma_f32_16x16x32_bf16 v[92:95], v[44:47], v[44:47], v[92:95]
    s_waitcnt vmcnt(17)
    s_add_u32 s22, s22, 4096
    buffer_store_dwordx4 v[48:51], v8, s[36:39], s22 offen offset:0 sc1
    v_mfma_f32_16x16x32_bf16 v[88:91], v[12:15], v[48:51], v[88:91]
    v_mfma_f32_16x16x32_bf16 v[92:95], v[48:51], v[48:51], v[92:95]
    s_waitcnt vmcnt(17)
    buffer_store_dwordx4 v[52:55], v8, s[36:39], s22 offen offset:1024 sc1
    v_mfma_f32_16x16x32_bf16 v[88:91], v[12:15], v[52:55], v[88:91]
    v_mfma_f32_16x16x32_bf16 v[92:95], v[52:55], v[52:55], v[92:95]
    s_waitcnt vmcnt(17)
    buffer_store_dwordx4 v[56:59], v8, s[36:39], s22 offen offset:2048 sc1
    v_mfma_f32_16x16x32_bf16 v[88:91], v[12:15], v[56:59], v[88:91]
    v_mfma_f32_16x16x32_bf16 v[92:95], v[56:59], v[56:59], v[92:95]
    s_waitcnt vmcnt(17)
    buffer_store_dwordx4 v[60:63], v8, s[36:39], s22 offen offset:3072 sc1
    v_mfma_f32_16x16x32_bf16 v[88:91], v[12:15], v[60:63], v[88:91]
    v_mfma_f32_16x16x32_bf16 v[92:95], v[60:63], v[60:63], v[92:95]
    s_waitcnt vmcnt(17)
    s_add_u32 s22, s22, 4096
    buffer_store_dwordx4 v[64:67], v8, s[36:39], s22 offen offset:0 sc1
    v_mfma_f32_16x16x32_bf16 v[88:91], v[12:15], v[64:67], v[88:91]
    v_mfma_f32_16x16x32_bf16 v[92:95], v[64:67], v[64:67], v[92:95]
    s_waitcnt vmcnt(17)
    buffer_store_dwordx4 v[68:71], v8, s[36:39], s22 offen offset:1024 sc1
    v_mfma_f32_16x16x32_bf16 v[88:91], v[12:15], v[68:71], v[88:91]
    v_mfma_f32_16x16x32_bf16 v[92:95], v[68:71], v[68:71], v[92:95]
    s_waitcnt vmcnt(17)
    buffer_store_dwordx4 v[72:75], v8, s[36:39], s22 offen offset:2048 sc1
    v_mfma_f32_16x16x32_bf16 v[88:91], v[12:15], v[72:75], v[88:91]
    v_mfma_f32_16x16x32_bf16 v[92:95], v[72:75], v[72:75], v[92:95]
    s_waitcnt vmcnt(17)
    buffer_store_dwordx4 v[76:79], v8, s[36:39], s22 offen offset:3072 sc1
    v_mfma_f32_16x16x32_bf16 v[88:91], v[12:15], v[76:79], v[88:91]
    v_mfma_f32_16x16x32_bf16 v[92:95], v[76:79], v[76:79], v[92:95]
    s_waitcnt vmcnt(17)
    s_add_u32 s22, s22, 4096
    buffer_store_dwordx4 v[80:83], v8, s[36:39], s22 offen offset:0 sc1
    v_mfma_f32_16x16x32_bf16 v[88:91], v[12:15], v[80:83], v[88:91]
    v_mfma_f32_16x16x32_bf16 v[92:95], v[80:83], v[80:83], v[92:95]
    s_waitcnt vmcnt(17)
    buffer_store_dwordx4 v[84:87], v8, s[36:39], s22 offen offset:1024 sc1
    v_mfma_f32_16x16x32_bf16 v[88:91], v[12:15], v[84:87], v[88:91]
    v_mfma_f32_16x16x32_bf16 v[92:95], v[84:87], v[84:87], v[92:95]
    v_and_b32 v6, 3, v3
    v_cmp_eq_u32 s[40:41], 1, v6
    v_cmp_eq_u32 s[42:43], 2, v6
    v_cmp_eq_u32 s[44:45], 3, v6
    v_lshrrev_b32 v5, 2, v3
    v_cmp_eq_u32 s[46:47], v5, v4
    s_nop 1
    v_mov_b32 v7, v92
    v_cndmask_b32 v7, v7, v93, s[40:41]
    v_cndmask_b32 v7, v7, v94, s[42:43]
    v_cndmask_b32 v7, v7, v95, s[44:45]
    v_mov_b32 v5, 0
    v_cndmask_b32 v96, v5, v88, s[46:47]
    v_cndmask_b32 v97, v5, v7, s[46:47]
    v_mov_b32 v98, 0
    v_mov_b32 v99, 0
    v_lshlrev_b32 v5, 6, v3
    v_lshlrev_b32 v6, 4, v4
    v_add_u32 v5, v5, v6
    s_lshl_b32 s22, s20, 10
    s_add_u32 s22, s22, 15605760
    buffer_store_dwordx4 v[96:99], v5, s[36:39], s22 offen sc1
    s_branch k0_kernel_fin8
k0_kernel_wq2:
    s_mov_b32 s32, s8
    s_and_b32 s33, s9, 0xffff
    s_mov_b32 s34, 1990656
    s_mov_b32 s35, 0x20000
    s_sub_u32 s23, s20, 128
    s_mul_hi_u32 s28, s23, 477218589
    s_mul_i32 s21, s28, 9
    s_sub_u32 s27, s23, s21
    s_lshr_b32 s57, s28, 1
    s_and_b32 s58, s28, 1
    s_lshl_b32 s21, s58, 3
    v_and_b32 v6, 7, v1
    v_add_u32 v6, s21, v6
    v_mov_b32 v110, 0x34241000
    v_mov_b32 v111, 0x4420
    v_lshlrev_b32 v7, 3, v6
    v_lshrrev_b64 v[110:111], v7, v[110:111]
    v_and_b32 v110, 0xff, v110
    v_lshlrev_b32 v7, 4, v6
    v_cmp_gt_u32 s[60:61], 11, v6
    v_cmp_gt_u32 s[62:63], 6, v6
    v_add_u32 v111, 2128, v7
    v_add_u32 v7, 1056, v7
    v_cndmask_b32 v7, v111, v7, s[60:61]
    v_cndmask_b32 v7, v7, v110, s[62:63]
    v_lshrrev_b32 v5, 3, v1
    v_mul_u32_u24 v5, 3456, v5
    v_add_u32 v104, v5, v7
    s_mul_i32 s24, s27, 221184
    s_mul_i32 s22, s57, 72
    s_add_u32 s24, s24, s22
    s_add_u32 m0, s26, 0
    s_add_u32 s25, s24, 0
    buffer_load_dwordx4 v104, s[32:35], s25 offen lds
    s_add_u32 m0, s26, 1024
    s_add_u32 s25, s24, 27648
    buffer_load_dwordx4 v104, s[32:35], s25 offen lds
    s_add_u32 m0, s26, 2048
    s_add_u32 s25, s24, 55296
    buffer_load_dwordx4 v104, s[32:35], s25 offen lds
    s_add_u32 m0, s26, 3072
    s_add_u32 s25, s24, 82944
    buffer_load_dwordx4 v104, s[32:35], s25 offen lds
    s_add_u32 m0, s26, 4096
    s_add_u32 s25, s24, 110592
    buffer_load_dwordx4 v104, s[32:35], s25 offen lds
    s_add_u32 m0, s26, 5120
    s_add_u32 s25, s24, 138240
    buffer_load_dwordx4 v104, s[32:35], s25 offen lds
    s_add_u32 m0, s26, 6144
    s_add_u32 s25, s24, 165888
    buffer_load_dwordx4 v104, s[32:35], s25 offen lds
    s_add_u32 m0, s26, 7168
    s_add_u32 s25, s24, 193536
    buffer_load_dwordx4 v104, s[32:35], s25 offen lds
    v_lshlrev_b32 v6, 7, v9
    v_add_u32 v6, v6, v10
    v_add_u32 v6, s26, v6
    s_mul_i32 s21, s57, 147456
    s_add_u32 s21, s21, 8425472
    s_lshl_b32 s22, s27, 1
    s_add_u32 s22, s22, 0
    s_mul_i32 s23, s22, 5
    s_add_u32 s48, s23, 1
    s_mul_i32 s23, s22, 3
    s_add_u32 s23, s23, 90
    s_cmp_eq_u32 s58, 1
    s_cselect_b32 s48, s48, s23
    s_lshl_b32 s48, s48, 10
    s_add_u32 s48, s48, s21
    s_lshl_b32 s22, s27, 1
    s_add_u32 s22, s22, 1
    s_mul_i32 s23, s22, 5
    s_add_u32 s49, s23, 1
    s_mul_i32 s23, s22, 3
    s_add_u32 s23, s23, 90
    s_cmp_eq_u32 s58, 1
    s_cselect_b32 s49, s49, s23
    s_lshl_b32 s49, s49, 10
    s_add_u32 s49, s49, s21
    s_lshl_b32 s22, s27, 1
    s_add_u32 s22, s22, 0
    s_mul_i32 s23, s22, 5
    s_add_u32 s50, s23, 2
    s_mul_i32 s23, s22, 3
    s_add_u32 s23, s23, 91
    s_cmp_eq_u32 s58, 1
    s_cselect_b32 s50, s50, s23
    s_lshl_b32 s50, s50, 10
    s_add_u32 s50, s50, s21
    s_lshl_b32 s22, s27, 1
    s_add_u32 s22, s22, 1
    s_mul_i32 s23, s22, 5
    s_add_u32 s51, s23, 2
    s_mul_i32 s23, s22, 3
    s_add_u32 s23, s23, 91
    s_cmp_eq_u32 s58, 1
    s_cselect_b32 s51, s51, s23
    s_lshl_b32 s51, s51, 10
    s_add_u32 s51, s51, s21
    s_lshl_b32 s22, s27, 1
    s_add_u32 s22, s22, 0
    s_mul_i32 s23, s22, 5
    s_add_u32 s52, s23, 3
    s_mul_i32 s23, s22, 3
    s_add_u32 s23, s23, 92
    s_cmp_eq_u32 s58, 1
    s_cselect_b32 s52, s52, s23
    s_lshl_b32 s52, s52, 10
    s_add_u32 s52, s52, s21
    s_lshl_b32 s22, s27, 1
    s_add_u32 s22, s22, 1
    s_mul_i32 s23, s22, 5
    s_add_u32 s53, s23, 3
    s_mul_i32 s23, s22, 3
    s_add_u32 s23, s23, 92
    s_cmp_eq_u32 s58, 1
    s_cselect_b32 s53, s53, s23
    s_lshl_b32 s53, s53, 10
    s_add_u32 s53, s53, s21
    s_lshl_b32 s22, s27, 1
    s_add_u32 s22, s22, 0
    s_mul_i32 s23, s22, 5
    s_add_u32 s54, s23, 4
    s_cmp_eq_u32 s58, 1
    s_cselect_b32 s54, s54, s23
    s_lshl_b32 s54, s54, 10
    s_add_u32 s54, s54, s21
    s_lshl_b32 s22, s27, 1
    s_add_u32 s22, s22, 1
    s_mul_i32 s23, s22, 5
    s_add_u32 s55, s23, 4
    s_cmp_eq_u32 s58, 1
    s_cselect_b32 s55, s55, s23
    s_lshl_b32 s55, s55, 10
    s_add_u32 s55, s55, s21
    s_lshl_b32 s56, s27, 13
    s_lshl_b32 s22, s28, 8
    s_add_u32 s56, s56, s22
    s_add_u32 s56, s56, 10784768
    s_waitcnt vmcnt(0)
    ds_read_b64_tr_b16 v[16:17], v6 offset:0
    ds_read_b64_tr_b16 v[18:19], v6 offset:512
    ds_read_b64_tr_b16 v[20:21], v6 offset:4096
    ds_read_b64_tr_b16 v[22:23], v6 offset:4608
    ds_read_b64_tr_b16 v[24:25], v6 offset:32
    ds_read_b64_tr_b16 v[26:27], v6 offset:544
    ds_read_b64_tr_b16 v[28:29], v6 offset:4128
    ds_read_b64_tr_b16 v[30:31], v6 offset:4640
    ds_read_b64_tr_b16 v[32:33], v6 offset:64
    ds_read_b64_tr_b16 v[34:35], v6 offset:576
    ds_read_b64_tr_b16 v[36:37], v6 offset:4160
    ds_read_b64_tr_b16 v[38:39], v6 offset:4672
    ds_read_b64_tr_b16 v[40:41], v6 offset:96
    ds_read_b64_tr_b16 v[42:43], v6 offset:608
    ds_read_b64_tr_b16 v[44:45], v6 offset:4192
    ds_read_b64_tr_b16 v[46:47], v6 offset:4704
    s_waitcnt lgkmcnt(14)
    buffer_store_dwordx4 v[16:19], v8, s[36:39], s48 offen sc1
    v_mfma_f32_16x16x32_bf16 v[88:91], v[12:15], v[16:19], 0
    s_waitcnt lgkmcnt(12)
    buffer_store_dwordx4 v[20:23], v8, s[36:39], s49 offen sc1
    v_mfma_f32_16x16x32_bf16 v[88:91], v[12:15], v[20:23], v[88:91]
    s_waitcnt lgkmcnt(10)
    buffer_store_dwordx4 v[24:27], v8, s[36:39], s50 offen sc1
    v_mfma_f32_16x16x32_bf16 v[92:95], v[12:15], v[24:27], 0
    s_waitcnt lgkmcnt(8)
    buffer_store_dwordx4 v[28:31], v8, s[36:39], s51 offen sc1
    v_mfma_f32_16x16x32_bf16 v[92:95], v[12:15], v[28:31], v[92:95]
    s_waitcnt lgkmcnt(6)
    buffer_store_dwordx4 v[32:35], v8, s[36:39], s52 offen sc1
    v_mfma_f32_16x16x32_bf16 v[96:99], v[12:15], v[32:35], 0
    s_waitcnt lgkmcnt(4)
    buffer_store_dwordx4 v[36:39], v8, s[36:39], s53 offen sc1
    v_mfma_f32_16x16x32_bf16 v[96:99], v[12:15], v[36:39], v[96:99]
    s_waitcnt lgkmcnt(2)
    buffer_store_dwordx4 v[40:43], v8, s[36:39], s54 offen sc1
    v_mfma_f32_16x16x32_bf16 v[100:103], v[12:15], v[40:43], 0
    s_waitcnt lgkmcnt(0)
    buffer_store_dwordx4 v[44:47], v8, s[36:39], s55 offen sc1
    v_mfma_f32_16x16x32_bf16 v[100:103], v[12:15], v[44:47], v[100:103]
    v_lshlrev_b32 v5, 2, v3
    v_lshlrev_b32 v6, 28, v4
    v_or_b32 v5, v5, v6
    buffer_store_dword v88, v5, s[36:39], s56 offen offset:0 sc1
    buffer_store_dword v92, v5, s[36:39], s56 offen offset:64 sc1
    buffer_store_dword v96, v5, s[36:39], s56 offen offset:128 sc1
    s_nop 1
    buffer_store_dword v100, v5, s[36:39], s56 offen offset:192 sc1
    s_branch k0_kernel_fin8
k0_kernel_in4:
    s_mov_b32 s32, s12
    s_and_b32 s33, s13, 0xffff
    s_mov_b32 s34, 5308416
    s_mov_b32 s35, 0x20000
    s_sub_u32 s23, s20, 672
    s_mul_hi_u32 s28, s23, 477218589
    s_mul_i32 s21, s28, 9
    s_sub_u32 s27, s23, s21
    v_lshrrev_b32 v5, 3, v1
    v_mul_u32_u24 v5, 9216, v5
    v_and_b32 v6, 7, v1
    v_lshlrev_b32 v6, 4, v6
    v_add_u32 v104, v5, v6
    s_mul_i32 s24, s27, 589824
    s_lshl_b32 s22, s28, 7
    s_add_u32 s24, s24, s22
    s_add_u32 m0, s26, 0
    s_add_u32 s25, s24, 0
    buffer_load_dwordx4 v104, s[32:35], s25 offen lds
    s_add_u32 m0, s26, 1024
    s_add_u32 s25, s24, 73728
    buffer_load_dwordx4 v104, s[32:35], s25 offen lds
    s_add_u32 m0, s26, 2048
    s_add_u32 s25, s24, 147456
    buffer_load_dwordx4 v104, s[32:35], s25 offen lds
    s_add_u32 m0, s26, 3072
    s_add_u32 s25, s24, 221184
    buffer_load_dwordx4 v104, s[32:35], s25 offen lds
    s_add_u32 m0, s26, 4096
    s_add_u32 s25, s24, 294912
    buffer_load_dwordx4 v104, s[32:35], s25 offen lds
    s_add_u32 m0, s26, 5120
    s_add_u32 s25, s24, 368640
    buffer_load_dwordx4 v104, s[32:35], s25 offen lds
    s_add_u32 m0, s26, 6144
    s_add_u32 s25, s24, 442368
    buffer_load_dwordx4 v104, s[32:35], s25 offen lds
    s_add_u32 m0, s26, 7168
    s_add_u32 s25, s24, 516096
    buffer_load_dwordx4 v104, s[32:35], s25 offen lds
    v_lshlrev_b32 v6, 7, v9
    v_add_u32 v6, v6, v10
    v_add_u32 v6, s26, v6
    s_lshl_b32 s21, s28, 2
    s_add_u32 s21, s21, 0
    s_mul_hi_u32 s22, s21, 477218589
    s_mul_i32 s56, s22, 9
    s_sub_u32 s23, s21, s56
    s_cmp_lt_u32 s22, 16
    s_cselect_b32 s56, 162, 0
    s_add_u32 s23, s23, s56
    s_and_b32 s22, s22, 15
    s_mul_i32 s22, s22, 324
    s_add_u32 s22, s22, s23
    s_mul_i32 s23, s27, 18
    s_add_u32 s22, s22, s23
    s_lshl_b32 s22, s22, 10
    s_add_u32 s48, s22, 0
    s_add_u32 s49, s48, 9216
    s_lshl_b32 s21, s28, 2
    s_add_u32 s21, s21, 1
    s_mul_hi_u32 s22, s21, 477218589
    s_mul_i32 s56, s22, 9
    s_sub_u32 s23, s21, s56
    s_cmp_lt_u32 s22, 16
    s_cselect_b32 s56, 162, 0
    s_add_u32 s23, s23, s56
    s_and_b32 s22, s22, 15
    s_mul_i32 s22, s22, 324
    s_add_u32 s22, s22, s23
    s_mul_i32 s23, s27, 18
    s_add_u32 s22, s22, s23
    s_lshl_b32 s22, s22, 10
    s_add_u32 s50, s22, 0
    s_add_u32 s51, s50, 9216
    s_lshl_b32 s21, s28, 2
    s_add_u32 s21, s21, 2
    s_mul_hi_u32 s22, s21, 477218589
    s_mul_i32 s56, s22, 9
    s_sub_u32 s23, s21, s56
    s_cmp_lt_u32 s22, 16
    s_cselect_b32 s56, 162, 0
    s_add_u32 s23, s23, s56
    s_and_b32 s22, s22, 15
    s_mul_i32 s22, s22, 324
    s_add_u32 s22, s22, s23
    s_mul_i32 s23, s27, 18
    s_add_u32 s22, s22, s23
    s_lshl_b32 s22, s22, 10
    s_add_u32 s52, s22, 0
    s_add_u32 s53, s52, 9216
    s_lshl_b32 s21, s28, 2
    s_add_u32 s21, s21, 3
    s_mul_hi_u32 s22, s21, 477218589
    s_mul_i32 s56, s22, 9
    s_sub_u32 s23, s21, s56
    s_cmp_lt_u32 s22, 16
    s_cselect_b32 s56, 162, 0
    s_add_u32 s23, s23, s56
    s_and_b32 s22, s22, 15
    s_mul_i32 s22, s22, 324
    s_add_u32 s22, s22, s23
    s_mul_i32 s23, s27, 18
    s_add_u32 s22, s22, s23
    s_lshl_b32 s22, s22, 10
    s_add_u32 s54, s22, 0
    s_add_u32 s55, s54, 9216
    s_mul_i32 s56, s27, 18432
    s_lshl_b32 s22, s28, 8
    s_add_u32 s56, s56, s22
    s_add_u32 s56, s56, 8257536
    s_waitcnt vmcnt(0)
    ds_read_b64_tr_b16 v[16:17], v6 offset:0
    ds_read_b64_tr_b16 v[18:19], v6 offset:512
    ds_read_b64_tr_b16 v[20:21], v6 offset:4096
    ds_read_b64_tr_b16 v[22:23], v6 offset:4608
    ds_read_b64_tr_b16 v[24:25], v6 offset:32
    ds_read_b64_tr_b16 v[26:27], v6 offset:544
    ds_read_b64_tr_b16 v[28:29], v6 offset:4128
    ds_read_b64_tr_b16 v[30:31], v6 offset:4640
    ds_read_b64_tr_b16 v[32:33], v6 offset:64
    ds_read_b64_tr_b16 v[34:35], v6 offset:576
    ds_read_b64_tr_b16 v[36:37], v6 offset:4160
    ds_read_b64_tr_b16 v[38:39], v6 offset:4672
    ds_read_b64_tr_b16 v[40:41], v6 offset:96
    ds_read_b64_tr_b16 v[42:43], v6 offset:608
    ds_read_b64_tr_b16 v[44:45], v6 offset:4192
    ds_read_b64_tr_b16 v[46:47], v6 offset:4704
    s_waitcnt lgkmcnt(14)
    buffer_store_dwordx4 v[16:19], v8, s[36:39], s48 offen sc1
    v_mfma_f32_16x16x32_bf16 v[88:91], v[12:15], v[16:19], 0
    s_waitcnt lgkmcnt(12)
    buffer_store_dwordx4 v[20:23], v8, s[36:39], s49 offen sc1
    v_mfma_f32_16x16x32_bf16 v[88:91], v[12:15], v[20:23], v[88:91]
    s_waitcnt lgkmcnt(10)
    buffer_store_dwordx4 v[24:27], v8, s[36:39], s50 offen sc1
    v_mfma_f32_16x16x32_bf16 v[92:95], v[12:15], v[24:27], 0
    s_waitcnt lgkmcnt(8)
    buffer_store_dwordx4 v[28:31], v8, s[36:39], s51 offen sc1
    v_mfma_f32_16x16x32_bf16 v[92:95], v[12:15], v[28:31], v[92:95]
    s_waitcnt lgkmcnt(6)
    buffer_store_dwordx4 v[32:35], v8, s[36:39], s52 offen sc1
    v_mfma_f32_16x16x32_bf16 v[96:99], v[12:15], v[32:35], 0
    s_waitcnt lgkmcnt(4)
    buffer_store_dwordx4 v[36:39], v8, s[36:39], s53 offen sc1
    v_mfma_f32_16x16x32_bf16 v[96:99], v[12:15], v[36:39], v[96:99]
    s_waitcnt lgkmcnt(2)
    buffer_store_dwordx4 v[40:43], v8, s[36:39], s54 offen sc1
    v_mfma_f32_16x16x32_bf16 v[100:103], v[12:15], v[40:43], 0
    s_waitcnt lgkmcnt(0)
    buffer_store_dwordx4 v[44:47], v8, s[36:39], s55 offen sc1
    v_mfma_f32_16x16x32_bf16 v[100:103], v[12:15], v[44:47], v[100:103]
    v_lshlrev_b32 v5, 2, v3
    v_lshlrev_b32 v6, 28, v4
    v_or_b32 v5, v5, v6
    buffer_store_dword v88, v5, s[36:39], s56 offen offset:0 sc1
    buffer_store_dword v92, v5, s[36:39], s56 offen offset:64 sc1
    buffer_store_dword v96, v5, s[36:39], s56 offen offset:128 sc1
    s_nop 1
    buffer_store_dword v100, v5, s[36:39], s56 offen offset:192 sc1
    s_branch k0_kernel_fin8
k0_kernel_out5:
    s_mov_b32 s32, s16
    s_and_b32 s33, s17, 0xffff
    s_mov_b32 s34, 2654208
    s_mov_b32 s35, 0x20000
    s_sub_u32 s23, s20, 1320
    s_mul_hi_u32 s28, s23, 119304648
    s_mul_i32 s21, s28, 36
    s_sub_u32 s27, s23, s21
    v_add_u32 v5, 0, v1
    v_mul_u32_u24 v6, 6554, v5
    v_lshrrev_b32 v6, 16, v6
    v_mul_u32_u24 v7, 10, v6
    v_sub_u32 v7, v5, v7
    v_mul_u32_u24 v6, 1152, v6
    v_lshlrev_b32 v7, 4, v7
    v_add_u32 v104, v6, v7
    v_add_u32 v5, 64, v1
    v_mul_u32_u24 v6, 6554, v5
    v_lshrrev_b32 v6, 16, v6
    v_mul_u32_u24 v7, 10, v6
    v_sub_u32 v7, v5, v7
    v_mul_u32_u24 v6, 1152, v6
    v_lshlrev_b32 v7, 4, v7
    v_add_u32 v105, v6, v7
    v_add_u32 v5, 128, v1
    v_mul_u32_u24 v6, 6554, v5
    v_lshrrev_b32 v6, 16, v6
    v_mul_u32_u24 v7, 10, v6
    v_sub_u32 v7, v5, v7
    v_mul_u32_u24 v6, 1152, v6
    v_lshlrev_b32 v7, 4, v7
    v_add_u32 v106, v6, v7
    v_add_u32 v5, 192, v1
    v_mul_u32_u24 v6, 6554, v5
    v_lshrrev_b32 v6, 16, v6
    v_mul_u32_u24 v7, 10, v6
    v_sub_u32 v7, v5, v7
    v_mul_u32_u24 v6, 1152, v6
    v_lshlrev_b32 v7, 4, v7
    v_add_u32 v107, v6, v7
    v_add_u32 v5, 256, v1
    v_mul_u32_u24 v6, 6554, v5
    v_lshrrev_b32 v6, 16, v6
    v_mul_u32_u24 v7, 10, v6
    v_sub_u32 v7, v5, v7
    v_mul_u32_u24 v6, 1152, v6
    v_lshlrev_b32 v7, 4, v7
    v_add_u32 v108, v6, v7
    s_mul_i32 s24, s27, 73728
    s_mul_i32 s22, s28, 144
    s_add_u32 s24, s24, s22
    s_mul_i32 s21, s28, 368640
    s_lshl_b32 s22, s27, 11
    s_add_u32 s21, s21, s22
    s_add_u32 s21, s21, 5308416
    s_add_u32 m0, s26, 0
    s_add_u32 s25, s24, 0
    buffer_load_dwordx4 v104, s[32:35], s25 offen lds
    s_add_u32 m0, s26, 1024
    s_add_u32 s25, s24, 0
    buffer_load_dwordx4 v105, s[32:35], s25 offen lds
    s_add_u32 m0, s26, 2048
    s_add_u32 s25, s24, 0
    buffer_load_dwordx4 v106, s[32:35], s25 offen lds
    s_add_u32 m0, s26, 3072
    s_add_u32 s25, s24, 0
    buffer_load_dwordx4 v107, s[32:35], s25 offen lds
    s_add_u32 m0, s26, 4096
    s_add_u32 s25, s24, 0
    buffer_load_dwordx4 v108, s[32:35], s25 offen lds
    s_add_u32 m0, s26, 5120
    s_add_u32 s25, s24, 36864
    buffer_load_dwordx4 v104, s[32:35], s25 offen lds
    s_add_u32 m0, s26, 6144
    s_add_u32 s25, s24, 36864
    buffer_load_dwordx4 v105, s[32:35], s25 offen lds
    s_add_u32 m0, s26, 7168
    s_add_u32 s25, s24, 36864
    buffer_load_dwordx4 v106, s[32:35], s25 offen lds
    s_add_u32 m0, s26, 8192
    s_add_u32 s25, s24, 36864
    buffer_load_dwordx4 v107, s[32:35], s25 offen lds
    s_add_u32 m0, s26, 9216
    s_add_u32 s25, s24, 36864
    buffer_load_dwordx4 v108, s[32:35], s25 offen lds
    v_mul_u32_u24 v6, 160, v9
    v_add_u32 v6, v6, v10
    v_add_u32 v6, s26, v6
    s_waitcnt vmcnt(0)
    ds_read_b64_tr_b16 v[16:17], v6 offset:0
    ds_read_b64_tr_b16 v[18:19], v6 offset:640
    ds_read_b64_tr_b16 v[20:21], v6 offset:5120
    ds_read_b64_tr_b16 v[22:23], v6 offset:5760
    ds_read_b64_tr_b16 v[24:25], v6 offset:32
    ds_read_b64_tr_b16 v[26:27], v6 offset:672
    ds_read_b64_tr_b16 v[28:29], v6 offset:5152
    ds_read_b64_tr_b16 v[30:31], v6 offset:5792
    ds_read_b64_tr_b16 v[32:33], v6 offset:64
    ds_read_b64_tr_b16 v[34:35], v6 offset:704
    ds_read_b64_tr_b16 v[36:37], v6 offset:5184
    ds_read_b64_tr_b16 v[38:39], v6 offset:5824
    s_waitcnt lgkmcnt(0)
    ds_read_b64_tr_b16 v[40:41], v6 offset:96
    ds_read_b64_tr_b16 v[42:43], v6 offset:736
    ds_read_b64_tr_b16 v[44:45], v6 offset:5216
    ds_read_b64_tr_b16 v[46:47], v6 offset:5856
    ds_read_b64_tr_b16 v[48:49], v6 offset:128
    ds_read_b64_tr_b16 v[50:51], v6 offset:768
    ds_read_b64_tr_b16 v[52:53], v6 offset:5248
    ds_read_b64_tr_b16 v[54:55], v6 offset:5888
    s_add_u32 s25, s21, 0
    buffer_store_dwordx4 v[16:19], v8, s[36:39], s25 offen offset:0 sc1
    buffer_store_dwordx4 v[20:23], v8, s[36:39], s25 offen offset:1024 sc1
    s_add_u32 s25, s21, 73728
    buffer_store_dwordx4 v[24:27], v8, s[36:39], s25 offen offset:0 sc1
    buffer_store_dwordx4 v[28:31], v8, s[36:39], s25 offen offset:1024 sc1
    s_add_u32 s25, s21, 147456
    buffer_store_dwordx4 v[32:35], v8, s[36:39], s25 offen offset:0 sc1
    buffer_store_dwordx4 v[36:39], v8, s[36:39], s25 offen offset:1024 sc1
    s_add_u32 s25, s21, 221184
    s_waitcnt lgkmcnt(6)
    buffer_store_dwordx4 v[40:43], v8, s[36:39], s25 offen offset:0 sc1
    s_waitcnt lgkmcnt(4)
    buffer_store_dwordx4 v[44:47], v8, s[36:39], s25 offen offset:1024 sc1
    s_add_u32 s25, s21, 294912
    s_waitcnt lgkmcnt(2)
    buffer_store_dwordx4 v[48:51], v8, s[36:39], s25 offen offset:0 sc1
    s_waitcnt lgkmcnt(0)
    buffer_store_dwordx4 v[52:55], v8, s[36:39], s25 offen offset:1024 sc1
    s_branch k0_kernel_fin8
k0_kernel_wo3:
    s_mov_b32 s32, s10
    s_and_b32 s33, s11, 0xffff
    s_mov_b32 s34, 663552
    s_mov_b32 s35, 0x20000
    s_sub_u32 s23, s20, 416
    v_add_u32 v5, 0, v1
    v_mul_u32_u24 v6, 6554, v5
    v_lshrrev_b32 v6, 16, v6
    v_mul_u32_u24 v7, 10, v6
    v_sub_u32 v7, v5, v7
    v_mul_u32_u24 v6, 1152, v6
    v_lshlrev_b32 v7, 4, v7
    v_add_u32 v104, v6, v7
    v_add_u32 v5, 64, v1
    v_mul_u32_u24 v6, 6554, v5
    v_lshrrev_b32 v6, 16, v6
    v_mul_u32_u24 v7, 10, v6
    v_sub_u32 v7, v5, v7
    v_mul_u32_u24 v6, 1152, v6
    v_lshlrev_b32 v7, 4, v7
    v_add_u32 v105, v6, v7
    v_add_u32 v5, 128, v1
    v_mul_u32_u24 v6, 6554, v5
    v_lshrrev_b32 v6, 16, v6
    v_mul_u32_u24 v7, 10, v6
    v_sub_u32 v7, v5, v7
    v_mul_u32_u24 v6, 1152, v6
    v_lshlrev_b32 v7, 4, v7
    v_add_u32 v106, v6, v7
    v_add_u32 v5, 192, v1
    v_mul_u32_u24 v6, 6554, v5
    v_lshrrev_b32 v6, 16, v6
    v_mul_u32_u24 v7, 10, v6
    v_sub_u32 v7, v5, v7
    v_mul_u32_u24 v6, 1152, v6
    v_lshlrev_b32 v7, 4, v7
    v_add_u32 v107, v6, v7
    v_add_u32 v5, 256, v1
    v_mul_u32_u24 v6, 6554, v5
    v_lshrrev_b32 v6, 16, v6
    v_mul_u32_u24 v7, 10, v6
    v_sub_u32 v7, v5, v7
    v_mul_u32_u24 v6, 1152, v6
    v_lshlrev_b32 v7, 4, v7
    v_add_u32 v108, v6, v7
    s_lshr_b32 s27, s23, 3
    s_and_b32 s28, s23, 7
    s_mul_i32 s24, s27, 20736
    s_mul_i32 s22, s28, 144
    s_add_u32 s24, s24, s22
    s_mul_i32 s21, s23, 5120
    s_add_u32 s21, s21, 10932224
    s_add_u32 m0, s26, 0
    s_add_u32 s25, s24, 0
    buffer_load_dwordx4 v104, s[32:35], s25 offen lds
    s_add_u32 m0, s26, 1024
    s_add_u32 s25, s24, 0
    buffer_load_dwordx4 v105, s[32:35], s25 offen lds
    s_add_u32 m0, s26, 2048
    s_add_u32 s25, s24, 0
    buffer_load_dwordx4 v106, s[32:35], s25 offen lds
    s_add_u32 m0, s26, 3072
    s_add_u32 s25, s24, 0
    buffer_load_dwordx4 v107, s[32:35], s25 offen lds
    s_add_u32 m0, s26, 4096
    s_add_u32 s25, s24, 0
    buffer_load_dwordx4 v108, s[32:35], s25 offen lds
    v_mul_u32_u24 v6, 160, v9
    v_add_u32 v6, v6, v10
    v_add_u32 v6, s26, v6
    s_waitcnt vmcnt(0)
    ds_read_b64_tr_b16 v[16:17], v6 offset:0
    ds_read_b64_tr_b16 v[18:19], v6 offset:640
    ds_read_b64_tr_b16 v[24:25], v6 offset:32
    ds_read_b64_tr_b16 v[26:27], v6 offset:672
    ds_read_b64_tr_b16 v[32:33], v6 offset:64
    ds_read_b64_tr_b16 v[34:35], v6 offset:704
    s_waitcnt lgkmcnt(0)
    ds_read_b64_tr_b16 v[40:41], v6 offset:96
    ds_read_b64_tr_b16 v[42:43], v6 offset:736
    ds_read_b64_tr_b16 v[48:49], v6 offset:128
    ds_read_b64_tr_b16 v[50:51], v6 offset:768
    s_add_u32 s25, s21, 0
    buffer_store_dwordx4 v[16:19], v8, s[36:39], s25 offen offset:0 sc1
    s_add_u32 s25, s21, 1024
    buffer_store_dwordx4 v[24:27], v8, s[36:39], s25 offen offset:0 sc1
    s_add_u32 s25, s21, 2048
    buffer_store_dwordx4 v[32:35], v8, s[36:39], s25 offen offset:0 sc1
    s_add_u32 s25, s21, 3072
    s_waitcnt lgkmcnt(2)
    buffer_store_dwordx4 v[40:43], v8, s[36:39], s25 offen offset:0 sc1
    s_add_u32 s25, s21, 4096
    s_waitcnt lgkmcnt(0)
    buffer_store_dwordx4 v[48:51], v8, s[36:39], s25 offen offset:0 sc1
    s_branch k0_kernel_fin8
k0_kernel_clr7:
    s_sub_u32 s24, s20, 1608
    s_cmp_ge_u32 s24, 128
    s_cbranch_scc1 k0_kernel_fl9
    s_lshr_b32 s22, s24, 6
    s_mul_i32 s22, s22, 28299264
    s_and_b32 s21, s24, 63
    s_mul_i32 s21, s21, 15360
    s_add_u32 s21, s21, s22
    s_add_u32 s21, s21, 12247040
    v_mov_b32 v16, -1
    v_mov_b32 v17, -1
    v_mov_b32 v18, -1
    v_mov_b32 v19, -1
    buffer_store_dwordx4 v[16:19], v8, s[36:39], s21 offen offset:0 sc1
    buffer_store_dwordx4 v[16:19], v8, s[36:39], s21 offen offset:1024 sc1
    buffer_store_dwordx4 v[16:19], v8, s[36:39], s21 offen offset:2048 sc1
    buffer_store_dwordx4 v[16:19], v8, s[36:39], s21 offen offset:3072 sc1
    s_add_u32 s21, s21, 4096
    buffer_store_dwordx4 v[16:19], v8, s[36:39], s21 offen offset:0 sc1
    buffer_store_dwordx4 v[16:19], v8, s[36:39], s21 offen offset:1024 sc1
    buffer_store_dwordx4 v[16:19], v8, s[36:39], s21 offen offset:2048 sc1
    buffer_store_dwordx4 v[16:19], v8, s[36:39], s21 offen offset:3072 sc1
    s_add_u32 s21, s21, 4096
    buffer_store_dwordx4 v[16:19], v8, s[36:39], s21 offen offset:0 sc1
    buffer_store_dwordx4 v[16:19], v8, s[36:39], s21 offen offset:1024 sc1
    buffer_store_dwordx4 v[16:19], v8, s[36:39], s21 offen offset:2048 sc1
    buffer_store_dwordx4 v[16:19], v8, s[36:39], s21 offen offset:3072 sc1
    s_add_u32 s21, s21, 4096
    buffer_store_dwordx4 v[16:19], v8, s[36:39], s21 offen offset:0 sc1
    buffer_store_dwordx4 v[16:19], v8, s[36:39], s21 offen offset:1024 sc1
    buffer_store_dwordx4 v[16:19], v8, s[36:39], s21 offen offset:2048 sc1
    s_branch k0_kernel_fin8
k0_kernel_fl9:
    s_cmp_lt_u32 s24, 130
    s_cbranch_scc1 k0_kernel_ct10
    s_getpc_b64 s[64:65]
L_k0pc:
    s_mov_b32 s32, s64
    s_and_b32 s33, s65, 0xffff
    s_mov_b32 s34, mega_end1-L_k0pc
    s_mov_b32 s35, 0x20000
    s_sub_u32 s21, s24, 132
    s_lshr_b32 s21, s21, 3
    s_lshl_b32 s21, s21, 13
    s_add_u32 s21, s21, mega_body-L_k0pc
    v_lshlrev_b32 v5, 7, v1
    buffer_load_dword v6, v5, s[32:35], s21 offen
    s_branch k0_kernel_fin8
k0_kernel_ct10:
    s_sub_u32 s24, s24, 128
    s_mul_i32 s21, s24, 28299264
    s_add_u32 s21, s21, 13230080
    s_xor_b32 s22, s24, 1
    v_mov_b32 v16, 0
    v_mov_b32 v24, s22
    v_mov_b32 v17, 0
    v_mov_b32 v25, s22
    v_mov_b32 v18, 0
    v_mov_b32 v26, s22
    v_mov_b32 v19, 0
    v_mov_b32 v27, s22
    v_mov_b32 v20, 0
    v_and_b32 v21, 1, v1
    v_and_b32 v22, 1, v1
    v_and_b32 v23, 1, v1
    buffer_store_dwordx4 v[16:19], v8, s[36:39], s21 offen offset:0 sc1
    buffer_store_dwordx4 v[16:19], v8, s[36:39], s21 offen offset:1024 sc1
    buffer_store_dwordx4 v[20:23], v8, s[36:39], s21 offen offset:2048 sc1
    buffer_store_dwordx4 v[20:23], v8, s[36:39], s21 offen offset:3072 sc1
    s_add_u32 s21, s21, 4096
    buffer_store_dwordx4 v[20:23], v8, s[36:39], s21 offen offset:0 sc1
    buffer_store_dwordx4 v[20:23], v8, s[36:39], s21 offen offset:1024 sc1
    buffer_store_dwordx4 v[16:19], v8, s[36:39], s21 offen offset:2048 sc1
    buffer_store_dwordx4 v[16:19], v8, s[36:39], s21 offen offset:3072 sc1
    s_add_u32 s21, s21, 4096
    buffer_store_dwordx4 v[16:19], v8, s[36:39], s21 offen offset:0 sc1
    buffer_store_dwordx4 v[16:19], v8, s[36:39], s21 offen offset:1024 sc1
    buffer_store_dwordx4 v[16:19], v8, s[36:39], s21 offen offset:2048 sc1
    buffer_store_dwordx4 v[16:19], v8, s[36:39], s21 offen offset:3072 sc1
    s_add_u32 s21, s21, 4096
    buffer_store_dwordx4 v[24:27], v8, s[36:39], s21 offen offset:0 sc1
    buffer_store_dwordx4 v[24:27], v8, s[36:39], s21 offen offset:1024 sc1
    buffer_store_dwordx4 v[16:19], v8, s[36:39], s21 offen offset:2048 sc1
    buffer_store_dwordx4 v[16:19], v8, s[36:39], s21 offen offset:3072 sc1
k0_kernel_fin8:
k0_kernel_end1:
    s_endpgm
.text
.globl mega_kernel
.p2align 8
.type mega_kernel,@function
mega_kernel:
    s_mov_b32 s3, 0
    s_branch mega_body
mega_body:
    s_cmp_ge_u32 s2, 256
    s_cbranch_scc1 mega_end1
    v_and_b32 v1, 63, v0
    v_lshrrev_b32 v2, 6, v0
    s_nop 0
    v_readfirstlane_b32 s4, v2
    s_load_dwordx2 s[6:7], s[0:1], 80
    s_load_dwordx2 s[8:9], s[0:1], 40
    s_load_dwordx2 s[10:11], s[0:1], 48
    s_load_dwordx2 s[12:13], s[0:1], 64
    v_and_b32 v3, 15, v1
    v_lshrrev_b32 v4, 4, v1
    v_lshlrev_b32 v5, 4, v1
    v_lshlrev_b32 v6, 4, v0
    v_mov_b32 v7, 1
    v_lshlrev_b32 v8, 26, v0
    v_min_u32 v8, 0x40000000, v8
    v_lshlrev_b32 v8, 18, v0
    v_lshlrev_b32 v8, 8, v8
    v_cmp_eq_u32 s[14:15], 0, v0
    v_mov_b32 v9, 0x40000000
    v_mov_b32 v8, 0
    v_cndmask_b32 v8, v9, v8, s[14:15]
    v_lshlrev_b32 v9, 2, v3
    v_lshrrev_b32 v10, 3, v3
    v_lshlrev_b32 v10, 30, v10
    v_or_b32 v10, v5, v10
    s_getpc_b64 s[32:33]
L_pc0:
    s_lshr_b32 s34, s2, 3
    s_lshl_b32 s34, s34, 2
    s_add_u32 s34, s34, s4
    s_lshl_b32 s34, s34, 13
    v_lshlrev_b32 v11, 7, v1
    s_mov_b32 s20, s32
    s_and_b32 s21, s33, 0xffff
    s_mov_b32 s22, mega_end1-L_pc0
    s_mov_b32 s23, 0x20000
    s_add_u32 s35, s34, L_pc0-L_pc0
    buffer_load_dword v12, v11, s[20:23], s35 offen
    s_waitcnt lgkmcnt(0)
    s_mov_b32 s16, s6
    s_and_b32 s17, s7, 0xffff
    s_mov_b32 s18, 12247040
    s_mov_b32 s19, 0x20000
    s_mov_b32 s25, 0x40000000
    s_nop 11
mega_top2:
    s_mul_i32 s24, s3, 28299264
    s_add_u32 s24, s24, 12247040
    s_add_u32 s20, s6, s24
    s_addc_u32 s21, s7, 0
    s_and_b32 s21, s21, 0xffff
    s_mov_b32 s22, 56598528
    s_mov_b32 s23, 0x20000
L_p1:
    s_and_b32 s37, s2, 3
    s_lshl_b32 s35, s37, 2
    s_bfe_u32 s37, s2, 0x20003
    s_add_u32 s35, s35, s37
    s_bfe_u32 s37, s2, 0x10002
    s_lshl_b32 s36, s37, 3
    s_lshr_b32 s37, s2, 5
    s_add_u32 s36, s36, s37
    s_lshl_b32 s42, s35, 2
    s_add_u32 s42, s42, s4
    s_mul_i32 s43, s36, 147456
    s_add_u32 s43, s43, 8425472
    s_mul_i32 s44, s4, 4096
    s_add_u32 s45, s43, s44
    s_add_u32 m0, s44, 8192
    s_add_u32 s46, s45, 0
    buffer_load_dwordx4 v5, s[16:19], s46 offen offset:0 sc1 lds
    buffer_load_dwordx4 v5, s[16:19], s46 offen offset:1024 sc1 lds
    buffer_load_dwordx4 v5, s[16:19], s46 offen offset:2048 sc1 lds
    buffer_load_dwordx4 v5, s[16:19], s46 offen offset:3072 sc1 lds
    s_add_u32 m0, s44, 24576
    s_add_u32 s46, s45, 16384
    buffer_load_dwordx4 v5, s[16:19], s46 offen offset:0 sc1 lds
    buffer_load_dwordx4 v5, s[16:19], s46 offen offset:1024 sc1 lds
    buffer_load_dwordx4 v5, s[16:19], s46 offen offset:2048 sc1 lds
    buffer_load_dwordx4 v5, s[16:19], s46 offen offset:3072 sc1 lds
    s_add_u32 m0, s44, 40960
    s_add_u32 s46, s45, 32768
    buffer_load_dwordx4 v5, s[16:19], s46 offen offset:0 sc1 lds
    buffer_load_dwordx4 v5, s[16:19], s46 offen offset:1024 sc1 lds
    buffer_load_dwordx4 v5, s[16:19], s46 offen offset:2048 sc1 lds
    buffer_load_dwordx4 v5, s[16:19], s46 offen offset:3072 sc1 lds
    s_waitcnt vmcnt(12)
    s_waitcnt lgkmcnt(0)
    s_barrier
    buffer_store_dword v7, v8, s[20:23], s25 offen sc1
    v_cmp_gt_u32 s[50:51], 32, v0
    v_mov_b32 v125, 0x40000000
    s_nop 0
    v_cndmask_b32 v128, v125, v6, s[50:51]
    s_lshl_b32 s47, s36, 9
    s_add_u32 s47, s47, 10784768
    s_min_u32 s38, s42, 39
    s_mul_i32 s39, s36, 80
    s_add_u32 s38, s38, s39
    s_lshl_b32 s38, s38, 10
    s_add_u32 s48, s38, 10932224
    s_add_u32 s52, s47, 0
    buffer_load_dwordx4 v[80:83], v128, s[16:19], s52 offen sc1
    s_lshl_b32 s38, s42, 1
    s_add_u32 s38, s38, 0
    s_mul_i32 s53, s38, 18432
    s_add_u32 s53, s53, 999424
    s_lshl_b32 s38, s42, 1
    s_add_u32 s38, s38, 1
    s_mul_i32 s54, s38, 18432
    s_add_u32 s54, s54, 999424
    v_add_u32 v129, 8192, v5
    v_add_u32 v130, 73728, v5
    s_add_u32 s52, s47, 8192
    buffer_load_dwordx4 v[84:87], v128, s[16:19], s52 offen sc1
    v_add_u32 v131, 139264, v5
    v_lshlrev_b32 v132, 6, v3
    v_lshlrev_b32 v124, 4, v4
    v_add_u32 v132, v132, v124
    s_lshl_b32 s55, s42, 11
    s_add_u32 s55, s55, 3358720
    v_mov_b32 v136, 0x3f803f80
    v_mov_b32 v137, 0x3f803f80
    v_mov_b32 v138, 0x3f803f80
    v_mov_b32 v139, 0x3f803f80
    s_add_u32 s52, s47, 16384
    buffer_load_dwordx4 v[88:91], v128, s[16:19], s52 offen sc1
    v_mov_b32 v16, 0
    v_mov_b32 v17, 0
    v_mov_b32 v18, 0
    v_mov_b32 v19, 0
    ds_write_b128 v6, v[16:19] offset:2048
    v_and_b32 v125, 255, v6
    ds_write_b128 v125, v[16:19] offset:6144
    s_lshl_b32 s38, s4, 8
    s_add_u32 s38, s38, 512
    v_lshlrev_b32 v144, 2, v3
    s_add_u32 s52, s47, 24576
    buffer_load_dwordx4 v[92:95], v128, s[16:19], s52 offen sc1
    v_add_u32 v140, s38, v144
    v_lshlrev_b32 v143, 4, v4
    v_add_u32 v141, s38, v143
    v_cmp_gt_u32 s[56:57], 8, v3
    v_mov_b32 v125, 1536
    v_cndmask_b32 v142, v125, v6, s[50:51]
    s_mul_i32 s38, s4, 12288
    s_add_u32 s38, s38, 8192
    v_add_u32 v145, s38, v132
    v_add_u32 v146, 0, v0
    s_add_u32 s52, s47, 32768
    buffer_load_dwordx4 v[96:99], v128, s[16:19], s52 offen sc1
    v_mul_u32_u24 v147, 3641, v146
    v_lshrrev_b32 v147, 16, v147
    v_mul_u32_u24 v148, 18, v147
    v_sub_u32 v148, v146, v148
    v_cmp_lt_u32 s[62:63], 17, v147
    v_add_u32 v124, 8, v148
    v_add_u32 v125, 26, v148
    v_cndmask_b32 v124, v124, v125, s[62:63]
    v_lshrrev_b32 v125, 4, v147
    s_add_u32 s52, s47, 40960
    buffer_load_dwordx4 v[100:103], v128, s[16:19], s52 offen sc1
    v_lshlrev_b32 v125, 12, v125
    v_lshlrev_b32 v124, 6, v124
    v_add_u32 v124, v124, v125
    v_and_b32 v125, 15, v147
    v_lshlrev_b32 v125, 2, v125
    v_add_u32 v149, v124, v125
    v_lshlrev_b32 v152, 2, v146
    v_add_u32 v146, 256, v0
    v_mul_u32_u24 v147, 3641, v146
    v_lshrrev_b32 v147, 16, v147
    s_add_u32 s52, s47, 49152
    buffer_load_dwordx4 v[104:107], v128, s[16:19], s52 offen sc1
    v_mul_u32_u24 v148, 18, v147
    v_sub_u32 v148, v146, v148
    v_cmp_lt_u32 s[62:63], 17, v147
    v_add_u32 v124, 8, v148
    v_add_u32 v125, 26, v148
    v_cndmask_b32 v124, v124, v125, s[62:63]
    v_lshrrev_b32 v125, 4, v147
    v_lshlrev_b32 v125, 12, v125
    v_lshlrev_b32 v124, 6, v124
    v_add_u32 v124, v124, v125
    s_add_u32 s52, s47, 57344
    buffer_load_dwordx4 v[108:111], v128, s[16:19], s52 offen sc1
    v_and_b32 v125, 15, v147
    v_lshlrev_b32 v125, 2, v125
    v_add_u32 v150, v124, v125
    v_lshlrev_b32 v153, 2, v146
    v_add_u32 v146, 512, v0
    v_mul_u32_u24 v147, 3641, v146
    v_lshrrev_b32 v147, 16, v147
    v_mul_u32_u24 v148, 18, v147
    v_sub_u32 v148, v146, v148
    v_cmp_lt_u32 s[62:63], 17, v147
    s_add_u32 s52, s47, 65536
    buffer_load_dwordx4 v[112:115], v128, s[16:19], s52 offen sc1
    v_add_u32 v124, 8, v148
    v_add_u32 v125, 26, v148
    v_cndmask_b32 v124, v124, v125, s[62:63]
    v_subrev_u32 v126, 648, v146
    v_add_u32 v125, 2, v126
    v_cmp_gt_u32 s[58:59], 16, v126
    s_nop 1
    v_cndmask_b32 v125, v125, v126, s[58:59]
    v_subrev_u32 v127, 16, v126
    v_cmp_gt_u32 s[58:59], 32, v126
    s_add_u32 s52, s48, 0
    buffer_load_dwordx4 a[176:179], v5, s[16:19], s52 offen sc1
    v_cndmask_b32 v125, v127, v125, s[58:59]
    v_subrev_u32 v127, 2, v126
    v_cmp_gt_u32 s[58:59], 36, v126
    s_nop 1
    v_cndmask_b32 v125, v127, v125, s[58:59]
    s_mov_b32 s66, 648
    v_cmp_gt_u32 s[60:61], s66, v146
    s_nop 1
    v_cndmask_b32 v147, v125, v147, s[60:61]
    v_mov_b32 v125, 48
    v_cndmask_b32 v124, v125, v124, s[60:61]
    v_lshrrev_b32 v125, 4, v147
    s_add_u32 s52, s48, 40960
    buffer_load_dwordx4 a[180:183], v5, s[16:19], s52 offen sc1
    v_lshlrev_b32 v125, 12, v125
    v_lshlrev_b32 v124, 6, v124
    v_add_u32 v124, v124, v125
    v_and_b32 v125, 15, v147
    v_lshlrev_b32 v125, 2, v125
    v_add_u32 v151, v124, v125
    v_lshlrev_b32 v154, 2, v146
    s_mov_b32 s66, 688
    v_cmp_gt_u32 s[60:61], s66, v146
    v_mov_b32 v125, 0x40000000
    s_add_u32 m0, s44, 57344
    s_add_u32 s46, s45, 49152
    buffer_load_dwordx4 v5, s[16:19], s46 offen offset:0 sc1 lds
    v_cndmask_b32 v154, v125, v154, s[60:61]
    v_mov_b32 v125, 0
    v_cndmask_b32 v151, v125, v151, s[60:61]
    v_and_b32 v125, 34, v126
    v_cmp_eq_u32 s[64:65], 34, v125
    s_mov_b32 s66, 648
    v_cmp_le_u32 s[60:61], s66, v146
    s_nop 0
    s_and_b64 s[64:65], s[64:65], s[60:61]
    v_lshlrev_b32 v146, 2, v0
    v_add_u32 v146, 0, v146
    buffer_load_dwordx4 v5, s[16:19], s46 offen offset:1024 sc1 lds
    v_mul_u32_u24 v147, 3641, v146
    v_lshrrev_b32 v147, 16, v147
    v_mul_u32_u24 v148, 18, v147
    v_sub_u32 v148, v146, v148
    v_cmp_lt_u32 s[62:63], 17, v147
    v_add_u32 v124, 14, v147
    s_nop 0
    v_cndmask_b32 v124, v147, v124, s[62:63]
    v_lshlrev_b32 v124, 6, v124
    v_lshlrev_b32 v125, 1, v148
    v_add_u32 v124, v124, v125
    buffer_load_dwordx4 v5, s[16:19], s46 offen offset:2048 sc1 lds
    v_add_u32 v124, 2048, v124
    s_mov_b32 s66, 648
    v_cmp_gt_u32 s[60:61], s66, v146
    v_mov_b32 v125, 1536
    s_nop 0
    v_cndmask_b32 v155, v125, v124, s[60:61]
    v_lshlrev_b32 v146, 2, v0
    v_add_u32 v146, 1, v146
    v_mul_u32_u24 v147, 3641, v146
    v_lshrrev_b32 v147, 16, v147
    buffer_load_dwordx4 v5, s[16:19], s46 offen offset:3072 sc1 lds
    v_mul_u32_u24 v148, 18, v147
    v_sub_u32 v148, v146, v148
    v_cmp_lt_u32 s[62:63], 17, v147
    v_add_u32 v124, 14, v147
    s_nop 0
    v_cndmask_b32 v124, v147, v124, s[62:63]
    v_lshlrev_b32 v124, 6, v124
    v_lshlrev_b32 v125, 1, v148
    v_add_u32 v124, v124, v125
    v_add_u32 v124, 2048, v124
    s_mov_b32 s66, 648
    s_add_u32 m0, s44, 73728
    s_add_u32 s46, s45, 65536
    buffer_load_dwordx4 v5, s[16:19], s46 offen offset:0 sc1 lds
    v_cmp_gt_u32 s[60:61], s66, v146
    v_mov_b32 v125, 1536
    s_nop 0
    v_cndmask_b32 v156, v125, v124, s[60:61]
    v_lshlrev_b32 v146, 2, v0
    v_add_u32 v146, 2, v146
    v_mul_u32_u24 v147, 3641, v146
    v_lshrrev_b32 v147, 16, v147
    v_mul_u32_u24 v148, 18, v147
    v_sub_u32 v148, v146, v148
    v_cmp_lt_u32 s[62:63], 17, v147
    buffer_load_dwordx4 v5, s[16:19], s46 offen offset:1024 sc1 lds
    v_add_u32 v124, 14, v147
    v_cndmask_b32 v124, v147, v124, s[62:63]
    v_lshlrev_b32 v124, 6, v124
    v_lshlrev_b32 v125, 1, v148
    v_add_u32 v124, v124, v125
    v_add_u32 v124, 2048, v124
    s_mov_b32 s66, 648
    v_cmp_gt_u32 s[60:61], s66, v146
    v_mov_b32 v125, 1536
    s_nop 0
    v_cndmask_b32 v157, v125, v124, s[60:61]
    buffer_load_dwordx4 v5, s[16:19], s46 offen offset:2048 sc1 lds
    v_lshlrev_b32 v146, 2, v0
    v_add_u32 v146, 3, v146
    v_mul_u32_u24 v147, 3641, v146
    v_lshrrev_b32 v147, 16, v147
    v_mul_u32_u24 v148, 18, v147
    v_sub_u32 v148, v146, v148
    v_cmp_lt_u32 s[62:63], 17, v147
    v_add_u32 v124, 14, v147
    s_nop 0
    v_cndmask_b32 v124, v147, v124, s[62:63]
    buffer_load_dwordx4 v5, s[16:19], s46 offen offset:3072 sc1 lds
    v_lshlrev_b32 v124, 6, v124
    v_lshlrev_b32 v125, 1, v148
    v_add_u32 v124, v124, v125
    v_add_u32 v124, 2048, v124
    s_mov_b32 s66, 648
    v_cmp_gt_u32 s[60:61], s66, v146
    v_mov_b32 v125, 1536
    s_nop 0
    v_cndmask_b32 v158, v125, v124, s[60:61]
    s_mul_i32 s67, s36, 45056
    s_add_u32 s67, s67, 0
    s_add_u32 m0, s44, 90112
    s_add_u32 s46, s45, 81920
    buffer_load_dwordx4 v5, s[16:19], s46 offen offset:0 sc1 lds
    s_mul_i32 s68, s35, 2816
    s_add_u32 s68, s68, s67
    s_mov_b32 s66, 172
    v_cmp_gt_u32 s[60:61], s66, v0
    v_mov_b32 v124, 0x40000000
    s_nop 0
    v_cndmask_b32 v159, v124, v6, s[60:61]
    s_cmp_ge_u32 s35, 10
    s_cselect_b32 s38, 162, 0
    v_cmp_gt_u32 s[58:59], s38, v0
    s_nop 1
    v_cndmask_b32 v159, v159, v124, s[58:59]
    buffer_load_dwordx4 v5, s[16:19], s46 offen offset:1024 sc1 lds
    v_add_u32 v125, 3552, v6
    v_mov_b32 v124, 1536
    v_cndmask_b32 v125, v124, v125, s[60:61]
    s_mov_b32 s66, 162
    v_cmp_gt_u32 s[58:59], s66, v0
    s_nop 1
    v_cndmask_b32 v160, v125, v124, s[58:59]
    v_lshlrev_b32 v124, 3, v4
    v_add_u32 v124, 128, v124
    v_mov_b32 v125, 160
    v_and_b32 v126, 1, v4
    buffer_load_dwordx4 v5, s[16:19], s46 offen offset:2048 sc1 lds
    v_cmp_eq_u32 s[58:59], 0, v126
    s_nop 1
    v_cndmask_b32 v161, v125, v124, s[58:59]
    v_cmp_gt_u32 s[70:71], 2, v4
    s_lshr_b32 s39, s36, 2
    s_mul_i32 s72, s39, 5120
    s_and_b32 s39, s36, 3
    s_lshl_b32 s39, s39, 8
    s_add_u32 s72, s72, s39
    s_mul_i32 s38, s42, 40960
    s_add_u32 s38, s38, s72
    buffer_load_dwordx4 v5, s[16:19], s46 offen offset:3072 sc1 lds
    s_add_u32 s38, s38, 3489792
    v_lshlrev_b32 v162, 4, v3
    v_add_u32 v162, s38, v162
    v_lshlrev_b32 v124, 2, v4
    v_add_u32 v163, v162, v124
    v_and_b32 v124, 1, v4
    v_lshlrev_b32 v124, 30, v124
    v_or_b32 v163, v163, v124
    v_and_b32 v124, 1, v4
    s_add_u32 m0, s44, 106496
    s_add_u32 s46, s45, 98304
    buffer_load_dwordx4 v5, s[16:19], s46 offen offset:0 sc1 lds
    v_mul_u32_u24 v124, 20480, v124
    v_add_u32 v162, v162, v124
    v_lshrrev_b32 v124, 1, v4
    v_lshlrev_b32 v124, 10, v124
    v_add_u32 v162, v162, v124
    v_and_b32 v124, 1, v4
    v_lshlrev_b32 v124, 11, v124
    v_lshrrev_b32 v125, 1, v4
    v_lshlrev_b32 v125, 10, v125
    v_add_u32 v124, v124, v125
    buffer_load_dwordx4 v5, s[16:19], s46 offen offset:1024 sc1 lds
    v_lshlrev_b32 v125, 4, v3
    v_add_u32 v164, v124, v125
    v_lshlrev_b32 v124, 28, v4
    v_or_b32 v124, v124, v125
    v_add_u32 v165, 4096, v124
    s_mul_i32 s73, s42, 20480
    s_add_u32 s73, s73, s72
    s_add_u32 s73, s73, 6111232
    s_mul_hi_u32 s38, s42, 858993460
    s_mul_i32 s40, s38, 5
    buffer_load_dwordx4 v5, s[16:19], s46 offen offset:2048 sc1 lds
    s_sub_u32 s39, s42, s40
    s_lshl_b32 s38, s38, 9
    s_lshl_b32 s39, s39, 2
    s_add_u32 s74, s38, s39
    v_lshlrev_b32 v167, 26, v1
    v_min_u32 v167, 0x40000000, v167
    s_lshl_b32 s75, s36, 5
    s_add_u32 s75, s75, 985088
    s_add_u32 s75, s75, s74
    s_cmp_ge_u32 s35, 10
    s_cselect_b32 s75, 0x20000000, s75
    buffer_load_dwordx4 v5, s[16:19], s46 offen offset:3072 sc1 lds
    s_lshl_b32 s76, s35, 7
    s_lshl_b32 s38, s36, 2
    s_add_u32 s76, s76, s38
    s_add_u32 s76, s76, 983040
    v_mov_b32 v168, 0x3fb8aa3b
    v_mov_b32 v170, 0x358637bd
    v_mov_b32 v169, 0x3fb8aa3b
    v_mov_b32 v171, 0x358637bd
    s_waitcnt vmcnt(18)
    v_pk_add_f32 v[80:81], v[80:81], v[84:85]
    v_pk_add_f32 v[82:83], v[82:83], v[86:87]
    v_pk_add_f32 v[80:81], v[80:81], v[88:89]
    v_pk_add_f32 v[82:83], v[82:83], v[90:91]
    v_pk_add_f32 v[80:81], v[80:81], v[92:93]
    v_pk_add_f32 v[82:83], v[82:83], v[94:95]
    v_pk_add_f32 v[80:81], v[80:81], v[96:97]
    v_pk_add_f32 v[82:83], v[82:83], v[98:99]
    v_pk_add_f32 v[80:81], v[80:81], v[100:101]
    v_pk_add_f32 v[82:83], v[82:83], v[102:103]
    v_pk_add_f32 v[80:81], v[80:81], v[104:105]
    v_pk_add_f32 v[82:83], v[82:83], v[106:107]
    v_pk_add_f32 v[80:81], v[80:81], v[108:109]
    v_pk_add_f32 v[82:83], v[82:83], v[110:111]
    v_pk_add_f32 v[80:81], v[80:81], v[112:113]
    v_pk_add_f32 v[82:83], v[82:83], v[114:115]
    ds_write_b128 v142, v[80:83] offset:0
    s_waitcnt lgkmcnt(0)
    s_lshl_b32 s38, s35, 7
    s_add_u32 s38, s38, 995328
    s_mov_b32 s24, 0
    s_nop 5
mega_fp3:
    buffer_load_dword v124, v9, s[20:23], s38 offen sc1
    s_waitcnt vmcnt(0)
    v_cmp_eq_u32 vcc, 0, v124
    s_add_u32 s24, s24, 1
    s_nop 3
    s_cbranch_vccz mega_fok4
    s_sleep 1
    s_cmp_lt_u32 s24, 524288
    s_cbranch_scc1 mega_fp3
mega_fok4:
    buffer_load_dwordx4 v[116:119], v132, s[20:23], s55 offen offset:0 sc1
    buffer_load_dwordx4 v[120:123], v132, s[20:23], s55 offen offset:1024 sc1
    buffer_load_dwordx4 a[0:3], v5, s[20:23], s53 offen offset:0 sc1
    buffer_load_dwordx4 a[72:75], v5, s[20:23], s54 offen offset:0 sc1
    buffer_load_dwordx4 a[4:7], v5, s[20:23], s53 offen offset:1024 sc1
    buffer_load_dwordx4 a[76:79], v5, s[20:23], s54 offen offset:1024 sc1
    buffer_load_dwordx4 a[8:11], v5, s[20:23], s53 offen offset:2048 sc1
    buffer_load_dwordx4 a[80:83], v5, s[20:23], s54 offen offset:2048 sc1
    buffer_load_dwordx4 a[12:15], v5, s[20:23], s53 offen offset:3072 sc1
    buffer_load_dwordx4 a[84:87], v5, s[20:23], s54 offen offset:3072 sc1
    s_add_u32 s53, s53, 4096
    buffer_load_dwordx4 a[16:19], v5, s[20:23], s53 offen offset:0 sc1
    s_add_u32 s54, s54, 4096
    buffer_load_dwordx4 a[88:91], v5, s[20:23], s54 offen offset:0 sc1
    buffer_load_dwordx4 a[20:23], v5, s[20:23], s53 offen offset:1024 sc1
    buffer_load_dwordx4 a[92:95], v5, s[20:23], s54 offen offset:1024 sc1
    buffer_load_dwordx4 a[24:27], v5, s[20:23], s53 offen offset:2048 sc1
    buffer_load_dwordx4 a[96:99], v5, s[20:23], s54 offen offset:2048 sc1
    buffer_load_dwordx4 a[28:31], v5, s[20:23], s53 offen offset:3072 sc1
    buffer_load_dwordx4 a[100:103], v5, s[20:23], s54 offen offset:3072 sc1
    s_add_u32 s53, s53, 4096
    buffer_load_dwordx4 a[32:35], v5, s[20:23], s53 offen offset:0 sc1
    s_add_u32 s54, s54, 4096
    buffer_load_dwordx4 a[104:107], v5, s[20:23], s54 offen offset:0 sc1
    s_barrier
    s_waitcnt vmcnt(18)
    v_add_f32 v116, v116, v118
    v_add_f32 v117, v117, v119
    v_mov_b32 v124, v116
    s_nop 1
    v_permlane32_swap_b32 v116, v124
    v_add_f32 v116, v116, v124
    v_mov_b32 v124, v116
    s_nop 1
    v_permlane16_swap_b32 v116, v124
    v_add_f32 v116, v116, v124
    v_mov_b32 v125, v117
    s_nop 1
    v_permlane32_swap_b32 v117, v125
    v_add_f32 v117, v117, v125
    v_mov_b32 v125, v117
    s_nop 1
    v_permlane16_swap_b32 v117, v125
    v_add_f32 v117, v117, v125
    v_mul_f32 v173, 0x3ae38e39, v116
    v_mul_f32 v117, 0x3ae38e39, v117
    v_fma_f32 v117, -v173, v173, v117
    v_max_f32 v117, 0, v117
    v_add_f32 v117, 0x3727c5ac, v117
    v_rsq_f32 v172, v117
    s_nop 0
    v_mul_f32 v173, -v173, v172
    ds_write_b32 v140, v172 offset:0
    ds_write_b32 v140, v173 offset:128
    v_add_f32 v120, v120, v122
    v_add_f32 v121, v121, v123
    v_mov_b32 v124, v120
    s_nop 1
    v_permlane32_swap_b32 v120, v124
    v_add_f32 v120, v120, v124
    v_mov_b32 v124, v120
    s_nop 1
    v_permlane16_swap_b32 v120, v124
    v_add_f32 v120, v120, v124
    v_mov_b32 v125, v121
    s_nop 1
    v_permlane32_swap_b32 v121, v125
    v_add_f32 v121, v121, v125
    v_mov_b32 v125, v121
    s_nop 1
    v_permlane16_swap_b32 v121, v125
    v_add_f32 v121, v121, v125
    v_mul_f32 v175, 0x3ae38e39, v120
    v_mul_f32 v121, 0x3ae38e39, v121
    v_fma_f32 v121, -v175, v175, v121
    v_max_f32 v121, 0, v121
    v_add_f32 v121, 0x3727c5ac, v121
    v_rsq_f32 v174, v121
    s_nop 0
    v_mul_f32 v175, -v175, v174
    ds_write_b32 v140, v174 offset:64
    ds_write_b32 v140, v175 offset:192
    ds_read_b128 v[84:87], v141 offset:0
    ds_read_b128 v[92:95], v141 offset:128
    ds_read_b128 v[88:91], v141 offset:64
    ds_read_b128 v[96:99], v141 offset:192
    ds_read_b32 v176, v144 offset:192
    ds_read_b32 v178, v144 offset:256
    ds_read_b32 v180, v144 offset:320
    ds_read_b32 v182, v144 offset:384
    ds_read_b32 v184, v144 offset:448
    s_waitcnt lgkmcnt(0)
    v_mov_b32 v177, v176
    v_mov_b32 v179, v178
    v_mov_b32 v181, v180
    v_mov_b32 v183, v182
    v_mov_b32 v185, v184
    ds_read_b128 a[144:147], v129 offset:0
    ds_read_b128 a[148:151], v129 offset:1024
    ds_read_b128 a[152:155], v129 offset:2048
    ds_read_b128 a[156:159], v129 offset:3072
    ds_read_b128 a[160:163], v129 offset:4096
    ds_read_b128 a[164:167], v129 offset:5120
    s_waitcnt vmcnt(16)
    s_waitcnt lgkmcnt(5)
    v_mfma_f32_16x16x32_bf16 v[28:31], a[0:3], a[144:147], 0
    ds_read_b128 a[168:171], v129 offset:6144
    v_mfma_f32_16x16x32_bf16 v[60:63], a[72:75], a[144:147], 0
    buffer_load_dwordx4 a[36:39], v5, s[20:23], s53 offen offset:1024 sc1
    s_waitcnt lgkmcnt(5)
    v_mfma_f32_16x16x32_bf16 v[32:35], a[0:3], a[148:151], 0
    ds_read_b128 a[172:175], v129 offset:7168
    v_mfma_f32_16x16x32_bf16 v[64:67], a[72:75], a[148:151], 0
    buffer_load_dwordx4 a[108:111], v5, s[20:23], s54 offen offset:1024 sc1
    s_waitcnt lgkmcnt(5)
    v_mfma_f32_16x16x32_bf16 v[36:39], a[0:3], a[152:155], 0
    ds_read_b128 a[144:147], v129 offset:8192
    v_mfma_f32_16x16x32_bf16 v[68:71], a[72:75], a[152:155], 0
    buffer_load_dwordx4 a[40:43], v5, s[20:23], s53 offen offset:2048 sc1
    s_waitcnt lgkmcnt(5)
    v_mfma_f32_16x16x32_bf16 v[40:43], a[0:3], a[156:159], 0
    ds_read_b128 a[148:151], v129 offset:9216
    v_mfma_f32_16x16x32_bf16 v[72:75], a[72:75], a[156:159], 0
    buffer_load_dwordx4 a[112:115], v5, s[20:23], s54 offen offset:2048 sc1
    s_waitcnt lgkmcnt(5)
    v_mfma_f32_16x16x32_bf16 v[44:47], a[0:3], a[160:163], 0
    ds_read_b128 a[152:155], v129 offset:10240
    v_mfma_f32_16x16x32_bf16 v[76:79], a[72:75], a[160:163], 0
    buffer_load_dwordx4 a[44:47], v5, s[20:23], s53 offen offset:3072 sc1
    s_waitcnt vmcnt(19)
    s_waitcnt lgkmcnt(5)
    v_mfma_f32_16x16x32_bf16 v[28:31], a[4:7], a[164:167], v[28:31]
    ds_read_b128 a[156:159], v129 offset:11264
    v_mfma_f32_16x16x32_bf16 v[60:63], a[76:79], a[164:167], v[60:63]
    buffer_load_dwordx4 a[116:119], v5, s[20:23], s54 offen offset:3072 sc1
    s_waitcnt lgkmcnt(5)
    v_mfma_f32_16x16x32_bf16 v[32:35], a[4:7], a[168:171], v[32:35]
    ds_read_b128 a[160:163], v129 offset:12288
    v_mfma_f32_16x16x32_bf16 v[64:67], a[76:79], a[168:171], v[64:67]
    s_add_u32 s53, s53, 4096
    buffer_load_dwordx4 a[48:51], v5, s[20:23], s53 offen offset:0 sc1
    s_waitcnt lgkmcnt(5)
    v_mfma_f32_16x16x32_bf16 v[36:39], a[4:7], a[172:175], v[36:39]
    ds_read_b128 a[164:167], v129 offset:13312
    v_mfma_f32_16x16x32_bf16 v[68:71], a[76:79], a[172:175], v[68:71]
    s_add_u32 s54, s54, 4096
    buffer_load_dwordx4 a[120:123], v5, s[20:23], s54 offen offset:0 sc1
    s_waitcnt lgkmcnt(5)
    v_mfma_f32_16x16x32_bf16 v[40:43], a[4:7], a[144:147], v[40:43]
    ds_read_b128 a[168:171], v129 offset:14336
    v_mfma_f32_16x16x32_bf16 v[72:75], a[76:79], a[144:147], v[72:75]
    buffer_load_dwordx4 a[52:55], v5, s[20:23], s53 offen offset:1024 sc1
    s_waitcnt lgkmcnt(5)
    v_mfma_f32_16x16x32_bf16 v[44:47], a[4:7], a[148:151], v[44:47]
    ds_read_b128 a[172:175], v129 offset:15360
    v_mfma_f32_16x16x32_bf16 v[76:79], a[76:79], a[148:151], v[76:79]
    buffer_load_dwordx4 a[124:127], v5, s[20:23], s54 offen offset:1024 sc1
    s_waitcnt vmcnt(22)
    s_waitcnt lgkmcnt(5)
    v_mfma_f32_16x16x32_bf16 v[28:31], a[8:11], a[152:155], v[28:31]
    ds_read_b128 a[144:147], v129 offset:16384
    v_mfma_f32_16x16x32_bf16 v[60:63], a[80:83], a[152:155], v[60:63]
    buffer_load_dwordx4 a[56:59], v5, s[20:23], s53 offen offset:2048 sc1
    s_waitcnt lgkmcnt(5)
    v_mfma_f32_16x16x32_bf16 v[32:35], a[8:11], a[156:159], v[32:35]
    ds_read_b128 a[148:151], v129 offset:17408
    v_mfma_f32_16x16x32_bf16 v[64:67], a[80:83], a[156:159], v[64:67]
    buffer_load_dwordx4 a[128:131], v5, s[20:23], s54 offen offset:2048 sc1
    s_waitcnt lgkmcnt(5)
    v_mfma_f32_16x16x32_bf16 v[36:39], a[8:11], a[160:163], v[36:39]
    ds_read_b128 a[152:155], v129 offset:18432
    v_mfma_f32_16x16x32_bf16 v[68:71], a[80:83], a[160:163], v[68:71]
    buffer_load_dwordx4 a[60:63], v5, s[20:23], s53 offen offset:3072 sc1
    s_waitcnt lgkmcnt(5)
    v_mfma_f32_16x16x32_bf16 v[40:43], a[8:11], a[164:167], v[40:43]
    ds_read_b128 a[156:159], v129 offset:19456
    v_mfma_f32_16x16x32_bf16 v[72:75], a[80:83], a[164:167], v[72:75]
    buffer_load_dwordx4 a[132:135], v5, s[20:23], s54 offen offset:3072 sc1
    s_waitcnt lgkmcnt(5)
    v_mfma_f32_16x16x32_bf16 v[44:47], a[8:11], a[168:171], v[44:47]
    ds_read_b128 a[160:163], v129 offset:20480
    v_mfma_f32_16x16x32_bf16 v[76:79], a[80:83], a[168:171], v[76:79]
    s_add_u32 s53, s53, 4096
    buffer_load_dwordx4 a[64:67], v5, s[20:23], s53 offen offset:0 sc1
    s_waitcnt vmcnt(25)
    s_waitcnt lgkmcnt(5)
    v_mfma_f32_16x16x32_bf16 v[28:31], a[12:15], a[172:175], v[28:31]
    ds_read_b128 a[164:167], v129 offset:21504
    v_mfma_f32_16x16x32_bf16 v[60:63], a[84:87], a[172:175], v[60:63]
    s_add_u32 s54, s54, 4096
    buffer_load_dwordx4 a[136:139], v5, s[20:23], s54 offen offset:0 sc1
    s_waitcnt lgkmcnt(5)
    v_mfma_f32_16x16x32_bf16 v[32:35], a[12:15], a[144:147], v[32:35]
    ds_read_b128 a[168:171], v129 offset:22528
    v_mfma_f32_16x16x32_bf16 v[64:67], a[84:87], a[144:147], v[64:67]
    buffer_load_dwordx4 a[68:71], v5, s[20:23], s53 offen offset:1024 sc1
    s_waitcnt lgkmcnt(5)
    v_mfma_f32_16x16x32_bf16 v[36:39], a[12:15], a[148:151], v[36:39]
    ds_read_b128 a[172:175], v129 offset:23552
    v_mfma_f32_16x16x32_bf16 v[68:71], a[84:87], a[148:151], v[68:71]
    buffer_load_dwordx4 a[140:143], v5, s[20:23], s54 offen offset:1024 sc1
    s_waitcnt lgkmcnt(5)
    v_mfma_f32_16x16x32_bf16 v[40:43], a[12:15], a[152:155], v[40:43]
    ds_read_b128 a[144:147], v129 offset:24576
    v_mfma_f32_16x16x32_bf16 v[72:75], a[84:87], a[152:155], v[72:75]
    s_add_u32 m0, s44, 122880
    s_add_u32 s46, s45, 114688
    buffer_load_dwordx4 v5, s[16:19], s46 offen offset:0 sc1 lds
    s_waitcnt lgkmcnt(5)
    v_mfma_f32_16x16x32_bf16 v[44:47], a[12:15], a[156:159], v[44:47]
    ds_read_b128 a[148:151], v129 offset:25600
    v_mfma_f32_16x16x32_bf16 v[76:79], a[84:87], a[156:159], v[76:79]
    s_waitcnt vmcnt(27)
    s_waitcnt lgkmcnt(5)
    v_mfma_f32_16x16x32_bf16 v[28:31], a[16:19], a[160:163], v[28:31]
    ds_read_b128 a[152:155], v129 offset:26624
    v_mfma_f32_16x16x32_bf16 v[60:63], a[88:91], a[160:163], v[60:63]
    buffer_load_dwordx4 v5, s[16:19], s46 offen offset:1024 sc1 lds
    s_waitcnt lgkmcnt(5)
    v_mfma_f32_16x16x32_bf16 v[32:35], a[16:19], a[164:167], v[32:35]
    ds_read_b128 a[156:159], v129 offset:27648
    v_mfma_f32_16x16x32_bf16 v[64:67], a[88:91], a[164:167], v[64:67]
    s_waitcnt lgkmcnt(5)
    v_mfma_f32_16x16x32_bf16 v[36:39], a[16:19], a[168:171], v[36:39]
    ds_read_b128 a[160:163], v129 offset:28672
    v_mfma_f32_16x16x32_bf16 v[68:71], a[88:91], a[168:171], v[68:71]
    s_waitcnt lgkmcnt(5)
    v_mfma_f32_16x16x32_bf16 v[40:43], a[16:19], a[172:175], v[40:43]
    ds_read_b128 a[164:167], v129 offset:29696
    v_mfma_f32_16x16x32_bf16 v[72:75], a[88:91], a[172:175], v[72:75]
    s_waitcnt lgkmcnt(5)
    v_mfma_f32_16x16x32_bf16 v[44:47], a[16:19], a[144:147], v[44:47]
    ds_read_b128 a[168:171], v129 offset:30720
    v_mfma_f32_16x16x32_bf16 v[76:79], a[88:91], a[144:147], v[76:79]
    buffer_load_dwordx4 v5, s[16:19], s46 offen offset:2048 sc1 lds
    s_waitcnt vmcnt(27)
    s_waitcnt lgkmcnt(5)
    v_mfma_f32_16x16x32_bf16 v[28:31], a[20:23], a[148:151], v[28:31]
    ds_read_b128 a[172:175], v129 offset:31744
    v_mfma_f32_16x16x32_bf16 v[60:63], a[92:95], a[148:151], v[60:63]
    s_waitcnt lgkmcnt(5)
    v_mfma_f32_16x16x32_bf16 v[32:35], a[20:23], a[152:155], v[32:35]
    ds_read_b128 a[144:147], v129 offset:32768
    v_mfma_f32_16x16x32_bf16 v[64:67], a[92:95], a[152:155], v[64:67]
    s_waitcnt lgkmcnt(5)
    v_mfma_f32_16x16x32_bf16 v[36:39], a[20:23], a[156:159], v[36:39]
    ds_read_b128 a[148:151], v129 offset:33792
    v_mfma_f32_16x16x32_bf16 v[68:71], a[92:95], a[156:159], v[68:71]
    s_waitcnt lgkmcnt(5)
    v_mfma_f32_16x16x32_bf16 v[40:43], a[20:23], a[160:163], v[40:43]
    ds_read_b128 a[152:155], v129 offset:34816
    v_mfma_f32_16x16x32_bf16 v[72:75], a[92:95], a[160:163], v[72:75]
    buffer_load_dwordx4 v5, s[16:19], s46 offen offset:3072 sc1 lds
    s_waitcnt lgkmcnt(5)
    v_mfma_f32_16x16x32_bf16 v[44:47], a[20:23], a[164:167], v[44:47]
    ds_read_b128 a[156:159], v129 offset:35840
    v_mfma_f32_16x16x32_bf16 v[76:79], a[92:95], a[164:167], v[76:79]
    s_waitcnt vmcnt(26)
    s_waitcnt lgkmcnt(5)
    v_mfma_f32_16x16x32_bf16 v[28:31], a[24:27], a[168:171], v[28:31]
    ds_read_b128 a[160:163], v129 offset:36864
    v_mfma_f32_16x16x32_bf16 v[60:63], a[96:99], a[168:171], v[60:63]
    s_waitcnt lgkmcnt(5)
    v_mfma_f32_16x16x32_bf16 v[32:35], a[24:27], a[172:175], v[32:35]
    ds_read_b128 a[164:167], v129 offset:37888
    v_mfma_f32_16x16x32_bf16 v[64:67], a[96:99], a[172:175], v[64:67]
    s_waitcnt lgkmcnt(5)
    v_mfma_f32_16x16x32_bf16 v[36:39], a[24:27], a[144:147], v[36:39]
    ds_read_b128 a[168:171], v129 offset:38912
    v_mfma_f32_16x16x32_bf16 v[68:71], a[96:99], a[144:147], v[68:71]
    s_add_u32 m0, s44, 139264
    s_add_u32 s46, s45, 131072
    buffer_load_dwordx4 v5, s[16:19], s46 offen offset:0 sc1 lds
    s_waitcnt lgkmcnt(5)
    v_mfma_f32_16x16x32_bf16 v[40:43], a[24:27], a[148:151], v[40:43]
    ds_read_b128 a[172:175], v129 offset:39936
    v_mfma_f32_16x16x32_bf16 v[72:75], a[96:99], a[148:151], v[72:75]
    s_waitcnt lgkmcnt(5)
    v_mfma_f32_16x16x32_bf16 v[44:47], a[24:27], a[152:155], v[44:47]
    ds_read_b128 a[144:147], v129 offset:40960
    v_mfma_f32_16x16x32_bf16 v[76:79], a[96:99], a[152:155], v[76:79]
    s_waitcnt vmcnt(25)
    s_waitcnt lgkmcnt(5)
    v_mfma_f32_16x16x32_bf16 v[28:31], a[28:31], a[156:159], v[28:31]
    ds_read_b128 a[148:151], v129 offset:41984
    v_mfma_f32_16x16x32_bf16 v[60:63], a[100:103], a[156:159], v[60:63]
    s_waitcnt lgkmcnt(5)
    v_mfma_f32_16x16x32_bf16 v[32:35], a[28:31], a[160:163], v[32:35]
    ds_read_b128 a[152:155], v129 offset:43008
    v_mfma_f32_16x16x32_bf16 v[64:67], a[100:103], a[160:163], v[64:67]
    buffer_load_dwordx4 v5, s[16:19], s46 offen offset:1024 sc1 lds
    s_waitcnt lgkmcnt(5)
    v_mfma_f32_16x16x32_bf16 v[36:39], a[28:31], a[164:167], v[36:39]
    ds_read_b128 a[156:159], v129 offset:44032
    v_mfma_f32_16x16x32_bf16 v[68:71], a[100:103], a[164:167], v[68:71]
    s_waitcnt lgkmcnt(5)
    v_mfma_f32_16x16x32_bf16 v[40:43], a[28:31], a[168:171], v[40:43]
    ds_read_b128 a[160:163], v129 offset:45056
    v_mfma_f32_16x16x32_bf16 v[72:75], a[100:103], a[168:171], v[72:75]
    s_waitcnt lgkmcnt(5)
    v_mfma_f32_16x16x32_bf16 v[44:47], a[28:31], a[172:175], v[44:47]
    ds_read_b128 a[164:167], v129 offset:46080
    v_mfma_f32_16x16x32_bf16 v[76:79], a[100:103], a[172:175], v[76:79]
    s_waitcnt vmcnt(24)
    s_waitcnt lgkmcnt(5)
    v_mfma_f32_16x16x32_bf16 v[28:31], a[32:35], a[144:147], v[28:31]
    ds_read_b128 a[168:171], v129 offset:47104
    v_mfma_f32_16x16x32_bf16 v[60:63], a[104:107], a[144:147], v[60:63]
    buffer_load_dwordx4 v5, s[16:19], s46 offen offset:2048 sc1 lds
    s_waitcnt lgkmcnt(5)
    v_mfma_f32_16x16x32_bf16 v[32:35], a[32:35], a[148:151], v[32:35]
    ds_read_b128 a[172:175], v129 offset:48128
    v_mfma_f32_16x16x32_bf16 v[64:67], a[104:107], a[148:151], v[64:67]
    s_waitcnt lgkmcnt(5)
    v_mfma_f32_16x16x32_bf16 v[36:39], a[32:35], a[152:155], v[36:39]
    ds_read_b128 a[144:147], v129 offset:49152
    v_mfma_f32_16x16x32_bf16 v[68:71], a[104:107], a[152:155], v[68:71]
    s_waitcnt lgkmcnt(5)
    v_mfma_f32_16x16x32_bf16 v[40:43], a[32:35], a[156:159], v[40:43]
    ds_read_b128 a[148:151], v129 offset:50176
    v_mfma_f32_16x16x32_bf16 v[72:75], a[104:107], a[156:159], v[72:75]
    s_waitcnt lgkmcnt(5)
    v_mfma_f32_16x16x32_bf16 v[44:47], a[32:35], a[160:163], v[44:47]
    ds_read_b128 a[152:155], v129 offset:51200
    v_mfma_f32_16x16x32_bf16 v[76:79], a[104:107], a[160:163], v[76:79]
    buffer_load_dwordx4 v5, s[16:19], s46 offen offset:3072 sc1 lds
    s_waitcnt vmcnt(24)
    s_waitcnt lgkmcnt(5)
    v_mfma_f32_16x16x32_bf16 v[28:31], a[36:39], a[164:167], v[28:31]
    ds_read_b128 a[156:159], v129 offset:52224
    v_mfma_f32_16x16x32_bf16 v[60:63], a[108:111], a[164:167], v[60:63]
    s_waitcnt lgkmcnt(5)
    v_mfma_f32_16x16x32_bf16 v[32:35], a[36:39], a[168:171], v[32:35]
    ds_read_b128 a[160:163], v129 offset:53248
    v_mfma_f32_16x16x32_bf16 v[64:67], a[108:111], a[168:171], v[64:67]
    s_waitcnt lgkmcnt(5)
    v_mfma_f32_16x16x32_bf16 v[36:39], a[36:39], a[172:175], v[36:39]
    ds_read_b128 a[164:167], v129 offset:54272
    v_mfma_f32_16x16x32_bf16 v[68:71], a[108:111], a[172:175], v[68:71]
    s_waitcnt lgkmcnt(5)
    v_mfma_f32_16x16x32_bf16 v[40:43], a[36:39], a[144:147], v[40:43]
    ds_read_b128 a[168:171], v129 offset:55296
    v_mfma_f32_16x16x32_bf16 v[72:75], a[108:111], a[144:147], v[72:75]
    s_waitcnt lgkmcnt(5)
    v_mfma_f32_16x16x32_bf16 v[44:47], a[36:39], a[148:151], v[44:47]
    ds_read_b128 a[172:175], v129 offset:56320
    v_mfma_f32_16x16x32_bf16 v[76:79], a[108:111], a[148:151], v[76:79]
    s_waitcnt vmcnt(22)
    s_waitcnt lgkmcnt(5)
    v_mfma_f32_16x16x32_bf16 v[28:31], a[40:43], a[152:155], v[28:31]
    ds_read_b128 a[144:147], v129 offset:57344
    v_mfma_f32_16x16x32_bf16 v[60:63], a[112:115], a[152:155], v[60:63]
    s_waitcnt lgkmcnt(5)
    v_mfma_f32_16x16x32_bf16 v[32:35], a[40:43], a[156:159], v[32:35]
    ds_read_b128 a[148:151], v129 offset:58368
    v_mfma_f32_16x16x32_bf16 v[64:67], a[112:115], a[156:159], v[64:67]
    s_waitcnt lgkmcnt(5)
    v_mfma_f32_16x16x32_bf16 v[36:39], a[40:43], a[160:163], v[36:39]
    ds_read_b128 a[152:155], v129 offset:59392
    v_mfma_f32_16x16x32_bf16 v[68:71], a[112:115], a[160:163], v[68:71]
    s_waitcnt lgkmcnt(5)
    v_mfma_f32_16x16x32_bf16 v[40:43], a[40:43], a[164:167], v[40:43]
    ds_read_b128 a[156:159], v129 offset:60416
    v_mfma_f32_16x16x32_bf16 v[72:75], a[112:115], a[164:167], v[72:75]
    s_waitcnt lgkmcnt(5)
    v_mfma_f32_16x16x32_bf16 v[44:47], a[40:43], a[168:171], v[44:47]
    ds_read_b128 a[160:163], v129 offset:61440
    v_mfma_f32_16x16x32_bf16 v[76:79], a[112:115], a[168:171], v[76:79]
    s_waitcnt vmcnt(20)
    s_waitcnt lgkmcnt(5)
    v_mfma_f32_16x16x32_bf16 v[28:31], a[44:47], a[172:175], v[28:31]
    ds_read_b128 a[164:167], v129 offset:62464
    v_mfma_f32_16x16x32_bf16 v[60:63], a[116:119], a[172:175], v[60:63]
    s_waitcnt lgkmcnt(5)
    v_mfma_f32_16x16x32_bf16 v[32:35], a[44:47], a[144:147], v[32:35]
    ds_read_b128 a[168:171], v129 offset:63488
    v_mfma_f32_16x16x32_bf16 v[64:67], a[116:119], a[144:147], v[64:67]
    s_waitcnt lgkmcnt(5)
    v_mfma_f32_16x16x32_bf16 v[36:39], a[44:47], a[148:151], v[36:39]
    ds_read_b128 a[172:175], v129 offset:64512
    v_mfma_f32_16x16x32_bf16 v[68:71], a[116:119], a[148:151], v[68:71]
    s_waitcnt lgkmcnt(5)
    v_mfma_f32_16x16x32_bf16 v[40:43], a[44:47], a[152:155], v[40:43]
    ds_read_b128 a[144:147], v130 offset:0
    v_mfma_f32_16x16x32_bf16 v[72:75], a[116:119], a[152:155], v[72:75]
    s_waitcnt lgkmcnt(5)
    v_mfma_f32_16x16x32_bf16 v[44:47], a[44:47], a[156:159], v[44:47]
    ds_read_b128 a[148:151], v130 offset:1024
    v_mfma_f32_16x16x32_bf16 v[76:79], a[116:119], a[156:159], v[76:79]
    s_waitcnt vmcnt(18)
    s_waitcnt lgkmcnt(5)
    v_mfma_f32_16x16x32_bf16 v[28:31], a[48:51], a[160:163], v[28:31]
    ds_read_b128 a[152:155], v130 offset:2048
    v_mfma_f32_16x16x32_bf16 v[60:63], a[120:123], a[160:163], v[60:63]
    s_waitcnt lgkmcnt(5)
    v_mfma_f32_16x16x32_bf16 v[32:35], a[48:51], a[164:167], v[32:35]
    ds_read_b128 a[156:159], v130 offset:3072
    v_mfma_f32_16x16x32_bf16 v[64:67], a[120:123], a[164:167], v[64:67]
    s_waitcnt lgkmcnt(5)
    v_mfma_f32_16x16x32_bf16 v[36:39], a[48:51], a[168:171], v[36:39]
    ds_read_b128 a[160:163], v130 offset:4096
    v_mfma_f32_16x16x32_bf16 v[68:71], a[120:123], a[168:171], v[68:71]
    s_waitcnt lgkmcnt(5)
    v_mfma_f32_16x16x32_bf16 v[40:43], a[48:51], a[172:175], v[40:43]
    ds_read_b128 a[164:167], v130 offset:5120
    v_mfma_f32_16x16x32_bf16 v[72:75], a[120:123], a[172:175], v[72:75]
    s_waitcnt lgkmcnt(5)
    v_mfma_f32_16x16x32_bf16 v[44:47], a[48:51], a[144:147], v[44:47]
    ds_read_b128 a[168:171], v130 offset:6144
    v_mfma_f32_16x16x32_bf16 v[76:79], a[120:123], a[144:147], v[76:79]
    s_waitcnt vmcnt(16)
    s_waitcnt lgkmcnt(5)
    v_mfma_f32_16x16x32_bf16 v[28:31], a[52:55], a[148:151], v[28:31]
    ds_read_b128 a[172:175], v130 offset:7168
    v_mfma_f32_16x16x32_bf16 v[60:63], a[124:127], a[148:151], v[60:63]
    s_waitcnt lgkmcnt(5)
    v_mfma_f32_16x16x32_bf16 v[32:35], a[52:55], a[152:155], v[32:35]
    ds_read_b128 a[144:147], v130 offset:8192
    v_mfma_f32_16x16x32_bf16 v[64:67], a[124:127], a[152:155], v[64:67]
    s_waitcnt lgkmcnt(5)
    v_mfma_f32_16x16x32_bf16 v[36:39], a[52:55], a[156:159], v[36:39]
    ds_read_b128 a[148:151], v130 offset:9216
    v_mfma_f32_16x16x32_bf16 v[68:71], a[124:127], a[156:159], v[68:71]
    s_waitcnt lgkmcnt(5)
    v_mfma_f32_16x16x32_bf16 v[40:43], a[52:55], a[160:163], v[40:43]
    ds_read_b128 a[152:155], v130 offset:10240
    v_mfma_f32_16x16x32_bf16 v[72:75], a[124:127], a[160:163], v[72:75]
    s_waitcnt lgkmcnt(5)
    v_mfma_f32_16x16x32_bf16 v[44:47], a[52:55], a[164:167], v[44:47]
    ds_read_b128 a[156:159], v130 offset:11264
    v_mfma_f32_16x16x32_bf16 v[76:79], a[124:127], a[164:167], v[76:79]
    s_waitcnt vmcnt(14)
    s_waitcnt lgkmcnt(5)
    v_mfma_f32_16x16x32_bf16 v[28:31], a[56:59], a[168:171], v[28:31]
    ds_read_b128 a[160:163], v130 offset:12288
    v_mfma_f32_16x16x32_bf16 v[60:63], a[128:131], a[168:171], v[60:63]
    s_waitcnt lgkmcnt(5)
    v_mfma_f32_16x16x32_bf16 v[32:35], a[56:59], a[172:175], v[32:35]
    ds_read_b128 a[164:167], v130 offset:13312
    v_mfma_f32_16x16x32_bf16 v[64:67], a[128:131], a[172:175], v[64:67]
    s_waitcnt lgkmcnt(5)
    v_mfma_f32_16x16x32_bf16 v[36:39], a[56:59], a[144:147], v[36:39]
    ds_read_b128 a[168:171], v130 offset:14336
    v_mfma_f32_16x16x32_bf16 v[68:71], a[128:131], a[144:147], v[68:71]
    s_waitcnt lgkmcnt(5)
    v_mfma_f32_16x16x32_bf16 v[40:43], a[56:59], a[148:151], v[40:43]
    ds_read_b128 a[172:175], v130 offset:15360
    v_mfma_f32_16x16x32_bf16 v[72:75], a[128:131], a[148:151], v[72:75]
    s_waitcnt lgkmcnt(5)
    v_mfma_f32_16x16x32_bf16 v[44:47], a[56:59], a[152:155], v[44:47]
    ds_read_b128 a[144:147], v130 offset:16384
    v_mfma_f32_16x16x32_bf16 v[76:79], a[128:131], a[152:155], v[76:79]
    s_waitcnt vmcnt(12)
    s_waitcnt lgkmcnt(5)
    v_mfma_f32_16x16x32_bf16 v[28:31], a[60:63], a[156:159], v[28:31]
    ds_read_b128 a[148:151], v130 offset:17408
    v_mfma_f32_16x16x32_bf16 v[60:63], a[132:135], a[156:159], v[60:63]
    s_waitcnt lgkmcnt(5)
    v_mfma_f32_16x16x32_bf16 v[32:35], a[60:63], a[160:163], v[32:35]
    ds_read_b128 a[152:155], v130 offset:18432
    v_mfma_f32_16x16x32_bf16 v[64:67], a[132:135], a[160:163], v[64:67]
    s_waitcnt lgkmcnt(5)
    v_mfma_f32_16x16x32_bf16 v[36:39], a[60:63], a[164:167], v[36:39]
    ds_read_b128 a[156:159], v130 offset:19456
    v_mfma_f32_16x16x32_bf16 v[68:71], a[132:135], a[164:167], v[68:71]
    s_waitcnt lgkmcnt(5)
    v_mfma_f32_16x16x32_bf16 v[40:43], a[60:63], a[168:171], v[40:43]
    ds_read_b128 a[160:163], v130 offset:20480
    v_mfma_f32_16x16x32_bf16 v[72:75], a[132:135], a[168:171], v[72:75]
    s_waitcnt lgkmcnt(5)
    v_mfma_f32_16x16x32_bf16 v[44:47], a[60:63], a[172:175], v[44:47]
    ds_read_b128 a[164:167], v130 offset:21504
    v_mfma_f32_16x16x32_bf16 v[76:79], a[132:135], a[172:175], v[76:79]
    s_waitcnt vmcnt(10)
    s_waitcnt lgkmcnt(5)
    v_mfma_f32_16x16x32_bf16 v[28:31], a[64:67], a[144:147], v[28:31]
    ds_read_b128 a[168:171], v130 offset:22528
    v_mfma_f32_16x16x32_bf16 v[60:63], a[136:139], a[144:147], v[60:63]
    s_waitcnt lgkmcnt(5)
    v_mfma_f32_16x16x32_bf16 v[32:35], a[64:67], a[148:151], v[32:35]
    ds_read_b128 a[172:175], v130 offset:23552
    v_mfma_f32_16x16x32_bf16 v[64:67], a[136:139], a[148:151], v[64:67]
    s_waitcnt lgkmcnt(5)
    v_mfma_f32_16x16x32_bf16 v[36:39], a[64:67], a[152:155], v[36:39]
    ds_read_b128 a[144:147], v130 offset:24576
    v_mfma_f32_16x16x32_bf16 v[68:71], a[136:139], a[152:155], v[68:71]
    s_waitcnt lgkmcnt(5)
    v_mfma_f32_16x16x32_bf16 v[40:43], a[64:67], a[156:159], v[40:43]
    ds_read_b128 a[148:151], v130 offset:25600
    v_mfma_f32_16x16x32_bf16 v[72:75], a[136:139], a[156:159], v[72:75]
    s_waitcnt lgkmcnt(5)
    v_mfma_f32_16x16x32_bf16 v[44:47], a[64:67], a[160:163], v[44:47]
    ds_read_b128 a[152:155], v130 offset:26624
    v_mfma_f32_16x16x32_bf16 v[76:79], a[136:139], a[160:163], v[76:79]
    s_waitcnt vmcnt(8)
    s_waitcnt lgkmcnt(5)
    v_mfma_f32_16x16x32_bf16 v[28:31], a[68:71], a[164:167], v[28:31]
    ds_read_b128 a[156:159], v130 offset:27648
    v_mfma_f32_16x16x32_bf16 v[60:63], a[140:143], a[164:167], v[60:63]
    s_waitcnt lgkmcnt(5)
    v_mfma_f32_16x16x32_bf16 v[32:35], a[68:71], a[168:171], v[32:35]
    ds_read_b128 a[160:163], v130 offset:28672
    v_mfma_f32_16x16x32_bf16 v[64:67], a[140:143], a[168:171], v[64:67]
    s_waitcnt lgkmcnt(5)
    v_mfma_f32_16x16x32_bf16 v[36:39], a[68:71], a[172:175], v[36:39]
    ds_read_b128 a[164:167], v130 offset:29696
    v_mfma_f32_16x16x32_bf16 v[68:71], a[140:143], a[172:175], v[68:71]
    s_waitcnt lgkmcnt(5)
    v_mfma_f32_16x16x32_bf16 v[40:43], a[68:71], a[144:147], v[40:43]
    ds_read_b128 a[168:171], v130 offset:30720
    v_mfma_f32_16x16x32_bf16 v[72:75], a[140:143], a[144:147], v[72:75]
    s_waitcnt lgkmcnt(5)
    v_mfma_f32_16x16x32_bf16 v[44:47], a[68:71], a[148:151], v[44:47]
    ds_read_b128 a[172:175], v130 offset:31744
    v_mfma_f32_16x16x32_bf16 v[76:79], a[140:143], a[148:151], v[76:79]
    v_pk_mul_f32 v[108:109], v[92:93], v[176:177]
    v_pk_mul_f32 v[110:111], v[94:95], v[176:177]
    v_pk_fma_f32 v[28:29], v[28:29], v[84:85], v[108:109]
    v_pk_fma_f32 v[30:31], v[30:31], v[86:87], v[110:111]
    v_min_f32 v104, 0, v28
    v_min_f32 v105, 0, v29
    v_min_f32 v106, 0, v30
    v_min_f32 v107, 0, v31
    v_pk_mul_f32 v[104:105], v[104:105], v[168:169]
    v_pk_mul_f32 v[106:107], v[106:107], v[168:169]
    v_exp_f32 v104, v104
    v_exp_f32 v105, v105
    v_exp_f32 v106, v106
    v_exp_f32 v107, v107
    v_max_f32 v108, 0, v28
    v_max_f32 v109, 0, v29
    v_max_f32 v110, 0, v30
    v_max_f32 v111, 0, v31
    v_pk_add_f32 v[104:105], v[104:105], v[108:109]
    v_pk_add_f32 v[106:107], v[106:107], v[110:111]
    v_pk_add_f32 v[28:29], v[104:105], v[170:171]
    v_pk_add_f32 v[30:31], v[106:107], v[170:171]
    v_cvt_pk_bf16_f32 v188, v28, v29
    v_cvt_pk_bf16_f32 v189, v30, v31
    v_pk_mul_f32 v[108:109], v[96:97], v[176:177]
    v_pk_mul_f32 v[110:111], v[98:99], v[176:177]
    v_pk_fma_f32 v[60:61], v[60:61], v[88:89], v[108:109]
    v_pk_fma_f32 v[62:63], v[62:63], v[90:91], v[110:111]
    v_min_f32 v104, 0, v60
    v_min_f32 v105, 0, v61
    v_min_f32 v106, 0, v62
    v_min_f32 v107, 0, v63
    v_pk_mul_f32 v[104:105], v[104:105], v[168:169]
    v_pk_mul_f32 v[106:107], v[106:107], v[168:169]
    v_exp_f32 v104, v104
    v_exp_f32 v105, v105
    v_exp_f32 v106, v106
    v_exp_f32 v107, v107
    v_max_f32 v108, 0, v60
    v_max_f32 v109, 0, v61
    v_max_f32 v110, 0, v62
    v_max_f32 v111, 0, v63
    v_pk_add_f32 v[104:105], v[104:105], v[108:109]
    v_pk_add_f32 v[106:107], v[106:107], v[110:111]
    v_pk_add_f32 v[60:61], v[104:105], v[170:171]
    v_pk_add_f32 v[62:63], v[106:107], v[170:171]
    v_cvt_pk_bf16_f32 v190, v60, v61
    v_cvt_pk_bf16_f32 v191, v62, v63
    v_pk_mul_f32 v[108:109], v[92:93], v[178:179]
    v_pk_mul_f32 v[110:111], v[94:95], v[178:179]
    v_pk_fma_f32 v[32:33], v[32:33], v[84:85], v[108:109]
    v_pk_fma_f32 v[34:35], v[34:35], v[86:87], v[110:111]
    v_min_f32 v104, 0, v32
    v_min_f32 v105, 0, v33
    v_min_f32 v106, 0, v34
    v_min_f32 v107, 0, v35
    v_pk_mul_f32 v[104:105], v[104:105], v[168:169]
    v_pk_mul_f32 v[106:107], v[106:107], v[168:169]
    v_exp_f32 v104, v104
    v_exp_f32 v105, v105
    v_exp_f32 v106, v106
    v_exp_f32 v107, v107
    v_max_f32 v108, 0, v32
    v_max_f32 v109, 0, v33
    v_max_f32 v110, 0, v34
    v_max_f32 v111, 0, v35
    v_pk_add_f32 v[104:105], v[104:105], v[108:109]
    v_pk_add_f32 v[106:107], v[106:107], v[110:111]
    v_pk_add_f32 v[32:33], v[104:105], v[170:171]
    v_pk_add_f32 v[34:35], v[106:107], v[170:171]
    v_cvt_pk_bf16_f32 v192, v32, v33
    v_cvt_pk_bf16_f32 v193, v34, v35
    v_pk_mul_f32 v[108:109], v[96:97], v[178:179]
    v_pk_mul_f32 v[110:111], v[98:99], v[178:179]
    v_pk_fma_f32 v[64:65], v[64:65], v[88:89], v[108:109]
    v_pk_fma_f32 v[66:67], v[66:67], v[90:91], v[110:111]
    v_min_f32 v104, 0, v64
    v_min_f32 v105, 0, v65
    v_min_f32 v106, 0, v66
    v_min_f32 v107, 0, v67
    v_pk_mul_f32 v[104:105], v[104:105], v[168:169]
    v_pk_mul_f32 v[106:107], v[106:107], v[168:169]
    v_exp_f32 v104, v104
    v_exp_f32 v105, v105
    v_exp_f32 v106, v106
    v_exp_f32 v107, v107
    v_max_f32 v108, 0, v64
    v_max_f32 v109, 0, v65
    v_max_f32 v110, 0, v66
    v_max_f32 v111, 0, v67
    v_pk_add_f32 v[104:105], v[104:105], v[108:109]
    v_pk_add_f32 v[106:107], v[106:107], v[110:111]
    v_pk_add_f32 v[64:65], v[104:105], v[170:171]
    v_pk_add_f32 v[66:67], v[106:107], v[170:171]
    v_cvt_pk_bf16_f32 v194, v64, v65
    v_cvt_pk_bf16_f32 v195, v66, v67
    v_pk_mul_f32 v[108:109], v[92:93], v[180:181]
    v_pk_mul_f32 v[110:111], v[94:95], v[180:181]
    v_pk_fma_f32 v[36:37], v[36:37], v[84:85], v[108:109]
    v_pk_fma_f32 v[38:39], v[38:39], v[86:87], v[110:111]
    v_min_f32 v104, 0, v36
    v_min_f32 v105, 0, v37
    v_min_f32 v106, 0, v38
    v_min_f32 v107, 0, v39
    v_pk_mul_f32 v[104:105], v[104:105], v[168:169]
    v_pk_mul_f32 v[106:107], v[106:107], v[168:169]
    v_exp_f32 v104, v104
    v_exp_f32 v105, v105
    v_exp_f32 v106, v106
    v_exp_f32 v107, v107
    v_max_f32 v108, 0, v36
    v_max_f32 v109, 0, v37
    v_max_f32 v110, 0, v38
    v_max_f32 v111, 0, v39
    v_pk_add_f32 v[104:105], v[104:105], v[108:109]
    v_pk_add_f32 v[106:107], v[106:107], v[110:111]
    v_pk_add_f32 v[104:105], v[104:105], v[170:171]
    v_pk_add_f32 v[106:107], v[106:107], v[170:171]
    v_cndmask_b32 v36, v36, v104, s[56:57]
    v_cndmask_b32 v37, v37, v105, s[56:57]
    v_cndmask_b32 v38, v38, v106, s[56:57]
    v_cndmask_b32 v39, v39, v107, s[56:57]
    v_cvt_pk_bf16_f32 v196, v36, v37
    v_cvt_pk_bf16_f32 v197, v38, v39
    v_pk_mul_f32 v[108:109], v[96:97], v[180:181]
    v_pk_mul_f32 v[110:111], v[98:99], v[180:181]
    v_pk_fma_f32 v[68:69], v[68:69], v[88:89], v[108:109]
    v_pk_fma_f32 v[70:71], v[70:71], v[90:91], v[110:111]
    v_min_f32 v104, 0, v68
    v_min_f32 v105, 0, v69
    v_min_f32 v106, 0, v70
    v_min_f32 v107, 0, v71
    v_pk_mul_f32 v[104:105], v[104:105], v[168:169]
    v_pk_mul_f32 v[106:107], v[106:107], v[168:169]
    v_exp_f32 v104, v104
    v_exp_f32 v105, v105
    v_exp_f32 v106, v106
    v_exp_f32 v107, v107
    v_max_f32 v108, 0, v68
    v_max_f32 v109, 0, v69
    v_max_f32 v110, 0, v70
    v_max_f32 v111, 0, v71
    v_pk_add_f32 v[104:105], v[104:105], v[108:109]
    v_pk_add_f32 v[106:107], v[106:107], v[110:111]
    v_pk_add_f32 v[104:105], v[104:105], v[170:171]
    v_pk_add_f32 v[106:107], v[106:107], v[170:171]
    v_cndmask_b32 v68, v68, v104, s[56:57]
    v_cndmask_b32 v69, v69, v105, s[56:57]
    v_cndmask_b32 v70, v70, v106, s[56:57]
    v_cndmask_b32 v71, v71, v107, s[56:57]
    v_cvt_pk_bf16_f32 v198, v68, v69
    v_cvt_pk_bf16_f32 v199, v70, v71
    v_pk_mul_f32 v[108:109], v[92:93], v[182:183]
    v_pk_mul_f32 v[110:111], v[94:95], v[182:183]
    v_pk_fma_f32 v[40:41], v[40:41], v[84:85], v[108:109]
    v_pk_fma_f32 v[42:43], v[42:43], v[86:87], v[110:111]
    v_cvt_pk_bf16_f32 v200, v40, v41
    v_cvt_pk_bf16_f32 v201, v42, v43
    v_pk_mul_f32 v[108:109], v[96:97], v[182:183]
    v_pk_mul_f32 v[110:111], v[98:99], v[182:183]
    v_pk_fma_f32 v[72:73], v[72:73], v[88:89], v[108:109]
    v_pk_fma_f32 v[74:75], v[74:75], v[90:91], v[110:111]
    v_cvt_pk_bf16_f32 v202, v72, v73
    v_cvt_pk_bf16_f32 v203, v74, v75
    v_pk_mul_f32 v[108:109], v[92:93], v[184:185]
    v_pk_mul_f32 v[110:111], v[94:95], v[184:185]
    v_pk_fma_f32 v[44:45], v[44:45], v[84:85], v[108:109]
    v_pk_fma_f32 v[46:47], v[46:47], v[86:87], v[110:111]
    v_cvt_pk_bf16_f32 v204, v44, v45
    v_cvt_pk_bf16_f32 v205, v46, v47
    v_pk_mul_f32 v[108:109], v[96:97], v[184:185]
    v_pk_mul_f32 v[110:111], v[98:99], v[184:185]
    v_pk_fma_f32 v[76:77], v[76:77], v[88:89], v[108:109]
    v_pk_fma_f32 v[78:79], v[78:79], v[90:91], v[110:111]
    v_cvt_pk_bf16_f32 v206, v76, v77
    v_cvt_pk_bf16_f32 v207, v78, v79
    v_mfma_f32_16x16x32_bf16 v[28:31], v[188:191], v[196:199], 0
    v_mfma_f32_16x16x32_bf16 v[32:35], v[188:191], v[200:203], 0
    v_mfma_f32_16x16x32_bf16 v[36:39], v[188:191], v[204:207], 0
    v_mfma_f32_16x16x32_bf16 v[40:43], v[188:191], v[136:139], 0
    v_mfma_f32_16x16x32_bf16 v[44:47], v[192:195], v[196:199], 0
    v_mfma_f32_16x16x32_bf16 v[60:63], v[192:195], v[200:203], 0
    v_mfma_f32_16x16x32_bf16 v[64:67], v[192:195], v[204:207], 0
    v_mfma_f32_16x16x32_bf16 v[68:71], v[192:195], v[136:139], 0
    v_mfma_f32_16x16x32_bf16 v[72:75], v[196:199], v[196:199], 0
    v_mfma_f32_16x16x32_bf16 v[76:79], v[196:199], v[200:203], 0
    v_mfma_f32_16x16x32_bf16 v[112:115], v[196:199], v[204:207], 0
    v_mfma_f32_16x16x32_bf16 v[80:83], v[196:199], v[136:139], 0
    s_barrier
    ds_write_b128 v145, v[28:31] offset:0
    ds_write_b128 v145, v[32:35] offset:1024
    ds_write_b128 v145, v[36:39] offset:2048
    ds_write_b128 v145, v[40:43] offset:3072
    ds_write_b128 v145, v[44:47] offset:4096
    ds_write_b128 v145, v[60:63] offset:5120
    ds_write_b128 v145, v[64:67] offset:6144
    ds_write_b128 v145, v[68:71] offset:7168
    ds_write_b128 v145, v[72:75] offset:8192
    ds_write_b128 v145, v[76:79] offset:9216
    ds_write_b128 v145, v[112:115] offset:10240
    ds_write_b128 v145, v[80:83] offset:11264
    s_waitcnt lgkmcnt(0)
    s_barrier
    ds_read_b32 v188, v149 offset:8192
    ds_read_b32 v189, v149 offset:20480
    ds_read_b32 v190, v149 offset:32768
    ds_read_b32 v191, v149 offset:45056
    ds_read_b32 v192, v150 offset:8192
    ds_read_b32 v193, v150 offset:20480
    ds_read_b32 v194, v150 offset:32768
    ds_read_b32 v195, v150 offset:45056
    ds_read_b32 v196, v151 offset:8192
    ds_read_b32 v197, v151 offset:20480
    ds_read_b32 v198, v151 offset:32768
    ds_read_b32 v199, v151 offset:45056
    s_waitcnt lgkmcnt(8)
    v_add_f32 v188, v188, v189
    v_add_f32 v190, v190, v191
    v_add_f32 v188, v188, v190
    v_min_u32 v188, -2, v188
    buffer_store_dword v188, v152, s[20:23], s68 offen sc1
    s_waitcnt lgkmcnt(4)
    v_add_f32 v192, v192, v193
    v_add_f32 v194, v194, v195
    v_add_f32 v192, v192, v194
    v_min_u32 v192, -2, v192
    buffer_store_dword v192, v153, s[20:23], s68 offen sc1
    s_waitcnt lgkmcnt(0)
    v_add_f32 v196, v196, v197
    v_add_f32 v198, v198, v199
    v_add_f32 v196, v196, v198
    v_min_u32 v196, -2, v196
    v_mov_b32 v125, 0
    v_cndmask_b32 v196, v196, v125, s[64:65]
    buffer_store_dword v196, v154, s[20:23], s68 offen sc1
    s_mov_b32 s80, s8
    s_and_b32 s81, s9, 0xffff
    s_mov_b32 s82, 8388608
    s_mov_b32 s83, 0x20000
    v_lshlrev_b32 v146, 7, v0
    s_lshl_b32 s38, s2, 15
    s_lshl_b32 s39, s3, 30
    s_or_b32 s38, s38, s39
    buffer_load_dword v208, v146, s[80:83], s38 offen
    s_mov_b32 s84, s32
    s_and_b32 s85, s33, 0xffff
    s_mov_b32 s86, L_p4-L_pc0
    s_mov_b32 s87, 0x20000
    s_add_u32 s88, s34, L_p2-L_pc0
    buffer_load_dword v12, v11, s[84:87], s88 offen
    v_mfma_f32_16x16x32_bf16 v[16:19], a[152:155], a[0:3], 0
    ds_read_b128 a[144:147], v130 offset:32768
    v_mfma_f32_16x16x32_bf16 v[48:51], a[152:155], a[72:75], 0
    v_mfma_f32_16x16x32_bf16 v[20:23], a[156:159], a[0:3], 0
    ds_read_b128 a[148:151], v130 offset:33792
    v_mfma_f32_16x16x32_bf16 v[52:55], a[156:159], a[72:75], 0
    v_mfma_f32_16x16x32_bf16 v[24:27], a[160:163], a[0:3], 0
    ds_read_b128 a[152:155], v130 offset:34816
    v_mfma_f32_16x16x32_bf16 v[56:59], a[160:163], a[72:75], 0
    v_mfma_f32_16x16x32_bf16 v[16:19], a[164:167], a[4:7], v[16:19]
    ds_read_b128 a[156:159], v130 offset:35840
    v_mfma_f32_16x16x32_bf16 v[48:51], a[164:167], a[76:79], v[48:51]
    v_mfma_f32_16x16x32_bf16 v[20:23], a[168:171], a[4:7], v[20:23]
    ds_read_b128 a[160:163], v130 offset:36864
    v_mfma_f32_16x16x32_bf16 v[52:55], a[168:171], a[76:79], v[52:55]
    v_mfma_f32_16x16x32_bf16 v[24:27], a[172:175], a[4:7], v[24:27]
    ds_read_b128 a[164:167], v130 offset:37888
    v_mfma_f32_16x16x32_bf16 v[56:59], a[172:175], a[76:79], v[56:59]
    s_waitcnt lgkmcnt(5)
    v_mfma_f32_16x16x32_bf16 v[16:19], a[144:147], a[8:11], v[16:19]
    ds_read_b128 a[168:171], v130 offset:38912
    v_mfma_f32_16x16x32_bf16 v[48:51], a[144:147], a[80:83], v[48:51]
    s_waitcnt lgkmcnt(5)
    v_mfma_f32_16x16x32_bf16 v[20:23], a[148:151], a[8:11], v[20:23]
    ds_read_b128 a[172:175], v130 offset:39936
    v_mfma_f32_16x16x32_bf16 v[52:55], a[148:151], a[80:83], v[52:55]
    s_waitcnt lgkmcnt(5)
    v_mfma_f32_16x16x32_bf16 v[24:27], a[152:155], a[8:11], v[24:27]
    ds_read_b128 a[144:147], v130 offset:40960
    v_mfma_f32_16x16x32_bf16 v[56:59], a[152:155], a[80:83], v[56:59]
    s_waitcnt lgkmcnt(5)
    v_mfma_f32_16x16x32_bf16 v[16:19], a[156:159], a[12:15], v[16:19]
    ds_read_b128 a[148:151], v130 offset:41984
    v_mfma_f32_16x16x32_bf16 v[48:51], a[156:159], a[84:87], v[48:51]
    s_waitcnt lgkmcnt(5)
    v_mfma_f32_16x16x32_bf16 v[20:23], a[160:163], a[12:15], v[20:23]
    ds_read_b128 a[152:155], v130 offset:43008
    v_mfma_f32_16x16x32_bf16 v[52:55], a[160:163], a[84:87], v[52:55]
    s_waitcnt lgkmcnt(5)
    v_mfma_f32_16x16x32_bf16 v[24:27], a[164:167], a[12:15], v[24:27]
    ds_read_b128 a[156:159], v130 offset:44032
    v_mfma_f32_16x16x32_bf16 v[56:59], a[164:167], a[84:87], v[56:59]
    s_waitcnt lgkmcnt(5)
    v_mfma_f32_16x16x32_bf16 v[16:19], a[168:171], a[16:19], v[16:19]
    ds_read_b128 a[160:163], v130 offset:45056
    v_mfma_f32_16x16x32_bf16 v[48:51], a[168:171], a[88:91], v[48:51]
    s_waitcnt lgkmcnt(5)
    v_mfma_f32_16x16x32_bf16 v[20:23], a[172:175], a[16:19], v[20:23]
    ds_read_b128 a[164:167], v130 offset:46080
    v_mfma_f32_16x16x32_bf16 v[52:55], a[172:175], a[88:91], v[52:55]
    s_waitcnt lgkmcnt(5)
    v_mfma_f32_16x16x32_bf16 v[24:27], a[144:147], a[16:19], v[24:27]
    ds_read_b128 a[168:171], v130 offset:47104
    v_mfma_f32_16x16x32_bf16 v[56:59], a[144:147], a[88:91], v[56:59]
    s_waitcnt lgkmcnt(5)
    v_mfma_f32_16x16x32_bf16 v[16:19], a[148:151], a[20:23], v[16:19]
    ds_read_b128 a[172:175], v130 offset:48128
    v_mfma_f32_16x16x32_bf16 v[48:51], a[148:151], a[92:95], v[48:51]
    s_waitcnt lgkmcnt(5)
    v_mfma_f32_16x16x32_bf16 v[20:23], a[152:155], a[20:23], v[20:23]
    v_mfma_f32_16x16x32_bf16 v[52:55], a[152:155], a[92:95], v[52:55]
    s_waitcnt vmcnt(9)
    s_barrier
    ds_read_b128 a[144:147], v130 offset:49152
    s_waitcnt lgkmcnt(5)
    v_mfma_f32_16x16x32_bf16 v[24:27], a[156:159], a[20:23], v[24:27]
    ds_read_b128 a[148:151], v130 offset:50176
    v_mfma_f32_16x16x32_bf16 v[56:59], a[156:159], a[92:95], v[56:59]
    s_waitcnt lgkmcnt(5)
    v_mfma_f32_16x16x32_bf16 v[16:19], a[160:163], a[24:27], v[16:19]
    ds_read_b128 a[152:155], v130 offset:51200
    v_mfma_f32_16x16x32_bf16 v[48:51], a[160:163], a[96:99], v[48:51]
    s_waitcnt lgkmcnt(5)
    v_mfma_f32_16x16x32_bf16 v[20:23], a[164:167], a[24:27], v[20:23]
    ds_read_b128 a[156:159], v130 offset:52224
    v_mfma_f32_16x16x32_bf16 v[52:55], a[164:167], a[96:99], v[52:55]
    s_waitcnt lgkmcnt(5)
    v_mfma_f32_16x16x32_bf16 v[24:27], a[168:171], a[24:27], v[24:27]
    ds_read_b128 a[160:163], v130 offset:53248
    v_mfma_f32_16x16x32_bf16 v[56:59], a[168:171], a[96:99], v[56:59]
    s_waitcnt lgkmcnt(5)
    v_mfma_f32_16x16x32_bf16 v[16:19], a[172:175], a[28:31], v[16:19]
    ds_read_b128 a[164:167], v130 offset:54272
    v_mfma_f32_16x16x32_bf16 v[48:51], a[172:175], a[100:103], v[48:51]
    s_waitcnt lgkmcnt(5)
    v_mfma_f32_16x16x32_bf16 v[20:23], a[144:147], a[28:31], v[20:23]
    ds_read_b128 a[168:171], v130 offset:55296
    v_mfma_f32_16x16x32_bf16 v[52:55], a[144:147], a[100:103], v[52:55]
    s_waitcnt lgkmcnt(5)
    v_mfma_f32_16x16x32_bf16 v[24:27], a[148:151], a[28:31], v[24:27]
    ds_read_b128 a[172:175], v130 offset:56320
    v_mfma_f32_16x16x32_bf16 v[56:59], a[148:151], a[100:103], v[56:59]
    s_waitcnt lgkmcnt(5)
    v_mfma_f32_16x16x32_bf16 v[16:19], a[152:155], a[32:35], v[16:19]
    ds_read_b128 a[144:147], v130 offset:57344
    v_mfma_f32_16x16x32_bf16 v[48:51], a[152:155], a[104:107], v[48:51]
    s_waitcnt lgkmcnt(5)
    v_mfma_f32_16x16x32_bf16 v[20:23], a[156:159], a[32:35], v[20:23]
    ds_read_b128 a[148:151], v130 offset:58368
    v_mfma_f32_16x16x32_bf16 v[52:55], a[156:159], a[104:107], v[52:55]
    s_waitcnt lgkmcnt(5)
    v_mfma_f32_16x16x32_bf16 v[24:27], a[160:163], a[32:35], v[24:27]
    ds_read_b128 a[152:155], v130 offset:59392
    v_mfma_f32_16x16x32_bf16 v[56:59], a[160:163], a[104:107], v[56:59]
    s_waitcnt lgkmcnt(5)
    v_mfma_f32_16x16x32_bf16 v[16:19], a[164:167], a[36:39], v[16:19]
    ds_read_b128 a[156:159], v130 offset:60416
    v_mfma_f32_16x16x32_bf16 v[48:51], a[164:167], a[108:111], v[48:51]
    s_waitcnt lgkmcnt(5)
    v_mfma_f32_16x16x32_bf16 v[20:23], a[168:171], a[36:39], v[20:23]
    ds_read_b128 a[160:163], v130 offset:61440
    v_mfma_f32_16x16x32_bf16 v[52:55], a[168:171], a[108:111], v[52:55]
    s_waitcnt lgkmcnt(5)
    v_mfma_f32_16x16x32_bf16 v[24:27], a[172:175], a[36:39], v[24:27]
    ds_read_b128 a[164:167], v130 offset:62464
    v_mfma_f32_16x16x32_bf16 v[56:59], a[172:175], a[108:111], v[56:59]
    s_waitcnt lgkmcnt(5)
    v_mfma_f32_16x16x32_bf16 v[16:19], a[144:147], a[40:43], v[16:19]
    ds_read_b128 a[168:171], v130 offset:63488
    v_mfma_f32_16x16x32_bf16 v[48:51], a[144:147], a[112:115], v[48:51]
    s_waitcnt lgkmcnt(5)
    v_mfma_f32_16x16x32_bf16 v[20:23], a[148:151], a[40:43], v[20:23]
    ds_read_b128 a[172:175], v130 offset:64512
    v_mfma_f32_16x16x32_bf16 v[52:55], a[148:151], a[112:115], v[52:55]
    s_waitcnt lgkmcnt(5)
    v_mfma_f32_16x16x32_bf16 v[24:27], a[152:155], a[40:43], v[24:27]
    v_mfma_f32_16x16x32_bf16 v[56:59], a[152:155], a[112:115], v[56:59]
    s_waitcnt vmcnt(5)
    s_barrier
    ds_read_b128 a[144:147], v131 offset:0
    s_waitcnt lgkmcnt(5)
    v_mfma_f32_16x16x32_bf16 v[16:19], a[156:159], a[44:47], v[16:19]
    ds_read_b128 a[148:151], v131 offset:1024
    v_mfma_f32_16x16x32_bf16 v[48:51], a[156:159], a[116:119], v[48:51]
    s_waitcnt lgkmcnt(5)
    v_mfma_f32_16x16x32_bf16 v[20:23], a[160:163], a[44:47], v[20:23]
    ds_read_b128 a[152:155], v131 offset:2048
    v_mfma_f32_16x16x32_bf16 v[52:55], a[160:163], a[116:119], v[52:55]
    s_waitcnt lgkmcnt(5)
    v_mfma_f32_16x16x32_bf16 v[24:27], a[164:167], a[44:47], v[24:27]
    ds_read_b128 a[156:159], v131 offset:3072
    v_mfma_f32_16x16x32_bf16 v[56:59], a[164:167], a[116:119], v[56:59]
    s_waitcnt lgkmcnt(5)
    v_mfma_f32_16x16x32_bf16 v[16:19], a[168:171], a[48:51], v[16:19]
    ds_read_b128 a[160:163], v131 offset:4096
    v_mfma_f32_16x16x32_bf16 v[48:51], a[168:171], a[120:123], v[48:51]
    s_waitcnt lgkmcnt(5)
    v_mfma_f32_16x16x32_bf16 v[20:23], a[172:175], a[48:51], v[20:23]
    ds_read_b128 a[164:167], v131 offset:5120
    v_mfma_f32_16x16x32_bf16 v[52:55], a[172:175], a[120:123], v[52:55]
    s_waitcnt lgkmcnt(5)
    v_mfma_f32_16x16x32_bf16 v[24:27], a[144:147], a[48:51], v[24:27]
    ds_read_b128 a[168:171], v131 offset:6144
    v_mfma_f32_16x16x32_bf16 v[56:59], a[144:147], a[120:123], v[56:59]
    s_waitcnt lgkmcnt(5)
    v_mfma_f32_16x16x32_bf16 v[16:19], a[148:151], a[52:55], v[16:19]
    ds_read_b128 a[172:175], v131 offset:7168
    v_mfma_f32_16x16x32_bf16 v[48:51], a[148:151], a[124:127], v[48:51]
    s_waitcnt lgkmcnt(5)
    v_mfma_f32_16x16x32_bf16 v[20:23], a[152:155], a[52:55], v[20:23]
    ds_read_b128 a[144:147], v131 offset:8192
    v_mfma_f32_16x16x32_bf16 v[52:55], a[152:155], a[124:127], v[52:55]
    s_waitcnt lgkmcnt(5)
    v_mfma_f32_16x16x32_bf16 v[24:27], a[156:159], a[52:55], v[24:27]
    ds_read_b128 a[148:151], v131 offset:9216
    v_mfma_f32_16x16x32_bf16 v[56:59], a[156:159], a[124:127], v[56:59]
    s_waitcnt lgkmcnt(5)
    v_mfma_f32_16x16x32_bf16 v[16:19], a[160:163], a[56:59], v[16:19]
    ds_read_b128 a[152:155], v131 offset:10240
    v_mfma_f32_16x16x32_bf16 v[48:51], a[160:163], a[128:131], v[48:51]
    s_waitcnt lgkmcnt(5)
    v_mfma_f32_16x16x32_bf16 v[20:23], a[164:167], a[56:59], v[20:23]
    ds_read_b128 a[156:159], v131 offset:11264
    v_mfma_f32_16x16x32_bf16 v[52:55], a[164:167], a[128:131], v[52:55]
    s_waitcnt lgkmcnt(5)
    v_mfma_f32_16x16x32_bf16 v[24:27], a[168:171], a[56:59], v[24:27]
    ds_read_b128 a[160:163], v131 offset:12288
    v_mfma_f32_16x16x32_bf16 v[56:59], a[168:171], a[128:131], v[56:59]
    s_waitcnt lgkmcnt(5)
    v_mfma_f32_16x16x32_bf16 v[16:19], a[172:175], a[60:63], v[16:19]
    ds_read_b128 a[164:167], v131 offset:13312
    v_mfma_f32_16x16x32_bf16 v[48:51], a[172:175], a[132:135], v[48:51]
    s_waitcnt lgkmcnt(5)
    v_mfma_f32_16x16x32_bf16 v[20:23], a[144:147], a[60:63], v[20:23]
    ds_read_b128 a[168:171], v131 offset:14336
    v_mfma_f32_16x16x32_bf16 v[52:55], a[144:147], a[132:135], v[52:55]
    s_waitcnt lgkmcnt(5)
    v_mfma_f32_16x16x32_bf16 v[24:27], a[148:151], a[60:63], v[24:27]
    ds_read_b128 a[172:175], v131 offset:15360
    v_mfma_f32_16x16x32_bf16 v[56:59], a[148:151], a[132:135], v[56:59]
    s_waitcnt lgkmcnt(5)
    v_mfma_f32_16x16x32_bf16 v[16:19], a[152:155], a[64:67], v[16:19]
    v_mfma_f32_16x16x32_bf16 v[48:51], a[152:155], a[136:139], v[48:51]
    s_waitcnt lgkmcnt(4)
    v_mfma_f32_16x16x32_bf16 v[20:23], a[156:159], a[64:67], v[20:23]
    v_mfma_f32_16x16x32_bf16 v[52:55], a[156:159], a[136:139], v[52:55]
    s_waitcnt lgkmcnt(3)
    v_mfma_f32_16x16x32_bf16 v[24:27], a[160:163], a[64:67], v[24:27]
    v_mfma_f32_16x16x32_bf16 v[56:59], a[160:163], a[136:139], v[56:59]
    s_waitcnt lgkmcnt(2)
    v_mfma_f32_16x16x32_bf16 v[16:19], a[164:167], a[68:71], v[16:19]
    v_mfma_f32_16x16x32_bf16 v[48:51], a[164:167], a[140:143], v[48:51]
    s_waitcnt lgkmcnt(1)
    v_mfma_f32_16x16x32_bf16 v[20:23], a[168:171], a[68:71], v[20:23]
    v_mfma_f32_16x16x32_bf16 v[52:55], a[168:171], a[140:143], v[52:55]
    s_waitcnt lgkmcnt(0)
    v_mfma_f32_16x16x32_bf16 v[24:27], a[172:175], a[68:71], v[24:27]
    v_mfma_f32_16x16x32_bf16 v[56:59], a[172:175], a[140:143], v[56:59]
    ds_read_b128 v[84:87], v143 offset:0
    ds_read_b128 v[88:91], v143 offset:64
    ds_read_b128 v[92:95], v143 offset:128
    s_add_u32 s41, s67, 0
    buffer_load_dwordx4 v[28:31], v159, s[20:23], s41 offen sc1
    s_add_u32 s41, s67, 2816
    buffer_load_dwordx4 v[32:35], v159, s[20:23], s41 offen sc1
    s_add_u32 s41, s67, 5632
    buffer_load_dwordx4 v[36:39], v159, s[20:23], s41 offen sc1
    s_add_u32 s41, s67, 8448
    buffer_load_dwordx4 v[40:43], v159, s[20:23], s41 offen sc1
    s_add_u32 s41, s67, 11264
    buffer_load_dwordx4 v[44:47], v159, s[20:23], s41 offen sc1
    s_add_u32 s41, s67, 14080
    buffer_load_dwordx4 v[60:63], v159, s[20:23], s41 offen sc1
    s_add_u32 s41, s67, 16896
    buffer_load_dwordx4 v[64:67], v159, s[20:23], s41 offen sc1
    s_add_u32 s41, s67, 19712
    buffer_load_dwordx4 v[68:71], v159, s[20:23], s41 offen sc1
    s_add_u32 s41, s67, 22528
    buffer_load_dwordx4 v[72:75], v159, s[20:23], s41 offen sc1
    s_add_u32 s41, s67, 25344
    buffer_load_dwordx4 v[76:79], v159, s[20:23], s41 offen sc1
    s_add_u32 s41, s67, 28160
    buffer_load_dwordx4 v[80:83], v159, s[20:23], s41 offen sc1
    s_add_u32 s41, s67, 30976
    buffer_load_dwordx4 v[112:115], v159, s[20:23], s41 offen sc1
    s_add_u32 s41, s67, 33792
    buffer_load_dwordx4 v[96:99], v159, s[20:23], s41 offen sc1
    s_add_u32 s41, s67, 36608
    buffer_load_dwordx4 v[100:103], v159, s[20:23], s41 offen sc1
    s_add_u32 s41, s67, 39424
    buffer_load_dwordx4 v[116:119], v159, s[20:23], s41 offen sc1
    s_add_u32 s41, s67, 42240
    buffer_load_dwordx4 v[120:123], v159, s[20:23], s41 offen sc1
    v_mov_b32 v200, v172
    v_mov_b32 v202, v173
    v_mov_b32 v201, v172
    v_mov_b32 v203, v173
    v_mov_b32 v204, v174
    v_mov_b32 v206, v175
    v_mov_b32 v205, v174
    v_mov_b32 v207, v175
    s_waitcnt lgkmcnt(0)
    v_pk_mul_f32 v[108:109], v[202:203], v[84:85]
    v_pk_mul_f32 v[110:111], v[202:203], v[86:87]
    v_pk_fma_f32 v[16:17], v[16:17], v[200:201], v[108:109]
    v_pk_fma_f32 v[18:19], v[18:19], v[200:201], v[110:111]
    v_min_f32 v104, 0, v16
    v_min_f32 v105, 0, v17
    v_min_f32 v106, 0, v18
    v_min_f32 v107, 0, v19
    v_pk_mul_f32 v[104:105], v[104:105], v[168:169]
    v_pk_mul_f32 v[106:107], v[106:107], v[168:169]
    v_exp_f32 v104, v104
    v_exp_f32 v105, v105
    v_exp_f32 v106, v106
    v_exp_f32 v107, v107
    v_max_f32 v108, 0, v16
    v_max_f32 v109, 0, v17
    v_max_f32 v110, 0, v18
    v_max_f32 v111, 0, v19
    v_pk_add_f32 v[104:105], v[104:105], v[108:109]
    v_pk_add_f32 v[106:107], v[106:107], v[110:111]
    v_pk_add_f32 v[16:17], v[104:105], v[170:171]
    v_pk_add_f32 v[18:19], v[106:107], v[170:171]
    v_pk_mul_f32 v[108:109], v[206:207], v[84:85]
    v_pk_mul_f32 v[110:111], v[206:207], v[86:87]
    v_pk_fma_f32 v[48:49], v[48:49], v[204:205], v[108:109]
    v_pk_fma_f32 v[50:51], v[50:51], v[204:205], v[110:111]
    v_min_f32 v104, 0, v48
    v_min_f32 v105, 0, v49
    v_min_f32 v106, 0, v50
    v_min_f32 v107, 0, v51
    v_pk_mul_f32 v[104:105], v[104:105], v[168:169]
    v_pk_mul_f32 v[106:107], v[106:107], v[168:169]
    v_exp_f32 v104, v104
    v_exp_f32 v105, v105
    v_exp_f32 v106, v106
    v_exp_f32 v107, v107
    v_max_f32 v108, 0, v48
    v_max_f32 v109, 0, v49
    v_max_f32 v110, 0, v50
    v_max_f32 v111, 0, v51
    v_pk_add_f32 v[104:105], v[104:105], v[108:109]
    v_pk_add_f32 v[106:107], v[106:107], v[110:111]
    v_pk_add_f32 v[48:49], v[104:105], v[170:171]
    v_pk_add_f32 v[50:51], v[106:107], v[170:171]
    v_pk_mul_f32 v[108:109], v[202:203], v[88:89]
    v_pk_mul_f32 v[110:111], v[202:203], v[90:91]
    v_pk_fma_f32 v[20:21], v[20:21], v[200:201], v[108:109]
    v_pk_fma_f32 v[22:23], v[22:23], v[200:201], v[110:111]
    v_min_f32 v104, 0, v20
    v_min_f32 v105, 0, v21
    v_min_f32 v106, 0, v22
    v_min_f32 v107, 0, v23
    v_pk_mul_f32 v[104:105], v[104:105], v[168:169]
    v_pk_mul_f32 v[106:107], v[106:107], v[168:169]
    v_exp_f32 v104, v104
    v_exp_f32 v105, v105
    v_exp_f32 v106, v106
    v_exp_f32 v107, v107
    v_max_f32 v108, 0, v20
    v_max_f32 v109, 0, v21
    v_max_f32 v110, 0, v22
    v_max_f32 v111, 0, v23
    v_pk_add_f32 v[104:105], v[104:105], v[108:109]
    v_pk_add_f32 v[106:107], v[106:107], v[110:111]
    v_pk_add_f32 v[20:21], v[104:105], v[170:171]
    v_pk_add_f32 v[22:23], v[106:107], v[170:171]
    v_pk_mul_f32 v[108:109], v[206:207], v[88:89]
    v_pk_mul_f32 v[110:111], v[206:207], v[90:91]
    v_pk_fma_f32 v[52:53], v[52:53], v[204:205], v[108:109]
    v_pk_fma_f32 v[54:55], v[54:55], v[204:205], v[110:111]
    v_min_f32 v104, 0, v52
    v_min_f32 v105, 0, v53
    v_min_f32 v106, 0, v54
    v_min_f32 v107, 0, v55
    v_pk_mul_f32 v[104:105], v[104:105], v[168:169]
    v_pk_mul_f32 v[106:107], v[106:107], v[168:169]
    v_exp_f32 v104, v104
    v_exp_f32 v105, v105
    v_exp_f32 v106, v106
    v_exp_f32 v107, v107
    v_max_f32 v108, 0, v52
    v_max_f32 v109, 0, v53
    v_max_f32 v110, 0, v54
    v_max_f32 v111, 0, v55
    v_pk_add_f32 v[104:105], v[104:105], v[108:109]
    v_pk_add_f32 v[106:107], v[106:107], v[110:111]
    v_pk_add_f32 v[52:53], v[104:105], v[170:171]
    v_pk_add_f32 v[54:55], v[106:107], v[170:171]
    v_pk_mul_f32 v[108:109], v[202:203], v[92:93]
    v_pk_mul_f32 v[110:111], v[202:203], v[94:95]
    v_pk_fma_f32 v[24:25], v[24:25], v[200:201], v[108:109]
    v_pk_fma_f32 v[26:27], v[26:27], v[200:201], v[110:111]
    v_min_f32 v104, 0, v24
    v_min_f32 v105, 0, v25
    v_min_f32 v106, 0, v26
    v_min_f32 v107, 0, v27
    v_pk_mul_f32 v[104:105], v[104:105], v[168:169]
    v_pk_mul_f32 v[106:107], v[106:107], v[168:169]
    v_exp_f32 v104, v104
    v_exp_f32 v105, v105
    v_exp_f32 v106, v106
    v_exp_f32 v107, v107
    v_max_f32 v108, 0, v24
    v_max_f32 v109, 0, v25
    v_max_f32 v110, 0, v26
    v_max_f32 v111, 0, v27
    v_pk_add_f32 v[104:105], v[104:105], v[108:109]
    v_pk_add_f32 v[106:107], v[106:107], v[110:111]
    v_pk_add_f32 v[24:25], v[104:105], v[170:171]
    v_pk_add_f32 v[26:27], v[106:107], v[170:171]
    v_pk_mul_f32 v[108:109], v[206:207], v[92:93]
    v_pk_mul_f32 v[110:111], v[206:207], v[94:95]
    v_pk_fma_f32 v[56:57], v[56:57], v[204:205], v[108:109]
    v_pk_fma_f32 v[58:59], v[58:59], v[204:205], v[110:111]
    v_min_f32 v104, 0, v56
    v_min_f32 v105, 0, v57
    v_min_f32 v106, 0, v58
    v_min_f32 v107, 0, v59
    v_pk_mul_f32 v[104:105], v[104:105], v[168:169]
    v_pk_mul_f32 v[106:107], v[106:107], v[168:169]
    v_exp_f32 v104, v104
    v_exp_f32 v105, v105
    v_exp_f32 v106, v106
    v_exp_f32 v107, v107
    v_max_f32 v108, 0, v56
    v_max_f32 v109, 0, v57
    v_max_f32 v110, 0, v58
    v_max_f32 v111, 0, v59
    v_pk_add_f32 v[104:105], v[104:105], v[108:109]
    v_pk_add_f32 v[106:107], v[106:107], v[110:111]
    v_pk_add_f32 v[56:57], v[104:105], v[170:171]
    v_pk_add_f32 v[58:59], v[106:107], v[170:171]
    s_mov_b32 s24, 0
    s_waitcnt vmcnt(0)
    s_nop 10
mega_chk6:
    v_max3_u32 v124, v28, v29, v30
    v_max_u32 v124, v31, v124
    v_max3_u32 v124, v32, v33, v124
    v_max3_u32 v124, v34, v35, v124
    v_max3_u32 v124, v36, v37, v124
    v_max3_u32 v124, v38, v39, v124
    v_max3_u32 v124, v40, v41, v124
    v_max3_u32 v124, v42, v43, v124
    v_max3_u32 v124, v44, v45, v124
    v_max3_u32 v124, v46, v47, v124
    v_max3_u32 v124, v60, v61, v124
    v_max3_u32 v124, v62, v63, v124
    v_max3_u32 v124, v64, v65, v124
    v_max3_u32 v124, v66, v67, v124
    v_max3_u32 v124, v68, v69, v124
    v_max3_u32 v124, v70, v71, v124
    v_max3_u32 v124, v72, v73, v124
    v_max3_u32 v124, v74, v75, v124
    v_max3_u32 v124, v76, v77, v124
    v_max3_u32 v124, v78, v79, v124
    v_max3_u32 v124, v80, v81, v124
    v_max3_u32 v124, v82, v83, v124
    v_max3_u32 v124, v112, v113, v124
    v_max3_u32 v124, v114, v115, v124
    v_max3_u32 v124, v96, v97, v124
    v_max3_u32 v124, v98, v99, v124
    v_max3_u32 v124, v100, v101, v124
    v_max3_u32 v124, v102, v103, v124
    v_max3_u32 v124, v116, v117, v124
    v_max3_u32 v124, v118, v119, v124
    v_max3_u32 v124, v120, v121, v124
    v_max3_u32 v124, v122, v123, v124
    v_cmp_eq_u32 vcc, -1, v124
    s_add_u32 s24, s24, 1
    s_nop 3
    s_cbranch_vccz mega_ok7
    s_cmp_ge_u32 s24, 262144
    s_cbranch_scc1 mega_ok7
    s_sleep 2
    s_add_u32 s41, s67, 0
    buffer_load_dwordx4 v[28:31], v159, s[20:23], s41 offen sc1
    s_add_u32 s41, s67, 2816
    buffer_load_dwordx4 v[32:35], v159, s[20:23], s41 offen sc1
    s_add_u32 s41, s67, 5632
    buffer_load_dwordx4 v[36:39], v159, s[20:23], s41 offen sc1
    s_add_u32 s41, s67, 8448
    buffer_load_dwordx4 v[40:43], v159, s[20:23], s41 offen sc1
    s_add_u32 s41, s67, 11264
    buffer_load_dwordx4 v[44:47], v159, s[20:23], s41 offen sc1
    s_add_u32 s41, s67, 14080
    buffer_load_dwordx4 v[60:63], v159, s[20:23], s41 offen sc1
    s_add_u32 s41, s67, 16896
    buffer_load_dwordx4 v[64:67], v159, s[20:23], s41 offen sc1
    s_add_u32 s41, s67, 19712
    buffer_load_dwordx4 v[68:71], v159, s[20:23], s41 offen sc1
    s_add_u32 s41, s67, 22528
    buffer_load_dwordx4 v[72:75], v159, s[20:23], s41 offen sc1
    s_add_u32 s41, s67, 25344
    buffer_load_dwordx4 v[76:79], v159, s[20:23], s41 offen sc1
    s_add_u32 s41, s67, 28160
    buffer_load_dwordx4 v[80:83], v159, s[20:23], s41 offen sc1
    s_add_u32 s41, s67, 30976
    buffer_load_dwordx4 v[112:115], v159, s[20:23], s41 offen sc1
    s_add_u32 s41, s67, 33792
    buffer_load_dwordx4 v[96:99], v159, s[20:23], s41 offen sc1
    s_add_u32 s41, s67, 36608
    buffer_load_dwordx4 v[100:103], v159, s[20:23], s41 offen sc1
    s_add_u32 s41, s67, 39424
    buffer_load_dwordx4 v[116:119], v159, s[20:23], s41 offen sc1
    s_add_u32 s41, s67, 42240
    buffer_load_dwordx4 v[120:123], v159, s[20:23], s41 offen sc1
    s_waitcnt vmcnt(0)
    s_branch mega_chk6
mega_ok7:
    v_pk_add_f32 v[28:29], v[28:29], v[32:33]
    v_pk_add_f32 v[30:31], v[30:31], v[34:35]
    v_pk_add_f32 v[28:29], v[28:29], v[36:37]
    v_pk_add_f32 v[30:31], v[30:31], v[38:39]
    v_pk_add_f32 v[28:29], v[28:29], v[40:41]
    v_pk_add_f32 v[30:31], v[30:31], v[42:43]
    v_pk_add_f32 v[28:29], v[28:29], v[44:45]
    v_pk_add_f32 v[30:31], v[30:31], v[46:47]
    v_pk_add_f32 v[28:29], v[28:29], v[60:61]
    v_pk_add_f32 v[30:31], v[30:31], v[62:63]
    v_pk_add_f32 v[28:29], v[28:29], v[64:65]
    v_pk_add_f32 v[30:31], v[30:31], v[66:67]
    v_pk_add_f32 v[28:29], v[28:29], v[68:69]
    v_pk_add_f32 v[30:31], v[30:31], v[70:71]
    v_pk_add_f32 v[28:29], v[28:29], v[72:73]
    v_pk_add_f32 v[30:31], v[30:31], v[74:75]
    v_pk_add_f32 v[28:29], v[28:29], v[76:77]
    v_pk_add_f32 v[30:31], v[30:31], v[78:79]
    v_pk_add_f32 v[28:29], v[28:29], v[80:81]
    v_pk_add_f32 v[30:31], v[30:31], v[82:83]
    v_pk_add_f32 v[28:29], v[28:29], v[112:113]
    v_pk_add_f32 v[30:31], v[30:31], v[114:115]
    v_pk_add_f32 v[28:29], v[28:29], v[96:97]
    v_pk_add_f32 v[30:31], v[30:31], v[98:99]
    v_pk_add_f32 v[28:29], v[28:29], v[100:101]
    v_pk_add_f32 v[30:31], v[30:31], v[102:103]
    v_pk_add_f32 v[28:29], v[28:29], v[116:117]
    v_pk_add_f32 v[30:31], v[30:31], v[118:119]
    v_pk_add_f32 v[28:29], v[28:29], v[120:121]
    v_pk_add_f32 v[30:31], v[30:31], v[122:123]
    v_cvt_pk_bf16_f32 v104, v28, v28
    ds_write_b16 v155, v104
    v_cvt_pk_bf16_f32 v105, v29, v29
    ds_write_b16 v156, v105
    v_cvt_pk_bf16_f32 v106, v30, v30
    ds_write_b16 v157, v106
    v_cvt_pk_bf16_f32 v107, v31, v31
    ds_write_b16 v158, v107
    ds_write_b128 v160, v[28:31]
    s_waitcnt lgkmcnt(0)
    s_barrier
    ds_read_b128 v[96:99], v143 offset:6144
    ds_read_b128 v[100:103], v143 offset:6208
    ds_read_b128 v[116:119], v161 offset:6144
    s_nop 11
    s_cmp_ge_u32 s35, 10
    s_cbranch_scc1 mega_skipM5
    ds_read_b128 v[32:35], v132 offset:2048
    ds_read_b128 v[36:39], v132 offset:3072
    ds_read_b128 v[40:43], v132 offset:4096
    ds_read_b128 v[44:47], v132 offset:5120
    s_waitcnt lgkmcnt(0)
    v_mfma_f32_16x16x32_bf16 v[64:67], v[32:35], a[176:179], 0
    v_mfma_f32_16x16x32_bf16 v[68:71], v[36:39], a[176:179], 0
    v_mfma_f32_16x16x32_bf16 v[72:75], v[40:43], a[180:183], 0
    v_mfma_f32_16x16x32_bf16 v[76:79], v[44:47], a[180:183], 0
    s_nop 4
    v_cvt_pk_bf16_f32 v80, v64, v65
    v_cvt_pk_bf16_f32 v81, v66, v67
    v_cvt_pk_bf16_f32 v112, v68, v69
    v_cvt_pk_bf16_f32 v113, v70, v71
    v_cvt_pk_bf16_f32 v82, v72, v73
    v_cvt_pk_bf16_f32 v83, v74, v75
    v_cvt_pk_bf16_f32 v114, v76, v77
    v_cvt_pk_bf16_f32 v115, v78, v79
    v_permlane16_swap_b32 v80, v82
    v_permlane16_swap_b32 v81, v83
    buffer_store_dwordx4 v[80:83], v164, s[20:23], s73 offen sc1
    buffer_store_dwordx4 v[112:115], v165, s[20:23], s73 offen sc1
    s_nop 9
mega_skipM5:
    s_waitcnt lgkmcnt(0)
    v_mov_b32 v109, 0
    v_mul_f32 v104, v16, v96
    v_fmac_f32 v104, v17, v97
    v_fmac_f32 v104, v18, v98
    v_fmac_f32 v104, v19, v99
    v_mul_f32 v105, v20, v100
    v_fmac_f32 v105, v21, v101
    v_fmac_f32 v105, v22, v102
    v_fmac_f32 v105, v23, v103
    v_mul_f32 v108, v24, v116
    v_fmac_f32 v108, v25, v117
    v_cndmask_b32 v110, v109, v108, s[70:71]
    v_cndmask_b32 v111, v108, v109, s[70:71]
    v_add_f32 v104, v104, v110
    v_add_f32 v105, v105, v111
    v_mul_f32 v106, v48, v96
    v_fmac_f32 v106, v49, v97
    v_fmac_f32 v106, v50, v98
    v_fmac_f32 v106, v51, v99
    v_mul_f32 v107, v52, v100
    v_fmac_f32 v107, v53, v101
    v_fmac_f32 v107, v54, v102
    v_fmac_f32 v107, v55, v103
    v_mul_f32 v108, v56, v116
    v_fmac_f32 v108, v57, v117
    v_cndmask_b32 v110, v109, v108, s[70:71]
    v_cndmask_b32 v111, v108, v109, s[70:71]
    v_add_f32 v106, v106, v110
    v_add_f32 v107, v107, v111
    v_mov_b32 v200, v104
    v_mov_b32 v201, v105
    v_mov_b32 v202, v106
    v_mov_b32 v203, v107
    v_permlane32_swap_b32 v104, v200
    v_permlane32_swap_b32 v105, v201
    v_permlane32_swap_b32 v106, v202
    v_permlane32_swap_b32 v107, v203
    v_add_f32 v104, v104, v200
    v_add_f32 v105, v105, v201
    v_add_f32 v106, v106, v202
    v_add_f32 v107, v107, v203
    v_mov_b32 v200, v104
    v_mov_b32 v201, v105
    v_mov_b32 v202, v106
    v_mov_b32 v203, v107
    v_permlane16_swap_b32 v104, v200
    v_permlane16_swap_b32 v105, v201
    v_permlane16_swap_b32 v106, v202
    v_permlane16_swap_b32 v107, v203
    v_add_f32 v104, v104, v200
    v_add_f32 v105, v105, v201
    v_add_f32 v106, v106, v202
    v_add_f32 v107, v107, v203
    v_add_f32 v104, 0x358637bd, v104
    v_add_f32 v105, 0x358637bd, v105
    v_add_f32 v106, 0x358637bd, v106
    v_add_f32 v107, 0x358637bd, v107
    v_rcp_f32 v104, v104
    v_rcp_f32 v105, v105
    v_rcp_f32 v106, v106
    v_rcp_f32 v107, v107
    v_mul_f32 v16, v16, v104
    v_mul_f32 v17, v17, v104
    v_mul_f32 v18, v18, v104
    v_mul_f32 v19, v19, v104
    v_cvt_pk_bf16_f32 v188, v16, v17
    v_cvt_pk_bf16_f32 v189, v18, v19
    v_mul_f32 v48, v48, v106
    v_mul_f32 v49, v49, v106
    v_mul_f32 v50, v50, v106
    v_mul_f32 v51, v51, v106
    v_cvt_pk_bf16_f32 v190, v48, v49
    v_cvt_pk_bf16_f32 v191, v50, v51
    s_nop 0
    v_permlane16_swap_b32 v188, v190
    v_permlane16_swap_b32 v189, v191
    buffer_store_dwordx4 v[188:191], v162, s[20:23], 0 offen offset:0 sc1
    v_mul_f32 v20, v20, v105
    v_mul_f32 v21, v21, v105
    v_mul_f32 v22, v22, v105
    v_mul_f32 v23, v23, v105
    v_cvt_pk_bf16_f32 v192, v20, v21
    v_cvt_pk_bf16_f32 v193, v22, v23
    v_mul_f32 v52, v52, v107
    v_mul_f32 v53, v53, v107
    v_mul_f32 v54, v54, v107
    v_mul_f32 v55, v55, v107
    v_cvt_pk_bf16_f32 v194, v52, v53
    v_cvt_pk_bf16_f32 v195, v54, v55
    s_nop 0
    v_permlane16_swap_b32 v192, v194
    v_permlane16_swap_b32 v193, v195
    buffer_store_dwordx4 v[192:195], v162, s[20:23], 0 offen offset:2048 sc1
    v_cndmask_b32 v108, v105, v104, s[70:71]
    v_mul_f32 v24, v24, v108
    v_mul_f32 v25, v25, v108
    v_mul_f32 v26, v26, v108
    v_mul_f32 v27, v27, v108
    v_cvt_pk_bf16_f32 v196, v24, v25
    v_cvt_pk_bf16_f32 v197, v26, v27
    s_mov_b32 s41, 4096
    buffer_store_dwordx2 v[196:197], v163, s[20:23], s41 offen sc1
    v_cndmask_b32 v108, v107, v106, s[70:71]
    v_mul_f32 v56, v56, v108
    v_mul_f32 v57, v57, v108
    v_mul_f32 v58, v58, v108
    v_mul_f32 v59, v59, v108
    v_cvt_pk_bf16_f32 v198, v56, v57
    v_cvt_pk_bf16_f32 v199, v58, v59
    s_mov_b32 s41, 24576
    buffer_store_dwordx2 v[198:199], v163, s[20:23], s41 offen sc1
    s_waitcnt vmcnt(4)
    buffer_store_dword v7, v167, s[20:23], s75 offen sc1
    s_waitcnt vmcnt(1)
    s_waitcnt lgkmcnt(0)
    s_barrier
    buffer_store_dword v7, v8, s[20:23], s76 offen sc1
L_p2:
    s_and_b32 s37, s2, 1
    s_lshl_b32 s35, s37, 3
    s_bfe_u32 s37, s2, 0x30003
    s_add_u32 s35, s35, s37
    s_bfe_u32 s37, s2, 0x20001
    s_lshl_b32 s36, s37, 2
    s_bfe_u32 s37, s2, 0x20006
    s_add_u32 s36, s36, s37
    s_mul_i32 s38, s36, 331776
    s_add_u32 s38, s38, 0
    s_mul_i32 s39, s4, 9216
    s_add_u32 s40, s38, s39
    s_add_u32 m0, s39, 4096
    s_add_u32 s41, s40, 0
    buffer_load_dwordx4 v5, s[16:19], s41 offen offset:0 sc1 lds
    s_and_b32 s44, s2, 3
    s_lshl_b32 s42, s44, 3
    s_bfe_u32 s44, s2, 0x30003
    s_add_u32 s42, s42, s44
    s_bfe_u32 s44, s2, 0x10002
    s_lshl_b32 s43, s44, 2
    buffer_load_dwordx4 v5, s[16:19], s41 offen offset:1024 sc1 lds
    s_lshr_b32 s44, s2, 6
    s_add_u32 s43, s43, s44
    v_lshlrev_b32 v15, 4, v4
    v_lshlrev_b32 v16, 3, v1
    s_mul_i32 s47, s4, 5120
    buffer_load_dwordx4 v5, s[16:19], s41 offen offset:2048 sc1 lds
    s_add_u32 s45, s4, 0
    s_and_b32 s45, s45, 3
    s_lshl_b32 s46, s42, 2
    s_add_u32 s45, s45, s46
    s_mul_i32 s45, s45, 20480
    buffer_load_dwordx4 v5, s[16:19], s41 offen offset:3072 sc1 lds
    s_add_u32 s45, s45, 3489792
    s_add_u32 s48, s45, s47
    s_add_u32 s45, s4, 1
    s_and_b32 s45, s45, 3
    s_lshl_b32 s46, s42, 2
    s_add_u32 s45, s45, s46
    s_add_u32 m0, s39, 8192
    s_add_u32 s41, s40, 4096
    buffer_load_dwordx4 v5, s[16:19], s41 offen offset:0 sc1 lds
    s_mul_i32 s45, s45, 20480
    s_add_u32 s45, s45, 3489792
    s_add_u32 s49, s45, s47
    s_add_u32 s45, s4, 2
    s_and_b32 s45, s45, 3
    buffer_load_dwordx4 v5, s[16:19], s41 offen offset:1024 sc1 lds
    s_lshl_b32 s46, s42, 2
    s_add_u32 s45, s45, s46
    s_mul_i32 s45, s45, 20480
    s_add_u32 s45, s45, 3489792
    s_add_u32 s50, s45, s47
    buffer_load_dwordx4 v5, s[16:19], s41 offen offset:2048 sc1 lds
    s_add_u32 s45, s4, 3
    s_and_b32 s45, s45, 3
    s_lshl_b32 s46, s42, 2
    s_add_u32 s45, s45, s46
    s_mul_i32 s45, s45, 20480
    s_add_u32 s45, s45, 3489792
    buffer_load_dwordx4 v5, s[16:19], s41 offen offset:3072 sc1 lds
    s_add_u32 s51, s45, s47
    s_mul_i32 s52, s43, 102400
    s_add_u32 s52, s52, s47
    s_add_u32 s52, s52, 6111232
    s_mul_i32 s53, s4, 320
    s_add_u32 m0, s39, 12288
    s_add_u32 s41, s40, 8192
    buffer_load_dwordx4 v5, s[16:19], s41 offen offset:0 sc1 lds
    s_add_u32 s53, s53, 6930432
    s_lshl_b32 s56, s42, 2
    s_add_u32 s56, s56, s4
    s_mul_i32 s56, s56, 18432
    s_mul_i32 s57, s43, 2304
    s_add_u32 m0, s39, 40960
    s_add_u32 s41, s40, 36864
    buffer_load_dwordx4 v5, s[16:19], s41 offen offset:0 sc1 lds
    s_add_u32 s56, s56, s57
    v_lshrrev_b32 v13, 1, v4
    v_lshlrev_b32 v14, 8, v13
    v_lshlrev_b32 v220, 4, v3
    v_add_u32 v220, v220, v14
    v_and_b32 v14, 1, v4
    buffer_load_dwordx4 v5, s[16:19], s41 offen offset:1024 sc1 lds
    v_lshlrev_b32 v14, 3, v14
    v_add_u32 v220, v220, v14
    v_add_u32 v220, s56, v220
    v_lshlrev_b32 v13, 30, v13
    v_or_b32 v221, v220, v13
    buffer_load_dwordx4 v5, s[16:19], s41 offen offset:2048 sc1 lds
    s_add_u32 s58, s4, 1
    s_and_b32 s58, s58, 3
    s_mul_i32 s58, s58, 15360
    s_add_u32 s58, s58, 98304
    v_add_u32 v222, s58, v5
    buffer_load_dwordx4 v5, s[16:19], s41 offen offset:3072 sc1 lds
    s_add_u32 s58, s4, 2
    s_and_b32 s58, s58, 3
    s_mul_i32 s58, s58, 15360
    s_add_u32 s58, s58, 103424
    v_add_u32 v223, s58, v5
    s_add_u32 s58, s4, 3
    s_add_u32 m0, s39, 45056
    s_add_u32 s41, s40, 40960
    buffer_load_dwordx4 v5, s[16:19], s41 offen offset:0 sc1 lds
    s_and_b32 s58, s58, 3
    s_mul_i32 s58, s58, 15360
    s_add_u32 s58, s58, 108544
    v_add_u32 v224, s58, v5
    s_mul_i32 s58, s4, 15360
    buffer_load_dwordx4 v5, s[16:19], s41 offen offset:1024 sc1 lds
    s_add_u32 s58, s58, 98304
    v_add_u32 v225, s58, v5
    s_mov_b32 s59, 999424
    s_mov_b32 s60, 6934528
    s_lshl_b32 s61, s42, 2
    buffer_load_dwordx4 v5, s[16:19], s41 offen offset:2048 sc1 lds
    s_add_u32 s61, s61, s4
    s_lshl_b32 s61, s61, 10
    s_lshl_b32 s62, s43, 3
    s_add_u32 s61, s61, s62
    s_add_u32 s61, s61, 9293824
    v_lshlrev_b32 v226, 6, v3
    buffer_load_dwordx4 v5, s[16:19], s41 offen offset:3072 sc1 lds
    v_lshlrev_b32 v227, 28, v4
    v_or_b32 v226, v226, v227
    s_lshr_b32 s63, s42, 1
    s_lshl_b32 s63, s63, 7
    s_and_b32 s64, s42, 1
    s_add_u32 m0, s39, 49152
    s_add_u32 s41, s40, 45056
    buffer_load_dwordx4 v5, s[16:19], s41 offen offset:0 sc1 lds
    s_lshl_b32 s64, s64, 5
    s_add_u32 s63, s63, s64
    s_lshl_b32 s64, s43, 2
    s_add_u32 s63, s63, s64
    s_add_u32 s63, s63, 989184
    buffer_load_dwordx2 v[200:201], v220, s[20:23], s59 offen offset:0 sc1
    buffer_load_dwordx2 v[202:203], v220, s[20:23], s59 offen offset:512 sc1
    buffer_load_dwordx2 v[204:205], v220, s[20:23], s59 offen offset:1024 sc1
    buffer_load_dwordx2 v[206:207], v220, s[20:23], s59 offen offset:1536 sc1
    buffer_load_dwordx2 v[208:209], v221, s[20:23], s59 offen offset:2048 sc1
    s_lshl_b32 s45, s43, 9
    s_add_u32 s45, s45, 985088
    s_lshr_b32 s46, s42, 1
    s_lshl_b32 s46, s46, 7
    s_add_u32 s46, s46, 983040
    s_mov_b32 s24, 0
    s_nop 5
mega_fp8:
    buffer_load_dword v13, v9, s[20:23], s46 offen sc1
    buffer_load_dwordx2 v[18:19], v16, s[20:23], s45 offen sc1
    s_waitcnt vmcnt(0)
    v_min3_u32 v18, v18, v19, v13
    v_cmp_eq_u32 vcc, 0, v18
    s_add_u32 s24, s24, 1
    s_nop 3
    s_cbranch_vccz mega_fok9
    s_sleep 1
    s_cmp_lt_u32 s24, 524288
    s_cbranch_scc1 mega_fp8
mega_fok9:
    s_add_u32 s55, s52, 0
    buffer_load_dwordx4 a[0:3], v5, s[20:23], s55 offen sc1
    s_add_u32 s55, s52, 20480
    buffer_load_dwordx4 a[20:23], v5, s[20:23], s55 offen sc1
    s_add_u32 s55, s52, 40960
    buffer_load_dwordx4 a[40:43], v5, s[20:23], s55 offen sc1
    s_add_u32 s55, s52, 61440
    buffer_load_dwordx4 a[60:63], v5, s[20:23], s55 offen sc1
    s_add_u32 s55, s52, 81920
    buffer_load_dwordx4 a[80:83], v10, s[20:23], s55 offen sc1
    s_add_u32 s54, s49, 0
    buffer_load_dwordx4 v[60:63], v5, s[20:23], s54 offen sc1
    s_add_u32 s54, s50, 0
    buffer_load_dwordx4 v[80:83], v5, s[20:23], s54 offen sc1
    s_add_u32 s54, s51, 0
    buffer_load_dwordx4 v[100:103], v5, s[20:23], s54 offen sc1
    s_add_u32 s54, s48, 0
    buffer_load_dwordx4 v[40:43], v5, s[20:23], s54 offen sc1
    s_add_u32 s55, s52, 1024
    buffer_load_dwordx4 a[4:7], v5, s[20:23], s55 offen sc1
    s_add_u32 s55, s52, 21504
    buffer_load_dwordx4 a[24:27], v5, s[20:23], s55 offen sc1
    s_add_u32 s55, s52, 41984
    buffer_load_dwordx4 a[44:47], v5, s[20:23], s55 offen sc1
    s_add_u32 s55, s52, 62464
    buffer_load_dwordx4 a[64:67], v5, s[20:23], s55 offen sc1
    s_add_u32 s55, s52, 82944
    buffer_load_dwordx4 a[84:87], v10, s[20:23], s55 offen sc1
    s_add_u32 s54, s49, 1024
    buffer_load_dwordx4 v[64:67], v5, s[20:23], s54 offen sc1
    s_add_u32 s54, s50, 1024
    buffer_load_dwordx4 v[84:87], v5, s[20:23], s54 offen sc1
    s_add_u32 s54, s51, 1024
    buffer_load_dwordx4 v[104:107], v5, s[20:23], s54 offen sc1
    s_add_u32 s54, s48, 1024
    buffer_load_dwordx4 v[44:47], v5, s[20:23], s54 offen sc1
    s_waitcnt vmcnt(9)
    v_mfma_f32_16x16x32_bf16 v[124:127], a[0:3], v[60:63], 0
    s_add_u32 s55, s52, 2048
    buffer_load_dwordx4 a[8:11], v5, s[20:23], s55 offen sc1
    v_mfma_f32_16x16x32_bf16 v[140:143], a[20:23], v[60:63], 0
    s_add_u32 s55, s52, 22528
    buffer_load_dwordx4 a[28:31], v5, s[20:23], s55 offen sc1
    v_mfma_f32_16x16x32_bf16 v[156:159], a[40:43], v[60:63], 0
    s_add_u32 s55, s52, 43008
    buffer_load_dwordx4 a[48:51], v5, s[20:23], s55 offen sc1
    v_mfma_f32_16x16x32_bf16 v[172:175], a[60:63], v[60:63], 0
    s_add_u32 s55, s52, 63488
    buffer_load_dwordx4 a[68:71], v5, s[20:23], s55 offen sc1
    v_mfma_f32_16x16x32_bf16 v[188:191], a[80:83], v[60:63], 0
    s_add_u32 s55, s52, 83968
    buffer_load_dwordx4 a[88:91], v10, s[20:23], s55 offen sc1
    v_mfma_f32_16x16x32_bf16 v[128:131], a[0:3], v[80:83], 0
    s_add_u32 s54, s49, 2048
    buffer_load_dwordx4 v[68:71], v5, s[20:23], s54 offen sc1
    v_mfma_f32_16x16x32_bf16 v[144:147], a[20:23], v[80:83], 0
    s_add_u32 s54, s50, 2048
    buffer_load_dwordx4 v[88:91], v5, s[20:23], s54 offen sc1
    v_mfma_f32_16x16x32_bf16 v[160:163], a[40:43], v[80:83], 0
    s_add_u32 s54, s51, 2048
    buffer_load_dwordx4 v[108:111], v5, s[20:23], s54 offen sc1
    v_mfma_f32_16x16x32_bf16 v[176:179], a[60:63], v[80:83], 0
    s_add_u32 s54, s48, 2048
    buffer_load_dwordx4 v[48:51], v5, s[20:23], s54 offen sc1
    v_mfma_f32_16x16x32_bf16 v[192:195], a[80:83], v[80:83], 0
    s_add_u32 s55, s52, 3072
    buffer_load_dwordx4 a[12:15], v5, s[20:23], s55 offen sc1
    v_mfma_f32_16x16x32_bf16 v[132:135], a[0:3], v[100:103], 0
    s_add_u32 s55, s52, 23552
    buffer_load_dwordx4 a[32:35], v5, s[20:23], s55 offen sc1
    v_mfma_f32_16x16x32_bf16 v[148:151], a[20:23], v[100:103], 0
    s_add_u32 s55, s52, 44032
    buffer_load_dwordx4 a[52:55], v5, s[20:23], s55 offen sc1
    v_mfma_f32_16x16x32_bf16 v[164:167], a[40:43], v[100:103], 0
    s_add_u32 s55, s52, 64512
    buffer_load_dwordx4 a[72:75], v5, s[20:23], s55 offen sc1
    v_mfma_f32_16x16x32_bf16 v[180:183], a[60:63], v[100:103], 0
    s_add_u32 s55, s52, 84992
    buffer_load_dwordx4 a[92:95], v10, s[20:23], s55 offen sc1
    v_mfma_f32_16x16x32_bf16 v[196:199], a[80:83], v[100:103], 0
    s_add_u32 s54, s49, 3072
    buffer_load_dwordx4 v[72:75], v5, s[20:23], s54 offen sc1
    v_mfma_f32_16x16x32_bf16 v[120:123], a[0:3], v[40:43], 0
    s_add_u32 s54, s50, 3072
    buffer_load_dwordx4 v[92:95], v5, s[20:23], s54 offen sc1
    v_mfma_f32_16x16x32_bf16 v[136:139], a[20:23], v[40:43], 0
    s_add_u32 s54, s51, 3072
    buffer_load_dwordx4 v[112:115], v5, s[20:23], s54 offen sc1
    v_mfma_f32_16x16x32_bf16 v[152:155], a[40:43], v[40:43], 0
    s_add_u32 s54, s48, 3072
    buffer_load_dwordx4 v[52:55], v5, s[20:23], s54 offen sc1
    v_mfma_f32_16x16x32_bf16 v[168:171], a[60:63], v[40:43], 0
    s_add_u32 s55, s52, 4096
    buffer_load_dwordx4 a[16:19], v5, s[20:23], s55 offen sc1
    v_mfma_f32_16x16x32_bf16 v[184:187], a[80:83], v[40:43], 0
    s_add_u32 s55, s52, 24576
    buffer_load_dwordx4 a[36:39], v5, s[20:23], s55 offen sc1
    s_waitcnt vmcnt(20)
    v_mfma_f32_16x16x32_bf16 v[124:127], a[4:7], v[64:67], v[124:127]
    s_add_u32 s55, s52, 45056
    buffer_load_dwordx4 a[56:59], v5, s[20:23], s55 offen sc1
    v_mfma_f32_16x16x32_bf16 v[140:143], a[24:27], v[64:67], v[140:143]
    s_add_u32 s55, s52, 65536
    buffer_load_dwordx4 a[76:79], v5, s[20:23], s55 offen sc1
    v_mfma_f32_16x16x32_bf16 v[156:159], a[44:47], v[64:67], v[156:159]
    s_add_u32 s55, s52, 86016
    buffer_load_dwordx4 a[96:99], v10, s[20:23], s55 offen sc1
    v_mfma_f32_16x16x32_bf16 v[172:175], a[64:67], v[64:67], v[172:175]
    s_add_u32 s54, s49, 4096
    buffer_load_dwordx4 v[76:79], v5, s[20:23], s54 offen sc1
    v_mfma_f32_16x16x32_bf16 v[188:191], a[84:87], v[64:67], v[188:191]
    s_add_u32 s54, s50, 4096
    buffer_load_dwordx4 v[96:99], v5, s[20:23], s54 offen sc1
    v_mfma_f32_16x16x32_bf16 v[128:131], a[4:7], v[84:87], v[128:131]
    s_add_u32 s54, s51, 4096
    buffer_load_dwordx4 v[116:119], v5, s[20:23], s54 offen sc1
    v_mfma_f32_16x16x32_bf16 v[144:147], a[24:27], v[84:87], v[144:147]
    s_add_u32 s54, s48, 4096
    buffer_load_dwordx4 v[56:59], v5, s[20:23], s54 offen sc1
    v_mfma_f32_16x16x32_bf16 v[160:163], a[44:47], v[84:87], v[160:163]
    v_mfma_f32_16x16x32_bf16 v[176:179], a[64:67], v[84:87], v[176:179]
    v_mfma_f32_16x16x32_bf16 v[192:195], a[84:87], v[84:87], v[192:195]
    v_mfma_f32_16x16x32_bf16 v[132:135], a[4:7], v[104:107], v[132:135]
    v_mfma_f32_16x16x32_bf16 v[148:151], a[24:27], v[104:107], v[148:151]
    v_mfma_f32_16x16x32_bf16 v[164:167], a[44:47], v[104:107], v[164:167]
    v_mfma_f32_16x16x32_bf16 v[180:183], a[64:67], v[104:107], v[180:183]
    v_mfma_f32_16x16x32_bf16 v[196:199], a[84:87], v[104:107], v[196:199]
    v_mfma_f32_16x16x32_bf16 v[120:123], a[4:7], v[44:47], v[120:123]
    v_mfma_f32_16x16x32_bf16 v[136:139], a[24:27], v[44:47], v[136:139]
    v_mfma_f32_16x16x32_bf16 v[152:155], a[44:47], v[44:47], v[152:155]
    v_mfma_f32_16x16x32_bf16 v[168:171], a[64:67], v[44:47], v[168:171]
    v_mfma_f32_16x16x32_bf16 v[184:187], a[84:87], v[44:47], v[184:187]
    s_waitcnt vmcnt(18)
    v_mfma_f32_16x16x32_bf16 v[124:127], a[8:11], v[68:71], v[124:127]
    v_mfma_f32_16x16x32_bf16 v[140:143], a[28:31], v[68:71], v[140:143]
    v_mfma_f32_16x16x32_bf16 v[156:159], a[48:51], v[68:71], v[156:159]
    v_mfma_f32_16x16x32_bf16 v[172:175], a[68:71], v[68:71], v[172:175]
    v_mfma_f32_16x16x32_bf16 v[188:191], a[88:91], v[68:71], v[188:191]
    v_mfma_f32_16x16x32_bf16 v[128:131], a[8:11], v[88:91], v[128:131]
    v_mfma_f32_16x16x32_bf16 v[144:147], a[28:31], v[88:91], v[144:147]
    v_mfma_f32_16x16x32_bf16 v[160:163], a[48:51], v[88:91], v[160:163]
    v_mfma_f32_16x16x32_bf16 v[176:179], a[68:71], v[88:91], v[176:179]
    v_mfma_f32_16x16x32_bf16 v[192:195], a[88:91], v[88:91], v[192:195]
    v_mfma_f32_16x16x32_bf16 v[132:135], a[8:11], v[108:111], v[132:135]
    v_mfma_f32_16x16x32_bf16 v[148:151], a[28:31], v[108:111], v[148:151]
    v_mfma_f32_16x16x32_bf16 v[164:167], a[48:51], v[108:111], v[164:167]
    v_mfma_f32_16x16x32_bf16 v[180:183], a[68:71], v[108:111], v[180:183]
    v_mfma_f32_16x16x32_bf16 v[196:199], a[88:91], v[108:111], v[196:199]
    v_mfma_f32_16x16x32_bf16 v[120:123], a[8:11], v[48:51], v[120:123]
    v_mfma_f32_16x16x32_bf16 v[136:139], a[28:31], v[48:51], v[136:139]
    v_mfma_f32_16x16x32_bf16 v[152:155], a[48:51], v[48:51], v[152:155]
    v_mfma_f32_16x16x32_bf16 v[168:171], a[68:71], v[48:51], v[168:171]
    v_mfma_f32_16x16x32_bf16 v[184:187], a[88:91], v[48:51], v[184:187]
    s_waitcnt vmcnt(9)
    v_mfma_f32_16x16x32_bf16 v[124:127], a[12:15], v[72:75], v[124:127]
    v_mfma_f32_16x16x32_bf16 v[140:143], a[32:35], v[72:75], v[140:143]
    v_mfma_f32_16x16x32_bf16 v[156:159], a[52:55], v[72:75], v[156:159]
    v_mfma_f32_16x16x32_bf16 v[172:175], a[72:75], v[72:75], v[172:175]
    v_mfma_f32_16x16x32_bf16 v[188:191], a[92:95], v[72:75], v[188:191]
    v_mfma_f32_16x16x32_bf16 v[128:131], a[12:15], v[92:95], v[128:131]
    v_mfma_f32_16x16x32_bf16 v[144:147], a[32:35], v[92:95], v[144:147]
    v_mfma_f32_16x16x32_bf16 v[160:163], a[52:55], v[92:95], v[160:163]
    v_mfma_f32_16x16x32_bf16 v[176:179], a[72:75], v[92:95], v[176:179]
    v_mfma_f32_16x16x32_bf16 v[192:195], a[92:95], v[92:95], v[192:195]
    v_mfma_f32_16x16x32_bf16 v[132:135], a[12:15], v[112:115], v[132:135]
    v_mfma_f32_16x16x32_bf16 v[148:151], a[32:35], v[112:115], v[148:151]
    v_mfma_f32_16x16x32_bf16 v[164:167], a[52:55], v[112:115], v[164:167]
    v_mfma_f32_16x16x32_bf16 v[180:183], a[72:75], v[112:115], v[180:183]
    v_mfma_f32_16x16x32_bf16 v[196:199], a[92:95], v[112:115], v[196:199]
    v_mfma_f32_16x16x32_bf16 v[120:123], a[12:15], v[52:55], v[120:123]
    v_mfma_f32_16x16x32_bf16 v[136:139], a[32:35], v[52:55], v[136:139]
    v_mfma_f32_16x16x32_bf16 v[152:155], a[52:55], v[52:55], v[152:155]
    v_mfma_f32_16x16x32_bf16 v[168:171], a[72:75], v[52:55], v[168:171]
    v_mfma_f32_16x16x32_bf16 v[184:187], a[92:95], v[52:55], v[184:187]
    s_waitcnt vmcnt(0)
    v_mfma_f32_16x16x32_bf16 v[124:127], a[16:19], v[76:79], v[124:127]
    v_mfma_f32_16x16x32_bf16 v[140:143], a[36:39], v[76:79], v[140:143]
    v_mfma_f32_16x16x32_bf16 v[156:159], a[56:59], v[76:79], v[156:159]
    v_mfma_f32_16x16x32_bf16 v[172:175], a[76:79], v[76:79], v[172:175]
    v_mfma_f32_16x16x32_bf16 v[188:191], a[96:99], v[76:79], v[188:191]
    v_mfma_f32_16x16x32_bf16 v[128:131], a[16:19], v[96:99], v[128:131]
    v_mfma_f32_16x16x32_bf16 v[144:147], a[36:39], v[96:99], v[144:147]
    v_mfma_f32_16x16x32_bf16 v[160:163], a[56:59], v[96:99], v[160:163]
    v_mfma_f32_16x16x32_bf16 v[176:179], a[76:79], v[96:99], v[176:179]
    v_mfma_f32_16x16x32_bf16 v[192:195], a[96:99], v[96:99], v[192:195]
    ds_write_b128 v222, v[124:127] offset:0
    ds_write_b128 v222, v[140:143] offset:1024
    ds_write_b128 v222, v[156:159] offset:2048
    ds_write_b128 v222, v[172:175] offset:3072
    ds_write_b128 v222, v[188:191] offset:4096
    v_mfma_f32_16x16x32_bf16 v[132:135], a[16:19], v[116:119], v[132:135]
    v_mfma_f32_16x16x32_bf16 v[148:151], a[36:39], v[116:119], v[148:151]
    v_mfma_f32_16x16x32_bf16 v[164:167], a[56:59], v[116:119], v[164:167]
    v_mfma_f32_16x16x32_bf16 v[180:183], a[76:79], v[116:119], v[180:183]
    v_mfma_f32_16x16x32_bf16 v[196:199], a[96:99], v[116:119], v[196:199]
    ds_write_b128 v223, v[128:131] offset:0
    ds_write_b128 v223, v[144:147] offset:1024
    ds_write_b128 v223, v[160:163] offset:2048
    ds_write_b128 v223, v[176:179] offset:3072
    ds_write_b128 v223, v[192:195] offset:4096
    v_mfma_f32_16x16x32_bf16 v[120:123], a[16:19], v[56:59], v[120:123]
    v_mfma_f32_16x16x32_bf16 v[136:139], a[36:39], v[56:59], v[136:139]
    v_mfma_f32_16x16x32_bf16 v[152:155], a[56:59], v[56:59], v[152:155]
    v_mfma_f32_16x16x32_bf16 v[168:171], a[76:79], v[56:59], v[168:171]
    v_mfma_f32_16x16x32_bf16 v[184:187], a[96:99], v[56:59], v[184:187]
    ds_write_b128 v224, v[132:135] offset:0
    ds_write_b128 v224, v[148:151] offset:1024
    ds_write_b128 v224, v[164:167] offset:2048
    ds_write_b128 v224, v[180:183] offset:3072
    ds_write_b128 v224, v[196:199] offset:4096
    s_waitcnt lgkmcnt(0)
    s_barrier
    ds_read_b128 v[124:127], v225 offset:0
    ds_read_b128 v[128:131], v225 offset:5120
    ds_read_b128 v[132:135], v225 offset:10240
    ds_read_b128 v[140:143], v225 offset:1024
    ds_read_b128 v[144:147], v225 offset:6144
    ds_read_b128 v[148:151], v225 offset:11264
    ds_read_b128 v[156:159], v225 offset:2048
    ds_read_b128 v[160:163], v225 offset:7168
    ds_read_b128 v[164:167], v225 offset:12288
    ds_read_b128 v[172:175], v225 offset:3072
    ds_read_b128 v[176:179], v225 offset:8192
    ds_read_b128 v[180:183], v225 offset:13312
    ds_read_b128 v[188:191], v225 offset:4096
    ds_read_b128 v[192:195], v225 offset:9216
    ds_read_b128 v[196:199], v225 offset:14336
    v_mov_b32 v228, 0
    v_mov_b32 v229, 0
    v_lshlrev_b32 v232, 16, v200
    v_and_b32 v233, 0xffff0000, v200
    v_lshlrev_b32 v234, 16, v201
    v_and_b32 v235, 0xffff0000, v201
    v_pk_add_f32 v[120:121], v[120:121], v[232:233]
    v_pk_add_f32 v[122:123], v[122:123], v[234:235]
    s_waitcnt lgkmcnt(12)
    v_pk_add_f32 v[124:125], v[124:125], v[128:129]
    v_pk_add_f32 v[126:127], v[126:127], v[130:131]
    v_pk_add_f32 v[120:121], v[120:121], v[132:133]
    v_pk_add_f32 v[122:123], v[122:123], v[134:135]
    v_pk_add_f32 v[120:121], v[120:121], v[124:125]
    v_pk_add_f32 v[122:123], v[122:123], v[126:127]
    v_cvt_pk_bf16_f32 v200, v120, v121
    v_cvt_pk_bf16_f32 v201, v122, v123
    buffer_store_dwordx2 v[200:201], v220, s[20:23], s60 offen offset:0 sc1
    v_lshlrev_b32 v232, 16, v200
    v_and_b32 v233, 0xffff0000, v200
    v_lshlrev_b32 v234, 16, v201
    v_and_b32 v235, 0xffff0000, v201
    v_add_f32 v228, v228, v232
    v_fmac_f32 v229, v232, v232
    v_add_f32 v228, v228, v233
    v_fmac_f32 v229, v233, v233
    v_add_f32 v228, v228, v234
    v_fmac_f32 v229, v234, v234
    v_add_f32 v228, v228, v235
    v_fmac_f32 v229, v235, v235
    v_lshlrev_b32 v232, 16, v202
    v_and_b32 v233, 0xffff0000, v202
    v_lshlrev_b32 v234, 16, v203
    v_and_b32 v235, 0xffff0000, v203
    v_pk_add_f32 v[136:137], v[136:137], v[232:233]
    v_pk_add_f32 v[138:139], v[138:139], v[234:235]
    s_waitcnt lgkmcnt(9)
    v_pk_add_f32 v[140:141], v[140:141], v[144:145]
    v_pk_add_f32 v[142:143], v[142:143], v[146:147]
    v_pk_add_f32 v[136:137], v[136:137], v[148:149]
    v_pk_add_f32 v[138:139], v[138:139], v[150:151]
    v_pk_add_f32 v[136:137], v[136:137], v[140:141]
    v_pk_add_f32 v[138:139], v[138:139], v[142:143]
    v_cvt_pk_bf16_f32 v202, v136, v137
    v_cvt_pk_bf16_f32 v203, v138, v139
    buffer_store_dwordx2 v[202:203], v220, s[20:23], s60 offen offset:512 sc1
    v_lshlrev_b32 v232, 16, v202
    v_and_b32 v233, 0xffff0000, v202
    v_lshlrev_b32 v234, 16, v203
    v_and_b32 v235, 0xffff0000, v203
    v_add_f32 v228, v228, v232
    v_fmac_f32 v229, v232, v232
    v_add_f32 v228, v228, v233
    v_fmac_f32 v229, v233, v233
    v_add_f32 v228, v228, v234
    v_fmac_f32 v229, v234, v234
    v_add_f32 v228, v228, v235
    v_fmac_f32 v229, v235, v235
    v_lshlrev_b32 v232, 16, v204
    v_and_b32 v233, 0xffff0000, v204
    v_lshlrev_b32 v234, 16, v205
    v_and_b32 v235, 0xffff0000, v205
    v_pk_add_f32 v[152:153], v[152:153], v[232:233]
    v_pk_add_f32 v[154:155], v[154:155], v[234:235]
    s_waitcnt lgkmcnt(6)
    v_pk_add_f32 v[156:157], v[156:157], v[160:161]
    v_pk_add_f32 v[158:159], v[158:159], v[162:163]
    v_pk_add_f32 v[152:153], v[152:153], v[164:165]
    v_pk_add_f32 v[154:155], v[154:155], v[166:167]
    v_pk_add_f32 v[152:153], v[152:153], v[156:157]
    v_pk_add_f32 v[154:155], v[154:155], v[158:159]
    v_cvt_pk_bf16_f32 v204, v152, v153
    v_cvt_pk_bf16_f32 v205, v154, v155
    buffer_store_dwordx2 v[204:205], v220, s[20:23], s60 offen offset:1024 sc1
    v_lshlrev_b32 v232, 16, v204
    v_and_b32 v233, 0xffff0000, v204
    v_lshlrev_b32 v234, 16, v205
    v_and_b32 v235, 0xffff0000, v205
    v_add_f32 v228, v228, v232
    v_fmac_f32 v229, v232, v232
    v_add_f32 v228, v228, v233
    v_fmac_f32 v229, v233, v233
    v_add_f32 v228, v228, v234
    v_fmac_f32 v229, v234, v234
    v_add_f32 v228, v228, v235
    v_fmac_f32 v229, v235, v235
    v_lshlrev_b32 v232, 16, v206
    v_and_b32 v233, 0xffff0000, v206
    v_lshlrev_b32 v234, 16, v207
    v_and_b32 v235, 0xffff0000, v207
    v_pk_add_f32 v[168:169], v[168:169], v[232:233]
    v_pk_add_f32 v[170:171], v[170:171], v[234:235]
    s_waitcnt lgkmcnt(3)
    v_pk_add_f32 v[172:173], v[172:173], v[176:177]
    v_pk_add_f32 v[174:175], v[174:175], v[178:179]
    v_pk_add_f32 v[168:169], v[168:169], v[180:181]
    v_pk_add_f32 v[170:171], v[170:171], v[182:183]
    v_pk_add_f32 v[168:169], v[168:169], v[172:173]
    v_pk_add_f32 v[170:171], v[170:171], v[174:175]
    v_cvt_pk_bf16_f32 v206, v168, v169
    v_cvt_pk_bf16_f32 v207, v170, v171
    buffer_store_dwordx2 v[206:207], v220, s[20:23], s60 offen offset:1536 sc1
    v_lshlrev_b32 v232, 16, v206
    v_and_b32 v233, 0xffff0000, v206
    v_lshlrev_b32 v234, 16, v207
    v_and_b32 v235, 0xffff0000, v207
    v_add_f32 v228, v228, v232
    v_fmac_f32 v229, v232, v232
    v_add_f32 v228, v228, v233
    v_fmac_f32 v229, v233, v233
    v_add_f32 v228, v228, v234
    v_fmac_f32 v229, v234, v234
    v_add_f32 v228, v228, v235
    v_fmac_f32 v229, v235, v235
    v_lshlrev_b32 v232, 16, v208
    v_and_b32 v233, 0xffff0000, v208
    v_lshlrev_b32 v234, 16, v209
    v_and_b32 v235, 0xffff0000, v209
    v_pk_add_f32 v[184:185], v[184:185], v[232:233]
    v_pk_add_f32 v[186:187], v[186:187], v[234:235]
    s_waitcnt lgkmcnt(0)
    v_pk_add_f32 v[188:189], v[188:189], v[192:193]
    v_pk_add_f32 v[190:191], v[190:191], v[194:195]
    v_pk_add_f32 v[184:185], v[184:185], v[196:197]
    v_pk_add_f32 v[186:187], v[186:187], v[198:199]
    v_pk_add_f32 v[184:185], v[184:185], v[188:189]
    v_pk_add_f32 v[186:187], v[186:187], v[190:191]
    v_cvt_pk_bf16_f32 v208, v184, v185
    v_cvt_pk_bf16_f32 v209, v186, v187
    buffer_store_dwordx2 v[208:209], v221, s[20:23], s60 offen offset:2048 sc1
    v_lshlrev_b32 v232, 16, v208
    v_and_b32 v233, 0xffff0000, v208
    v_lshlrev_b32 v234, 16, v209
    v_and_b32 v235, 0xffff0000, v209
    v_add_f32 v228, v228, v232
    v_fmac_f32 v229, v232, v232
    v_add_f32 v228, v228, v233
    v_fmac_f32 v229, v233, v233
    v_add_f32 v228, v228, v234
    v_fmac_f32 v229, v234, v234
    v_add_f32 v228, v228, v235
    v_fmac_f32 v229, v235, v235
    v_mov_b32 v13, v228
    s_nop 1
    v_permlane32_swap_b32 v228, v13
    v_add_f32 v228, v228, v13
    v_mov_b32 v13, v228
    s_nop 1
    v_permlane16_swap_b32 v228, v13
    v_add_f32 v228, v228, v13
    v_mov_b32 v14, v229
    s_nop 1
    v_permlane32_swap_b32 v229, v14
    v_add_f32 v229, v229, v14
    v_mov_b32 v14, v229
    s_nop 1
    v_permlane16_swap_b32 v229, v14
    v_add_f32 v229, v229, v14
    buffer_store_dwordx2 v[228:229], v226, s[20:23], s61 offen sc1
    s_mov_b32 s25, s63
L_p34:
    s_and_b32 s37, s2, 1
    s_lshl_b32 s35, s37, 3
    s_bfe_u32 s37, s2, 0x30003
    s_add_u32 s35, s35, s37
    s_bfe_u32 s37, s2, 0x20001
    s_lshl_b32 s36, s37, 2
    s_bfe_u32 s37, s2, 0x20006
    s_add_u32 s36, s36, s37
    s_lshl_b32 s41, s35, 2
    s_add_u32 s41, s41, s4
    s_mul_i32 s43, s36, 331776
    s_add_u32 s43, s43, 0
    s_mul_i32 s44, s4, 9216
    s_add_u32 s45, s43, s44
    s_waitcnt vmcnt(0)
    s_waitcnt lgkmcnt(0)
    s_barrier
    buffer_store_dword v7, v8, s[20:23], s25 offen sc1
    v_add_u32 v177, 9216, v6
    v_subrev_u32 v179, 576, v6
    v_cmp_gt_u32 s[52:53], 36, v0
    s_nop 1
    v_cndmask_b32 v179, v179, v177, s[52:53]
    s_mov_b32 s54, 72
    v_cmp_gt_u32 s[50:51], s54, v0
    v_mov_b32 v177, 0x40000000
    s_nop 0
    v_cndmask_b32 v179, v177, v179, s[50:51]
    s_mul_i32 s47, s36, 576
    s_add_u32 s47, s47, 8257536
    s_add_u32 s42, s47, 0
    buffer_load_dwordx4 v[124:127], v179, s[16:19], s42 offen sc1
    s_lshl_b32 s38, s41, 1
    s_add_u32 s38, s38, 0
    s_mul_i32 s55, s38, 18432
    s_add_u32 s55, s55, 6934528
    s_add_u32 s42, s47, 18432
    buffer_load_dwordx4 v[128:131], v179, s[16:19], s42 offen sc1
    s_lshl_b32 s38, s41, 1
    s_add_u32 s38, s38, 1
    s_mul_i32 s56, s38, 18432
    s_add_u32 s56, s56, 6934528
    s_add_u32 s42, s47, 36864
    buffer_load_dwordx4 v[132:135], v179, s[16:19], s42 offen sc1
    v_add_u32 v181, 4096, v5
    v_add_u32 v182, 69632, v5
    v_add_u32 v183, 135168, v5
    v_lshlrev_b32 v180, 6, v3
    s_add_u32 s42, s47, 55296
    buffer_load_dwordx4 v[136:139], v179, s[16:19], s42 offen sc1
    v_lshlrev_b32 v176, 4, v4
    v_add_u32 v180, v180, v176
    s_lshl_b32 s48, s41, 11
    s_add_u32 s42, s47, 73728
    buffer_load_dwordx4 v[140:143], v179, s[16:19], s42 offen sc1
    s_add_u32 s48, s48, 9293824
    s_lshl_b32 s38, s36, 6
    s_add_u32 s38, s38, s41
    s_mul_i32 s38, s38, 9216
    s_add_u32 s42, s47, 92160
    buffer_load_dwordx4 v[144:147], v179, s[16:19], s42 offen sc1
    s_add_u32 s57, s38, 9424896
    v_mov_b32 v177, 1280
    v_cndmask_b32 v184, v177, v6, s[50:51]
    s_lshl_b32 s38, s4, 9
    s_add_u32 s42, s47, 110592
    buffer_load_dwordx4 v[148:151], v179, s[16:19], s42 offen sc1
    s_add_u32 s38, s38, 2048
    v_lshlrev_b32 v187, 2, v3
    v_lshlrev_b32 v188, 4, v4
    s_add_u32 s42, s47, 129024
    buffer_load_dwordx4 v[152:155], v179, s[16:19], s42 offen sc1
    v_add_u32 v185, s38, v187
    v_add_u32 v186, s38, v188
    v_lshlrev_b32 v189, 6, v4
    v_lshlrev_b32 v176, 10, v3
    s_add_u32 s42, s47, 147456
    buffer_load_dwordx4 v[156:159], v179, s[16:19], s42 offen sc1
    v_add_u32 v190, v189, v176
    v_lshlrev_b32 v176, 26, v3
    v_or_b32 v189, v189, v176
    s_lshl_b32 s59, s35, 14
    s_add_u32 m0, s44, 77824
    s_add_u32 s46, s45, 73728
    buffer_load_dwordx4 v5, s[16:19], s46 offen offset:0 sc1 lds
    s_lshl_b32 s38, s4, 8
    s_add_u32 s59, s59, s38
    s_add_u32 s59, s59, 720896
    s_lshl_b32 s38, s36, 10
    buffer_load_dwordx4 v5, s[16:19], s46 offen offset:1024 sc1 lds
    s_add_u32 s58, s38, s59
    s_lshl_b32 s60, s36, 7
    s_add_u32 s60, s60, 991232
    buffer_load_dwordx4 v5, s[16:19], s46 offen offset:2048 sc1 lds
    s_mov_b32 s64, s8
    s_and_b32 s65, s9, 0xffff
    s_mov_b32 s66, 8388608
    s_mov_b32 s67, 0x20000
    buffer_load_dwordx4 v5, s[16:19], s46 offen offset:3072 sc1 lds
    s_mov_b32 s68, s10
    s_and_b32 s69, s11, 0xffff
    s_mov_b32 s70, 4096
    s_mov_b32 s71, 0x20000
    s_add_u32 m0, s44, 81920
    s_add_u32 s46, s45, 77824
    buffer_load_dwordx4 v5, s[16:19], s46 offen offset:0 sc1 lds
    v_lshrrev_b32 v176, 3, v1
    v_lshlrev_b32 v176, 12, v176
    v_and_b32 v177, 1, v4
    buffer_load_dwordx4 v5, s[16:19], s46 offen offset:1024 sc1 lds
    v_and_b32 v178, 7, v1
    v_xor_b32 v177, v177, v178
    v_xor_b32 v178, 0, v177
    v_lshlrev_b32 v178, 4, v178
    buffer_load_dwordx4 v5, s[16:19], s46 offen offset:2048 sc1 lds
    v_add_u32 v191, v176, v178
    v_xor_b32 v178, 2, v177
    v_lshlrev_b32 v178, 4, v178
    v_add_u32 v192, v176, v178
    buffer_load_dwordx4 v5, s[16:19], s46 offen offset:3072 sc1 lds
    v_add_u32 v192, 32768, v192
    v_xor_b32 v178, 4, v177
    v_lshlrev_b32 v178, 4, v178
    s_add_u32 m0, s44, 86016
    s_add_u32 s46, s45, 81920
    buffer_load_dwordx4 v5, s[16:19], s46 offen offset:0 sc1 lds
    v_add_u32 v193, v176, v178
    v_add_u32 v193, 65536, v193
    v_xor_b32 v178, 6, v177
    v_lshlrev_b32 v178, 4, v178
    s_add_u32 m0, s44, 114688
    s_add_u32 s46, s45, 110592
    buffer_load_dwordx4 v5, s[16:19], s46 offen offset:0 sc1 lds
    v_add_u32 v194, v176, v178
    v_add_u32 v194, 98304, v194
    s_lshl_b32 s72, s41, 17
    s_mul_i32 s73, s4, 12288
    buffer_load_dwordx4 v5, s[16:19], s46 offen offset:1024 sc1 lds
    s_add_u32 s73, s73, 110592
    v_lshrrev_b32 v176, 2, v3
    v_lshlrev_b32 v176, 3, v176
    v_and_b32 v177, 3, v3
    buffer_load_dwordx4 v5, s[16:19], s46 offen offset:2048 sc1 lds
    v_add_u32 v176, v176, v177
    v_lshlrev_b32 v197, 1, v176
    v_lshlrev_b32 v176, 7, v176
    buffer_load_dwordx4 v5, s[16:19], s46 offen offset:3072 sc1 lds
    v_add_u32 v176, s73, v176
    v_lshrrev_b32 v177, 1, v3
    v_xor_b32 v177, v177, v4
    v_lshlrev_b32 v177, 4, v177
    s_add_u32 m0, s44, 118784
    s_add_u32 s46, s45, 114688
    buffer_load_dwordx4 v5, s[16:19], s46 offen offset:0 sc1 lds
    v_add_u32 v195, v176, v177
    v_xor_b32 v196, 64, v195
    s_lshl_b32 s74, s41, 6
    buffer_load_ushort v198, v197, s[68:71], s74 offen offset:0
    buffer_load_dwordx4 v5, s[16:19], s46 offen offset:1024 sc1 lds
    buffer_load_ushort v200, v197, s[68:71], s74 offen offset:8
    v_and_b32 v176, 1, v4
    s_mov_b32 s38, 73728
    buffer_load_dwordx4 v5, s[16:19], s46 offen offset:2048 sc1 lds
    v_mul_lo_u32 v176, s38, v176
    v_lshrrev_b32 v177, 1, v4
    v_lshlrev_b32 v177, 8, v177
    v_add_u32 v176, v176, v177
    buffer_load_dwordx4 v5, s[16:19], s46 offen offset:3072 sc1 lds
    v_lshlrev_b32 v177, 4, v3
    v_add_u32 v202, v176, v177
    s_mul_i32 s75, s41, 147456
    s_mul_i32 s39, s36, 4608
    s_add_u32 m0, s44, 122880
    s_add_u32 s46, s45, 118784
    buffer_load_dwordx4 v5, s[16:19], s46 offen offset:0 sc1 lds
    s_add_u32 s75, s75, s39
    s_add_u32 s75, s75, 18862080
    s_add_u32 s76, s75, 4096
    s_waitcnt vmcnt(20)
    v_pk_add_f32 v[124:125], v[124:125], v[128:129]
    v_pk_add_f32 v[126:127], v[126:127], v[130:131]
    v_pk_add_f32 v[124:125], v[124:125], v[132:133]
    v_pk_add_f32 v[126:127], v[126:127], v[134:135]
    v_pk_add_f32 v[124:125], v[124:125], v[136:137]
    v_pk_add_f32 v[126:127], v[126:127], v[138:139]
    v_pk_add_f32 v[124:125], v[124:125], v[140:141]
    v_pk_add_f32 v[126:127], v[126:127], v[142:143]
    v_pk_add_f32 v[124:125], v[124:125], v[144:145]
    v_pk_add_f32 v[126:127], v[126:127], v[146:147]
    v_pk_add_f32 v[124:125], v[124:125], v[148:149]
    v_pk_add_f32 v[126:127], v[126:127], v[150:151]
    v_pk_add_f32 v[124:125], v[124:125], v[152:153]
    v_pk_add_f32 v[126:127], v[126:127], v[154:155]
    v_pk_add_f32 v[124:125], v[124:125], v[156:157]
    v_pk_add_f32 v[126:127], v[126:127], v[158:159]
    ds_write_b128 v184, v[124:127] offset:0
    s_waitcnt lgkmcnt(0)
    s_lshl_b32 s38, s35, 7
    s_add_u32 s38, s38, 989184
    s_mov_b32 s24, 0
    s_nop 5
mega_fp10:
    buffer_load_dword v176, v9, s[20:23], s38 offen sc1
    s_waitcnt vmcnt(0)
    v_cmp_eq_u32 vcc, 0, v176
    s_add_u32 s24, s24, 1
    s_nop 3
    s_cbranch_vccz mega_fok11
    s_sleep 1
    s_cmp_lt_u32 s24, 524288
    s_cbranch_scc1 mega_fp10
mega_fok11:
    s_lshl_b32 s77, s4, 13
    s_add_u32 s77, s77, 40960
    s_sub_u32 s38, s77, s73
    v_add_u32 v203, s38, v195
    v_add_u32 v204, s38, v196
    buffer_load_dwordx4 v[160:163], v180, s[20:23], s48 offen offset:0 sc1
    buffer_load_dwordx4 v[164:167], v180, s[20:23], s48 offen offset:1024 sc1
    buffer_load_dwordx4 a[32:35], v5, s[20:23], s55 offen offset:0 sc1
    buffer_load_dwordx4 a[104:107], v5, s[20:23], s56 offen offset:0 sc1
    buffer_load_dwordx4 a[36:39], v5, s[20:23], s55 offen offset:1024 sc1
    buffer_load_dwordx4 a[108:111], v5, s[20:23], s56 offen offset:1024 sc1
    buffer_load_dwordx4 a[40:43], v5, s[20:23], s55 offen offset:2048 sc1
    buffer_load_dwordx4 a[112:115], v5, s[20:23], s56 offen offset:2048 sc1
    buffer_load_dwordx4 a[44:47], v5, s[20:23], s55 offen offset:3072 sc1
    buffer_load_dwordx4 a[116:119], v5, s[20:23], s56 offen offset:3072 sc1
    s_add_u32 s55, s55, 4096
    buffer_load_dwordx4 a[48:51], v5, s[20:23], s55 offen offset:0 sc1
    s_add_u32 s56, s56, 4096
    buffer_load_dwordx4 a[120:123], v5, s[20:23], s56 offen offset:0 sc1
    buffer_load_dwordx4 a[52:55], v5, s[20:23], s55 offen offset:1024 sc1
    buffer_load_dwordx4 a[124:127], v5, s[20:23], s56 offen offset:1024 sc1
    buffer_load_dwordx4 a[56:59], v5, s[20:23], s55 offen offset:2048 sc1
    buffer_load_dwordx4 a[128:131], v5, s[20:23], s56 offen offset:2048 sc1
    buffer_load_dwordx4 a[60:63], v5, s[20:23], s55 offen offset:3072 sc1
    buffer_load_dwordx4 a[132:135], v5, s[20:23], s56 offen offset:3072 sc1
    s_barrier
    s_waitcnt vmcnt(16)
    v_add_f32 v160, v160, v162
    v_add_f32 v161, v161, v163
    v_mov_b32 v176, v160
    s_nop 1
    v_permlane32_swap_b32 v160, v176
    v_add_f32 v160, v160, v176
    v_mov_b32 v176, v160
    s_nop 1
    v_permlane16_swap_b32 v160, v176
    v_add_f32 v160, v160, v176
    v_mov_b32 v177, v161
    s_nop 1
    v_permlane32_swap_b32 v161, v177
    v_add_f32 v161, v161, v177
    v_mov_b32 v177, v161
    s_nop 1
    v_permlane16_swap_b32 v161, v177
    v_add_f32 v161, v161, v177
    v_mul_f32 v169, 0x3ae38e39, v160
    v_mul_f32 v161, 0x3ae38e39, v161
    v_fma_f32 v161, -v169, v169, v161
    v_max_f32 v161, 0, v161
    v_add_f32 v161, 0x3727c5ac, v161
    v_rsq_f32 v168, v161
    s_nop 0
    v_mul_f32 v137, 0xc0135761, v168
    v_mul_f32 v177, v168, v168
    v_mul_f32 v177, v177, v168
    v_mul_f32 v138, 0xbdd2d3e8, v177
    v_mul_f32 v139, 0x3727c5ac, v161
    v_sub_f32 v136, 0, v169
    ds_write_b32 v185, v136 offset:0
    ds_write_b32 v185, v137 offset:128
    ds_write_b32 v185, v138 offset:256
    ds_write_b32 v185, v139 offset:384
    v_mov_b32 v170, v137
    v_mov_b32 v171, v138
    v_mov_b32 v169, v136
    v_add_f32 v164, v164, v166
    v_add_f32 v165, v165, v167
    v_mov_b32 v176, v164
    s_nop 1
    v_permlane32_swap_b32 v164, v176
    v_add_f32 v164, v164, v176
    v_mov_b32 v176, v164
    s_nop 1
    v_permlane16_swap_b32 v164, v176
    v_add_f32 v164, v164, v176
    v_mov_b32 v177, v165
    s_nop 1
    v_permlane32_swap_b32 v165, v177
    v_add_f32 v165, v165, v177
    v_mov_b32 v177, v165
    s_nop 1
    v_permlane16_swap_b32 v165, v177
    v_add_f32 v165, v165, v177
    v_mul_f32 v173, 0x3ae38e39, v164
    v_mul_f32 v165, 0x3ae38e39, v165
    v_fma_f32 v165, -v173, v173, v165
    v_max_f32 v165, 0, v165
    v_add_f32 v165, 0x3727c5ac, v165
    v_rsq_f32 v172, v165
    s_nop 0
    v_mul_f32 v137, 0xc0135761, v172
    v_mul_f32 v177, v172, v172
    v_mul_f32 v177, v177, v172
    v_mul_f32 v138, 0xbdd2d3e8, v177
    v_mul_f32 v139, 0x3727c5ac, v165
    v_sub_f32 v136, 0, v173
    ds_write_b32 v185, v136 offset:64
    ds_write_b32 v185, v137 offset:192
    ds_write_b32 v185, v138 offset:320
    ds_write_b32 v185, v139 offset:448
    v_mov_b32 v174, v137
    v_mov_b32 v175, v138
    v_mov_b32 v173, v136
    ds_read_b128 v[52:55], v186 offset:0
    ds_read_b128 v[56:59], v186 offset:64
    ds_read_b128 v[60:63], v186 offset:128
    ds_read_b128 v[64:67], v186 offset:192
    ds_read_b128 v[68:71], v186 offset:256
    ds_read_b128 v[72:75], v186 offset:320
    ds_read_b128 v[208:211], v186 offset:384
    ds_read_b128 v[212:215], v186 offset:448
    ds_read_b32 v76, v187 offset:0
    ds_read_b32 v78, v187 offset:64
    ds_read_b32 v80, v187 offset:128
    ds_read_b32 v82, v187 offset:192
    ds_read_b32 v84, v187 offset:256
    ds_read_b32 v86, v187 offset:320
    ds_read_b32 v124, v187 offset:384
    ds_read_b32 v126, v187 offset:448
    ds_read_b32 v128, v187 offset:512
    s_waitcnt lgkmcnt(0)
    v_mov_b32 v77, v76
    v_mov_b32 v79, v78
    v_mov_b32 v81, v80
    v_mov_b32 v83, v82
    v_mov_b32 v85, v84
    v_mov_b32 v87, v86
    v_mov_b32 v125, v124
    v_mov_b32 v127, v126
    v_mov_b32 v129, v128
    ds_read_b128 a[0:3], v181 offset:0
    ds_read_b128 a[4:7], v181 offset:1024
    ds_read_b128 a[8:11], v181 offset:2048
    ds_read_b128 a[12:15], v181 offset:3072
    ds_read_b128 a[16:19], v181 offset:4096
    ds_read_b128 a[20:23], v181 offset:5120
    s_waitcnt vmcnt(14)
    s_waitcnt lgkmcnt(5)
    v_mfma_f32_16x16x32_bf16 v[16:19], a[32:35], a[0:3], 0
    ds_read_b128 a[24:27], v181 offset:6144
    v_mfma_f32_16x16x32_bf16 v[88:91], a[104:107], a[0:3], 0
    s_add_u32 s55, s55, 4096
    buffer_load_dwordx4 a[64:67], v5, s[20:23], s55 offen offset:0 sc1
    s_waitcnt lgkmcnt(5)
    v_mfma_f32_16x16x32_bf16 v[20:23], a[32:35], a[4:7], 0
    ds_read_b128 a[28:31], v181 offset:7168
    v_mfma_f32_16x16x32_bf16 v[92:95], a[104:107], a[4:7], 0
    s_add_u32 s56, s56, 4096
    buffer_load_dwordx4 a[136:139], v5, s[20:23], s56 offen offset:0 sc1
    s_waitcnt lgkmcnt(5)
    v_mfma_f32_16x16x32_bf16 v[24:27], a[32:35], a[8:11], 0
    ds_read_b128 a[0:3], v181 offset:8192
    v_mfma_f32_16x16x32_bf16 v[96:99], a[104:107], a[8:11], 0
    buffer_load_dwordx4 a[68:71], v5, s[20:23], s55 offen offset:1024 sc1
    s_waitcnt lgkmcnt(5)
    v_mfma_f32_16x16x32_bf16 v[28:31], a[32:35], a[12:15], 0
    ds_read_b128 a[4:7], v181 offset:9216
    v_mfma_f32_16x16x32_bf16 v[100:103], a[104:107], a[12:15], 0
    buffer_load_dwordx4 a[140:143], v5, s[20:23], s56 offen offset:1024 sc1
    s_waitcnt lgkmcnt(5)
    v_mfma_f32_16x16x32_bf16 v[32:35], a[32:35], a[16:19], 0
    ds_read_b128 a[8:11], v181 offset:10240
    v_mfma_f32_16x16x32_bf16 v[104:107], a[104:107], a[16:19], 0
    buffer_load_dwordx4 a[72:75], v5, s[20:23], s55 offen offset:2048 sc1
    s_waitcnt lgkmcnt(5)
    v_mfma_f32_16x16x32_bf16 v[36:39], a[32:35], a[20:23], 0
    ds_read_b128 a[12:15], v181 offset:11264
    v_mfma_f32_16x16x32_bf16 v[108:111], a[104:107], a[20:23], 0
    buffer_load_dwordx4 a[144:147], v5, s[20:23], s56 offen offset:2048 sc1
    s_waitcnt lgkmcnt(5)
    v_mfma_f32_16x16x32_bf16 v[40:43], a[32:35], a[24:27], 0
    ds_read_b128 a[16:19], v181 offset:12288
    v_mfma_f32_16x16x32_bf16 v[112:115], a[104:107], a[24:27], 0
    buffer_load_dwordx4 a[76:79], v5, s[20:23], s55 offen offset:3072 sc1
    s_waitcnt lgkmcnt(5)
    v_mfma_f32_16x16x32_bf16 v[44:47], a[32:35], a[28:31], 0
    ds_read_b128 a[20:23], v181 offset:13312
    v_mfma_f32_16x16x32_bf16 v[116:119], a[104:107], a[28:31], 0
    buffer_load_dwordx4 a[148:151], v5, s[20:23], s56 offen offset:3072 sc1
    s_waitcnt lgkmcnt(5)
    v_mfma_f32_16x16x32_bf16 v[48:51], a[32:35], a[0:3], 0
    ds_read_b128 a[24:27], v181 offset:14336
    v_mfma_f32_16x16x32_bf16 v[120:123], a[104:107], a[0:3], 0
    s_add_u32 s55, s55, 4096
    buffer_load_dwordx4 a[80:83], v5, s[20:23], s55 offen offset:0 sc1
    s_waitcnt vmcnt(21)
    s_waitcnt lgkmcnt(5)
    v_mfma_f32_16x16x32_bf16 v[16:19], a[36:39], a[4:7], v[16:19]
    ds_read_b128 a[28:31], v181 offset:15360
    v_mfma_f32_16x16x32_bf16 v[88:91], a[108:111], a[4:7], v[88:91]
    s_add_u32 s56, s56, 4096
    buffer_load_dwordx4 a[152:155], v5, s[20:23], s56 offen offset:0 sc1
    s_waitcnt lgkmcnt(5)
    v_mfma_f32_16x16x32_bf16 v[20:23], a[36:39], a[8:11], v[20:23]
    ds_read_b128 a[0:3], v181 offset:16384
    v_mfma_f32_16x16x32_bf16 v[92:95], a[108:111], a[8:11], v[92:95]
    buffer_load_dwordx4 a[84:87], v5, s[20:23], s55 offen offset:1024 sc1
    s_waitcnt lgkmcnt(5)
    v_mfma_f32_16x16x32_bf16 v[24:27], a[36:39], a[12:15], v[24:27]
    ds_read_b128 a[4:7], v181 offset:17408
    v_mfma_f32_16x16x32_bf16 v[96:99], a[108:111], a[12:15], v[96:99]
    buffer_load_dwordx4 a[156:159], v5, s[20:23], s56 offen offset:1024 sc1
    s_waitcnt lgkmcnt(5)
    v_mfma_f32_16x16x32_bf16 v[28:31], a[36:39], a[16:19], v[28:31]
    ds_read_b128 a[8:11], v181 offset:18432
    v_mfma_f32_16x16x32_bf16 v[100:103], a[108:111], a[16:19], v[100:103]
    buffer_load_dwordx4 a[88:91], v5, s[20:23], s55 offen offset:2048 sc1
    s_waitcnt lgkmcnt(5)
    v_mfma_f32_16x16x32_bf16 v[32:35], a[36:39], a[20:23], v[32:35]
    ds_read_b128 a[12:15], v181 offset:19456
    v_mfma_f32_16x16x32_bf16 v[104:107], a[108:111], a[20:23], v[104:107]
    buffer_load_dwordx4 a[160:163], v5, s[20:23], s56 offen offset:2048 sc1
    s_waitcnt lgkmcnt(5)
    v_mfma_f32_16x16x32_bf16 v[36:39], a[36:39], a[24:27], v[36:39]
    ds_read_b128 a[16:19], v181 offset:20480
    v_mfma_f32_16x16x32_bf16 v[108:111], a[108:111], a[24:27], v[108:111]
    buffer_load_dwordx4 a[92:95], v5, s[20:23], s55 offen offset:3072 sc1
    s_waitcnt lgkmcnt(5)
    v_mfma_f32_16x16x32_bf16 v[40:43], a[36:39], a[28:31], v[40:43]
    ds_read_b128 a[20:23], v181 offset:21504
    v_mfma_f32_16x16x32_bf16 v[112:115], a[108:111], a[28:31], v[112:115]
    buffer_load_dwordx4 a[164:167], v5, s[20:23], s56 offen offset:3072 sc1
    s_waitcnt lgkmcnt(5)
    v_mfma_f32_16x16x32_bf16 v[44:47], a[36:39], a[0:3], v[44:47]
    ds_read_b128 a[24:27], v181 offset:22528
    v_mfma_f32_16x16x32_bf16 v[116:119], a[108:111], a[0:3], v[116:119]
    s_add_u32 s55, s55, 4096
    buffer_load_dwordx4 a[96:99], v5, s[20:23], s55 offen offset:0 sc1
    s_waitcnt lgkmcnt(5)
    v_mfma_f32_16x16x32_bf16 v[48:51], a[36:39], a[4:7], v[48:51]
    ds_read_b128 a[28:31], v181 offset:23552
    v_mfma_f32_16x16x32_bf16 v[120:123], a[108:111], a[4:7], v[120:123]
    s_add_u32 s56, s56, 4096
    buffer_load_dwordx4 a[168:171], v5, s[20:23], s56 offen offset:0 sc1
    s_waitcnt vmcnt(28)
    s_waitcnt lgkmcnt(5)
    v_mfma_f32_16x16x32_bf16 v[16:19], a[40:43], a[8:11], v[16:19]
    ds_read_b128 a[0:3], v181 offset:24576
    v_mfma_f32_16x16x32_bf16 v[88:91], a[112:115], a[8:11], v[88:91]
    buffer_load_dwordx4 a[100:103], v5, s[20:23], s55 offen offset:1024 sc1
    s_waitcnt lgkmcnt(5)
    v_mfma_f32_16x16x32_bf16 v[20:23], a[40:43], a[12:15], v[20:23]
    ds_read_b128 a[4:7], v181 offset:25600
    v_mfma_f32_16x16x32_bf16 v[92:95], a[112:115], a[12:15], v[92:95]
    buffer_load_dwordx4 a[172:175], v5, s[20:23], s56 offen offset:1024 sc1
    s_waitcnt lgkmcnt(5)
    v_mfma_f32_16x16x32_bf16 v[24:27], a[40:43], a[16:19], v[24:27]
    ds_read_b128 a[8:11], v181 offset:26624
    v_mfma_f32_16x16x32_bf16 v[96:99], a[112:115], a[16:19], v[96:99]
    s_waitcnt lgkmcnt(5)
    v_mfma_f32_16x16x32_bf16 v[28:31], a[40:43], a[20:23], v[28:31]
    ds_read_b128 a[12:15], v181 offset:27648
    v_mfma_f32_16x16x32_bf16 v[100:103], a[112:115], a[20:23], v[100:103]
    s_waitcnt lgkmcnt(5)
    v_mfma_f32_16x16x32_bf16 v[32:35], a[40:43], a[24:27], v[32:35]
    ds_read_b128 a[16:19], v181 offset:28672
    v_mfma_f32_16x16x32_bf16 v[104:107], a[112:115], a[24:27], v[104:107]
    s_waitcnt lgkmcnt(5)
    v_mfma_f32_16x16x32_bf16 v[36:39], a[40:43], a[28:31], v[36:39]
    ds_read_b128 a[20:23], v181 offset:29696
    v_mfma_f32_16x16x32_bf16 v[108:111], a[112:115], a[28:31], v[108:111]
    s_waitcnt lgkmcnt(5)
    v_mfma_f32_16x16x32_bf16 v[40:43], a[40:43], a[0:3], v[40:43]
    ds_read_b128 a[24:27], v181 offset:30720
    v_mfma_f32_16x16x32_bf16 v[112:115], a[112:115], a[0:3], v[112:115]
    s_waitcnt lgkmcnt(5)
    v_mfma_f32_16x16x32_bf16 v[44:47], a[40:43], a[4:7], v[44:47]
    ds_read_b128 a[28:31], v181 offset:31744
    v_mfma_f32_16x16x32_bf16 v[116:119], a[112:115], a[4:7], v[116:119]
    s_waitcnt lgkmcnt(5)
    v_mfma_f32_16x16x32_bf16 v[48:51], a[40:43], a[8:11], v[48:51]
    ds_read_b128 a[0:3], v181 offset:32768
    v_mfma_f32_16x16x32_bf16 v[120:123], a[112:115], a[8:11], v[120:123]
    s_waitcnt vmcnt(28)
    s_waitcnt lgkmcnt(5)
    v_mfma_f32_16x16x32_bf16 v[16:19], a[44:47], a[12:15], v[16:19]
    ds_read_b128 a[4:7], v181 offset:33792
    v_mfma_f32_16x16x32_bf16 v[88:91], a[116:119], a[12:15], v[88:91]
    s_waitcnt lgkmcnt(5)
    v_mfma_f32_16x16x32_bf16 v[20:23], a[44:47], a[16:19], v[20:23]
    ds_read_b128 a[8:11], v181 offset:34816
    v_mfma_f32_16x16x32_bf16 v[92:95], a[116:119], a[16:19], v[92:95]
    s_waitcnt lgkmcnt(5)
    v_mfma_f32_16x16x32_bf16 v[24:27], a[44:47], a[20:23], v[24:27]
    ds_read_b128 a[12:15], v181 offset:35840
    v_mfma_f32_16x16x32_bf16 v[96:99], a[116:119], a[20:23], v[96:99]
    s_waitcnt lgkmcnt(5)
    v_mfma_f32_16x16x32_bf16 v[28:31], a[44:47], a[24:27], v[28:31]
    v_mfma_f32_16x16x32_bf16 v[100:103], a[116:119], a[24:27], v[100:103]
    s_waitcnt lgkmcnt(4)
    v_mfma_f32_16x16x32_bf16 v[32:35], a[44:47], a[28:31], v[32:35]
    v_mfma_f32_16x16x32_bf16 v[104:107], a[116:119], a[28:31], v[104:107]
    s_waitcnt lgkmcnt(3)
    v_mfma_f32_16x16x32_bf16 v[36:39], a[44:47], a[0:3], v[36:39]
    v_mfma_f32_16x16x32_bf16 v[108:111], a[116:119], a[0:3], v[108:111]
    s_waitcnt lgkmcnt(0)
    s_barrier
    ds_read_b128 a[16:19], v181 offset:36864
    s_add_u32 m0, s44, 4096
    s_add_u32 s46, s45, 147456
    buffer_load_dwordx4 v5, s[16:19], s46 offen offset:0 sc1 lds
    v_mfma_f32_16x16x32_bf16 v[40:43], a[44:47], a[4:7], v[40:43]
    ds_read_b128 a[20:23], v181 offset:37888
    v_mfma_f32_16x16x32_bf16 v[112:115], a[116:119], a[4:7], v[112:115]
    ds_read_b128 a[24:27], v181 offset:38912
    v_mfma_f32_16x16x32_bf16 v[44:47], a[44:47], a[8:11], v[44:47]
    ds_read_b128 a[28:31], v181 offset:39936
    v_mfma_f32_16x16x32_bf16 v[116:119], a[116:119], a[8:11], v[116:119]
    ds_read_b128 a[0:3], v181 offset:40960
    v_mfma_f32_16x16x32_bf16 v[48:51], a[44:47], a[12:15], v[48:51]
    ds_read_b128 a[4:7], v181 offset:41984
    v_mfma_f32_16x16x32_bf16 v[120:123], a[116:119], a[12:15], v[120:123]
    buffer_load_dwordx4 v5, s[16:19], s46 offen offset:1024 sc1 lds
    s_waitcnt vmcnt(28)
    s_waitcnt lgkmcnt(5)
    v_mfma_f32_16x16x32_bf16 v[16:19], a[48:51], a[16:19], v[16:19]
    ds_read_b128 a[8:11], v181 offset:43008
    v_mfma_f32_16x16x32_bf16 v[88:91], a[120:123], a[16:19], v[88:91]
    s_waitcnt lgkmcnt(5)
    v_mfma_f32_16x16x32_bf16 v[20:23], a[48:51], a[20:23], v[20:23]
    ds_read_b128 a[12:15], v181 offset:44032
    v_mfma_f32_16x16x32_bf16 v[92:95], a[120:123], a[20:23], v[92:95]
    s_waitcnt lgkmcnt(5)
    v_mfma_f32_16x16x32_bf16 v[24:27], a[48:51], a[24:27], v[24:27]
    ds_read_b128 a[16:19], v181 offset:45056
    v_mfma_f32_16x16x32_bf16 v[96:99], a[120:123], a[24:27], v[96:99]
    s_waitcnt lgkmcnt(5)
    v_mfma_f32_16x16x32_bf16 v[28:31], a[48:51], a[28:31], v[28:31]
    ds_read_b128 a[20:23], v181 offset:46080
    v_mfma_f32_16x16x32_bf16 v[100:103], a[120:123], a[28:31], v[100:103]
    buffer_load_dwordx4 v5, s[16:19], s46 offen offset:2048 sc1 lds
    s_waitcnt lgkmcnt(5)
    v_mfma_f32_16x16x32_bf16 v[32:35], a[48:51], a[0:3], v[32:35]
    ds_read_b128 a[24:27], v181 offset:47104
    v_mfma_f32_16x16x32_bf16 v[104:107], a[120:123], a[0:3], v[104:107]
    s_waitcnt lgkmcnt(5)
    v_mfma_f32_16x16x32_bf16 v[36:39], a[48:51], a[4:7], v[36:39]
    ds_read_b128 a[28:31], v181 offset:48128
    v_mfma_f32_16x16x32_bf16 v[108:111], a[120:123], a[4:7], v[108:111]
    s_waitcnt lgkmcnt(5)
    v_mfma_f32_16x16x32_bf16 v[40:43], a[48:51], a[8:11], v[40:43]
    ds_read_b128 a[0:3], v181 offset:49152
    v_mfma_f32_16x16x32_bf16 v[112:115], a[120:123], a[8:11], v[112:115]
    s_waitcnt lgkmcnt(5)
    v_mfma_f32_16x16x32_bf16 v[44:47], a[48:51], a[12:15], v[44:47]
    ds_read_b128 a[4:7], v181 offset:50176
    v_mfma_f32_16x16x32_bf16 v[116:119], a[120:123], a[12:15], v[116:119]
    buffer_load_dwordx4 v5, s[16:19], s46 offen offset:3072 sc1 lds
    s_waitcnt lgkmcnt(5)
    v_mfma_f32_16x16x32_bf16 v[48:51], a[48:51], a[16:19], v[48:51]
    ds_read_b128 a[8:11], v181 offset:51200
    v_mfma_f32_16x16x32_bf16 v[120:123], a[120:123], a[16:19], v[120:123]
    s_waitcnt vmcnt(28)
    s_waitcnt lgkmcnt(5)
    v_mfma_f32_16x16x32_bf16 v[16:19], a[52:55], a[20:23], v[16:19]
    ds_read_b128 a[12:15], v181 offset:52224
    v_mfma_f32_16x16x32_bf16 v[88:91], a[124:127], a[20:23], v[88:91]
    s_waitcnt lgkmcnt(5)
    v_mfma_f32_16x16x32_bf16 v[20:23], a[52:55], a[24:27], v[20:23]
    ds_read_b128 a[16:19], v181 offset:53248
    v_mfma_f32_16x16x32_bf16 v[92:95], a[124:127], a[24:27], v[92:95]
    s_waitcnt lgkmcnt(5)
    v_mfma_f32_16x16x32_bf16 v[24:27], a[52:55], a[28:31], v[24:27]
    ds_read_b128 a[20:23], v181 offset:54272
    v_mfma_f32_16x16x32_bf16 v[96:99], a[124:127], a[28:31], v[96:99]
    s_add_u32 m0, s44, 8192
    s_add_u32 s46, s45, 151552
    buffer_load_dwordx4 v5, s[16:19], s46 offen offset:0 sc1 lds
    s_waitcnt lgkmcnt(5)
    v_mfma_f32_16x16x32_bf16 v[28:31], a[52:55], a[0:3], v[28:31]
    ds_read_b128 a[24:27], v181 offset:55296
    v_mfma_f32_16x16x32_bf16 v[100:103], a[124:127], a[0:3], v[100:103]
    s_waitcnt lgkmcnt(5)
    v_mfma_f32_16x16x32_bf16 v[32:35], a[52:55], a[4:7], v[32:35]
    ds_read_b128 a[28:31], v181 offset:56320
    v_mfma_f32_16x16x32_bf16 v[104:107], a[124:127], a[4:7], v[104:107]
    s_waitcnt lgkmcnt(5)
    v_mfma_f32_16x16x32_bf16 v[36:39], a[52:55], a[8:11], v[36:39]
    ds_read_b128 a[0:3], v181 offset:57344
    v_mfma_f32_16x16x32_bf16 v[108:111], a[124:127], a[8:11], v[108:111]
    s_waitcnt lgkmcnt(5)
    v_mfma_f32_16x16x32_bf16 v[40:43], a[52:55], a[12:15], v[40:43]
    ds_read_b128 a[4:7], v181 offset:58368
    v_mfma_f32_16x16x32_bf16 v[112:115], a[124:127], a[12:15], v[112:115]
    buffer_load_dwordx4 v5, s[16:19], s46 offen offset:1024 sc1 lds
    s_waitcnt lgkmcnt(5)
    v_mfma_f32_16x16x32_bf16 v[44:47], a[52:55], a[16:19], v[44:47]
    ds_read_b128 a[8:11], v181 offset:59392
    v_mfma_f32_16x16x32_bf16 v[116:119], a[124:127], a[16:19], v[116:119]
    s_waitcnt lgkmcnt(5)
    v_mfma_f32_16x16x32_bf16 v[48:51], a[52:55], a[20:23], v[48:51]
    ds_read_b128 a[12:15], v181 offset:60416
    v_mfma_f32_16x16x32_bf16 v[120:123], a[124:127], a[20:23], v[120:123]
    s_waitcnt vmcnt(28)
    s_waitcnt lgkmcnt(5)
    v_mfma_f32_16x16x32_bf16 v[16:19], a[56:59], a[24:27], v[16:19]
    ds_read_b128 a[16:19], v181 offset:61440
    v_mfma_f32_16x16x32_bf16 v[88:91], a[128:131], a[24:27], v[88:91]
    s_waitcnt lgkmcnt(5)
    v_mfma_f32_16x16x32_bf16 v[20:23], a[56:59], a[28:31], v[20:23]
    ds_read_b128 a[20:23], v181 offset:62464
    v_mfma_f32_16x16x32_bf16 v[92:95], a[128:131], a[28:31], v[92:95]
    buffer_load_dwordx4 v5, s[16:19], s46 offen offset:2048 sc1 lds
    s_waitcnt lgkmcnt(5)
    v_mfma_f32_16x16x32_bf16 v[24:27], a[56:59], a[0:3], v[24:27]
    ds_read_b128 a[24:27], v181 offset:63488
    v_mfma_f32_16x16x32_bf16 v[96:99], a[128:131], a[0:3], v[96:99]
    s_waitcnt lgkmcnt(5)
    v_mfma_f32_16x16x32_bf16 v[28:31], a[56:59], a[4:7], v[28:31]
    ds_read_b128 a[28:31], v181 offset:64512
    v_mfma_f32_16x16x32_bf16 v[100:103], a[128:131], a[4:7], v[100:103]
    s_waitcnt lgkmcnt(5)
    v_mfma_f32_16x16x32_bf16 v[32:35], a[56:59], a[8:11], v[32:35]
    ds_read_b128 a[0:3], v182 offset:0
    v_mfma_f32_16x16x32_bf16 v[104:107], a[128:131], a[8:11], v[104:107]
    s_waitcnt lgkmcnt(5)
    v_mfma_f32_16x16x32_bf16 v[36:39], a[56:59], a[12:15], v[36:39]
    ds_read_b128 a[4:7], v182 offset:1024
    v_mfma_f32_16x16x32_bf16 v[108:111], a[128:131], a[12:15], v[108:111]
    buffer_load_dwordx4 v5, s[16:19], s46 offen offset:3072 sc1 lds
    s_waitcnt lgkmcnt(5)
    v_mfma_f32_16x16x32_bf16 v[40:43], a[56:59], a[16:19], v[40:43]
    ds_read_b128 a[8:11], v182 offset:2048
    v_mfma_f32_16x16x32_bf16 v[112:115], a[128:131], a[16:19], v[112:115]
    s_waitcnt lgkmcnt(5)
    v_mfma_f32_16x16x32_bf16 v[44:47], a[56:59], a[20:23], v[44:47]
    ds_read_b128 a[12:15], v182 offset:3072
    v_mfma_f32_16x16x32_bf16 v[116:119], a[128:131], a[20:23], v[116:119]
    s_waitcnt lgkmcnt(5)
    v_mfma_f32_16x16x32_bf16 v[48:51], a[56:59], a[24:27], v[48:51]
    ds_read_b128 a[16:19], v182 offset:4096
    v_mfma_f32_16x16x32_bf16 v[120:123], a[128:131], a[24:27], v[120:123]
    s_waitcnt vmcnt(28)
    s_waitcnt lgkmcnt(5)
    v_mfma_f32_16x16x32_bf16 v[16:19], a[60:63], a[28:31], v[16:19]
    ds_read_b128 a[20:23], v182 offset:5120
    v_mfma_f32_16x16x32_bf16 v[88:91], a[132:135], a[28:31], v[88:91]
    s_add_u32 m0, s44, 12288
    s_add_u32 s46, s45, 155648
    buffer_load_dwordx4 v5, s[16:19], s46 offen offset:0 sc1 lds
    s_waitcnt lgkmcnt(5)
    v_mfma_f32_16x16x32_bf16 v[20:23], a[60:63], a[0:3], v[20:23]
    ds_read_b128 a[24:27], v182 offset:6144
    v_mfma_f32_16x16x32_bf16 v[92:95], a[132:135], a[0:3], v[92:95]
    s_waitcnt lgkmcnt(5)
    v_mfma_f32_16x16x32_bf16 v[24:27], a[60:63], a[4:7], v[24:27]
    ds_read_b128 a[28:31], v182 offset:7168
    v_mfma_f32_16x16x32_bf16 v[96:99], a[132:135], a[4:7], v[96:99]
    s_waitcnt lgkmcnt(5)
    v_mfma_f32_16x16x32_bf16 v[28:31], a[60:63], a[8:11], v[28:31]
    v_mfma_f32_16x16x32_bf16 v[100:103], a[132:135], a[8:11], v[100:103]
    s_waitcnt lgkmcnt(4)
    v_mfma_f32_16x16x32_bf16 v[32:35], a[60:63], a[12:15], v[32:35]
    v_mfma_f32_16x16x32_bf16 v[104:107], a[132:135], a[12:15], v[104:107]
    s_waitcnt lgkmcnt(3)
    v_mfma_f32_16x16x32_bf16 v[36:39], a[60:63], a[16:19], v[36:39]
    v_mfma_f32_16x16x32_bf16 v[108:111], a[132:135], a[16:19], v[108:111]
    s_waitcnt lgkmcnt(0)
    s_barrier
    ds_read_b128 a[0:3], v182 offset:8192
    s_add_u32 m0, s44, 40960
    s_add_u32 s46, s45, 184320
    buffer_load_dwordx4 v5, s[16:19], s46 offen offset:0 sc1 lds
    v_mfma_f32_16x16x32_bf16 v[40:43], a[60:63], a[20:23], v[40:43]
    ds_read_b128 a[4:7], v182 offset:9216
    v_mfma_f32_16x16x32_bf16 v[112:115], a[132:135], a[20:23], v[112:115]
    ds_read_b128 a[8:11], v182 offset:10240
    v_mfma_f32_16x16x32_bf16 v[44:47], a[60:63], a[24:27], v[44:47]
    ds_read_b128 a[12:15], v182 offset:11264
    v_mfma_f32_16x16x32_bf16 v[116:119], a[132:135], a[24:27], v[116:119]
    ds_read_b128 a[16:19], v182 offset:12288
    v_mfma_f32_16x16x32_bf16 v[48:51], a[60:63], a[28:31], v[48:51]
    ds_read_b128 a[20:23], v182 offset:13312
    v_mfma_f32_16x16x32_bf16 v[120:123], a[132:135], a[28:31], v[120:123]
    buffer_load_dwordx4 v5, s[16:19], s46 offen offset:1024 sc1 lds
    s_waitcnt vmcnt(29)
    s_waitcnt lgkmcnt(5)
    v_mfma_f32_16x16x32_bf16 v[16:19], a[64:67], a[0:3], v[16:19]
    ds_read_b128 a[24:27], v182 offset:14336
    v_mfma_f32_16x16x32_bf16 v[88:91], a[136:139], a[0:3], v[88:91]
    s_waitcnt lgkmcnt(5)
    v_mfma_f32_16x16x32_bf16 v[20:23], a[64:67], a[4:7], v[20:23]
    ds_read_b128 a[28:31], v182 offset:15360
    v_mfma_f32_16x16x32_bf16 v[92:95], a[136:139], a[4:7], v[92:95]
    s_waitcnt lgkmcnt(5)
    v_mfma_f32_16x16x32_bf16 v[24:27], a[64:67], a[8:11], v[24:27]
    ds_read_b128 a[0:3], v182 offset:16384
    v_mfma_f32_16x16x32_bf16 v[96:99], a[136:139], a[8:11], v[96:99]
    s_waitcnt lgkmcnt(5)
    v_mfma_f32_16x16x32_bf16 v[28:31], a[64:67], a[12:15], v[28:31]
    ds_read_b128 a[4:7], v182 offset:17408
    v_mfma_f32_16x16x32_bf16 v[100:103], a[136:139], a[12:15], v[100:103]
    buffer_load_dwordx4 v5, s[16:19], s46 offen offset:2048 sc1 lds
    s_waitcnt lgkmcnt(5)
    v_mfma_f32_16x16x32_bf16 v[32:35], a[64:67], a[16:19], v[32:35]
    ds_read_b128 a[8:11], v182 offset:18432
    v_mfma_f32_16x16x32_bf16 v[104:107], a[136:139], a[16:19], v[104:107]
    s_waitcnt lgkmcnt(5)
    v_mfma_f32_16x16x32_bf16 v[36:39], a[64:67], a[20:23], v[36:39]
    ds_read_b128 a[12:15], v182 offset:19456
    v_mfma_f32_16x16x32_bf16 v[108:111], a[136:139], a[20:23], v[108:111]
    s_waitcnt lgkmcnt(5)
    v_mfma_f32_16x16x32_bf16 v[40:43], a[64:67], a[24:27], v[40:43]
    ds_read_b128 a[16:19], v182 offset:20480
    v_mfma_f32_16x16x32_bf16 v[112:115], a[136:139], a[24:27], v[112:115]
    s_waitcnt lgkmcnt(5)
    v_mfma_f32_16x16x32_bf16 v[44:47], a[64:67], a[28:31], v[44:47]
    ds_read_b128 a[20:23], v182 offset:21504
    v_mfma_f32_16x16x32_bf16 v[116:119], a[136:139], a[28:31], v[116:119]
    buffer_load_dwordx4 v5, s[16:19], s46 offen offset:3072 sc1 lds
    s_waitcnt lgkmcnt(5)
    v_mfma_f32_16x16x32_bf16 v[48:51], a[64:67], a[0:3], v[48:51]
    ds_read_b128 a[24:27], v182 offset:22528
    v_mfma_f32_16x16x32_bf16 v[120:123], a[136:139], a[0:3], v[120:123]
    s_waitcnt vmcnt(29)
    s_waitcnt lgkmcnt(5)
    v_mfma_f32_16x16x32_bf16 v[16:19], a[68:71], a[4:7], v[16:19]
    ds_read_b128 a[28:31], v182 offset:23552
    v_mfma_f32_16x16x32_bf16 v[88:91], a[140:143], a[4:7], v[88:91]
    s_waitcnt lgkmcnt(5)
    v_mfma_f32_16x16x32_bf16 v[20:23], a[68:71], a[8:11], v[20:23]
    ds_read_b128 a[0:3], v182 offset:24576
    v_mfma_f32_16x16x32_bf16 v[92:95], a[140:143], a[8:11], v[92:95]
    s_waitcnt lgkmcnt(5)
    v_mfma_f32_16x16x32_bf16 v[24:27], a[68:71], a[12:15], v[24:27]
    ds_read_b128 a[4:7], v182 offset:25600
    v_mfma_f32_16x16x32_bf16 v[96:99], a[140:143], a[12:15], v[96:99]
    s_add_u32 m0, s44, 45056
    s_add_u32 s46, s45, 188416
    buffer_load_dwordx4 v5, s[16:19], s46 offen offset:0 sc1 lds
    s_waitcnt lgkmcnt(5)
    v_mfma_f32_16x16x32_bf16 v[28:31], a[68:71], a[16:19], v[28:31]
    ds_read_b128 a[8:11], v182 offset:26624
    v_mfma_f32_16x16x32_bf16 v[100:103], a[140:143], a[16:19], v[100:103]
    s_waitcnt lgkmcnt(5)
    v_mfma_f32_16x16x32_bf16 v[32:35], a[68:71], a[20:23], v[32:35]
    ds_read_b128 a[12:15], v182 offset:27648
    v_mfma_f32_16x16x32_bf16 v[104:107], a[140:143], a[20:23], v[104:107]
    s_waitcnt lgkmcnt(5)
    v_mfma_f32_16x16x32_bf16 v[36:39], a[68:71], a[24:27], v[36:39]
    ds_read_b128 a[16:19], v182 offset:28672
    v_mfma_f32_16x16x32_bf16 v[108:111], a[140:143], a[24:27], v[108:111]
    s_waitcnt lgkmcnt(5)
    v_mfma_f32_16x16x32_bf16 v[40:43], a[68:71], a[28:31], v[40:43]
    ds_read_b128 a[20:23], v182 offset:29696
    v_mfma_f32_16x16x32_bf16 v[112:115], a[140:143], a[28:31], v[112:115]
    buffer_load_dwordx4 v5, s[16:19], s46 offen offset:1024 sc1 lds
    s_waitcnt lgkmcnt(5)
    v_mfma_f32_16x16x32_bf16 v[44:47], a[68:71], a[0:3], v[44:47]
    ds_read_b128 a[24:27], v182 offset:30720
    v_mfma_f32_16x16x32_bf16 v[116:119], a[140:143], a[0:3], v[116:119]
    s_waitcnt lgkmcnt(5)
    v_mfma_f32_16x16x32_bf16 v[48:51], a[68:71], a[4:7], v[48:51]
    ds_read_b128 a[28:31], v182 offset:31744
    v_mfma_f32_16x16x32_bf16 v[120:123], a[140:143], a[4:7], v[120:123]
    s_waitcnt vmcnt(29)
    s_waitcnt lgkmcnt(5)
    v_mfma_f32_16x16x32_bf16 v[16:19], a[72:75], a[8:11], v[16:19]
    ds_read_b128 a[0:3], v182 offset:32768
    v_mfma_f32_16x16x32_bf16 v[88:91], a[144:147], a[8:11], v[88:91]
    s_waitcnt lgkmcnt(5)
    v_mfma_f32_16x16x32_bf16 v[20:23], a[72:75], a[12:15], v[20:23]
    ds_read_b128 a[4:7], v182 offset:33792
    v_mfma_f32_16x16x32_bf16 v[92:95], a[144:147], a[12:15], v[92:95]
    buffer_load_dwordx4 v5, s[16:19], s46 offen offset:2048 sc1 lds
    s_waitcnt lgkmcnt(5)
    v_mfma_f32_16x16x32_bf16 v[24:27], a[72:75], a[16:19], v[24:27]
    ds_read_b128 a[8:11], v182 offset:34816
    v_mfma_f32_16x16x32_bf16 v[96:99], a[144:147], a[16:19], v[96:99]
    s_waitcnt lgkmcnt(5)
    v_mfma_f32_16x16x32_bf16 v[28:31], a[72:75], a[20:23], v[28:31]
    ds_read_b128 a[12:15], v182 offset:35840
    v_mfma_f32_16x16x32_bf16 v[100:103], a[144:147], a[20:23], v[100:103]
    s_waitcnt lgkmcnt(5)
    v_mfma_f32_16x16x32_bf16 v[32:35], a[72:75], a[24:27], v[32:35]
    ds_read_b128 a[16:19], v182 offset:36864
    v_mfma_f32_16x16x32_bf16 v[104:107], a[144:147], a[24:27], v[104:107]
    s_waitcnt lgkmcnt(5)
    v_mfma_f32_16x16x32_bf16 v[36:39], a[72:75], a[28:31], v[36:39]
    ds_read_b128 a[20:23], v182 offset:37888
    v_mfma_f32_16x16x32_bf16 v[108:111], a[144:147], a[28:31], v[108:111]
    buffer_load_dwordx4 v5, s[16:19], s46 offen offset:3072 sc1 lds
    s_waitcnt lgkmcnt(5)
    v_mfma_f32_16x16x32_bf16 v[40:43], a[72:75], a[0:3], v[40:43]
    ds_read_b128 a[24:27], v182 offset:38912
    v_mfma_f32_16x16x32_bf16 v[112:115], a[144:147], a[0:3], v[112:115]
    s_waitcnt lgkmcnt(5)
    v_mfma_f32_16x16x32_bf16 v[44:47], a[72:75], a[4:7], v[44:47]
    ds_read_b128 a[28:31], v182 offset:39936
    v_mfma_f32_16x16x32_bf16 v[116:119], a[144:147], a[4:7], v[116:119]
    s_waitcnt lgkmcnt(5)
    v_mfma_f32_16x16x32_bf16 v[48:51], a[72:75], a[8:11], v[48:51]
    ds_read_b128 a[0:3], v182 offset:40960
    v_mfma_f32_16x16x32_bf16 v[120:123], a[144:147], a[8:11], v[120:123]
    s_waitcnt vmcnt(29)
    s_waitcnt lgkmcnt(5)
    v_mfma_f32_16x16x32_bf16 v[16:19], a[76:79], a[12:15], v[16:19]
    ds_read_b128 a[4:7], v182 offset:41984
    v_mfma_f32_16x16x32_bf16 v[88:91], a[148:151], a[12:15], v[88:91]
    s_add_u32 m0, s44, 49152
    s_add_u32 s46, s45, 192512
    buffer_load_dwordx4 v5, s[16:19], s46 offen offset:0 sc1 lds
    s_waitcnt lgkmcnt(5)
    v_mfma_f32_16x16x32_bf16 v[20:23], a[76:79], a[16:19], v[20:23]
    ds_read_b128 a[8:11], v182 offset:43008
    v_mfma_f32_16x16x32_bf16 v[92:95], a[148:151], a[16:19], v[92:95]
    s_waitcnt lgkmcnt(5)
    v_mfma_f32_16x16x32_bf16 v[24:27], a[76:79], a[20:23], v[24:27]
    ds_read_b128 a[12:15], v182 offset:44032
    v_mfma_f32_16x16x32_bf16 v[96:99], a[148:151], a[20:23], v[96:99]
    s_waitcnt lgkmcnt(5)
    v_mfma_f32_16x16x32_bf16 v[28:31], a[76:79], a[24:27], v[28:31]
    v_mfma_f32_16x16x32_bf16 v[100:103], a[148:151], a[24:27], v[100:103]
    s_waitcnt lgkmcnt(4)
    v_mfma_f32_16x16x32_bf16 v[32:35], a[76:79], a[28:31], v[32:35]
    v_mfma_f32_16x16x32_bf16 v[104:107], a[148:151], a[28:31], v[104:107]
    s_waitcnt lgkmcnt(3)
    v_mfma_f32_16x16x32_bf16 v[36:39], a[76:79], a[0:3], v[36:39]
    v_mfma_f32_16x16x32_bf16 v[108:111], a[148:151], a[0:3], v[108:111]
    s_waitcnt lgkmcnt(0)
    s_barrier
    ds_read_b128 a[16:19], v182 offset:45056
    s_add_u32 m0, s44, 77824
    s_add_u32 s46, s45, 221184
    buffer_load_dwordx4 v5, s[16:19], s46 offen offset:0 sc1 lds
    v_mfma_f32_16x16x32_bf16 v[40:43], a[76:79], a[4:7], v[40:43]
    ds_read_b128 a[20:23], v182 offset:46080
    v_mfma_f32_16x16x32_bf16 v[112:115], a[148:151], a[4:7], v[112:115]
    ds_read_b128 a[24:27], v182 offset:47104
    v_mfma_f32_16x16x32_bf16 v[44:47], a[76:79], a[8:11], v[44:47]
    ds_read_b128 a[28:31], v182 offset:48128
    v_mfma_f32_16x16x32_bf16 v[116:119], a[148:151], a[8:11], v[116:119]
    ds_read_b128 a[0:3], v182 offset:49152
    v_mfma_f32_16x16x32_bf16 v[48:51], a[76:79], a[12:15], v[48:51]
    ds_read_b128 a[4:7], v182 offset:50176
    v_mfma_f32_16x16x32_bf16 v[120:123], a[148:151], a[12:15], v[120:123]
    buffer_load_dwordx4 v5, s[16:19], s46 offen offset:1024 sc1 lds
    s_waitcnt vmcnt(30)
    s_waitcnt lgkmcnt(5)
    v_mfma_f32_16x16x32_bf16 v[16:19], a[80:83], a[16:19], v[16:19]
    ds_read_b128 a[8:11], v182 offset:51200
    v_mfma_f32_16x16x32_bf16 v[88:91], a[152:155], a[16:19], v[88:91]
    s_waitcnt lgkmcnt(5)
    v_mfma_f32_16x16x32_bf16 v[20:23], a[80:83], a[20:23], v[20:23]
    ds_read_b128 a[12:15], v182 offset:52224
    v_mfma_f32_16x16x32_bf16 v[92:95], a[152:155], a[20:23], v[92:95]
    s_waitcnt lgkmcnt(5)
    v_mfma_f32_16x16x32_bf16 v[24:27], a[80:83], a[24:27], v[24:27]
    ds_read_b128 a[16:19], v182 offset:53248
    v_mfma_f32_16x16x32_bf16 v[96:99], a[152:155], a[24:27], v[96:99]
    s_waitcnt lgkmcnt(5)
    v_mfma_f32_16x16x32_bf16 v[28:31], a[80:83], a[28:31], v[28:31]
    ds_read_b128 a[20:23], v182 offset:54272
    v_mfma_f32_16x16x32_bf16 v[100:103], a[152:155], a[28:31], v[100:103]
    buffer_load_dwordx4 v5, s[16:19], s46 offen offset:2048 sc1 lds
    s_waitcnt lgkmcnt(5)
    v_mfma_f32_16x16x32_bf16 v[32:35], a[80:83], a[0:3], v[32:35]
    ds_read_b128 a[24:27], v182 offset:55296
    v_mfma_f32_16x16x32_bf16 v[104:107], a[152:155], a[0:3], v[104:107]
    s_waitcnt lgkmcnt(5)
    v_mfma_f32_16x16x32_bf16 v[36:39], a[80:83], a[4:7], v[36:39]
    ds_read_b128 a[28:31], v182 offset:56320
    v_mfma_f32_16x16x32_bf16 v[108:111], a[152:155], a[4:7], v[108:111]
    s_waitcnt lgkmcnt(5)
    v_mfma_f32_16x16x32_bf16 v[40:43], a[80:83], a[8:11], v[40:43]
    ds_read_b128 a[0:3], v182 offset:57344
    v_mfma_f32_16x16x32_bf16 v[112:115], a[152:155], a[8:11], v[112:115]
    s_waitcnt lgkmcnt(5)
    v_mfma_f32_16x16x32_bf16 v[44:47], a[80:83], a[12:15], v[44:47]
    ds_read_b128 a[4:7], v182 offset:58368
    v_mfma_f32_16x16x32_bf16 v[116:119], a[152:155], a[12:15], v[116:119]
    buffer_load_dwordx4 v5, s[16:19], s46 offen offset:3072 sc1 lds
    s_waitcnt lgkmcnt(5)
    v_mfma_f32_16x16x32_bf16 v[48:51], a[80:83], a[16:19], v[48:51]
    ds_read_b128 a[8:11], v182 offset:59392
    v_mfma_f32_16x16x32_bf16 v[120:123], a[152:155], a[16:19], v[120:123]
    s_waitcnt vmcnt(30)
    s_waitcnt lgkmcnt(5)
    v_mfma_f32_16x16x32_bf16 v[16:19], a[84:87], a[20:23], v[16:19]
    ds_read_b128 a[12:15], v182 offset:60416
    v_mfma_f32_16x16x32_bf16 v[88:91], a[156:159], a[20:23], v[88:91]
    s_waitcnt lgkmcnt(5)
    v_mfma_f32_16x16x32_bf16 v[20:23], a[84:87], a[24:27], v[20:23]
    ds_read_b128 a[16:19], v182 offset:61440
    v_mfma_f32_16x16x32_bf16 v[92:95], a[156:159], a[24:27], v[92:95]
    s_waitcnt lgkmcnt(5)
    v_mfma_f32_16x16x32_bf16 v[24:27], a[84:87], a[28:31], v[24:27]
    ds_read_b128 a[20:23], v182 offset:62464
    v_mfma_f32_16x16x32_bf16 v[96:99], a[156:159], a[28:31], v[96:99]
    s_add_u32 m0, s44, 81920
    s_add_u32 s46, s45, 225280
    buffer_load_dwordx4 v5, s[16:19], s46 offen offset:0 sc1 lds
    s_waitcnt lgkmcnt(5)
    v_mfma_f32_16x16x32_bf16 v[28:31], a[84:87], a[0:3], v[28:31]
    ds_read_b128 a[24:27], v182 offset:63488
    v_mfma_f32_16x16x32_bf16 v[100:103], a[156:159], a[0:3], v[100:103]
    s_waitcnt lgkmcnt(5)
    v_mfma_f32_16x16x32_bf16 v[32:35], a[84:87], a[4:7], v[32:35]
    ds_read_b128 a[28:31], v182 offset:64512
    v_mfma_f32_16x16x32_bf16 v[104:107], a[156:159], a[4:7], v[104:107]
    s_waitcnt lgkmcnt(5)
    v_mfma_f32_16x16x32_bf16 v[36:39], a[84:87], a[8:11], v[36:39]
    ds_read_b128 a[0:3], v183 offset:0
    v_mfma_f32_16x16x32_bf16 v[108:111], a[156:159], a[8:11], v[108:111]
    s_waitcnt lgkmcnt(5)
    v_mfma_f32_16x16x32_bf16 v[40:43], a[84:87], a[12:15], v[40:43]
    ds_read_b128 a[4:7], v183 offset:1024
    v_mfma_f32_16x16x32_bf16 v[112:115], a[156:159], a[12:15], v[112:115]
    buffer_load_dwordx4 v5, s[16:19], s46 offen offset:1024 sc1 lds
    s_waitcnt lgkmcnt(5)
    v_mfma_f32_16x16x32_bf16 v[44:47], a[84:87], a[16:19], v[44:47]
    ds_read_b128 a[8:11], v183 offset:2048
    v_mfma_f32_16x16x32_bf16 v[116:119], a[156:159], a[16:19], v[116:119]
    s_waitcnt lgkmcnt(5)
    v_mfma_f32_16x16x32_bf16 v[48:51], a[84:87], a[20:23], v[48:51]
    ds_read_b128 a[12:15], v183 offset:3072
    v_mfma_f32_16x16x32_bf16 v[120:123], a[156:159], a[20:23], v[120:123]
    s_waitcnt vmcnt(30)
    s_waitcnt lgkmcnt(5)
    v_mfma_f32_16x16x32_bf16 v[16:19], a[88:91], a[24:27], v[16:19]
    ds_read_b128 a[16:19], v183 offset:4096
    v_mfma_f32_16x16x32_bf16 v[88:91], a[160:163], a[24:27], v[88:91]
    s_waitcnt lgkmcnt(5)
    v_mfma_f32_16x16x32_bf16 v[20:23], a[88:91], a[28:31], v[20:23]
    ds_read_b128 a[20:23], v183 offset:5120
    v_mfma_f32_16x16x32_bf16 v[92:95], a[160:163], a[28:31], v[92:95]
    buffer_load_dwordx4 v5, s[16:19], s46 offen offset:2048 sc1 lds
    s_waitcnt lgkmcnt(5)
    v_mfma_f32_16x16x32_bf16 v[24:27], a[88:91], a[0:3], v[24:27]
    ds_read_b128 a[24:27], v183 offset:6144
    v_mfma_f32_16x16x32_bf16 v[96:99], a[160:163], a[0:3], v[96:99]
    s_waitcnt lgkmcnt(5)
    v_mfma_f32_16x16x32_bf16 v[28:31], a[88:91], a[4:7], v[28:31]
    ds_read_b128 a[28:31], v183 offset:7168
    v_mfma_f32_16x16x32_bf16 v[100:103], a[160:163], a[4:7], v[100:103]
    s_waitcnt lgkmcnt(5)
    v_mfma_f32_16x16x32_bf16 v[32:35], a[88:91], a[8:11], v[32:35]
    ds_read_b128 a[0:3], v183 offset:8192
    v_mfma_f32_16x16x32_bf16 v[104:107], a[160:163], a[8:11], v[104:107]
    s_waitcnt lgkmcnt(5)
    v_mfma_f32_16x16x32_bf16 v[36:39], a[88:91], a[12:15], v[36:39]
    ds_read_b128 a[4:7], v183 offset:9216
    v_mfma_f32_16x16x32_bf16 v[108:111], a[160:163], a[12:15], v[108:111]
    buffer_load_dwordx4 v5, s[16:19], s46 offen offset:3072 sc1 lds
    s_waitcnt lgkmcnt(5)
    v_mfma_f32_16x16x32_bf16 v[40:43], a[88:91], a[16:19], v[40:43]
    ds_read_b128 a[8:11], v183 offset:10240
    v_mfma_f32_16x16x32_bf16 v[112:115], a[160:163], a[16:19], v[112:115]
    s_waitcnt lgkmcnt(5)
    v_mfma_f32_16x16x32_bf16 v[44:47], a[88:91], a[20:23], v[44:47]
    ds_read_b128 a[12:15], v183 offset:11264
    v_mfma_f32_16x16x32_bf16 v[116:119], a[160:163], a[20:23], v[116:119]
    s_waitcnt lgkmcnt(5)
    v_mfma_f32_16x16x32_bf16 v[48:51], a[88:91], a[24:27], v[48:51]
    ds_read_b128 a[16:19], v183 offset:12288
    v_mfma_f32_16x16x32_bf16 v[120:123], a[160:163], a[24:27], v[120:123]
    s_waitcnt vmcnt(30)
    s_waitcnt lgkmcnt(5)
    v_mfma_f32_16x16x32_bf16 v[16:19], a[92:95], a[28:31], v[16:19]
    ds_read_b128 a[20:23], v183 offset:13312
    v_mfma_f32_16x16x32_bf16 v[88:91], a[164:167], a[28:31], v[88:91]
    s_add_u32 m0, s44, 86016
    s_add_u32 s46, s45, 229376
    buffer_load_dwordx4 v5, s[16:19], s46 offen offset:0 sc1 lds
    s_waitcnt lgkmcnt(5)
    v_mfma_f32_16x16x32_bf16 v[20:23], a[92:95], a[0:3], v[20:23]
    ds_read_b128 a[24:27], v183 offset:14336
    v_mfma_f32_16x16x32_bf16 v[92:95], a[164:167], a[0:3], v[92:95]
    s_waitcnt lgkmcnt(5)
    v_mfma_f32_16x16x32_bf16 v[24:27], a[92:95], a[4:7], v[24:27]
    ds_read_b128 a[28:31], v183 offset:15360
    v_mfma_f32_16x16x32_bf16 v[96:99], a[164:167], a[4:7], v[96:99]
    s_waitcnt lgkmcnt(5)
    v_mfma_f32_16x16x32_bf16 v[28:31], a[92:95], a[8:11], v[28:31]
    v_mfma_f32_16x16x32_bf16 v[100:103], a[164:167], a[8:11], v[100:103]
    s_waitcnt lgkmcnt(4)
    v_mfma_f32_16x16x32_bf16 v[32:35], a[92:95], a[12:15], v[32:35]
    v_mfma_f32_16x16x32_bf16 v[104:107], a[164:167], a[12:15], v[104:107]
    s_waitcnt lgkmcnt(3)
    v_mfma_f32_16x16x32_bf16 v[36:39], a[92:95], a[16:19], v[36:39]
    v_mfma_f32_16x16x32_bf16 v[108:111], a[164:167], a[16:19], v[108:111]
    s_waitcnt lgkmcnt(0)
    s_waitcnt vmcnt(18)
    s_barrier
    ds_read_b128 a[0:3], v181 offset:0
    s_add_u32 m0, s44, 114688
    s_add_u32 s46, s45, 258048
    buffer_load_dwordx4 v5, s[16:19], s46 offen offset:0 sc1 lds
    v_mfma_f32_16x16x32_bf16 v[40:43], a[92:95], a[20:23], v[40:43]
    ds_read_b128 a[4:7], v181 offset:1024
    v_mfma_f32_16x16x32_bf16 v[112:115], a[164:167], a[20:23], v[112:115]
    ds_read_b128 a[8:11], v181 offset:2048
    v_mfma_f32_16x16x32_bf16 v[44:47], a[92:95], a[24:27], v[44:47]
    ds_read_b128 a[12:15], v181 offset:3072
    v_mfma_f32_16x16x32_bf16 v[116:119], a[164:167], a[24:27], v[116:119]
    ds_read_b128 a[16:19], v181 offset:4096
    v_mfma_f32_16x16x32_bf16 v[48:51], a[92:95], a[28:31], v[48:51]
    ds_read_b128 a[20:23], v181 offset:5120
    v_mfma_f32_16x16x32_bf16 v[120:123], a[164:167], a[28:31], v[120:123]
    buffer_load_dwordx4 v5, s[16:19], s46 offen offset:1024 sc1 lds
    s_waitcnt lgkmcnt(5)
    v_mfma_f32_16x16x32_bf16 v[16:19], a[96:99], a[0:3], v[16:19]
    ds_read_b128 a[24:27], v181 offset:6144
    v_mfma_f32_16x16x32_bf16 v[88:91], a[168:171], a[0:3], v[88:91]
    s_waitcnt lgkmcnt(5)
    v_mfma_f32_16x16x32_bf16 v[20:23], a[96:99], a[4:7], v[20:23]
    ds_read_b128 a[28:31], v181 offset:7168
    v_mfma_f32_16x16x32_bf16 v[92:95], a[168:171], a[4:7], v[92:95]
    s_waitcnt lgkmcnt(5)
    v_mfma_f32_16x16x32_bf16 v[24:27], a[96:99], a[8:11], v[24:27]
    ds_read_b128 a[0:3], v181 offset:8192
    v_mfma_f32_16x16x32_bf16 v[96:99], a[168:171], a[8:11], v[96:99]
    s_waitcnt lgkmcnt(5)
    v_mfma_f32_16x16x32_bf16 v[28:31], a[96:99], a[12:15], v[28:31]
    ds_read_b128 a[4:7], v181 offset:9216
    v_mfma_f32_16x16x32_bf16 v[100:103], a[168:171], a[12:15], v[100:103]
    buffer_load_dwordx4 v5, s[16:19], s46 offen offset:2048 sc1 lds
    s_waitcnt lgkmcnt(5)
    v_mfma_f32_16x16x32_bf16 v[32:35], a[96:99], a[16:19], v[32:35]
    ds_read_b128 a[8:11], v181 offset:10240
    v_mfma_f32_16x16x32_bf16 v[104:107], a[168:171], a[16:19], v[104:107]
    s_waitcnt lgkmcnt(5)
    v_mfma_f32_16x16x32_bf16 v[36:39], a[96:99], a[20:23], v[36:39]
    ds_read_b128 a[12:15], v181 offset:11264
    v_mfma_f32_16x16x32_bf16 v[108:111], a[168:171], a[20:23], v[108:111]
    s_waitcnt lgkmcnt(5)
    v_mfma_f32_16x16x32_bf16 v[40:43], a[96:99], a[24:27], v[40:43]
    ds_read_b128 a[16:19], v181 offset:12288
    v_mfma_f32_16x16x32_bf16 v[112:115], a[168:171], a[24:27], v[112:115]
    s_waitcnt lgkmcnt(5)
    v_mfma_f32_16x16x32_bf16 v[44:47], a[96:99], a[28:31], v[44:47]
    ds_read_b128 a[20:23], v181 offset:13312
    v_mfma_f32_16x16x32_bf16 v[116:119], a[168:171], a[28:31], v[116:119]
    buffer_load_dwordx4 v5, s[16:19], s46 offen offset:3072 sc1 lds
    s_waitcnt lgkmcnt(5)
    v_mfma_f32_16x16x32_bf16 v[48:51], a[96:99], a[0:3], v[48:51]
    ds_read_b128 a[24:27], v181 offset:14336
    v_mfma_f32_16x16x32_bf16 v[120:123], a[168:171], a[0:3], v[120:123]
    s_waitcnt lgkmcnt(5)
    v_mfma_f32_16x16x32_bf16 v[16:19], a[100:103], a[4:7], v[16:19]
    ds_read_b128 a[28:31], v181 offset:15360
    v_mfma_f32_16x16x32_bf16 v[88:91], a[172:175], a[4:7], v[88:91]
    s_waitcnt lgkmcnt(5)
    v_mfma_f32_16x16x32_bf16 v[20:23], a[100:103], a[8:11], v[20:23]
    ds_read_b128 a[0:3], v181 offset:16384
    v_mfma_f32_16x16x32_bf16 v[92:95], a[172:175], a[8:11], v[92:95]
    s_waitcnt lgkmcnt(5)
    v_mfma_f32_16x16x32_bf16 v[24:27], a[100:103], a[12:15], v[24:27]
    ds_read_b128 a[4:7], v181 offset:17408
    v_mfma_f32_16x16x32_bf16 v[96:99], a[172:175], a[12:15], v[96:99]
    s_add_u32 m0, s44, 118784
    s_add_u32 s46, s45, 262144
    buffer_load_dwordx4 v5, s[16:19], s46 offen offset:0 sc1 lds
    s_waitcnt lgkmcnt(5)
    v_mfma_f32_16x16x32_bf16 v[28:31], a[100:103], a[16:19], v[28:31]
    ds_read_b128 a[8:11], v181 offset:18432
    v_mfma_f32_16x16x32_bf16 v[100:103], a[172:175], a[16:19], v[100:103]
    s_waitcnt lgkmcnt(5)
    v_mfma_f32_16x16x32_bf16 v[32:35], a[100:103], a[20:23], v[32:35]
    ds_read_b128 a[12:15], v181 offset:19456
    v_mfma_f32_16x16x32_bf16 v[104:107], a[172:175], a[20:23], v[104:107]
    s_waitcnt lgkmcnt(5)
    v_mfma_f32_16x16x32_bf16 v[36:39], a[100:103], a[24:27], v[36:39]
    ds_read_b128 a[16:19], v181 offset:20480
    v_mfma_f32_16x16x32_bf16 v[108:111], a[172:175], a[24:27], v[108:111]
    s_waitcnt lgkmcnt(5)
    v_mfma_f32_16x16x32_bf16 v[40:43], a[100:103], a[28:31], v[40:43]
    ds_read_b128 a[20:23], v181 offset:21504
    v_mfma_f32_16x16x32_bf16 v[112:115], a[172:175], a[28:31], v[112:115]
    buffer_load_dwordx4 v5, s[16:19], s46 offen offset:1024 sc1 lds
    s_waitcnt lgkmcnt(5)
    v_mfma_f32_16x16x32_bf16 v[44:47], a[100:103], a[0:3], v[44:47]
    ds_read_b128 a[24:27], v181 offset:22528
    v_mfma_f32_16x16x32_bf16 v[116:119], a[172:175], a[0:3], v[116:119]
    s_waitcnt lgkmcnt(5)
    v_mfma_f32_16x16x32_bf16 v[48:51], a[100:103], a[4:7], v[48:51]
    ds_read_b128 a[28:31], v181 offset:23552
    v_mfma_f32_16x16x32_bf16 v[120:123], a[172:175], a[4:7], v[120:123]
    v_pk_fma_f32 v[16:17], v[52:53], v[76:77], v[16:17]
    v_pk_fma_f32 v[18:19], v[54:55], v[76:77], v[18:19]
    v_pk_mul_f32 v[132:133], v[16:17], v[16:17]
    v_pk_mul_f32 v[134:135], v[18:19], v[18:19]
    v_pk_fma_f32 v[132:133], v[132:133], v[68:69], v[60:61]
    v_pk_fma_f32 v[134:135], v[134:135], v[70:71], v[62:63]
    v_pk_mul_f32 v[132:133], v[132:133], v[16:17]
    v_pk_mul_f32 v[134:135], v[134:135], v[18:19]
    v_exp_f32 v132, v132
    v_pk_fma_f32 v[88:89], v[56:57], v[76:77], v[88:89]
    v_exp_f32 v133, v133
    v_pk_fma_f32 v[90:91], v[58:59], v[76:77], v[90:91]
    v_exp_f32 v134, v134
    v_pk_mul_f32 v[136:137], v[88:89], v[88:89]
    v_exp_f32 v135, v135
    v_pk_mul_f32 v[138:139], v[90:91], v[90:91]
    v_pk_add_f32 v[132:133], v[132:133], 1.0 op_sel_hi:[1,0]
    v_pk_add_f32 v[134:135], v[134:135], 1.0 op_sel_hi:[1,0]
    v_rcp_f32 v132, v132
    v_pk_fma_f32 v[136:137], v[136:137], v[72:73], v[64:65]
    v_rcp_f32 v133, v133
    v_pk_fma_f32 v[138:139], v[138:139], v[74:75], v[66:67]
    v_rcp_f32 v134, v134
    v_pk_mul_f32 v[136:137], v[136:137], v[88:89]
    v_rcp_f32 v135, v135
    v_pk_mul_f32 v[138:139], v[138:139], v[90:91]
    buffer_load_dwordx4 v5, s[16:19], s46 offen offset:2048 sc1 lds
    v_exp_f32 v136, v136
    v_pk_mul_f32 v[16:17], v[16:17], v[132:133]
    v_pk_mul_f32 v[18:19], v[18:19], v[134:135]
    v_exp_f32 v137, v137
    v_pk_mul_f32 v[224:225], v[16:17], v[16:17]
    v_pk_mul_f32 v[226:227], v[18:19], v[18:19]
    v_exp_f32 v138, v138
    v_mov_b32 v216, v16
    v_mov_b32 v217, v17
    v_exp_f32 v139, v139
    v_mov_b32 v218, v18
    v_mov_b32 v219, v19
    v_pk_add_f32 v[136:137], v[136:137], 1.0 op_sel_hi:[1,0]
    v_pk_add_f32 v[138:139], v[138:139], 1.0 op_sel_hi:[1,0]
    v_rcp_f32 v136, v136
    v_pk_fma_f32 v[20:21], v[52:53], v[78:79], v[20:21]
    v_pk_fma_f32 v[22:23], v[54:55], v[78:79], v[22:23]
    v_rcp_f32 v137, v137
    v_pk_mul_f32 v[132:133], v[20:21], v[20:21]
    v_pk_mul_f32 v[134:135], v[22:23], v[22:23]
    v_rcp_f32 v138, v138
    v_pk_fma_f32 v[132:133], v[132:133], v[68:69], v[60:61]
    v_pk_fma_f32 v[134:135], v[134:135], v[70:71], v[62:63]
    v_rcp_f32 v139, v139
    v_pk_mul_f32 v[132:133], v[132:133], v[20:21]
    v_pk_mul_f32 v[134:135], v[134:135], v[22:23]
    buffer_load_dwordx4 v5, s[16:19], s46 offen offset:3072 sc1 lds
    v_exp_f32 v132, v132
    v_pk_mul_f32 v[88:89], v[88:89], v[136:137]
    v_pk_mul_f32 v[90:91], v[90:91], v[138:139]
    v_exp_f32 v133, v133
    v_pk_mul_f32 v[228:229], v[88:89], v[88:89]
    v_pk_mul_f32 v[230:231], v[90:91], v[90:91]
    v_exp_f32 v134, v134
    v_mov_b32 v220, v88
    v_mov_b32 v221, v89
    v_exp_f32 v135, v135
    v_mov_b32 v222, v90
    v_mov_b32 v223, v91
    v_pk_add_f32 v[132:133], v[132:133], 1.0 op_sel_hi:[1,0]
    v_pk_add_f32 v[134:135], v[134:135], 1.0 op_sel_hi:[1,0]
    v_rcp_f32 v132, v132
    v_pk_fma_f32 v[92:93], v[56:57], v[78:79], v[92:93]
    v_pk_fma_f32 v[94:95], v[58:59], v[78:79], v[94:95]
    v_rcp_f32 v133, v133
    v_pk_mul_f32 v[136:137], v[92:93], v[92:93]
    v_pk_mul_f32 v[138:139], v[94:95], v[94:95]
    v_rcp_f32 v134, v134
    v_pk_fma_f32 v[136:137], v[136:137], v[72:73], v[64:65]
    v_pk_fma_f32 v[138:139], v[138:139], v[74:75], v[66:67]
    v_rcp_f32 v135, v135
    v_pk_mul_f32 v[136:137], v[136:137], v[92:93]
    v_pk_mul_f32 v[138:139], v[138:139], v[94:95]
    s_add_u32 m0, s44, 122880
    s_add_u32 s46, s45, 266240
    buffer_load_dwordx4 v5, s[16:19], s46 offen offset:0 sc1 lds
    v_exp_f32 v136, v136
    v_pk_mul_f32 v[20:21], v[20:21], v[132:133]
    v_pk_mul_f32 v[22:23], v[22:23], v[134:135]
    v_exp_f32 v137, v137
    v_pk_add_f32 v[216:217], v[216:217], v[20:21]
    v_pk_add_f32 v[218:219], v[218:219], v[22:23]
    v_exp_f32 v138, v138
    v_pk_fma_f32 v[224:225], v[20:21], v[20:21], v[224:225]
    v_pk_fma_f32 v[226:227], v[22:23], v[22:23], v[226:227]
    v_exp_f32 v139, v139
    v_pk_fma_f32 v[24:25], v[52:53], v[80:81], v[24:25]
    v_pk_fma_f32 v[26:27], v[54:55], v[80:81], v[26:27]
    v_pk_add_f32 v[136:137], v[136:137], 1.0 op_sel_hi:[1,0]
    v_pk_add_f32 v[138:139], v[138:139], 1.0 op_sel_hi:[1,0]
    v_rcp_f32 v136, v136
    v_pk_mul_f32 v[132:133], v[24:25], v[24:25]
    v_pk_mul_f32 v[134:135], v[26:27], v[26:27]
    v_rcp_f32 v137, v137
    v_pk_fma_f32 v[132:133], v[132:133], v[68:69], v[60:61]
    v_pk_fma_f32 v[134:135], v[134:135], v[70:71], v[62:63]
    v_rcp_f32 v138, v138
    v_pk_mul_f32 v[132:133], v[132:133], v[24:25]
    v_pk_mul_f32 v[134:135], v[134:135], v[26:27]
    v_rcp_f32 v139, v139
    v_exp_f32 v132, v132
    v_pk_mul_f32 v[92:93], v[92:93], v[136:137]
    v_pk_mul_f32 v[94:95], v[94:95], v[138:139]
    v_exp_f32 v133, v133
    v_pk_add_f32 v[220:221], v[220:221], v[92:93]
    v_pk_add_f32 v[222:223], v[222:223], v[94:95]
    v_exp_f32 v134, v134
    v_pk_fma_f32 v[228:229], v[92:93], v[92:93], v[228:229]
    v_pk_fma_f32 v[230:231], v[94:95], v[94:95], v[230:231]
    v_exp_f32 v135, v135
    v_pk_fma_f32 v[96:97], v[56:57], v[80:81], v[96:97]
    v_pk_fma_f32 v[98:99], v[58:59], v[80:81], v[98:99]
    v_pk_add_f32 v[132:133], v[132:133], 1.0 op_sel_hi:[1,0]
    v_pk_add_f32 v[134:135], v[134:135], 1.0 op_sel_hi:[1,0]
    v_rcp_f32 v132, v132
    v_pk_mul_f32 v[136:137], v[96:97], v[96:97]
    v_pk_mul_f32 v[138:139], v[98:99], v[98:99]
    v_rcp_f32 v133, v133
    v_pk_fma_f32 v[136:137], v[136:137], v[72:73], v[64:65]
    v_pk_fma_f32 v[138:139], v[138:139], v[74:75], v[66:67]
    v_rcp_f32 v134, v134
    v_pk_mul_f32 v[136:137], v[136:137], v[96:97]
    v_pk_mul_f32 v[138:139], v[138:139], v[98:99]
    v_rcp_f32 v135, v135
    v_exp_f32 v136, v136
    v_pk_mul_f32 v[24:25], v[24:25], v[132:133]
    v_pk_mul_f32 v[26:27], v[26:27], v[134:135]
    v_exp_f32 v137, v137
    v_pk_add_f32 v[216:217], v[216:217], v[24:25]
    v_pk_add_f32 v[218:219], v[218:219], v[26:27]
    v_exp_f32 v138, v138
    v_pk_fma_f32 v[224:225], v[24:25], v[24:25], v[224:225]
    v_pk_fma_f32 v[226:227], v[26:27], v[26:27], v[226:227]
    v_exp_f32 v139, v139
    v_pk_fma_f32 v[28:29], v[52:53], v[82:83], v[28:29]
    v_pk_fma_f32 v[30:31], v[54:55], v[82:83], v[30:31]
    v_pk_add_f32 v[136:137], v[136:137], 1.0 op_sel_hi:[1,0]
    v_pk_add_f32 v[138:139], v[138:139], 1.0 op_sel_hi:[1,0]
    v_rcp_f32 v136, v136
    v_pk_mul_f32 v[132:133], v[28:29], v[28:29]
    v_pk_mul_f32 v[134:135], v[30:31], v[30:31]
    v_rcp_f32 v137, v137
    v_pk_fma_f32 v[132:133], v[132:133], v[68:69], v[60:61]
    v_pk_fma_f32 v[134:135], v[134:135], v[70:71], v[62:63]
    v_rcp_f32 v138, v138
    v_pk_mul_f32 v[132:133], v[132:133], v[28:29]
    v_pk_mul_f32 v[134:135], v[134:135], v[30:31]
    v_rcp_f32 v139, v139
    v_exp_f32 v132, v132
    v_pk_mul_f32 v[96:97], v[96:97], v[136:137]
    v_pk_mul_f32 v[98:99], v[98:99], v[138:139]
    v_exp_f32 v133, v133
    v_pk_add_f32 v[220:221], v[220:221], v[96:97]
    v_pk_add_f32 v[222:223], v[222:223], v[98:99]
    v_exp_f32 v134, v134
    v_pk_fma_f32 v[228:229], v[96:97], v[96:97], v[228:229]
    v_pk_fma_f32 v[230:231], v[98:99], v[98:99], v[230:231]
    v_exp_f32 v135, v135
    v_pk_fma_f32 v[100:101], v[56:57], v[82:83], v[100:101]
    v_pk_fma_f32 v[102:103], v[58:59], v[82:83], v[102:103]
    v_pk_add_f32 v[132:133], v[132:133], 1.0 op_sel_hi:[1,0]
    v_pk_add_f32 v[134:135], v[134:135], 1.0 op_sel_hi:[1,0]
    v_rcp_f32 v132, v132
    v_pk_mul_f32 v[136:137], v[100:101], v[100:101]
    v_pk_mul_f32 v[138:139], v[102:103], v[102:103]
    v_rcp_f32 v133, v133
    v_pk_fma_f32 v[136:137], v[136:137], v[72:73], v[64:65]
    v_pk_fma_f32 v[138:139], v[138:139], v[74:75], v[66:67]
    v_rcp_f32 v134, v134
    v_pk_mul_f32 v[136:137], v[136:137], v[100:101]
    v_pk_mul_f32 v[138:139], v[138:139], v[102:103]
    v_rcp_f32 v135, v135
    v_exp_f32 v136, v136
    v_pk_mul_f32 v[28:29], v[28:29], v[132:133]
    v_pk_mul_f32 v[30:31], v[30:31], v[134:135]
    v_exp_f32 v137, v137
    v_pk_add_f32 v[216:217], v[216:217], v[28:29]
    v_pk_add_f32 v[218:219], v[218:219], v[30:31]
    v_exp_f32 v138, v138
    v_pk_fma_f32 v[224:225], v[28:29], v[28:29], v[224:225]
    v_pk_fma_f32 v[226:227], v[30:31], v[30:31], v[226:227]
    v_exp_f32 v139, v139
    v_pk_fma_f32 v[32:33], v[52:53], v[84:85], v[32:33]
    v_pk_fma_f32 v[34:35], v[54:55], v[84:85], v[34:35]
    v_pk_add_f32 v[136:137], v[136:137], 1.0 op_sel_hi:[1,0]
    v_pk_add_f32 v[138:139], v[138:139], 1.0 op_sel_hi:[1,0]
    v_rcp_f32 v136, v136
    v_pk_mul_f32 v[132:133], v[32:33], v[32:33]
    v_pk_mul_f32 v[134:135], v[34:35], v[34:35]
    v_rcp_f32 v137, v137
    v_pk_fma_f32 v[132:133], v[132:133], v[68:69], v[60:61]
    v_pk_fma_f32 v[134:135], v[134:135], v[70:71], v[62:63]
    v_rcp_f32 v138, v138
    v_pk_mul_f32 v[132:133], v[132:133], v[32:33]
    v_pk_mul_f32 v[134:135], v[134:135], v[34:35]
    v_rcp_f32 v139, v139
    v_exp_f32 v132, v132
    v_pk_mul_f32 v[100:101], v[100:101], v[136:137]
    v_pk_mul_f32 v[102:103], v[102:103], v[138:139]
    v_exp_f32 v133, v133
    v_pk_add_f32 v[220:221], v[220:221], v[100:101]
    v_pk_add_f32 v[222:223], v[222:223], v[102:103]
    v_exp_f32 v134, v134
    v_pk_fma_f32 v[228:229], v[100:101], v[100:101], v[228:229]
    v_pk_fma_f32 v[230:231], v[102:103], v[102:103], v[230:231]
    v_exp_f32 v135, v135
    v_pk_fma_f32 v[104:105], v[56:57], v[84:85], v[104:105]
    v_pk_fma_f32 v[106:107], v[58:59], v[84:85], v[106:107]
    v_pk_add_f32 v[132:133], v[132:133], 1.0 op_sel_hi:[1,0]
    v_pk_add_f32 v[134:135], v[134:135], 1.0 op_sel_hi:[1,0]
    v_rcp_f32 v132, v132
    v_pk_mul_f32 v[136:137], v[104:105], v[104:105]
    v_pk_mul_f32 v[138:139], v[106:107], v[106:107]
    v_rcp_f32 v133, v133
    v_pk_fma_f32 v[136:137], v[136:137], v[72:73], v[64:65]
    v_pk_fma_f32 v[138:139], v[138:139], v[74:75], v[66:67]
    v_rcp_f32 v134, v134
    v_pk_mul_f32 v[136:137], v[136:137], v[104:105]
    v_pk_mul_f32 v[138:139], v[138:139], v[106:107]
    v_rcp_f32 v135, v135
    v_exp_f32 v136, v136
    v_pk_mul_f32 v[32:33], v[32:33], v[132:133]
    v_pk_mul_f32 v[34:35], v[34:35], v[134:135]
    v_exp_f32 v137, v137
    v_pk_add_f32 v[216:217], v[216:217], v[32:33]
    v_pk_add_f32 v[218:219], v[218:219], v[34:35]
    v_exp_f32 v138, v138
    v_pk_fma_f32 v[224:225], v[32:33], v[32:33], v[224:225]
    v_pk_fma_f32 v[226:227], v[34:35], v[34:35], v[226:227]
    v_exp_f32 v139, v139
    v_pk_fma_f32 v[36:37], v[52:53], v[86:87], v[36:37]
    v_pk_fma_f32 v[38:39], v[54:55], v[86:87], v[38:39]
    v_pk_add_f32 v[136:137], v[136:137], 1.0 op_sel_hi:[1,0]
    v_pk_add_f32 v[138:139], v[138:139], 1.0 op_sel_hi:[1,0]
    v_rcp_f32 v136, v136
    v_pk_mul_f32 v[132:133], v[36:37], v[36:37]
    v_pk_mul_f32 v[134:135], v[38:39], v[38:39]
    v_rcp_f32 v137, v137
    v_pk_fma_f32 v[132:133], v[132:133], v[68:69], v[60:61]
    v_pk_fma_f32 v[134:135], v[134:135], v[70:71], v[62:63]
    v_rcp_f32 v138, v138
    v_pk_mul_f32 v[132:133], v[132:133], v[36:37]
    v_pk_mul_f32 v[134:135], v[134:135], v[38:39]
    v_rcp_f32 v139, v139
    v_exp_f32 v132, v132
    v_pk_mul_f32 v[104:105], v[104:105], v[136:137]
    v_pk_mul_f32 v[106:107], v[106:107], v[138:139]
    v_exp_f32 v133, v133
    v_pk_add_f32 v[220:221], v[220:221], v[104:105]
    v_pk_add_f32 v[222:223], v[222:223], v[106:107]
    v_exp_f32 v134, v134
    v_pk_fma_f32 v[228:229], v[104:105], v[104:105], v[228:229]
    v_pk_fma_f32 v[230:231], v[106:107], v[106:107], v[230:231]
    v_exp_f32 v135, v135
    v_pk_fma_f32 v[108:109], v[56:57], v[86:87], v[108:109]
    v_pk_fma_f32 v[110:111], v[58:59], v[86:87], v[110:111]
    v_pk_add_f32 v[132:133], v[132:133], 1.0 op_sel_hi:[1,0]
    v_pk_add_f32 v[134:135], v[134:135], 1.0 op_sel_hi:[1,0]
    v_rcp_f32 v132, v132
    v_pk_mul_f32 v[136:137], v[108:109], v[108:109]
    v_pk_mul_f32 v[138:139], v[110:111], v[110:111]
    v_rcp_f32 v133, v133
    v_pk_fma_f32 v[136:137], v[136:137], v[72:73], v[64:65]
    v_pk_fma_f32 v[138:139], v[138:139], v[74:75], v[66:67]
    v_rcp_f32 v134, v134
    v_pk_mul_f32 v[136:137], v[136:137], v[108:109]
    v_pk_mul_f32 v[138:139], v[138:139], v[110:111]
    v_rcp_f32 v135, v135
    v_exp_f32 v136, v136
    v_pk_mul_f32 v[36:37], v[36:37], v[132:133]
    v_pk_mul_f32 v[38:39], v[38:39], v[134:135]
    v_exp_f32 v137, v137
    v_pk_add_f32 v[216:217], v[216:217], v[36:37]
    v_pk_add_f32 v[218:219], v[218:219], v[38:39]
    v_exp_f32 v138, v138
    v_pk_fma_f32 v[224:225], v[36:37], v[36:37], v[224:225]
    v_pk_fma_f32 v[226:227], v[38:39], v[38:39], v[226:227]
    v_exp_f32 v139, v139
    v_pk_fma_f32 v[40:41], v[52:53], v[124:125], v[40:41]
    v_pk_fma_f32 v[42:43], v[54:55], v[124:125], v[42:43]
    v_pk_add_f32 v[136:137], v[136:137], 1.0 op_sel_hi:[1,0]
    v_pk_add_f32 v[138:139], v[138:139], 1.0 op_sel_hi:[1,0]
    v_rcp_f32 v136, v136
    v_pk_mul_f32 v[132:133], v[40:41], v[40:41]
    v_pk_mul_f32 v[134:135], v[42:43], v[42:43]
    v_rcp_f32 v137, v137
    v_pk_fma_f32 v[132:133], v[132:133], v[68:69], v[60:61]
    v_pk_fma_f32 v[134:135], v[134:135], v[70:71], v[62:63]
    v_rcp_f32 v138, v138
    v_pk_mul_f32 v[132:133], v[132:133], v[40:41]
    v_pk_mul_f32 v[134:135], v[134:135], v[42:43]
    v_rcp_f32 v139, v139
    v_exp_f32 v132, v132
    v_pk_mul_f32 v[108:109], v[108:109], v[136:137]
    v_pk_mul_f32 v[110:111], v[110:111], v[138:139]
    v_exp_f32 v133, v133
    v_pk_add_f32 v[220:221], v[220:221], v[108:109]
    v_pk_add_f32 v[222:223], v[222:223], v[110:111]
    v_exp_f32 v134, v134
    v_pk_fma_f32 v[228:229], v[108:109], v[108:109], v[228:229]
    v_pk_fma_f32 v[230:231], v[110:111], v[110:111], v[230:231]
    v_exp_f32 v135, v135
    v_pk_fma_f32 v[112:113], v[56:57], v[124:125], v[112:113]
    v_pk_fma_f32 v[114:115], v[58:59], v[124:125], v[114:115]
    v_pk_add_f32 v[132:133], v[132:133], 1.0 op_sel_hi:[1,0]
    v_pk_add_f32 v[134:135], v[134:135], 1.0 op_sel_hi:[1,0]
    v_rcp_f32 v132, v132
    v_pk_mul_f32 v[136:137], v[112:113], v[112:113]
    v_pk_mul_f32 v[138:139], v[114:115], v[114:115]
    v_rcp_f32 v133, v133
    v_pk_fma_f32 v[136:137], v[136:137], v[72:73], v[64:65]
    v_pk_fma_f32 v[138:139], v[138:139], v[74:75], v[66:67]
    v_rcp_f32 v134, v134
    v_pk_mul_f32 v[136:137], v[136:137], v[112:113]
    v_pk_mul_f32 v[138:139], v[138:139], v[114:115]
    v_rcp_f32 v135, v135
    v_exp_f32 v136, v136
    v_pk_mul_f32 v[40:41], v[40:41], v[132:133]
    v_pk_mul_f32 v[42:43], v[42:43], v[134:135]
    v_exp_f32 v137, v137
    v_pk_add_f32 v[216:217], v[216:217], v[40:41]
    v_pk_add_f32 v[218:219], v[218:219], v[42:43]
    v_exp_f32 v138, v138
    v_pk_fma_f32 v[224:225], v[40:41], v[40:41], v[224:225]
    v_pk_fma_f32 v[226:227], v[42:43], v[42:43], v[226:227]
    v_exp_f32 v139, v139
    v_pk_fma_f32 v[44:45], v[52:53], v[126:127], v[44:45]
    v_pk_fma_f32 v[46:47], v[54:55], v[126:127], v[46:47]
    v_pk_add_f32 v[136:137], v[136:137], 1.0 op_sel_hi:[1,0]
    v_pk_add_f32 v[138:139], v[138:139], 1.0 op_sel_hi:[1,0]
    v_rcp_f32 v136, v136
    v_pk_mul_f32 v[132:133], v[44:45], v[44:45]
    v_pk_mul_f32 v[134:135], v[46:47], v[46:47]
    v_rcp_f32 v137, v137
    v_pk_fma_f32 v[132:133], v[132:133], v[68:69], v[60:61]
    v_pk_fma_f32 v[134:135], v[134:135], v[70:71], v[62:63]
    v_rcp_f32 v138, v138
    v_pk_mul_f32 v[132:133], v[132:133], v[44:45]
    v_pk_mul_f32 v[134:135], v[134:135], v[46:47]
    v_rcp_f32 v139, v139
    v_exp_f32 v132, v132
    v_pk_mul_f32 v[112:113], v[112:113], v[136:137]
    v_pk_mul_f32 v[114:115], v[114:115], v[138:139]
    v_exp_f32 v133, v133
    v_pk_add_f32 v[220:221], v[220:221], v[112:113]
    v_pk_add_f32 v[222:223], v[222:223], v[114:115]
    v_exp_f32 v134, v134
    v_pk_fma_f32 v[228:229], v[112:113], v[112:113], v[228:229]
    v_pk_fma_f32 v[230:231], v[114:115], v[114:115], v[230:231]
    v_exp_f32 v135, v135
    v_pk_fma_f32 v[116:117], v[56:57], v[126:127], v[116:117]
    v_pk_fma_f32 v[118:119], v[58:59], v[126:127], v[118:119]
    v_pk_add_f32 v[132:133], v[132:133], 1.0 op_sel_hi:[1,0]
    v_pk_add_f32 v[134:135], v[134:135], 1.0 op_sel_hi:[1,0]
    v_rcp_f32 v132, v132
    v_pk_mul_f32 v[136:137], v[116:117], v[116:117]
    v_pk_mul_f32 v[138:139], v[118:119], v[118:119]
    v_rcp_f32 v133, v133
    v_pk_fma_f32 v[136:137], v[136:137], v[72:73], v[64:65]
    v_pk_fma_f32 v[138:139], v[138:139], v[74:75], v[66:67]
    v_rcp_f32 v134, v134
    v_pk_mul_f32 v[136:137], v[136:137], v[116:117]
    v_pk_mul_f32 v[138:139], v[138:139], v[118:119]
    v_rcp_f32 v135, v135
    v_exp_f32 v136, v136
    v_pk_mul_f32 v[44:45], v[44:45], v[132:133]
    v_pk_mul_f32 v[46:47], v[46:47], v[134:135]
    v_exp_f32 v137, v137
    v_pk_add_f32 v[216:217], v[216:217], v[44:45]
    v_pk_add_f32 v[218:219], v[218:219], v[46:47]
    v_exp_f32 v138, v138
    v_pk_fma_f32 v[224:225], v[44:45], v[44:45], v[224:225]
    v_pk_fma_f32 v[226:227], v[46:47], v[46:47], v[226:227]
    v_exp_f32 v139, v139
    v_pk_fma_f32 v[48:49], v[52:53], v[128:129], v[48:49]
    v_pk_fma_f32 v[50:51], v[54:55], v[128:129], v[50:51]
    v_pk_add_f32 v[136:137], v[136:137], 1.0 op_sel_hi:[1,0]
    v_pk_add_f32 v[138:139], v[138:139], 1.0 op_sel_hi:[1,0]
    v_rcp_f32 v136, v136
    v_pk_mul_f32 v[132:133], v[48:49], v[48:49]
    v_pk_mul_f32 v[134:135], v[50:51], v[50:51]
    v_rcp_f32 v137, v137
    v_pk_fma_f32 v[132:133], v[132:133], v[68:69], v[60:61]
    v_pk_fma_f32 v[134:135], v[134:135], v[70:71], v[62:63]
    v_rcp_f32 v138, v138
    v_pk_mul_f32 v[132:133], v[132:133], v[48:49]
    v_pk_mul_f32 v[134:135], v[134:135], v[50:51]
    v_rcp_f32 v139, v139
    v_exp_f32 v132, v132
    v_pk_mul_f32 v[116:117], v[116:117], v[136:137]
    v_pk_mul_f32 v[118:119], v[118:119], v[138:139]
    v_exp_f32 v133, v133
    v_pk_add_f32 v[220:221], v[220:221], v[116:117]
    v_pk_add_f32 v[222:223], v[222:223], v[118:119]
    v_exp_f32 v134, v134
    v_pk_fma_f32 v[228:229], v[116:117], v[116:117], v[228:229]
    v_pk_fma_f32 v[230:231], v[118:119], v[118:119], v[230:231]
    v_exp_f32 v135, v135
    v_pk_fma_f32 v[120:121], v[56:57], v[128:129], v[120:121]
    v_pk_fma_f32 v[122:123], v[58:59], v[128:129], v[122:123]
    v_pk_add_f32 v[132:133], v[132:133], 1.0 op_sel_hi:[1,0]
    v_pk_add_f32 v[134:135], v[134:135], 1.0 op_sel_hi:[1,0]
    v_rcp_f32 v132, v132
    v_pk_mul_f32 v[136:137], v[120:121], v[120:121]
    v_pk_mul_f32 v[138:139], v[122:123], v[122:123]
    v_rcp_f32 v133, v133
    v_pk_fma_f32 v[136:137], v[136:137], v[72:73], v[64:65]
    v_pk_fma_f32 v[138:139], v[138:139], v[74:75], v[66:67]
    v_rcp_f32 v134, v134
    v_pk_mul_f32 v[136:137], v[136:137], v[120:121]
    v_pk_mul_f32 v[138:139], v[138:139], v[122:123]
    v_rcp_f32 v135, v135
    v_exp_f32 v136, v136
    v_pk_mul_f32 v[48:49], v[48:49], v[132:133]
    v_exp_f32 v137, v137
    v_pk_mul_f32 v[50:51], v[50:51], v[134:135]
    v_exp_f32 v138, v138
    v_pk_add_f32 v[216:217], v[216:217], v[48:49]
    v_exp_f32 v139, v139
    v_pk_add_f32 v[218:219], v[218:219], v[50:51]
    v_pk_add_f32 v[136:137], v[136:137], 1.0 op_sel_hi:[1,0]
    v_pk_add_f32 v[138:139], v[138:139], 1.0 op_sel_hi:[1,0]
    v_rcp_f32 v136, v136
    v_pk_fma_f32 v[224:225], v[48:49], v[48:49], v[224:225]
    v_rcp_f32 v137, v137
    v_pk_fma_f32 v[226:227], v[50:51], v[50:51], v[226:227]
    v_rcp_f32 v138, v138
    v_rcp_f32 v139, v139
    v_pk_mul_f32 v[120:121], v[120:121], v[136:137]
    v_pk_mul_f32 v[122:123], v[122:123], v[138:139]
    v_pk_add_f32 v[220:221], v[220:221], v[120:121]
    v_pk_add_f32 v[222:223], v[222:223], v[122:123]
    v_pk_fma_f32 v[228:229], v[120:121], v[120:121], v[228:229]
    v_pk_fma_f32 v[230:231], v[122:123], v[122:123], v[230:231]
    v_add_f32_dpp v216, v216, v216 row_ror:8 row_mask:0xf bank_mask:0xf
    v_add_f32_dpp v217, v217, v217 row_ror:8 row_mask:0xf bank_mask:0xf
    v_add_f32_dpp v218, v218, v218 row_ror:8 row_mask:0xf bank_mask:0xf
    v_add_f32_dpp v219, v219, v219 row_ror:8 row_mask:0xf bank_mask:0xf
    v_add_f32_dpp v220, v220, v220 row_ror:8 row_mask:0xf bank_mask:0xf
    v_add_f32_dpp v221, v221, v221 row_ror:8 row_mask:0xf bank_mask:0xf
    v_add_f32_dpp v222, v222, v222 row_ror:8 row_mask:0xf bank_mask:0xf
    v_add_f32_dpp v223, v223, v223 row_ror:8 row_mask:0xf bank_mask:0xf
    v_add_f32_dpp v224, v224, v224 row_ror:8 row_mask:0xf bank_mask:0xf
    v_add_f32_dpp v225, v225, v225 row_ror:8 row_mask:0xf bank_mask:0xf
    v_add_f32_dpp v226, v226, v226 row_ror:8 row_mask:0xf bank_mask:0xf
    v_add_f32_dpp v227, v227, v227 row_ror:8 row_mask:0xf bank_mask:0xf
    v_add_f32_dpp v228, v228, v228 row_ror:8 row_mask:0xf bank_mask:0xf
    v_add_f32_dpp v229, v229, v229 row_ror:8 row_mask:0xf bank_mask:0xf
    v_add_f32_dpp v230, v230, v230 row_ror:8 row_mask:0xf bank_mask:0xf
    v_add_f32_dpp v231, v231, v231 row_ror:8 row_mask:0xf bank_mask:0xf
    v_add_f32_dpp v216, v216, v216 row_ror:4 row_mask:0xf bank_mask:0xf
    v_add_f32_dpp v217, v217, v217 row_ror:4 row_mask:0xf bank_mask:0xf
    v_add_f32_dpp v218, v218, v218 row_ror:4 row_mask:0xf bank_mask:0xf
    v_add_f32_dpp v219, v219, v219 row_ror:4 row_mask:0xf bank_mask:0xf
    v_add_f32_dpp v220, v220, v220 row_ror:4 row_mask:0xf bank_mask:0xf
    v_add_f32_dpp v221, v221, v221 row_ror:4 row_mask:0xf bank_mask:0xf
    v_add_f32_dpp v222, v222, v222 row_ror:4 row_mask:0xf bank_mask:0xf
    v_add_f32_dpp v223, v223, v223 row_ror:4 row_mask:0xf bank_mask:0xf
    v_add_f32_dpp v224, v224, v224 row_ror:4 row_mask:0xf bank_mask:0xf
    v_add_f32_dpp v225, v225, v225 row_ror:4 row_mask:0xf bank_mask:0xf
    v_add_f32_dpp v226, v226, v226 row_ror:4 row_mask:0xf bank_mask:0xf
    v_add_f32_dpp v227, v227, v227 row_ror:4 row_mask:0xf bank_mask:0xf
    v_add_f32_dpp v228, v228, v228 row_ror:4 row_mask:0xf bank_mask:0xf
    v_add_f32_dpp v229, v229, v229 row_ror:4 row_mask:0xf bank_mask:0xf
    v_add_f32_dpp v230, v230, v230 row_ror:4 row_mask:0xf bank_mask:0xf
    v_add_f32_dpp v231, v231, v231 row_ror:4 row_mask:0xf bank_mask:0xf
    v_add_f32_dpp v216, v216, v216 row_ror:2 row_mask:0xf bank_mask:0xf
    v_add_f32_dpp v217, v217, v217 row_ror:2 row_mask:0xf bank_mask:0xf
    v_add_f32_dpp v218, v218, v218 row_ror:2 row_mask:0xf bank_mask:0xf
    v_add_f32_dpp v219, v219, v219 row_ror:2 row_mask:0xf bank_mask:0xf
    v_add_f32_dpp v220, v220, v220 row_ror:2 row_mask:0xf bank_mask:0xf
    v_add_f32_dpp v221, v221, v221 row_ror:2 row_mask:0xf bank_mask:0xf
    v_add_f32_dpp v222, v222, v222 row_ror:2 row_mask:0xf bank_mask:0xf
    v_add_f32_dpp v223, v223, v223 row_ror:2 row_mask:0xf bank_mask:0xf
    v_add_f32_dpp v224, v224, v224 row_ror:2 row_mask:0xf bank_mask:0xf
    v_add_f32_dpp v225, v225, v225 row_ror:2 row_mask:0xf bank_mask:0xf
    v_add_f32_dpp v226, v226, v226 row_ror:2 row_mask:0xf bank_mask:0xf
    v_add_f32_dpp v227, v227, v227 row_ror:2 row_mask:0xf bank_mask:0xf
    v_add_f32_dpp v228, v228, v228 row_ror:2 row_mask:0xf bank_mask:0xf
    v_add_f32_dpp v229, v229, v229 row_ror:2 row_mask:0xf bank_mask:0xf
    v_add_f32_dpp v230, v230, v230 row_ror:2 row_mask:0xf bank_mask:0xf
    v_add_f32_dpp v231, v231, v231 row_ror:2 row_mask:0xf bank_mask:0xf
    v_add_f32_dpp v216, v216, v216 row_ror:1 row_mask:0xf bank_mask:0xf
    v_add_f32_dpp v217, v217, v217 row_ror:1 row_mask:0xf bank_mask:0xf
    v_add_f32_dpp v218, v218, v218 row_ror:1 row_mask:0xf bank_mask:0xf
    v_add_f32_dpp v219, v219, v219 row_ror:1 row_mask:0xf bank_mask:0xf
    v_add_f32_dpp v220, v220, v220 row_ror:1 row_mask:0xf bank_mask:0xf
    v_add_f32_dpp v221, v221, v221 row_ror:1 row_mask:0xf bank_mask:0xf
    v_add_f32_dpp v222, v222, v222 row_ror:1 row_mask:0xf bank_mask:0xf
    v_add_f32_dpp v223, v223, v223 row_ror:1 row_mask:0xf bank_mask:0xf
    v_add_f32_dpp v224, v224, v224 row_ror:1 row_mask:0xf bank_mask:0xf
    v_add_f32_dpp v225, v225, v225 row_ror:1 row_mask:0xf bank_mask:0xf
    v_add_f32_dpp v226, v226, v226 row_ror:1 row_mask:0xf bank_mask:0xf
    v_add_f32_dpp v227, v227, v227 row_ror:1 row_mask:0xf bank_mask:0xf
    v_add_f32_dpp v228, v228, v228 row_ror:1 row_mask:0xf bank_mask:0xf
    v_add_f32_dpp v229, v229, v229 row_ror:1 row_mask:0xf bank_mask:0xf
    v_add_f32_dpp v230, v230, v230 row_ror:1 row_mask:0xf bank_mask:0xf
    v_add_f32_dpp v231, v231, v231 row_ror:1 row_mask:0xf bank_mask:0xf
    v_min_u32 v216, -2, v216
    v_min_u32 v217, -2, v217
    v_min_u32 v218, -2, v218
    v_min_u32 v219, -2, v219
    v_min_u32 v220, -2, v220
    v_min_u32 v221, -2, v221
    v_min_u32 v222, -2, v222
    v_min_u32 v223, -2, v223
    v_min_u32 v224, -2, v224
    v_min_u32 v225, -2, v225
    v_min_u32 v226, -2, v226
    v_min_u32 v227, -2, v227
    v_min_u32 v228, -2, v228
    v_min_u32 v229, -2, v229
    v_min_u32 v230, -2, v230
    v_min_u32 v231, -2, v231
    buffer_store_dwordx4 v[216:219], v189, s[20:23], s58 offen offset:0 sc1
    buffer_store_dwordx4 v[220:223], v189, s[20:23], s58 offen offset:16 sc1
    buffer_store_dwordx4 v[224:227], v189, s[20:23], s58 offen offset:32 sc1
    buffer_store_dwordx4 v[228:231], v189, s[20:23], s58 offen offset:48 sc1
    s_mov_b32 s80, s32
    s_and_b32 s81, s33, 0xffff
    s_mov_b32 s82, L_p5-L_pc0
    s_mov_b32 s83, 0x20000
    s_add_u32 s84, s34, L_p4-L_pc0
    buffer_load_dword v12, v11, s[80:83], s84 offen
    s_waitcnt lgkmcnt(5)
    v_mfma_f32_16x16x32_bf16 v[52:55], a[8:11], a[32:35], 0
    ds_read_b128 a[0:3], v181 offset:24576
    v_mfma_f32_16x16x32_bf16 v[124:127], a[8:11], a[104:107], 0
    s_waitcnt lgkmcnt(5)
    v_mfma_f32_16x16x32_bf16 v[56:59], a[12:15], a[32:35], 0
    ds_read_b128 a[4:7], v181 offset:25600
    v_mfma_f32_16x16x32_bf16 v[128:131], a[12:15], a[104:107], 0
    s_waitcnt lgkmcnt(5)
    v_mfma_f32_16x16x32_bf16 v[60:63], a[16:19], a[32:35], 0
    ds_read_b128 a[8:11], v181 offset:26624
    v_mfma_f32_16x16x32_bf16 v[132:135], a[16:19], a[104:107], 0
    s_waitcnt lgkmcnt(5)
    v_mfma_f32_16x16x32_bf16 v[64:67], a[20:23], a[32:35], 0
    ds_read_b128 a[12:15], v181 offset:27648
    v_mfma_f32_16x16x32_bf16 v[136:139], a[20:23], a[104:107], 0
    s_waitcnt lgkmcnt(5)
    v_mfma_f32_16x16x32_bf16 v[68:71], a[24:27], a[32:35], 0
    ds_read_b128 a[16:19], v181 offset:28672
    v_mfma_f32_16x16x32_bf16 v[140:143], a[24:27], a[104:107], 0
    s_waitcnt lgkmcnt(5)
    v_mfma_f32_16x16x32_bf16 v[72:75], a[28:31], a[32:35], 0
    ds_read_b128 a[20:23], v181 offset:29696
    v_mfma_f32_16x16x32_bf16 v[144:147], a[28:31], a[104:107], 0
    s_waitcnt lgkmcnt(5)
    v_mfma_f32_16x16x32_bf16 v[76:79], a[0:3], a[32:35], 0
    ds_read_b128 a[24:27], v181 offset:30720
    v_mfma_f32_16x16x32_bf16 v[148:151], a[0:3], a[104:107], 0
    s_waitcnt lgkmcnt(5)
    v_mfma_f32_16x16x32_bf16 v[80:83], a[4:7], a[32:35], 0
    ds_read_b128 a[28:31], v181 offset:31744
    v_mfma_f32_16x16x32_bf16 v[152:155], a[4:7], a[104:107], 0
    s_waitcnt lgkmcnt(5)
    v_mfma_f32_16x16x32_bf16 v[84:87], a[8:11], a[32:35], 0
    ds_read_b128 a[0:3], v181 offset:32768
    v_mfma_f32_16x16x32_bf16 v[156:159], a[8:11], a[104:107], 0
    s_waitcnt lgkmcnt(5)
    v_mfma_f32_16x16x32_bf16 v[52:55], a[12:15], a[36:39], v[52:55]
    ds_read_b128 a[4:7], v181 offset:33792
    v_mfma_f32_16x16x32_bf16 v[124:127], a[12:15], a[108:111], v[124:127]
    s_waitcnt lgkmcnt(5)
    v_mfma_f32_16x16x32_bf16 v[56:59], a[16:19], a[36:39], v[56:59]
    ds_read_b128 a[8:11], v181 offset:34816
    v_mfma_f32_16x16x32_bf16 v[128:131], a[16:19], a[108:111], v[128:131]
    s_waitcnt lgkmcnt(5)
    v_mfma_f32_16x16x32_bf16 v[60:63], a[20:23], a[36:39], v[60:63]
    ds_read_b128 a[12:15], v181 offset:35840
    v_mfma_f32_16x16x32_bf16 v[132:135], a[20:23], a[108:111], v[132:135]
    s_waitcnt lgkmcnt(5)
    v_mfma_f32_16x16x32_bf16 v[64:67], a[24:27], a[36:39], v[64:67]
    v_mfma_f32_16x16x32_bf16 v[136:139], a[24:27], a[108:111], v[136:139]
    s_waitcnt lgkmcnt(4)
    v_mfma_f32_16x16x32_bf16 v[68:71], a[28:31], a[36:39], v[68:71]
    v_mfma_f32_16x16x32_bf16 v[140:143], a[28:31], a[108:111], v[140:143]
    s_waitcnt lgkmcnt(3)
    v_mfma_f32_16x16x32_bf16 v[72:75], a[0:3], a[36:39], v[72:75]
    v_mfma_f32_16x16x32_bf16 v[144:147], a[0:3], a[108:111], v[144:147]
    s_waitcnt lgkmcnt(0)
    s_waitcnt vmcnt(23)
    s_barrier
    ds_read_b128 a[16:19], v181 offset:36864
    s_add_u32 m0, s44, 4096
    s_add_u32 s46, s45, 294912
    buffer_load_dwordx4 v5, s[16:19], s46 offen offset:0 sc1 lds
    v_mfma_f32_16x16x32_bf16 v[76:79], a[4:7], a[36:39], v[76:79]
    ds_read_b128 a[20:23], v181 offset:37888
    v_mfma_f32_16x16x32_bf16 v[148:151], a[4:7], a[108:111], v[148:151]
    ds_read_b128 a[24:27], v181 offset:38912
    v_mfma_f32_16x16x32_bf16 v[80:83], a[8:11], a[36:39], v[80:83]
    ds_read_b128 a[28:31], v181 offset:39936
    v_mfma_f32_16x16x32_bf16 v[152:155], a[8:11], a[108:111], v[152:155]
    ds_read_b128 a[0:3], v181 offset:40960
    v_mfma_f32_16x16x32_bf16 v[84:87], a[12:15], a[36:39], v[84:87]
    ds_read_b128 a[4:7], v181 offset:41984
    v_mfma_f32_16x16x32_bf16 v[156:159], a[12:15], a[108:111], v[156:159]
    buffer_load_dwordx4 v5, s[16:19], s46 offen offset:1024 sc1 lds
    s_waitcnt lgkmcnt(5)
    v_mfma_f32_16x16x32_bf16 v[52:55], a[16:19], a[40:43], v[52:55]
    ds_read_b128 a[8:11], v181 offset:43008
    v_mfma_f32_16x16x32_bf16 v[124:127], a[16:19], a[112:115], v[124:127]
    s_waitcnt lgkmcnt(5)
    v_mfma_f32_16x16x32_bf16 v[56:59], a[20:23], a[40:43], v[56:59]
    ds_read_b128 a[12:15], v181 offset:44032
    v_mfma_f32_16x16x32_bf16 v[128:131], a[20:23], a[112:115], v[128:131]
    s_waitcnt lgkmcnt(5)
    v_mfma_f32_16x16x32_bf16 v[60:63], a[24:27], a[40:43], v[60:63]
    ds_read_b128 a[16:19], v181 offset:45056
    v_mfma_f32_16x16x32_bf16 v[132:135], a[24:27], a[112:115], v[132:135]
    s_waitcnt lgkmcnt(5)
    v_mfma_f32_16x16x32_bf16 v[64:67], a[28:31], a[40:43], v[64:67]
    ds_read_b128 a[20:23], v181 offset:46080
    v_mfma_f32_16x16x32_bf16 v[136:139], a[28:31], a[112:115], v[136:139]
    buffer_load_dwordx4 v5, s[16:19], s46 offen offset:2048 sc1 lds
    s_waitcnt lgkmcnt(5)
    v_mfma_f32_16x16x32_bf16 v[68:71], a[0:3], a[40:43], v[68:71]
    ds_read_b128 a[24:27], v181 offset:47104
    v_mfma_f32_16x16x32_bf16 v[140:143], a[0:3], a[112:115], v[140:143]
    s_waitcnt lgkmcnt(5)
    v_mfma_f32_16x16x32_bf16 v[72:75], a[4:7], a[40:43], v[72:75]
    ds_read_b128 a[28:31], v181 offset:48128
    v_mfma_f32_16x16x32_bf16 v[144:147], a[4:7], a[112:115], v[144:147]
    s_waitcnt lgkmcnt(5)
    v_mfma_f32_16x16x32_bf16 v[76:79], a[8:11], a[40:43], v[76:79]
    ds_read_b128 a[0:3], v181 offset:49152
    v_mfma_f32_16x16x32_bf16 v[148:151], a[8:11], a[112:115], v[148:151]
    s_waitcnt lgkmcnt(5)
    v_mfma_f32_16x16x32_bf16 v[80:83], a[12:15], a[40:43], v[80:83]
    ds_read_b128 a[4:7], v181 offset:50176
    v_mfma_f32_16x16x32_bf16 v[152:155], a[12:15], a[112:115], v[152:155]
    buffer_load_dwordx4 v5, s[16:19], s46 offen offset:3072 sc1 lds
    s_waitcnt lgkmcnt(5)
    v_mfma_f32_16x16x32_bf16 v[84:87], a[16:19], a[40:43], v[84:87]
    ds_read_b128 a[8:11], v181 offset:51200
    v_mfma_f32_16x16x32_bf16 v[156:159], a[16:19], a[112:115], v[156:159]
    s_waitcnt lgkmcnt(5)
    v_mfma_f32_16x16x32_bf16 v[52:55], a[20:23], a[44:47], v[52:55]
    ds_read_b128 a[12:15], v181 offset:52224
    v_mfma_f32_16x16x32_bf16 v[124:127], a[20:23], a[116:119], v[124:127]
    s_waitcnt lgkmcnt(5)
    v_mfma_f32_16x16x32_bf16 v[56:59], a[24:27], a[44:47], v[56:59]
    ds_read_b128 a[16:19], v181 offset:53248
    v_mfma_f32_16x16x32_bf16 v[128:131], a[24:27], a[116:119], v[128:131]
    s_waitcnt lgkmcnt(5)
    v_mfma_f32_16x16x32_bf16 v[60:63], a[28:31], a[44:47], v[60:63]
    ds_read_b128 a[20:23], v181 offset:54272
    v_mfma_f32_16x16x32_bf16 v[132:135], a[28:31], a[116:119], v[132:135]
    s_add_u32 m0, s44, 8192
    s_add_u32 s46, s45, 299008
    buffer_load_dwordx4 v5, s[16:19], s46 offen offset:0 sc1 lds
    s_waitcnt lgkmcnt(5)
    v_mfma_f32_16x16x32_bf16 v[64:67], a[0:3], a[44:47], v[64:67]
    ds_read_b128 a[24:27], v181 offset:55296
    v_mfma_f32_16x16x32_bf16 v[136:139], a[0:3], a[116:119], v[136:139]
    s_waitcnt lgkmcnt(5)
    v_mfma_f32_16x16x32_bf16 v[68:71], a[4:7], a[44:47], v[68:71]
    ds_read_b128 a[28:31], v181 offset:56320
    v_mfma_f32_16x16x32_bf16 v[140:143], a[4:7], a[116:119], v[140:143]
    s_waitcnt lgkmcnt(5)
    v_mfma_f32_16x16x32_bf16 v[72:75], a[8:11], a[44:47], v[72:75]
    ds_read_b128 a[0:3], v181 offset:57344
    v_mfma_f32_16x16x32_bf16 v[144:147], a[8:11], a[116:119], v[144:147]
    s_waitcnt lgkmcnt(5)
    v_mfma_f32_16x16x32_bf16 v[76:79], a[12:15], a[44:47], v[76:79]
    ds_read_b128 a[4:7], v181 offset:58368
    v_mfma_f32_16x16x32_bf16 v[148:151], a[12:15], a[116:119], v[148:151]
    buffer_load_dwordx4 v5, s[16:19], s46 offen offset:1024 sc1 lds
    s_waitcnt lgkmcnt(5)
    v_mfma_f32_16x16x32_bf16 v[80:83], a[16:19], a[44:47], v[80:83]
    ds_read_b128 a[8:11], v181 offset:59392
    v_mfma_f32_16x16x32_bf16 v[152:155], a[16:19], a[116:119], v[152:155]
    s_waitcnt lgkmcnt(5)
    v_mfma_f32_16x16x32_bf16 v[84:87], a[20:23], a[44:47], v[84:87]
    ds_read_b128 a[12:15], v181 offset:60416
    v_mfma_f32_16x16x32_bf16 v[156:159], a[20:23], a[116:119], v[156:159]
    s_waitcnt lgkmcnt(5)
    v_mfma_f32_16x16x32_bf16 v[52:55], a[24:27], a[48:51], v[52:55]
    ds_read_b128 a[16:19], v181 offset:61440
    v_mfma_f32_16x16x32_bf16 v[124:127], a[24:27], a[120:123], v[124:127]
    s_waitcnt lgkmcnt(5)
    v_mfma_f32_16x16x32_bf16 v[56:59], a[28:31], a[48:51], v[56:59]
    ds_read_b128 a[20:23], v181 offset:62464
    v_mfma_f32_16x16x32_bf16 v[128:131], a[28:31], a[120:123], v[128:131]
    buffer_load_dwordx4 v5, s[16:19], s46 offen offset:2048 sc1 lds
    s_waitcnt lgkmcnt(5)
    v_mfma_f32_16x16x32_bf16 v[60:63], a[0:3], a[48:51], v[60:63]
    ds_read_b128 a[24:27], v181 offset:63488
    v_mfma_f32_16x16x32_bf16 v[132:135], a[0:3], a[120:123], v[132:135]
    s_waitcnt lgkmcnt(5)
    v_mfma_f32_16x16x32_bf16 v[64:67], a[4:7], a[48:51], v[64:67]
    ds_read_b128 a[28:31], v181 offset:64512
    v_mfma_f32_16x16x32_bf16 v[136:139], a[4:7], a[120:123], v[136:139]
    s_waitcnt lgkmcnt(5)
    v_mfma_f32_16x16x32_bf16 v[68:71], a[8:11], a[48:51], v[68:71]
    ds_read_b128 a[0:3], v182 offset:0
    v_mfma_f32_16x16x32_bf16 v[140:143], a[8:11], a[120:123], v[140:143]
    s_waitcnt lgkmcnt(5)
    v_mfma_f32_16x16x32_bf16 v[72:75], a[12:15], a[48:51], v[72:75]
    ds_read_b128 a[4:7], v182 offset:1024
    v_mfma_f32_16x16x32_bf16 v[144:147], a[12:15], a[120:123], v[144:147]
    buffer_load_dwordx4 v5, s[16:19], s46 offen offset:3072 sc1 lds
    s_waitcnt lgkmcnt(5)
    v_mfma_f32_16x16x32_bf16 v[76:79], a[16:19], a[48:51], v[76:79]
    ds_read_b128 a[8:11], v182 offset:2048
    v_mfma_f32_16x16x32_bf16 v[148:151], a[16:19], a[120:123], v[148:151]
    buffer_load_dwordx4 v[216:219], v190, s[20:23], s59 offen offset:0 sc1
    buffer_load_dwordx4 v[220:223], v190, s[20:23], s59 offen offset:16 sc1
    buffer_load_dwordx4 v[224:227], v190, s[20:23], s59 offen offset:32 sc1
    buffer_load_dwordx4 v[228:231], v190, s[20:23], s59 offen offset:48 sc1
    s_waitcnt lgkmcnt(5)
    v_mfma_f32_16x16x32_bf16 v[80:83], a[20:23], a[48:51], v[80:83]
    ds_read_b128 a[12:15], v182 offset:3072
    v_mfma_f32_16x16x32_bf16 v[152:155], a[20:23], a[120:123], v[152:155]
    s_waitcnt lgkmcnt(5)
    v_mfma_f32_16x16x32_bf16 v[84:87], a[24:27], a[48:51], v[84:87]
    ds_read_b128 a[16:19], v182 offset:4096
    v_mfma_f32_16x16x32_bf16 v[156:159], a[24:27], a[120:123], v[156:159]
    s_waitcnt lgkmcnt(5)
    v_mfma_f32_16x16x32_bf16 v[52:55], a[28:31], a[52:55], v[52:55]
    ds_read_b128 a[20:23], v182 offset:5120
    v_mfma_f32_16x16x32_bf16 v[124:127], a[28:31], a[124:127], v[124:127]
    s_add_u32 m0, s44, 12288
    s_add_u32 s46, s45, 303104
    buffer_load_dwordx4 v5, s[16:19], s46 offen offset:0 sc1 lds
    s_waitcnt lgkmcnt(5)
    v_mfma_f32_16x16x32_bf16 v[56:59], a[0:3], a[52:55], v[56:59]
    ds_read_b128 a[24:27], v182 offset:6144
    v_mfma_f32_16x16x32_bf16 v[128:131], a[0:3], a[124:127], v[128:131]
    s_waitcnt lgkmcnt(5)
    v_mfma_f32_16x16x32_bf16 v[60:63], a[4:7], a[52:55], v[60:63]
    ds_read_b128 a[28:31], v182 offset:7168
    v_mfma_f32_16x16x32_bf16 v[132:135], a[4:7], a[124:127], v[132:135]
    s_waitcnt lgkmcnt(5)
    v_mfma_f32_16x16x32_bf16 v[64:67], a[8:11], a[52:55], v[64:67]
    v_mfma_f32_16x16x32_bf16 v[136:139], a[8:11], a[124:127], v[136:139]
    s_waitcnt lgkmcnt(4)
    v_mfma_f32_16x16x32_bf16 v[68:71], a[12:15], a[52:55], v[68:71]
    v_mfma_f32_16x16x32_bf16 v[140:143], a[12:15], a[124:127], v[140:143]
    s_waitcnt lgkmcnt(3)
    v_mfma_f32_16x16x32_bf16 v[72:75], a[16:19], a[52:55], v[72:75]
    v_mfma_f32_16x16x32_bf16 v[144:147], a[16:19], a[124:127], v[144:147]
    s_waitcnt lgkmcnt(0)
    s_waitcnt vmcnt(27)
    s_barrier
    ds_read_b128 a[0:3], v182 offset:8192
    v_mfma_f32_16x16x32_bf16 v[76:79], a[20:23], a[52:55], v[76:79]
    ds_read_b128 a[4:7], v182 offset:9216
    v_mfma_f32_16x16x32_bf16 v[148:151], a[20:23], a[124:127], v[148:151]
    ds_read_b128 a[8:11], v182 offset:10240
    v_mfma_f32_16x16x32_bf16 v[80:83], a[24:27], a[52:55], v[80:83]
    ds_read_b128 a[12:15], v182 offset:11264
    v_mfma_f32_16x16x32_bf16 v[152:155], a[24:27], a[124:127], v[152:155]
    ds_read_b128 a[16:19], v182 offset:12288
    v_mfma_f32_16x16x32_bf16 v[84:87], a[28:31], a[52:55], v[84:87]
    ds_read_b128 a[20:23], v182 offset:13312
    v_mfma_f32_16x16x32_bf16 v[156:159], a[28:31], a[124:127], v[156:159]
    s_waitcnt lgkmcnt(5)
    v_mfma_f32_16x16x32_bf16 v[52:55], a[0:3], a[56:59], v[52:55]
    ds_read_b128 a[24:27], v182 offset:14336
    v_mfma_f32_16x16x32_bf16 v[124:127], a[0:3], a[128:131], v[124:127]
    s_waitcnt lgkmcnt(5)
    v_mfma_f32_16x16x32_bf16 v[56:59], a[4:7], a[56:59], v[56:59]
    ds_read_b128 a[28:31], v182 offset:15360
    v_mfma_f32_16x16x32_bf16 v[128:131], a[4:7], a[128:131], v[128:131]
    s_waitcnt lgkmcnt(5)
    v_mfma_f32_16x16x32_bf16 v[60:63], a[8:11], a[56:59], v[60:63]
    ds_read_b128 a[0:3], v182 offset:16384
    v_mfma_f32_16x16x32_bf16 v[132:135], a[8:11], a[128:131], v[132:135]
    s_waitcnt lgkmcnt(5)
    v_mfma_f32_16x16x32_bf16 v[64:67], a[12:15], a[56:59], v[64:67]
    ds_read_b128 a[4:7], v182 offset:17408
    v_mfma_f32_16x16x32_bf16 v[136:139], a[12:15], a[128:131], v[136:139]
    s_waitcnt lgkmcnt(5)
    v_mfma_f32_16x16x32_bf16 v[68:71], a[16:19], a[56:59], v[68:71]
    ds_read_b128 a[8:11], v182 offset:18432
    v_mfma_f32_16x16x32_bf16 v[140:143], a[16:19], a[128:131], v[140:143]
    s_waitcnt lgkmcnt(5)
    v_mfma_f32_16x16x32_bf16 v[72:75], a[20:23], a[56:59], v[72:75]
    ds_read_b128 a[12:15], v182 offset:19456
    v_mfma_f32_16x16x32_bf16 v[144:147], a[20:23], a[128:131], v[144:147]
    s_waitcnt lgkmcnt(5)
    v_mfma_f32_16x16x32_bf16 v[76:79], a[24:27], a[56:59], v[76:79]
    ds_read_b128 a[16:19], v182 offset:20480
    v_mfma_f32_16x16x32_bf16 v[148:151], a[24:27], a[128:131], v[148:151]
    s_waitcnt lgkmcnt(5)
    v_mfma_f32_16x16x32_bf16 v[80:83], a[28:31], a[56:59], v[80:83]
    ds_read_b128 a[20:23], v182 offset:21504
    v_mfma_f32_16x16x32_bf16 v[152:155], a[28:31], a[128:131], v[152:155]
    s_waitcnt lgkmcnt(5)
    v_mfma_f32_16x16x32_bf16 v[84:87], a[0:3], a[56:59], v[84:87]
    ds_read_b128 a[24:27], v182 offset:22528
    v_mfma_f32_16x16x32_bf16 v[156:159], a[0:3], a[128:131], v[156:159]
    s_waitcnt lgkmcnt(5)
    v_mfma_f32_16x16x32_bf16 v[52:55], a[4:7], a[60:63], v[52:55]
    ds_read_b128 a[28:31], v182 offset:23552
    v_mfma_f32_16x16x32_bf16 v[124:127], a[4:7], a[132:135], v[124:127]
    s_waitcnt lgkmcnt(5)
    v_mfma_f32_16x16x32_bf16 v[56:59], a[8:11], a[60:63], v[56:59]
    ds_read_b128 a[0:3], v182 offset:24576
    v_mfma_f32_16x16x32_bf16 v[128:131], a[8:11], a[132:135], v[128:131]
    s_waitcnt lgkmcnt(5)
    v_mfma_f32_16x16x32_bf16 v[60:63], a[12:15], a[60:63], v[60:63]
    ds_read_b128 a[4:7], v182 offset:25600
    v_mfma_f32_16x16x32_bf16 v[132:135], a[12:15], a[132:135], v[132:135]
    s_waitcnt lgkmcnt(5)
    v_mfma_f32_16x16x32_bf16 v[64:67], a[16:19], a[60:63], v[64:67]
    ds_read_b128 a[8:11], v182 offset:26624
    v_mfma_f32_16x16x32_bf16 v[136:139], a[16:19], a[132:135], v[136:139]
    s_waitcnt lgkmcnt(5)
    v_mfma_f32_16x16x32_bf16 v[68:71], a[20:23], a[60:63], v[68:71]
    ds_read_b128 a[12:15], v182 offset:27648
    v_mfma_f32_16x16x32_bf16 v[140:143], a[20:23], a[132:135], v[140:143]
    s_waitcnt lgkmcnt(5)
    v_mfma_f32_16x16x32_bf16 v[72:75], a[24:27], a[60:63], v[72:75]
    ds_read_b128 a[16:19], v182 offset:28672
    v_mfma_f32_16x16x32_bf16 v[144:147], a[24:27], a[132:135], v[144:147]
    s_waitcnt lgkmcnt(5)
    v_mfma_f32_16x16x32_bf16 v[76:79], a[28:31], a[60:63], v[76:79]
    ds_read_b128 a[20:23], v182 offset:29696
    v_mfma_f32_16x16x32_bf16 v[148:151], a[28:31], a[132:135], v[148:151]
    s_waitcnt vmcnt(1)
    v_max3_u32 v232, v216, v217, v218
    v_max3_u32 v232, v219, v220, v232
    v_max3_u32 v232, v221, v222, v232
    v_max3_u32 v232, v223, v224, v232
    v_max3_u32 v232, v225, v226, v232
    v_max3_u32 v232, v227, v228, v232
    v_max3_u32 v232, v229, v230, v232
    v_max_u32 v232, v231, v232
    v_cmp_eq_u32 vcc, -1, v232
    s_mov_b32 s24, 0
    s_nop 3
    s_cbranch_vccz mega_ok12
mega_poll13:
    s_sleep 2
    buffer_load_dwordx4 v[216:219], v190, s[20:23], s59 offen offset:0 sc1
    buffer_load_dwordx4 v[220:223], v190, s[20:23], s59 offen offset:16 sc1
    buffer_load_dwordx4 v[224:227], v190, s[20:23], s59 offen offset:32 sc1
    buffer_load_dwordx4 v[228:231], v190, s[20:23], s59 offen offset:48 sc1
    s_waitcnt vmcnt(0)
    v_max3_u32 v232, v216, v217, v218
    v_max3_u32 v232, v219, v220, v232
    v_max3_u32 v232, v221, v222, v232
    v_max3_u32 v232, v223, v224, v232
    v_max3_u32 v232, v225, v226, v232
    v_max3_u32 v232, v227, v228, v232
    v_max3_u32 v232, v229, v230, v232
    v_max_u32 v232, v231, v232
    v_cmp_eq_u32 vcc, -1, v232
    s_add_u32 s24, s24, 1
    s_nop 3
    s_cbranch_vccz mega_ok12
    s_cmp_lt_u32 s24, 262144
    s_cbranch_scc1 mega_poll13
mega_ok12:
    v_add_f32_dpp v216, v216, v216 row_ror:8 row_mask:0xf bank_mask:0xf
    v_add_f32_dpp v217, v217, v217 row_ror:8 row_mask:0xf bank_mask:0xf
    v_add_f32_dpp v218, v218, v218 row_ror:8 row_mask:0xf bank_mask:0xf
    v_add_f32_dpp v219, v219, v219 row_ror:8 row_mask:0xf bank_mask:0xf
    v_add_f32_dpp v220, v220, v220 row_ror:8 row_mask:0xf bank_mask:0xf
    v_add_f32_dpp v221, v221, v221 row_ror:8 row_mask:0xf bank_mask:0xf
    v_add_f32_dpp v222, v222, v222 row_ror:8 row_mask:0xf bank_mask:0xf
    v_add_f32_dpp v223, v223, v223 row_ror:8 row_mask:0xf bank_mask:0xf
    v_add_f32_dpp v224, v224, v224 row_ror:8 row_mask:0xf bank_mask:0xf
    v_add_f32_dpp v225, v225, v225 row_ror:8 row_mask:0xf bank_mask:0xf
    v_add_f32_dpp v226, v226, v226 row_ror:8 row_mask:0xf bank_mask:0xf
    v_add_f32_dpp v227, v227, v227 row_ror:8 row_mask:0xf bank_mask:0xf
    v_add_f32_dpp v228, v228, v228 row_ror:8 row_mask:0xf bank_mask:0xf
    v_add_f32_dpp v229, v229, v229 row_ror:8 row_mask:0xf bank_mask:0xf
    v_add_f32_dpp v230, v230, v230 row_ror:8 row_mask:0xf bank_mask:0xf
    v_add_f32_dpp v231, v231, v231 row_ror:8 row_mask:0xf bank_mask:0xf
    v_add_f32_dpp v216, v216, v216 row_ror:4 row_mask:0xf bank_mask:0xf
    v_add_f32_dpp v217, v217, v217 row_ror:4 row_mask:0xf bank_mask:0xf
    v_add_f32_dpp v218, v218, v218 row_ror:4 row_mask:0xf bank_mask:0xf
    v_add_f32_dpp v219, v219, v219 row_ror:4 row_mask:0xf bank_mask:0xf
    v_add_f32_dpp v220, v220, v220 row_ror:4 row_mask:0xf bank_mask:0xf
    v_add_f32_dpp v221, v221, v221 row_ror:4 row_mask:0xf bank_mask:0xf
    v_add_f32_dpp v222, v222, v222 row_ror:4 row_mask:0xf bank_mask:0xf
    v_add_f32_dpp v223, v223, v223 row_ror:4 row_mask:0xf bank_mask:0xf
    v_add_f32_dpp v224, v224, v224 row_ror:4 row_mask:0xf bank_mask:0xf
    v_add_f32_dpp v225, v225, v225 row_ror:4 row_mask:0xf bank_mask:0xf
    v_add_f32_dpp v226, v226, v226 row_ror:4 row_mask:0xf bank_mask:0xf
    v_add_f32_dpp v227, v227, v227 row_ror:4 row_mask:0xf bank_mask:0xf
    v_add_f32_dpp v228, v228, v228 row_ror:4 row_mask:0xf bank_mask:0xf
    v_add_f32_dpp v229, v229, v229 row_ror:4 row_mask:0xf bank_mask:0xf
    v_add_f32_dpp v230, v230, v230 row_ror:4 row_mask:0xf bank_mask:0xf
    v_add_f32_dpp v231, v231, v231 row_ror:4 row_mask:0xf bank_mask:0xf
    v_add_f32_dpp v216, v216, v216 row_ror:2 row_mask:0xf bank_mask:0xf
    v_add_f32_dpp v217, v217, v217 row_ror:2 row_mask:0xf bank_mask:0xf
    v_add_f32_dpp v218, v218, v218 row_ror:2 row_mask:0xf bank_mask:0xf
    v_add_f32_dpp v219, v219, v219 row_ror:2 row_mask:0xf bank_mask:0xf
    v_add_f32_dpp v220, v220, v220 row_ror:2 row_mask:0xf bank_mask:0xf
    v_add_f32_dpp v221, v221, v221 row_ror:2 row_mask:0xf bank_mask:0xf
    v_add_f32_dpp v222, v222, v222 row_ror:2 row_mask:0xf bank_mask:0xf
    v_add_f32_dpp v223, v223, v223 row_ror:2 row_mask:0xf bank_mask:0xf
    v_add_f32_dpp v224, v224, v224 row_ror:2 row_mask:0xf bank_mask:0xf
    v_add_f32_dpp v225, v225, v225 row_ror:2 row_mask:0xf bank_mask:0xf
    v_add_f32_dpp v226, v226, v226 row_ror:2 row_mask:0xf bank_mask:0xf
    v_add_f32_dpp v227, v227, v227 row_ror:2 row_mask:0xf bank_mask:0xf
    v_add_f32_dpp v228, v228, v228 row_ror:2 row_mask:0xf bank_mask:0xf
    v_add_f32_dpp v229, v229, v229 row_ror:2 row_mask:0xf bank_mask:0xf
    v_add_f32_dpp v230, v230, v230 row_ror:2 row_mask:0xf bank_mask:0xf
    v_add_f32_dpp v231, v231, v231 row_ror:2 row_mask:0xf bank_mask:0xf
    v_add_f32_dpp v216, v216, v216 row_ror:1 row_mask:0xf bank_mask:0xf
    v_add_f32_dpp v217, v217, v217 row_ror:1 row_mask:0xf bank_mask:0xf
    v_add_f32_dpp v218, v218, v218 row_ror:1 row_mask:0xf bank_mask:0xf
    v_add_f32_dpp v219, v219, v219 row_ror:1 row_mask:0xf bank_mask:0xf
    v_add_f32_dpp v220, v220, v220 row_ror:1 row_mask:0xf bank_mask:0xf
    v_add_f32_dpp v221, v221, v221 row_ror:1 row_mask:0xf bank_mask:0xf
    v_add_f32_dpp v222, v222, v222 row_ror:1 row_mask:0xf bank_mask:0xf
    v_add_f32_dpp v223, v223, v223 row_ror:1 row_mask:0xf bank_mask:0xf
    v_add_f32_dpp v224, v224, v224 row_ror:1 row_mask:0xf bank_mask:0xf
    v_add_f32_dpp v225, v225, v225 row_ror:1 row_mask:0xf bank_mask:0xf
    v_add_f32_dpp v226, v226, v226 row_ror:1 row_mask:0xf bank_mask:0xf
    v_add_f32_dpp v227, v227, v227 row_ror:1 row_mask:0xf bank_mask:0xf
    v_add_f32_dpp v228, v228, v228 row_ror:1 row_mask:0xf bank_mask:0xf
    v_add_f32_dpp v229, v229, v229 row_ror:1 row_mask:0xf bank_mask:0xf
    v_add_f32_dpp v230, v230, v230 row_ror:1 row_mask:0xf bank_mask:0xf
    v_add_f32_dpp v231, v231, v231 row_ror:1 row_mask:0xf bank_mask:0xf
    v_mov_b32 v244, 0x39e38e39
    v_mov_b32 v245, 0x39e38e39
    v_pk_mul_f32 v[216:217], v[216:217], v[244:245]
    v_pk_mul_f32 v[218:219], v[218:219], v[244:245]
    v_pk_mul_f32 v[224:225], v[224:225], v[244:245]
    v_pk_mul_f32 v[226:227], v[226:227], v[244:245]
    v_fma_f32 v224, -v216, v216, v224
    v_fma_f32 v225, -v217, v217, v225
    v_fma_f32 v226, -v218, v218, v226
    v_fma_f32 v227, -v219, v219, v227
    v_max_f32 v224, 0, v224
    v_max_f32 v225, 0, v225
    v_max_f32 v226, 0, v226
    v_max_f32 v227, 0, v227
    v_pk_add_f32 v[224:225], v[224:225], v[208:209]
    v_pk_add_f32 v[226:227], v[226:227], v[210:211]
    v_rsq_f32 v224, v224
    v_rsq_f32 v225, v225
    v_rsq_f32 v226, v226
    v_rsq_f32 v227, v227
    v_mul_f32 v216, -v216, v224
    v_mul_f32 v217, -v217, v225
    v_mul_f32 v218, -v218, v226
    v_mul_f32 v219, -v219, v227
    v_pk_mul_f32 v[220:221], v[220:221], v[244:245]
    v_pk_mul_f32 v[222:223], v[222:223], v[244:245]
    v_pk_mul_f32 v[228:229], v[228:229], v[244:245]
    v_pk_mul_f32 v[230:231], v[230:231], v[244:245]
    v_fma_f32 v228, -v220, v220, v228
    v_fma_f32 v229, -v221, v221, v229
    v_fma_f32 v230, -v222, v222, v230
    v_fma_f32 v231, -v223, v223, v231
    v_max_f32 v228, 0, v228
    v_max_f32 v229, 0, v229
    v_max_f32 v230, 0, v230
    v_max_f32 v231, 0, v231
    v_pk_add_f32 v[228:229], v[228:229], v[212:213]
    v_pk_add_f32 v[230:231], v[230:231], v[214:215]
    v_rsq_f32 v228, v228
    v_rsq_f32 v229, v229
    v_rsq_f32 v230, v230
    v_rsq_f32 v231, v231
    v_mul_f32 v220, -v220, v228
    v_mul_f32 v221, -v221, v229
    v_mul_f32 v222, -v222, v230
    v_mul_f32 v223, -v223, v231
    v_pk_fma_f32 v[16:17], v[16:17], v[224:225], v[216:217]
    v_pk_fma_f32 v[18:19], v[18:19], v[226:227], v[218:219]
    v_cvt_pk_bf16_f32 v236, v16, v17
    v_cvt_pk_bf16_f32 v237, v18, v19
    v_pk_fma_f32 v[88:89], v[88:89], v[228:229], v[220:221]
    v_pk_fma_f32 v[90:91], v[90:91], v[230:231], v[222:223]
    v_cvt_pk_bf16_f32 v238, v88, v89
    v_cvt_pk_bf16_f32 v239, v90, v91
    buffer_store_dwordx4 v[236:239], v5, s[20:23], s57 offen offset:0 sc1
    v_pk_fma_f32 v[20:21], v[20:21], v[224:225], v[216:217]
    v_pk_fma_f32 v[22:23], v[22:23], v[226:227], v[218:219]
    v_cvt_pk_bf16_f32 v240, v20, v21
    v_cvt_pk_bf16_f32 v241, v22, v23
    v_pk_fma_f32 v[92:93], v[92:93], v[228:229], v[220:221]
    v_pk_fma_f32 v[94:95], v[94:95], v[230:231], v[222:223]
    v_cvt_pk_bf16_f32 v242, v92, v93
    v_cvt_pk_bf16_f32 v243, v94, v95
    buffer_store_dwordx4 v[240:243], v5, s[20:23], s57 offen offset:1024 sc1
    v_pk_fma_f32 v[24:25], v[24:25], v[224:225], v[216:217]
    v_pk_fma_f32 v[26:27], v[26:27], v[226:227], v[218:219]
    v_cvt_pk_bf16_f32 v236, v24, v25
    v_cvt_pk_bf16_f32 v237, v26, v27
    v_pk_fma_f32 v[96:97], v[96:97], v[228:229], v[220:221]
    v_pk_fma_f32 v[98:99], v[98:99], v[230:231], v[222:223]
    v_cvt_pk_bf16_f32 v238, v96, v97
    v_cvt_pk_bf16_f32 v239, v98, v99
    buffer_store_dwordx4 v[236:239], v5, s[20:23], s57 offen offset:2048 sc1
    v_pk_fma_f32 v[28:29], v[28:29], v[224:225], v[216:217]
    v_pk_fma_f32 v[30:31], v[30:31], v[226:227], v[218:219]
    v_cvt_pk_bf16_f32 v240, v28, v29
    v_cvt_pk_bf16_f32 v241, v30, v31
    v_pk_fma_f32 v[100:101], v[100:101], v[228:229], v[220:221]
    v_pk_fma_f32 v[102:103], v[102:103], v[230:231], v[222:223]
    v_cvt_pk_bf16_f32 v242, v100, v101
    v_cvt_pk_bf16_f32 v243, v102, v103
    buffer_store_dwordx4 v[240:243], v5, s[20:23], s57 offen offset:3072 sc1
    v_pk_fma_f32 v[32:33], v[32:33], v[224:225], v[216:217]
    v_pk_fma_f32 v[34:35], v[34:35], v[226:227], v[218:219]
    v_cvt_pk_bf16_f32 v236, v32, v33
    v_cvt_pk_bf16_f32 v237, v34, v35
    v_pk_fma_f32 v[104:105], v[104:105], v[228:229], v[220:221]
    v_pk_fma_f32 v[106:107], v[106:107], v[230:231], v[222:223]
    v_cvt_pk_bf16_f32 v238, v104, v105
    v_cvt_pk_bf16_f32 v239, v106, v107
    s_add_u32 s57, s57, 4096
    buffer_store_dwordx4 v[236:239], v5, s[20:23], s57 offen offset:0 sc1
    v_pk_fma_f32 v[36:37], v[36:37], v[224:225], v[216:217]
    v_pk_fma_f32 v[38:39], v[38:39], v[226:227], v[218:219]
    v_cvt_pk_bf16_f32 v240, v36, v37
    v_cvt_pk_bf16_f32 v241, v38, v39
    v_pk_fma_f32 v[108:109], v[108:109], v[228:229], v[220:221]
    v_pk_fma_f32 v[110:111], v[110:111], v[230:231], v[222:223]
    v_cvt_pk_bf16_f32 v242, v108, v109
    v_cvt_pk_bf16_f32 v243, v110, v111
    buffer_store_dwordx4 v[240:243], v5, s[20:23], s57 offen offset:1024 sc1
    v_pk_fma_f32 v[40:41], v[40:41], v[224:225], v[216:217]
    v_pk_fma_f32 v[42:43], v[42:43], v[226:227], v[218:219]
    v_cvt_pk_bf16_f32 v236, v40, v41
    v_cvt_pk_bf16_f32 v237, v42, v43
    v_pk_fma_f32 v[112:113], v[112:113], v[228:229], v[220:221]
    v_pk_fma_f32 v[114:115], v[114:115], v[230:231], v[222:223]
    v_cvt_pk_bf16_f32 v238, v112, v113
    v_cvt_pk_bf16_f32 v239, v114, v115
    buffer_store_dwordx4 v[236:239], v5, s[20:23], s57 offen offset:2048 sc1
    v_pk_fma_f32 v[44:45], v[44:45], v[224:225], v[216:217]
    v_pk_fma_f32 v[46:47], v[46:47], v[226:227], v[218:219]
    v_cvt_pk_bf16_f32 v240, v44, v45
    v_cvt_pk_bf16_f32 v241, v46, v47
    v_pk_fma_f32 v[116:117], v[116:117], v[228:229], v[220:221]
    v_pk_fma_f32 v[118:119], v[118:119], v[230:231], v[222:223]
    v_cvt_pk_bf16_f32 v242, v116, v117
    v_cvt_pk_bf16_f32 v243, v118, v119
    buffer_store_dwordx4 v[240:243], v5, s[20:23], s57 offen offset:3072 sc1
    v_pk_fma_f32 v[48:49], v[48:49], v[224:225], v[216:217]
    v_pk_fma_f32 v[50:51], v[50:51], v[226:227], v[218:219]
    v_cvt_pk_bf16_f32 v236, v48, v49
    v_cvt_pk_bf16_f32 v237, v50, v51
    v_pk_fma_f32 v[120:121], v[120:121], v[228:229], v[220:221]
    v_pk_fma_f32 v[122:123], v[122:123], v[230:231], v[222:223]
    v_cvt_pk_bf16_f32 v238, v120, v121
    v_cvt_pk_bf16_f32 v239, v122, v123
    s_add_u32 s57, s57, 4096
    buffer_store_dwordx4 v[236:239], v5, s[20:23], s57 offen offset:0 sc1
    s_lshl_b32 s78, s35, 2
    s_add_u32 s78, s78, s60
    ds_read_b128 v[16:19], v188 offset:576
    ds_read_b128 v[20:23], v188 offset:640
    ds_read_b128 v[24:27], v188 offset:704
    ds_read_b128 v[28:31], v188 offset:768
    ds_read_b128 v[32:35], v188 offset:832
    ds_read_b128 v[36:39], v188 offset:896
    ds_read_b128 v[40:43], v188 offset:960
    ds_read_b128 v[44:47], v188 offset:1024
    ds_read_b128 v[48:51], v188 offset:1088
    s_waitcnt lgkmcnt(14)
    v_mfma_f32_16x16x32_bf16 v[80:83], a[0:3], a[60:63], v[80:83]
    ds_read_b128 a[24:27], v182 offset:30720
    v_mfma_f32_16x16x32_bf16 v[152:155], a[0:3], a[132:135], v[152:155]
    s_waitcnt lgkmcnt(14)
    v_mfma_f32_16x16x32_bf16 v[84:87], a[4:7], a[60:63], v[84:87]
    ds_read_b128 a[28:31], v182 offset:31744
    v_mfma_f32_16x16x32_bf16 v[156:159], a[4:7], a[132:135], v[156:159]
    s_waitcnt lgkmcnt(14)
    v_mfma_f32_16x16x32_bf16 v[52:55], a[8:11], a[64:67], v[52:55]
    ds_read_b128 a[0:3], v182 offset:32768
    v_mfma_f32_16x16x32_bf16 v[124:127], a[8:11], a[136:139], v[124:127]
    s_waitcnt lgkmcnt(14)
    v_mfma_f32_16x16x32_bf16 v[56:59], a[12:15], a[64:67], v[56:59]
    ds_read_b128 a[4:7], v182 offset:33792
    v_mfma_f32_16x16x32_bf16 v[128:131], a[12:15], a[136:139], v[128:131]
    s_waitcnt lgkmcnt(14)
    v_mfma_f32_16x16x32_bf16 v[60:63], a[16:19], a[64:67], v[60:63]
    ds_read_b128 a[8:11], v182 offset:34816
    v_mfma_f32_16x16x32_bf16 v[132:135], a[16:19], a[136:139], v[132:135]
    s_waitcnt lgkmcnt(14)
    v_mfma_f32_16x16x32_bf16 v[64:67], a[20:23], a[64:67], v[64:67]
    ds_read_b128 a[12:15], v182 offset:35840
    v_mfma_f32_16x16x32_bf16 v[136:139], a[20:23], a[136:139], v[136:139]
    s_waitcnt lgkmcnt(5)
    v_mfma_f32_16x16x32_bf16 v[68:71], a[24:27], a[64:67], v[68:71]
    ds_read_b128 a[16:19], v182 offset:36864
    v_mfma_f32_16x16x32_bf16 v[140:143], a[24:27], a[136:139], v[140:143]
    s_waitcnt lgkmcnt(5)
    v_mfma_f32_16x16x32_bf16 v[72:75], a[28:31], a[64:67], v[72:75]
    ds_read_b128 a[20:23], v182 offset:37888
    v_mfma_f32_16x16x32_bf16 v[144:147], a[28:31], a[136:139], v[144:147]
    s_waitcnt lgkmcnt(5)
    v_mfma_f32_16x16x32_bf16 v[76:79], a[0:3], a[64:67], v[76:79]
    ds_read_b128 a[24:27], v182 offset:38912
    v_mfma_f32_16x16x32_bf16 v[148:151], a[0:3], a[136:139], v[148:151]
    s_waitcnt lgkmcnt(5)
    v_mfma_f32_16x16x32_bf16 v[80:83], a[4:7], a[64:67], v[80:83]
    ds_read_b128 a[28:31], v182 offset:39936
    v_mfma_f32_16x16x32_bf16 v[152:155], a[4:7], a[136:139], v[152:155]
    s_waitcnt lgkmcnt(5)
    v_mfma_f32_16x16x32_bf16 v[84:87], a[8:11], a[64:67], v[84:87]
    ds_read_b128 a[0:3], v182 offset:40960
    v_mfma_f32_16x16x32_bf16 v[156:159], a[8:11], a[136:139], v[156:159]
    s_waitcnt lgkmcnt(5)
    v_mfma_f32_16x16x32_bf16 v[52:55], a[12:15], a[68:71], v[52:55]
    ds_read_b128 a[4:7], v182 offset:41984
    v_mfma_f32_16x16x32_bf16 v[124:127], a[12:15], a[140:143], v[124:127]
    s_waitcnt lgkmcnt(5)
    v_mfma_f32_16x16x32_bf16 v[56:59], a[16:19], a[68:71], v[56:59]
    ds_read_b128 a[8:11], v182 offset:43008
    v_mfma_f32_16x16x32_bf16 v[128:131], a[16:19], a[140:143], v[128:131]
    s_waitcnt lgkmcnt(5)
    v_mfma_f32_16x16x32_bf16 v[60:63], a[20:23], a[68:71], v[60:63]
    ds_read_b128 a[12:15], v182 offset:44032
    v_mfma_f32_16x16x32_bf16 v[132:135], a[20:23], a[140:143], v[132:135]
    s_waitcnt lgkmcnt(5)
    v_mfma_f32_16x16x32_bf16 v[64:67], a[24:27], a[68:71], v[64:67]
    v_mfma_f32_16x16x32_bf16 v[136:139], a[24:27], a[140:143], v[136:139]
    s_waitcnt lgkmcnt(4)
    v_mfma_f32_16x16x32_bf16 v[68:71], a[28:31], a[68:71], v[68:71]
    v_mfma_f32_16x16x32_bf16 v[140:143], a[28:31], a[140:143], v[140:143]
    s_waitcnt lgkmcnt(3)
    v_mfma_f32_16x16x32_bf16 v[72:75], a[0:3], a[68:71], v[72:75]
    v_mfma_f32_16x16x32_bf16 v[144:147], a[0:3], a[140:143], v[144:147]
    s_waitcnt lgkmcnt(0)
    s_barrier
    ds_read_b128 a[16:19], v182 offset:45056
    v_mfma_f32_16x16x32_bf16 v[76:79], a[4:7], a[68:71], v[76:79]
    ds_read_b128 a[20:23], v182 offset:46080
    v_mfma_f32_16x16x32_bf16 v[148:151], a[4:7], a[140:143], v[148:151]
    ds_read_b128 a[24:27], v182 offset:47104
    v_mfma_f32_16x16x32_bf16 v[80:83], a[8:11], a[68:71], v[80:83]
    ds_read_b128 a[28:31], v182 offset:48128
    v_mfma_f32_16x16x32_bf16 v[152:155], a[8:11], a[140:143], v[152:155]
    ds_read_b128 a[0:3], v182 offset:49152
    v_mfma_f32_16x16x32_bf16 v[84:87], a[12:15], a[68:71], v[84:87]
    ds_read_b128 a[4:7], v182 offset:50176
    v_mfma_f32_16x16x32_bf16 v[156:159], a[12:15], a[140:143], v[156:159]
    s_waitcnt lgkmcnt(5)
    v_mfma_f32_16x16x32_bf16 v[52:55], a[16:19], a[72:75], v[52:55]
    ds_read_b128 a[8:11], v182 offset:51200
    v_mfma_f32_16x16x32_bf16 v[124:127], a[16:19], a[144:147], v[124:127]
    s_waitcnt lgkmcnt(5)
    v_mfma_f32_16x16x32_bf16 v[56:59], a[20:23], a[72:75], v[56:59]
    ds_read_b128 a[12:15], v182 offset:52224
    v_mfma_f32_16x16x32_bf16 v[128:131], a[20:23], a[144:147], v[128:131]
    s_waitcnt lgkmcnt(5)
    v_mfma_f32_16x16x32_bf16 v[60:63], a[24:27], a[72:75], v[60:63]
    ds_read_b128 a[16:19], v182 offset:53248
    v_mfma_f32_16x16x32_bf16 v[132:135], a[24:27], a[144:147], v[132:135]
    s_waitcnt lgkmcnt(5)
    v_mfma_f32_16x16x32_bf16 v[64:67], a[28:31], a[72:75], v[64:67]
    ds_read_b128 a[20:23], v182 offset:54272
    v_mfma_f32_16x16x32_bf16 v[136:139], a[28:31], a[144:147], v[136:139]
    s_waitcnt lgkmcnt(5)
    v_mfma_f32_16x16x32_bf16 v[68:71], a[0:3], a[72:75], v[68:71]
    ds_read_b128 a[24:27], v182 offset:55296
    v_mfma_f32_16x16x32_bf16 v[140:143], a[0:3], a[144:147], v[140:143]
    s_waitcnt lgkmcnt(5)
    v_mfma_f32_16x16x32_bf16 v[72:75], a[4:7], a[72:75], v[72:75]
    ds_read_b128 a[28:31], v182 offset:56320
    v_mfma_f32_16x16x32_bf16 v[144:147], a[4:7], a[144:147], v[144:147]
    s_waitcnt lgkmcnt(5)
    v_mfma_f32_16x16x32_bf16 v[76:79], a[8:11], a[72:75], v[76:79]
    ds_read_b128 a[0:3], v182 offset:57344
    v_mfma_f32_16x16x32_bf16 v[148:151], a[8:11], a[144:147], v[148:151]
    s_waitcnt lgkmcnt(5)
    v_mfma_f32_16x16x32_bf16 v[80:83], a[12:15], a[72:75], v[80:83]
    ds_read_b128 a[4:7], v182 offset:58368
    v_mfma_f32_16x16x32_bf16 v[152:155], a[12:15], a[144:147], v[152:155]
    s_waitcnt lgkmcnt(5)
    v_mfma_f32_16x16x32_bf16 v[84:87], a[16:19], a[72:75], v[84:87]
    ds_read_b128 a[8:11], v182 offset:59392
    v_mfma_f32_16x16x32_bf16 v[156:159], a[16:19], a[144:147], v[156:159]
    s_waitcnt lgkmcnt(5)
    v_mfma_f32_16x16x32_bf16 v[52:55], a[20:23], a[76:79], v[52:55]
    ds_read_b128 a[12:15], v182 offset:60416
    v_mfma_f32_16x16x32_bf16 v[124:127], a[20:23], a[148:151], v[124:127]
    s_waitcnt lgkmcnt(5)
    v_mfma_f32_16x16x32_bf16 v[56:59], a[24:27], a[76:79], v[56:59]
    ds_read_b128 a[16:19], v182 offset:61440
    v_mfma_f32_16x16x32_bf16 v[128:131], a[24:27], a[148:151], v[128:131]
    s_waitcnt lgkmcnt(5)
    v_mfma_f32_16x16x32_bf16 v[60:63], a[28:31], a[76:79], v[60:63]
    ds_read_b128 a[20:23], v182 offset:62464
    v_mfma_f32_16x16x32_bf16 v[132:135], a[28:31], a[148:151], v[132:135]
    s_waitcnt lgkmcnt(5)
    v_mfma_f32_16x16x32_bf16 v[64:67], a[0:3], a[76:79], v[64:67]
    ds_read_b128 a[24:27], v182 offset:63488
    v_mfma_f32_16x16x32_bf16 v[136:139], a[0:3], a[148:151], v[136:139]
    s_waitcnt lgkmcnt(5)
    v_mfma_f32_16x16x32_bf16 v[68:71], a[4:7], a[76:79], v[68:71]
    ds_read_b128 a[28:31], v182 offset:64512
    v_mfma_f32_16x16x32_bf16 v[140:143], a[4:7], a[148:151], v[140:143]
    s_waitcnt lgkmcnt(5)
    v_mfma_f32_16x16x32_bf16 v[72:75], a[8:11], a[76:79], v[72:75]
    ds_read_b128 a[0:3], v183 offset:0
    v_mfma_f32_16x16x32_bf16 v[144:147], a[8:11], a[148:151], v[144:147]
    s_waitcnt lgkmcnt(5)
    v_mfma_f32_16x16x32_bf16 v[76:79], a[12:15], a[76:79], v[76:79]
    ds_read_b128 a[4:7], v183 offset:1024
    v_mfma_f32_16x16x32_bf16 v[148:151], a[12:15], a[148:151], v[148:151]
    s_waitcnt lgkmcnt(5)
    v_mfma_f32_16x16x32_bf16 v[80:83], a[16:19], a[76:79], v[80:83]
    ds_read_b128 a[8:11], v183 offset:2048
    v_mfma_f32_16x16x32_bf16 v[152:155], a[16:19], a[148:151], v[152:155]
    s_waitcnt lgkmcnt(5)
    v_mfma_f32_16x16x32_bf16 v[84:87], a[20:23], a[76:79], v[84:87]
    ds_read_b128 a[12:15], v183 offset:3072
    v_mfma_f32_16x16x32_bf16 v[156:159], a[20:23], a[148:151], v[156:159]
    s_waitcnt lgkmcnt(5)
    v_mfma_f32_16x16x32_bf16 v[52:55], a[24:27], a[80:83], v[52:55]
    ds_read_b128 a[16:19], v183 offset:4096
    v_mfma_f32_16x16x32_bf16 v[124:127], a[24:27], a[152:155], v[124:127]
    s_waitcnt lgkmcnt(5)
    v_mfma_f32_16x16x32_bf16 v[56:59], a[28:31], a[80:83], v[56:59]
    ds_read_b128 a[20:23], v183 offset:5120
    v_mfma_f32_16x16x32_bf16 v[128:131], a[28:31], a[152:155], v[128:131]
    s_waitcnt lgkmcnt(5)
    v_mfma_f32_16x16x32_bf16 v[60:63], a[0:3], a[80:83], v[60:63]
    ds_read_b128 a[24:27], v183 offset:6144
    v_mfma_f32_16x16x32_bf16 v[132:135], a[0:3], a[152:155], v[132:135]
    s_waitcnt lgkmcnt(5)
    v_mfma_f32_16x16x32_bf16 v[64:67], a[4:7], a[80:83], v[64:67]
    ds_read_b128 a[28:31], v183 offset:7168
    v_mfma_f32_16x16x32_bf16 v[136:139], a[4:7], a[152:155], v[136:139]
    s_waitcnt lgkmcnt(5)
    v_mfma_f32_16x16x32_bf16 v[68:71], a[8:11], a[80:83], v[68:71]
    ds_read_b128 a[0:3], v183 offset:8192
    v_mfma_f32_16x16x32_bf16 v[140:143], a[8:11], a[152:155], v[140:143]
    s_waitcnt lgkmcnt(5)
    v_mfma_f32_16x16x32_bf16 v[72:75], a[12:15], a[80:83], v[72:75]
    ds_read_b128 a[4:7], v183 offset:9216
    v_mfma_f32_16x16x32_bf16 v[144:147], a[12:15], a[152:155], v[144:147]
    s_waitcnt lgkmcnt(5)
    v_mfma_f32_16x16x32_bf16 v[76:79], a[16:19], a[80:83], v[76:79]
    ds_read_b128 a[8:11], v183 offset:10240
    v_mfma_f32_16x16x32_bf16 v[148:151], a[16:19], a[152:155], v[148:151]
    s_waitcnt lgkmcnt(5)
    v_mfma_f32_16x16x32_bf16 v[80:83], a[20:23], a[80:83], v[80:83]
    ds_read_b128 a[12:15], v183 offset:11264
    v_mfma_f32_16x16x32_bf16 v[152:155], a[20:23], a[152:155], v[152:155]
    s_waitcnt lgkmcnt(5)
    v_mfma_f32_16x16x32_bf16 v[84:87], a[24:27], a[80:83], v[84:87]
    ds_read_b128 a[16:19], v183 offset:12288
    v_mfma_f32_16x16x32_bf16 v[156:159], a[24:27], a[152:155], v[156:159]
    s_waitcnt lgkmcnt(5)
    v_mfma_f32_16x16x32_bf16 v[52:55], a[28:31], a[84:87], v[52:55]
    ds_read_b128 a[20:23], v183 offset:13312
    v_mfma_f32_16x16x32_bf16 v[124:127], a[28:31], a[156:159], v[124:127]
    s_waitcnt lgkmcnt(5)
    v_mfma_f32_16x16x32_bf16 v[56:59], a[0:3], a[84:87], v[56:59]
    ds_read_b128 a[24:27], v183 offset:14336
    v_mfma_f32_16x16x32_bf16 v[128:131], a[0:3], a[156:159], v[128:131]
    s_waitcnt lgkmcnt(5)
    v_mfma_f32_16x16x32_bf16 v[60:63], a[4:7], a[84:87], v[60:63]
    ds_read_b128 a[28:31], v183 offset:15360
    v_mfma_f32_16x16x32_bf16 v[132:135], a[4:7], a[156:159], v[132:135]
    s_waitcnt lgkmcnt(5)
    v_mfma_f32_16x16x32_bf16 v[64:67], a[8:11], a[84:87], v[64:67]
    v_mfma_f32_16x16x32_bf16 v[136:139], a[8:11], a[156:159], v[136:139]
    s_waitcnt lgkmcnt(4)
    v_mfma_f32_16x16x32_bf16 v[68:71], a[12:15], a[84:87], v[68:71]
    v_mfma_f32_16x16x32_bf16 v[140:143], a[12:15], a[156:159], v[140:143]
    s_waitcnt lgkmcnt(3)
    v_mfma_f32_16x16x32_bf16 v[72:75], a[16:19], a[84:87], v[72:75]
    v_mfma_f32_16x16x32_bf16 v[144:147], a[16:19], a[156:159], v[144:147]
    s_waitcnt lgkmcnt(0)
    s_waitcnt vmcnt(9)
    s_waitcnt vmcnt(0)
    s_barrier
    buffer_store_dword v7, v8, s[20:23], s78 offen sc1
    ds_read_b128 a[0:3], v181 offset:0
    v_mfma_f32_16x16x32_bf16 v[76:79], a[20:23], a[84:87], v[76:79]
    ds_read_b128 a[4:7], v181 offset:1024
    v_mfma_f32_16x16x32_bf16 v[148:151], a[20:23], a[156:159], v[148:151]
    ds_read_b128 a[8:11], v181 offset:2048
    v_mfma_f32_16x16x32_bf16 v[80:83], a[24:27], a[84:87], v[80:83]
    ds_read_b128 a[12:15], v181 offset:3072
    v_mfma_f32_16x16x32_bf16 v[152:155], a[24:27], a[156:159], v[152:155]
    ds_read_b128 a[16:19], v181 offset:4096
    v_mfma_f32_16x16x32_bf16 v[84:87], a[28:31], a[84:87], v[84:87]
    ds_read_b128 a[20:23], v181 offset:5120
    v_mfma_f32_16x16x32_bf16 v[156:159], a[28:31], a[156:159], v[156:159]
    s_add_u32 m0, s73, 0
    s_nop 0
    buffer_load_dwordx4 v191, s[64:67], s72 offen lds
    s_waitcnt lgkmcnt(5)
    v_mfma_f32_16x16x32_bf16 v[52:55], a[0:3], a[88:91], v[52:55]
    ds_read_b128 a[24:27], v181 offset:6144
    v_mfma_f32_16x16x32_bf16 v[124:127], a[0:3], a[160:163], v[124:127]
    s_waitcnt lgkmcnt(5)
    v_mfma_f32_16x16x32_bf16 v[56:59], a[4:7], a[88:91], v[56:59]
    ds_read_b128 a[28:31], v181 offset:7168
    v_mfma_f32_16x16x32_bf16 v[128:131], a[4:7], a[160:163], v[128:131]
    s_add_u32 m0, s73, 1024
    s_nop 0
    buffer_load_dwordx4 v192, s[64:67], s72 offen lds
    s_waitcnt lgkmcnt(5)
    v_mfma_f32_16x16x32_bf16 v[60:63], a[8:11], a[88:91], v[60:63]
    ds_read_b128 a[0:3], v181 offset:8192
    v_mfma_f32_16x16x32_bf16 v[132:135], a[8:11], a[160:163], v[132:135]
    s_add_u32 m0, s73, 2048
    s_nop 0
    buffer_load_dwordx4 v193, s[64:67], s72 offen lds
    s_waitcnt lgkmcnt(5)
    v_mfma_f32_16x16x32_bf16 v[64:67], a[12:15], a[88:91], v[64:67]
    ds_read_b128 a[4:7], v181 offset:9216
    v_mfma_f32_16x16x32_bf16 v[136:139], a[12:15], a[160:163], v[136:139]
    s_waitcnt lgkmcnt(5)
    v_mfma_f32_16x16x32_bf16 v[68:71], a[16:19], a[88:91], v[68:71]
    ds_read_b128 a[8:11], v181 offset:10240
    v_mfma_f32_16x16x32_bf16 v[140:143], a[16:19], a[160:163], v[140:143]
    s_add_u32 m0, s73, 3072
    s_nop 0
    buffer_load_dwordx4 v194, s[64:67], s72 offen lds
    s_waitcnt lgkmcnt(5)
    v_mfma_f32_16x16x32_bf16 v[72:75], a[20:23], a[88:91], v[72:75]
    ds_read_b128 a[12:15], v181 offset:11264
    v_mfma_f32_16x16x32_bf16 v[144:147], a[20:23], a[160:163], v[144:147]
    s_add_u32 m0, s73, 4096
    s_add_u32 s72, s72, 128
    buffer_load_dwordx4 v191, s[64:67], s72 offen lds
    s_waitcnt lgkmcnt(5)
    v_mfma_f32_16x16x32_bf16 v[76:79], a[24:27], a[88:91], v[76:79]
    ds_read_b128 a[16:19], v181 offset:12288
    v_mfma_f32_16x16x32_bf16 v[148:151], a[24:27], a[160:163], v[148:151]
    s_waitcnt lgkmcnt(5)
    v_mfma_f32_16x16x32_bf16 v[80:83], a[28:31], a[88:91], v[80:83]
    ds_read_b128 a[20:23], v181 offset:13312
    v_mfma_f32_16x16x32_bf16 v[152:155], a[28:31], a[160:163], v[152:155]
    s_add_u32 m0, s73, 5120
    s_nop 0
    buffer_load_dwordx4 v192, s[64:67], s72 offen lds
    s_waitcnt lgkmcnt(5)
    v_mfma_f32_16x16x32_bf16 v[84:87], a[0:3], a[88:91], v[84:87]
    ds_read_b128 a[24:27], v181 offset:14336
    v_mfma_f32_16x16x32_bf16 v[156:159], a[0:3], a[160:163], v[156:159]
    s_add_u32 m0, s73, 6144
    s_nop 0
    buffer_load_dwordx4 v193, s[64:67], s72 offen lds
    s_waitcnt lgkmcnt(5)
    v_mfma_f32_16x16x32_bf16 v[52:55], a[4:7], a[92:95], v[52:55]
    ds_read_b128 a[28:31], v181 offset:15360
    v_mfma_f32_16x16x32_bf16 v[124:127], a[4:7], a[164:167], v[124:127]
    s_waitcnt lgkmcnt(5)
    v_mfma_f32_16x16x32_bf16 v[56:59], a[8:11], a[92:95], v[56:59]
    ds_read_b128 a[0:3], v181 offset:16384
    v_mfma_f32_16x16x32_bf16 v[128:131], a[8:11], a[164:167], v[128:131]
    s_add_u32 m0, s73, 7168
    s_nop 0
    buffer_load_dwordx4 v194, s[64:67], s72 offen lds
    s_waitcnt lgkmcnt(5)
    v_mfma_f32_16x16x32_bf16 v[60:63], a[12:15], a[92:95], v[60:63]
    ds_read_b128 a[4:7], v181 offset:17408
    v_mfma_f32_16x16x32_bf16 v[132:135], a[12:15], a[164:167], v[132:135]
    s_add_u32 m0, s73, 8192
    s_add_u32 s72, s72, 128
    buffer_load_dwordx4 v191, s[64:67], s72 offen lds
    s_waitcnt lgkmcnt(5)
    v_mfma_f32_16x16x32_bf16 v[64:67], a[16:19], a[92:95], v[64:67]
    ds_read_b128 a[8:11], v181 offset:18432
    v_mfma_f32_16x16x32_bf16 v[136:139], a[16:19], a[164:167], v[136:139]
    s_waitcnt lgkmcnt(5)
    v_mfma_f32_16x16x32_bf16 v[68:71], a[20:23], a[92:95], v[68:71]
    ds_read_b128 a[12:15], v181 offset:19456
    v_mfma_f32_16x16x32_bf16 v[140:143], a[20:23], a[164:167], v[140:143]
    s_add_u32 m0, s73, 9216
    s_nop 0
    buffer_load_dwordx4 v192, s[64:67], s72 offen lds
    s_waitcnt lgkmcnt(5)
    v_mfma_f32_16x16x32_bf16 v[72:75], a[24:27], a[92:95], v[72:75]
    ds_read_b128 a[16:19], v181 offset:20480
    v_mfma_f32_16x16x32_bf16 v[144:147], a[24:27], a[164:167], v[144:147]
    s_add_u32 m0, s73, 10240
    s_nop 0
    buffer_load_dwordx4 v193, s[64:67], s72 offen lds
    s_waitcnt lgkmcnt(5)
    v_mfma_f32_16x16x32_bf16 v[76:79], a[28:31], a[92:95], v[76:79]
    ds_read_b128 a[20:23], v181 offset:21504
    v_mfma_f32_16x16x32_bf16 v[148:151], a[28:31], a[164:167], v[148:151]
    s_waitcnt lgkmcnt(5)
    v_mfma_f32_16x16x32_bf16 v[80:83], a[0:3], a[92:95], v[80:83]
    ds_read_b128 a[24:27], v181 offset:22528
    v_mfma_f32_16x16x32_bf16 v[152:155], a[0:3], a[164:167], v[152:155]
    s_add_u32 m0, s73, 11264
    s_nop 0
    buffer_load_dwordx4 v194, s[64:67], s72 offen lds
    s_waitcnt lgkmcnt(5)
    v_mfma_f32_16x16x32_bf16 v[84:87], a[4:7], a[92:95], v[84:87]
    ds_read_b128 a[28:31], v181 offset:23552
    v_mfma_f32_16x16x32_bf16 v[156:159], a[4:7], a[164:167], v[156:159]
    s_waitcnt lgkmcnt(5)
    v_mfma_f32_16x16x32_bf16 v[52:55], a[8:11], a[96:99], v[52:55]
    ds_read_b128 a[0:3], v181 offset:24576
    v_mfma_f32_16x16x32_bf16 v[124:127], a[8:11], a[168:171], v[124:127]
    s_waitcnt lgkmcnt(5)
    v_mfma_f32_16x16x32_bf16 v[56:59], a[12:15], a[96:99], v[56:59]
    ds_read_b128 a[4:7], v181 offset:25600
    v_mfma_f32_16x16x32_bf16 v[128:131], a[12:15], a[168:171], v[128:131]
    s_waitcnt lgkmcnt(5)
    v_mfma_f32_16x16x32_bf16 v[60:63], a[16:19], a[96:99], v[60:63]
    ds_read_b128 a[8:11], v181 offset:26624
    v_mfma_f32_16x16x32_bf16 v[132:135], a[16:19], a[168:171], v[132:135]
    s_waitcnt lgkmcnt(5)
    v_mfma_f32_16x16x32_bf16 v[64:67], a[20:23], a[96:99], v[64:67]
    ds_read_b128 a[12:15], v181 offset:27648
    v_mfma_f32_16x16x32_bf16 v[136:139], a[20:23], a[168:171], v[136:139]
    s_waitcnt lgkmcnt(5)
    v_mfma_f32_16x16x32_bf16 v[68:71], a[24:27], a[96:99], v[68:71]
    ds_read_b128 a[16:19], v181 offset:28672
    v_mfma_f32_16x16x32_bf16 v[140:143], a[24:27], a[168:171], v[140:143]
    s_waitcnt lgkmcnt(5)
    v_mfma_f32_16x16x32_bf16 v[72:75], a[28:31], a[96:99], v[72:75]
    ds_read_b128 a[20:23], v181 offset:29696
    v_mfma_f32_16x16x32_bf16 v[144:147], a[28:31], a[168:171], v[144:147]
    s_waitcnt lgkmcnt(5)
    v_mfma_f32_16x16x32_bf16 v[76:79], a[0:3], a[96:99], v[76:79]
    ds_read_b128 a[24:27], v181 offset:30720
    v_mfma_f32_16x16x32_bf16 v[148:151], a[0:3], a[168:171], v[148:151]
    s_waitcnt lgkmcnt(5)
    v_mfma_f32_16x16x32_bf16 v[80:83], a[4:7], a[96:99], v[80:83]
    ds_read_b128 a[28:31], v181 offset:31744
    v_mfma_f32_16x16x32_bf16 v[152:155], a[4:7], a[168:171], v[152:155]
    s_waitcnt lgkmcnt(5)
    v_mfma_f32_16x16x32_bf16 v[84:87], a[8:11], a[96:99], v[84:87]
    ds_read_b128 a[0:3], v181 offset:32768
    v_mfma_f32_16x16x32_bf16 v[156:159], a[8:11], a[168:171], v[156:159]
    s_waitcnt lgkmcnt(5)
    v_mfma_f32_16x16x32_bf16 v[52:55], a[12:15], a[100:103], v[52:55]
    ds_read_b128 a[4:7], v181 offset:33792
    v_mfma_f32_16x16x32_bf16 v[124:127], a[12:15], a[172:175], v[124:127]
    s_waitcnt lgkmcnt(5)
    v_mfma_f32_16x16x32_bf16 v[56:59], a[16:19], a[100:103], v[56:59]
    ds_read_b128 a[8:11], v181 offset:34816
    v_mfma_f32_16x16x32_bf16 v[128:131], a[16:19], a[172:175], v[128:131]
    s_waitcnt lgkmcnt(5)
    v_mfma_f32_16x16x32_bf16 v[60:63], a[20:23], a[100:103], v[60:63]
    ds_read_b128 a[12:15], v181 offset:35840
    v_mfma_f32_16x16x32_bf16 v[132:135], a[20:23], a[172:175], v[132:135]
    s_waitcnt lgkmcnt(5)
    v_mfma_f32_16x16x32_bf16 v[64:67], a[24:27], a[100:103], v[64:67]
    v_mfma_f32_16x16x32_bf16 v[136:139], a[24:27], a[172:175], v[136:139]
    s_waitcnt lgkmcnt(4)
    v_mfma_f32_16x16x32_bf16 v[68:71], a[28:31], a[100:103], v[68:71]
    v_mfma_f32_16x16x32_bf16 v[140:143], a[28:31], a[172:175], v[140:143]
    s_waitcnt lgkmcnt(3)
    v_mfma_f32_16x16x32_bf16 v[72:75], a[0:3], a[100:103], v[72:75]
    v_mfma_f32_16x16x32_bf16 v[144:147], a[0:3], a[172:175], v[144:147]
    s_waitcnt lgkmcnt(2)
    v_mfma_f32_16x16x32_bf16 v[76:79], a[4:7], a[100:103], v[76:79]
    v_mfma_f32_16x16x32_bf16 v[148:151], a[4:7], a[172:175], v[148:151]
    s_waitcnt lgkmcnt(1)
    v_mfma_f32_16x16x32_bf16 v[80:83], a[8:11], a[100:103], v[80:83]
    v_mfma_f32_16x16x32_bf16 v[152:155], a[8:11], a[172:175], v[152:155]
    s_waitcnt lgkmcnt(0)
    v_mfma_f32_16x16x32_bf16 v[84:87], a[12:15], a[100:103], v[84:87]
    v_mfma_f32_16x16x32_bf16 v[156:159], a[12:15], a[172:175], v[156:159]
    s_waitcnt lgkmcnt(0)
    s_barrier
    s_mov_b32 s24, 0
    s_nop 5
mega_fp14:
    buffer_load_dword v176, v9, s[20:23], s60 offen sc1
    s_waitcnt vmcnt(0)
    v_cmp_eq_u32 vcc, 0, v176
    s_add_u32 s24, s24, 1
    s_nop 3
    s_cbranch_vccz mega_fok15
    s_sleep 1
    s_cmp_lt_u32 s24, 524288
    s_cbranch_scc1 mega_fp14
mega_fok15:
L_p4:
    s_mul_i32 s79, s36, 589824
    s_add_u32 s79, s79, 9424896
    s_mul_i32 s80, s4, 9216
    s_add_u32 s81, s79, s80
    v_add_u32 v246, 0, v5
    v_add_u32 v247, 65536, v5
    s_mul_i32 s85, s4, 9
    s_and_b32 s88, s2, 3
    s_lshl_b32 s86, s88, 3
    s_bfe_u32 s88, s2, 0x30003
    s_add_u32 s86, s86, s88
    s_bfe_u32 s88, s2, 0x10002
    s_lshl_b32 s87, s88, 2
    s_lshr_b32 s88, s2, 6
    s_add_u32 s87, s87, s88
    s_mul_i32 s90, s4, 18432
    s_mul_i32 s89, s87, 368640
    s_add_u32 s89, s89, s90
    s_add_u32 s89, s89, 5308416
    s_add_u32 s26, s89, 0
    s_add_u32 s27, s89, 73728
    s_add_u32 s28, s89, 147456
    s_add_u32 s29, s89, 221184
    s_add_u32 s30, s89, 294912
    s_add_u32 m0, s80, 0
    s_add_u32 s82, s81, 0
    buffer_load_dwordx4 v5, s[20:23], s82 offen offset:0 sc1 lds
    s_add_u32 m0, s80, 0
    s_nop 0
    buffer_load_dwordx4 v5, s[20:23], s82 offen offset:1024 sc1 lds
    s_add_u32 m0, s80, 0
    s_nop 0
    buffer_load_dwordx4 v5, s[20:23], s82 offen offset:2048 sc1 lds
    s_add_u32 m0, s80, 0
    s_nop 0
    buffer_load_dwordx4 v5, s[20:23], s82 offen offset:3072 sc1 lds
    s_add_u32 m0, s80, 4096
    s_add_u32 s82, s81, 4096
    buffer_load_dwordx4 v5, s[20:23], s82 offen offset:0 sc1 lds
    s_add_u32 m0, s80, 4096
    s_nop 0
    buffer_load_dwordx4 v5, s[20:23], s82 offen offset:1024 sc1 lds
    s_add_u32 m0, s80, 4096
    s_nop 0
    buffer_load_dwordx4 v5, s[20:23], s82 offen offset:2048 sc1 lds
    s_add_u32 m0, s80, 4096
    s_nop 0
    buffer_load_dwordx4 v5, s[20:23], s82 offen offset:3072 sc1 lds
    s_add_u32 m0, s80, 8192
    s_add_u32 s82, s81, 8192
    buffer_load_dwordx4 v5, s[20:23], s82 offen offset:0 sc1 lds
    s_add_u32 m0, s80, 36864
    s_add_u32 s82, s81, 36864
    buffer_load_dwordx4 v5, s[20:23], s82 offen offset:0 sc1 lds
    ds_read_b128 a[176:179], v195 offset:0
    ds_read_b128 a[180:183], v195 offset:512
    ds_read_b128 a[184:187], v196 offset:0
    ds_read_b128 a[188:191], v196 offset:512
    ds_read_b128 a[192:195], v195 offset:4096
    ds_read_b128 a[196:199], v195 offset:4608
    ds_read_b128 a[200:203], v196 offset:4096
    ds_read_b128 a[204:207], v196 offset:4608
    ds_read_b128 a[208:211], v195 offset:8192
    ds_read_b128 a[212:215], v195 offset:8704
    ds_read_b128 a[216:219], v196 offset:8192
    ds_read_b128 a[220:223], v196 offset:8704
    s_waitcnt lgkmcnt(0)
    v_mov_b32 v216, v169
    v_mov_b32 v217, v169
    v_mov_b32 v218, v170
    v_mov_b32 v219, v170
    v_mov_b32 v220, v171
    v_mov_b32 v221, v171
    v_mov_b32 v222, v173
    v_mov_b32 v223, v173
    v_mov_b32 v224, v174
    v_mov_b32 v225, v174
    v_mov_b32 v226, v175
    v_mov_b32 v227, v175
    v_pk_fma_f32 v[52:53], v[216:217], v[16:17], v[52:53]
    v_pk_fma_f32 v[54:55], v[216:217], v[18:19], v[54:55]
    v_pk_mul_f32 v[228:229], v[52:53], v[52:53]
    v_pk_mul_f32 v[230:231], v[54:55], v[54:55]
    v_pk_fma_f32 v[228:229], v[228:229], v[220:221], v[218:219]
    v_pk_fma_f32 v[230:231], v[230:231], v[220:221], v[218:219]
    v_pk_mul_f32 v[228:229], v[228:229], v[52:53]
    v_pk_mul_f32 v[230:231], v[230:231], v[54:55]
    v_exp_f32 v228, v228
    v_pk_fma_f32 v[124:125], v[222:223], v[16:17], v[124:125]
    v_exp_f32 v229, v229
    v_pk_fma_f32 v[126:127], v[222:223], v[18:19], v[126:127]
    v_exp_f32 v230, v230
    v_pk_mul_f32 v[208:209], v[124:125], v[124:125]
    v_exp_f32 v231, v231
    v_pk_mul_f32 v[210:211], v[126:127], v[126:127]
    v_pk_add_f32 v[228:229], v[228:229], 1.0 op_sel_hi:[1,0]
    v_pk_add_f32 v[230:231], v[230:231], 1.0 op_sel_hi:[1,0]
    v_rcp_f32 v228, v228
    v_pk_fma_f32 v[208:209], v[208:209], v[226:227], v[224:225]
    v_rcp_f32 v229, v229
    v_pk_fma_f32 v[210:211], v[210:211], v[226:227], v[224:225]
    v_rcp_f32 v230, v230
    v_pk_mul_f32 v[208:209], v[208:209], v[124:125]
    v_rcp_f32 v231, v231
    v_pk_mul_f32 v[210:211], v[210:211], v[126:127]
    s_add_u32 m0, s80, 36864
    s_nop 0
    buffer_load_dwordx4 v5, s[20:23], s82 offen offset:1024 sc1 lds
    s_add_u32 m0, s80, 36864
    s_nop 0
    buffer_load_dwordx4 v5, s[20:23], s82 offen offset:2048 sc1 lds
    v_exp_f32 v208, v208
    v_pk_mul_f32 v[52:53], v[52:53], v[228:229]
    v_pk_mul_f32 v[54:55], v[54:55], v[230:231]
    v_exp_f32 v209, v209
    v_pk_fma_f32 v[56:57], v[216:217], v[20:21], v[56:57]
    v_pk_fma_f32 v[58:59], v[216:217], v[22:23], v[58:59]
    v_exp_f32 v210, v210
    v_pk_mul_f32 v[228:229], v[56:57], v[56:57]
    v_pk_mul_f32 v[230:231], v[58:59], v[58:59]
    v_exp_f32 v211, v211
    v_pk_fma_f32 v[228:229], v[228:229], v[220:221], v[218:219]
    v_pk_fma_f32 v[230:231], v[230:231], v[220:221], v[218:219]
    v_pk_add_f32 v[208:209], v[208:209], 1.0 op_sel_hi:[1,0]
    v_pk_add_f32 v[210:211], v[210:211], 1.0 op_sel_hi:[1,0]
    v_rcp_f32 v208, v208
    v_pk_mul_f32 v[228:229], v[228:229], v[56:57]
    v_pk_mul_f32 v[230:231], v[230:231], v[58:59]
    v_rcp_f32 v209, v209
    v_rcp_f32 v210, v210
    v_rcp_f32 v211, v211
    s_add_u32 m0, s80, 36864
    s_nop 0
    buffer_load_dwordx4 v5, s[20:23], s82 offen offset:3072 sc1 lds
    s_add_u32 m0, s80, 40960
    s_add_u32 s82, s81, 40960
    buffer_load_dwordx4 v5, s[20:23], s82 offen offset:0 sc1 lds
    v_exp_f32 v228, v228
    v_pk_mul_f32 v[124:125], v[124:125], v[208:209]
    v_pk_mul_f32 v[126:127], v[126:127], v[210:211]
    v_exp_f32 v229, v229
    v_pk_fma_f32 v[128:129], v[222:223], v[20:21], v[128:129]
    v_pk_fma_f32 v[130:131], v[222:223], v[22:23], v[130:131]
    v_exp_f32 v230, v230
    v_pk_mul_f32 v[208:209], v[128:129], v[128:129]
    v_pk_mul_f32 v[210:211], v[130:131], v[130:131]
    v_exp_f32 v231, v231
    v_pk_fma_f32 v[208:209], v[208:209], v[226:227], v[224:225]
    v_pk_fma_f32 v[210:211], v[210:211], v[226:227], v[224:225]
    v_pk_add_f32 v[228:229], v[228:229], 1.0 op_sel_hi:[1,0]
    v_pk_add_f32 v[230:231], v[230:231], 1.0 op_sel_hi:[1,0]
    v_rcp_f32 v228, v228
    v_pk_mul_f32 v[208:209], v[208:209], v[128:129]
    v_pk_mul_f32 v[210:211], v[210:211], v[130:131]
    v_rcp_f32 v229, v229
    v_rcp_f32 v230, v230
    v_rcp_f32 v231, v231
    s_add_u32 m0, s80, 40960
    s_nop 0
    buffer_load_dwordx4 v5, s[20:23], s82 offen offset:1024 sc1 lds
    s_add_u32 m0, s80, 40960
    s_nop 0
    buffer_load_dwordx4 v5, s[20:23], s82 offen offset:2048 sc1 lds
    v_exp_f32 v208, v208
    v_pk_mul_f32 v[56:57], v[56:57], v[228:229]
    v_pk_mul_f32 v[58:59], v[58:59], v[230:231]
    v_exp_f32 v209, v209
    v_pk_fma_f32 v[60:61], v[216:217], v[24:25], v[60:61]
    v_pk_fma_f32 v[62:63], v[216:217], v[26:27], v[62:63]
    v_exp_f32 v210, v210
    v_pk_mul_f32 v[228:229], v[60:61], v[60:61]
    v_pk_mul_f32 v[230:231], v[62:63], v[62:63]
    v_exp_f32 v211, v211
    v_pk_fma_f32 v[228:229], v[228:229], v[220:221], v[218:219]
    v_pk_fma_f32 v[230:231], v[230:231], v[220:221], v[218:219]
    v_pk_add_f32 v[208:209], v[208:209], 1.0 op_sel_hi:[1,0]
    v_pk_add_f32 v[210:211], v[210:211], 1.0 op_sel_hi:[1,0]
    v_rcp_f32 v208, v208
    v_pk_mul_f32 v[228:229], v[228:229], v[60:61]
    v_pk_mul_f32 v[230:231], v[230:231], v[62:63]
    v_rcp_f32 v209, v209
    v_rcp_f32 v210, v210
    v_rcp_f32 v211, v211
    s_add_u32 m0, s80, 40960
    s_nop 0
    buffer_load_dwordx4 v5, s[20:23], s82 offen offset:3072 sc1 lds
    s_add_u32 m0, s80, 45056
    s_add_u32 s82, s81, 45056
    buffer_load_dwordx4 v5, s[20:23], s82 offen offset:0 sc1 lds
    v_exp_f32 v228, v228
    v_pk_mul_f32 v[128:129], v[128:129], v[208:209]
    v_pk_mul_f32 v[130:131], v[130:131], v[210:211]
    v_exp_f32 v229, v229
    v_pk_fma_f32 v[132:133], v[222:223], v[24:25], v[132:133]
    v_pk_fma_f32 v[134:135], v[222:223], v[26:27], v[134:135]
    v_exp_f32 v230, v230
    v_pk_mul_f32 v[208:209], v[132:133], v[132:133]
    v_pk_mul_f32 v[210:211], v[134:135], v[134:135]
    v_exp_f32 v231, v231
    v_pk_fma_f32 v[208:209], v[208:209], v[226:227], v[224:225]
    v_pk_fma_f32 v[210:211], v[210:211], v[226:227], v[224:225]
    v_pk_add_f32 v[228:229], v[228:229], 1.0 op_sel_hi:[1,0]
    v_pk_add_f32 v[230:231], v[230:231], 1.0 op_sel_hi:[1,0]
    v_rcp_f32 v228, v228
    v_pk_mul_f32 v[208:209], v[208:209], v[132:133]
    v_pk_mul_f32 v[210:211], v[210:211], v[134:135]
    v_rcp_f32 v229, v229
    v_rcp_f32 v230, v230
    v_rcp_f32 v231, v231
    s_add_u32 m0, s80, 73728
    s_add_u32 s82, s81, 73728
    buffer_load_dwordx4 v5, s[20:23], s82 offen offset:0 sc1 lds
    s_add_u32 m0, s80, 73728
    s_nop 0
    buffer_load_dwordx4 v5, s[20:23], s82 offen offset:1024 sc1 lds
    v_exp_f32 v208, v208
    v_pk_mul_f32 v[60:61], v[60:61], v[228:229]
    v_pk_mul_f32 v[62:63], v[62:63], v[230:231]
    v_exp_f32 v209, v209
    v_pk_fma_f32 v[64:65], v[216:217], v[28:29], v[64:65]
    v_pk_fma_f32 v[66:67], v[216:217], v[30:31], v[66:67]
    v_exp_f32 v210, v210
    v_pk_mul_f32 v[228:229], v[64:65], v[64:65]
    v_pk_mul_f32 v[230:231], v[66:67], v[66:67]
    v_exp_f32 v211, v211
    v_pk_fma_f32 v[228:229], v[228:229], v[220:221], v[218:219]
    v_pk_fma_f32 v[230:231], v[230:231], v[220:221], v[218:219]
    v_pk_add_f32 v[208:209], v[208:209], 1.0 op_sel_hi:[1,0]
    v_pk_add_f32 v[210:211], v[210:211], 1.0 op_sel_hi:[1,0]
    v_rcp_f32 v208, v208
    v_pk_mul_f32 v[228:229], v[228:229], v[64:65]
    v_pk_mul_f32 v[230:231], v[230:231], v[66:67]
    v_rcp_f32 v209, v209
    v_rcp_f32 v210, v210
    v_rcp_f32 v211, v211
    s_add_u32 m0, s73, 0
    s_add_u32 s72, s72, 128
    buffer_load_dwordx4 v191, s[64:67], s72 offen lds
    s_add_u32 m0, s73, 1024
    s_nop 0
    buffer_load_dwordx4 v192, s[64:67], s72 offen lds
    v_exp_f32 v228, v228
    v_pk_mul_f32 v[132:133], v[132:133], v[208:209]
    v_pk_mul_f32 v[134:135], v[134:135], v[210:211]
    v_exp_f32 v229, v229
    v_pk_fma_f32 v[136:137], v[222:223], v[28:29], v[136:137]
    v_pk_fma_f32 v[138:139], v[222:223], v[30:31], v[138:139]
    v_exp_f32 v230, v230
    v_pk_mul_f32 v[208:209], v[136:137], v[136:137]
    v_pk_mul_f32 v[210:211], v[138:139], v[138:139]
    v_exp_f32 v231, v231
    v_pk_fma_f32 v[208:209], v[208:209], v[226:227], v[224:225]
    v_pk_fma_f32 v[210:211], v[210:211], v[226:227], v[224:225]
    v_pk_add_f32 v[228:229], v[228:229], 1.0 op_sel_hi:[1,0]
    v_pk_add_f32 v[230:231], v[230:231], 1.0 op_sel_hi:[1,0]
    v_rcp_f32 v228, v228
    v_pk_mul_f32 v[208:209], v[208:209], v[136:137]
    v_pk_mul_f32 v[210:211], v[210:211], v[138:139]
    v_rcp_f32 v229, v229
    v_rcp_f32 v230, v230
    v_rcp_f32 v231, v231
    s_add_u32 m0, s73, 2048
    s_nop 0
    buffer_load_dwordx4 v193, s[64:67], s72 offen lds
    s_add_u32 m0, s73, 3072
    s_nop 0
    buffer_load_dwordx4 v194, s[64:67], s72 offen lds
    v_exp_f32 v208, v208
    v_pk_mul_f32 v[64:65], v[64:65], v[228:229]
    v_pk_mul_f32 v[66:67], v[66:67], v[230:231]
    v_exp_f32 v209, v209
    v_pk_fma_f32 v[68:69], v[216:217], v[32:33], v[68:69]
    v_pk_fma_f32 v[70:71], v[216:217], v[34:35], v[70:71]
    v_exp_f32 v210, v210
    v_pk_mul_f32 v[228:229], v[68:69], v[68:69]
    v_pk_mul_f32 v[230:231], v[70:71], v[70:71]
    v_exp_f32 v211, v211
    v_pk_fma_f32 v[228:229], v[228:229], v[220:221], v[218:219]
    v_pk_fma_f32 v[230:231], v[230:231], v[220:221], v[218:219]
    v_pk_add_f32 v[208:209], v[208:209], 1.0 op_sel_hi:[1,0]
    v_pk_add_f32 v[210:211], v[210:211], 1.0 op_sel_hi:[1,0]
    v_rcp_f32 v208, v208
    v_pk_mul_f32 v[228:229], v[228:229], v[68:69]
    v_pk_mul_f32 v[230:231], v[230:231], v[70:71]
    v_rcp_f32 v209, v209
    v_rcp_f32 v210, v210
    v_rcp_f32 v211, v211
    s_add_u32 m0, s73, 4096
    s_add_u32 s72, s72, 128
    buffer_load_dwordx4 v191, s[64:67], s72 offen lds
    s_add_u32 m0, s73, 5120
    s_nop 0
    buffer_load_dwordx4 v192, s[64:67], s72 offen lds
    v_exp_f32 v228, v228
    v_pk_mul_f32 v[136:137], v[136:137], v[208:209]
    v_pk_mul_f32 v[138:139], v[138:139], v[210:211]
    v_exp_f32 v229, v229
    v_pk_fma_f32 v[140:141], v[222:223], v[32:33], v[140:141]
    v_pk_fma_f32 v[142:143], v[222:223], v[34:35], v[142:143]
    v_exp_f32 v230, v230
    v_pk_mul_f32 v[208:209], v[140:141], v[140:141]
    v_pk_mul_f32 v[210:211], v[142:143], v[142:143]
    v_exp_f32 v231, v231
    v_pk_fma_f32 v[208:209], v[208:209], v[226:227], v[224:225]
    v_pk_fma_f32 v[210:211], v[210:211], v[226:227], v[224:225]
    v_pk_add_f32 v[228:229], v[228:229], 1.0 op_sel_hi:[1,0]
    v_pk_add_f32 v[230:231], v[230:231], 1.0 op_sel_hi:[1,0]
    v_rcp_f32 v228, v228
    v_pk_mul_f32 v[208:209], v[208:209], v[140:141]
    v_pk_mul_f32 v[210:211], v[210:211], v[142:143]
    v_rcp_f32 v229, v229
    v_rcp_f32 v230, v230
    v_rcp_f32 v231, v231
    s_add_u32 m0, s73, 6144
    s_nop 0
    buffer_load_dwordx4 v193, s[64:67], s72 offen lds
    s_add_u32 m0, s73, 7168
    s_nop 0
    buffer_load_dwordx4 v194, s[64:67], s72 offen lds
    v_exp_f32 v208, v208
    v_pk_mul_f32 v[68:69], v[68:69], v[228:229]
    v_pk_mul_f32 v[70:71], v[70:71], v[230:231]
    v_exp_f32 v209, v209
    v_pk_fma_f32 v[72:73], v[216:217], v[36:37], v[72:73]
    v_pk_fma_f32 v[74:75], v[216:217], v[38:39], v[74:75]
    v_exp_f32 v210, v210
    v_pk_mul_f32 v[228:229], v[72:73], v[72:73]
    v_pk_mul_f32 v[230:231], v[74:75], v[74:75]
    v_exp_f32 v211, v211
    v_pk_fma_f32 v[228:229], v[228:229], v[220:221], v[218:219]
    v_pk_fma_f32 v[230:231], v[230:231], v[220:221], v[218:219]
    v_pk_add_f32 v[208:209], v[208:209], 1.0 op_sel_hi:[1,0]
    v_pk_add_f32 v[210:211], v[210:211], 1.0 op_sel_hi:[1,0]
    v_rcp_f32 v208, v208
    v_pk_mul_f32 v[228:229], v[228:229], v[72:73]
    v_pk_mul_f32 v[230:231], v[230:231], v[74:75]
    v_rcp_f32 v209, v209
    v_rcp_f32 v210, v210
    v_rcp_f32 v211, v211
    s_add_u32 m0, s73, 8192
    s_add_u32 s72, s72, 128
    buffer_load_dwordx4 v191, s[64:67], s72 offen lds
    s_add_u32 m0, s73, 9216
    s_nop 0
    buffer_load_dwordx4 v192, s[64:67], s72 offen lds
    v_exp_f32 v228, v228
    v_pk_mul_f32 v[140:141], v[140:141], v[208:209]
    v_pk_mul_f32 v[142:143], v[142:143], v[210:211]
    v_exp_f32 v229, v229
    v_pk_fma_f32 v[144:145], v[222:223], v[36:37], v[144:145]
    v_pk_fma_f32 v[146:147], v[222:223], v[38:39], v[146:147]
    v_exp_f32 v230, v230
    v_pk_mul_f32 v[208:209], v[144:145], v[144:145]
    v_pk_mul_f32 v[210:211], v[146:147], v[146:147]
    v_exp_f32 v231, v231
    v_pk_fma_f32 v[208:209], v[208:209], v[226:227], v[224:225]
    v_pk_fma_f32 v[210:211], v[210:211], v[226:227], v[224:225]
    v_pk_add_f32 v[228:229], v[228:229], 1.0 op_sel_hi:[1,0]
    v_pk_add_f32 v[230:231], v[230:231], 1.0 op_sel_hi:[1,0]
    v_rcp_f32 v228, v228
    v_pk_mul_f32 v[208:209], v[208:209], v[144:145]
    v_pk_mul_f32 v[210:211], v[210:211], v[146:147]
    v_rcp_f32 v229, v229
    v_rcp_f32 v230, v230
    v_rcp_f32 v231, v231
    s_add_u32 m0, s73, 10240
    s_nop 0
    buffer_load_dwordx4 v193, s[64:67], s72 offen lds
    s_add_u32 m0, s73, 11264
    s_nop 0
    buffer_load_dwordx4 v194, s[64:67], s72 offen lds
    v_exp_f32 v208, v208
    v_pk_mul_f32 v[72:73], v[72:73], v[228:229]
    v_pk_mul_f32 v[74:75], v[74:75], v[230:231]
    v_exp_f32 v209, v209
    v_pk_fma_f32 v[76:77], v[216:217], v[40:41], v[76:77]
    v_pk_fma_f32 v[78:79], v[216:217], v[42:43], v[78:79]
    v_exp_f32 v210, v210
    v_pk_mul_f32 v[228:229], v[76:77], v[76:77]
    v_pk_mul_f32 v[230:231], v[78:79], v[78:79]
    v_exp_f32 v211, v211
    v_pk_fma_f32 v[228:229], v[228:229], v[220:221], v[218:219]
    v_pk_fma_f32 v[230:231], v[230:231], v[220:221], v[218:219]
    v_pk_add_f32 v[208:209], v[208:209], 1.0 op_sel_hi:[1,0]
    v_pk_add_f32 v[210:211], v[210:211], 1.0 op_sel_hi:[1,0]
    v_rcp_f32 v208, v208
    v_pk_mul_f32 v[228:229], v[228:229], v[76:77]
    v_pk_mul_f32 v[230:231], v[230:231], v[78:79]
    v_rcp_f32 v209, v209
    v_rcp_f32 v210, v210
    v_rcp_f32 v211, v211
    s_add_u32 m0, s80, 73728
    s_nop 0
    buffer_load_dwordx4 v5, s[20:23], s82 offen offset:2048 sc1 lds
    s_add_u32 m0, s80, 73728
    s_nop 0
    buffer_load_dwordx4 v5, s[20:23], s82 offen offset:3072 sc1 lds
    v_exp_f32 v228, v228
    v_pk_mul_f32 v[144:145], v[144:145], v[208:209]
    v_pk_mul_f32 v[146:147], v[146:147], v[210:211]
    v_exp_f32 v229, v229
    v_pk_fma_f32 v[148:149], v[222:223], v[40:41], v[148:149]
    v_pk_fma_f32 v[150:151], v[222:223], v[42:43], v[150:151]
    v_exp_f32 v230, v230
    v_pk_mul_f32 v[208:209], v[148:149], v[148:149]
    v_pk_mul_f32 v[210:211], v[150:151], v[150:151]
    v_exp_f32 v231, v231
    v_pk_fma_f32 v[208:209], v[208:209], v[226:227], v[224:225]
    v_pk_fma_f32 v[210:211], v[210:211], v[226:227], v[224:225]
    v_pk_add_f32 v[228:229], v[228:229], 1.0 op_sel_hi:[1,0]
    v_pk_add_f32 v[230:231], v[230:231], 1.0 op_sel_hi:[1,0]
    v_rcp_f32 v228, v228
    v_pk_mul_f32 v[208:209], v[208:209], v[148:149]
    v_pk_mul_f32 v[210:211], v[210:211], v[150:151]
    v_rcp_f32 v229, v229
    v_rcp_f32 v230, v230
    v_rcp_f32 v231, v231
    s_add_u32 m0, s80, 77824
    s_add_u32 s82, s81, 77824
    buffer_load_dwordx4 v5, s[20:23], s82 offen offset:0 sc1 lds
    v_exp_f32 v208, v208
    v_pk_mul_f32 v[76:77], v[76:77], v[228:229]
    v_pk_mul_f32 v[78:79], v[78:79], v[230:231]
    v_exp_f32 v209, v209
    v_pk_fma_f32 v[80:81], v[216:217], v[44:45], v[80:81]
    v_pk_fma_f32 v[82:83], v[216:217], v[46:47], v[82:83]
    v_exp_f32 v210, v210
    v_pk_mul_f32 v[228:229], v[80:81], v[80:81]
    v_pk_mul_f32 v[230:231], v[82:83], v[82:83]
    v_exp_f32 v211, v211
    v_pk_fma_f32 v[228:229], v[228:229], v[220:221], v[218:219]
    v_pk_fma_f32 v[230:231], v[230:231], v[220:221], v[218:219]
    v_pk_add_f32 v[208:209], v[208:209], 1.0 op_sel_hi:[1,0]
    v_pk_add_f32 v[210:211], v[210:211], 1.0 op_sel_hi:[1,0]
    v_rcp_f32 v208, v208
    v_pk_mul_f32 v[228:229], v[228:229], v[80:81]
    v_pk_mul_f32 v[230:231], v[230:231], v[82:83]
    v_rcp_f32 v209, v209
    v_rcp_f32 v210, v210
    v_rcp_f32 v211, v211
    v_exp_f32 v228, v228
    v_pk_mul_f32 v[148:149], v[148:149], v[208:209]
    v_pk_mul_f32 v[150:151], v[150:151], v[210:211]
    v_exp_f32 v229, v229
    v_pk_fma_f32 v[152:153], v[222:223], v[44:45], v[152:153]
    v_pk_fma_f32 v[154:155], v[222:223], v[46:47], v[154:155]
    v_exp_f32 v230, v230
    v_pk_mul_f32 v[208:209], v[152:153], v[152:153]
    v_pk_mul_f32 v[210:211], v[154:155], v[154:155]
    v_exp_f32 v231, v231
    v_pk_fma_f32 v[208:209], v[208:209], v[226:227], v[224:225]
    v_pk_fma_f32 v[210:211], v[210:211], v[226:227], v[224:225]
    v_pk_add_f32 v[228:229], v[228:229], 1.0 op_sel_hi:[1,0]
    v_pk_add_f32 v[230:231], v[230:231], 1.0 op_sel_hi:[1,0]
    v_rcp_f32 v228, v228
    v_pk_mul_f32 v[208:209], v[208:209], v[152:153]
    v_pk_mul_f32 v[210:211], v[210:211], v[154:155]
    v_rcp_f32 v229, v229
    v_rcp_f32 v230, v230
    v_rcp_f32 v231, v231
    v_exp_f32 v208, v208
    v_pk_mul_f32 v[80:81], v[80:81], v[228:229]
    v_pk_mul_f32 v[82:83], v[82:83], v[230:231]
    v_exp_f32 v209, v209
    v_pk_fma_f32 v[84:85], v[216:217], v[48:49], v[84:85]
    v_pk_fma_f32 v[86:87], v[216:217], v[50:51], v[86:87]
    v_exp_f32 v210, v210
    v_pk_mul_f32 v[228:229], v[84:85], v[84:85]
    v_pk_mul_f32 v[230:231], v[86:87], v[86:87]
    v_exp_f32 v211, v211
    v_pk_fma_f32 v[228:229], v[228:229], v[220:221], v[218:219]
    v_pk_fma_f32 v[230:231], v[230:231], v[220:221], v[218:219]
    v_pk_add_f32 v[208:209], v[208:209], 1.0 op_sel_hi:[1,0]
    v_pk_add_f32 v[210:211], v[210:211], 1.0 op_sel_hi:[1,0]
    v_rcp_f32 v208, v208
    v_pk_mul_f32 v[228:229], v[228:229], v[84:85]
    v_pk_mul_f32 v[230:231], v[230:231], v[86:87]
    v_rcp_f32 v209, v209
    v_rcp_f32 v210, v210
    v_rcp_f32 v211, v211
    v_exp_f32 v228, v228
    v_pk_mul_f32 v[152:153], v[152:153], v[208:209]
    v_pk_mul_f32 v[154:155], v[154:155], v[210:211]
    v_exp_f32 v229, v229
    v_pk_fma_f32 v[156:157], v[222:223], v[48:49], v[156:157]
    v_pk_fma_f32 v[158:159], v[222:223], v[50:51], v[158:159]
    v_exp_f32 v230, v230
    v_pk_mul_f32 v[208:209], v[156:157], v[156:157]
    v_pk_mul_f32 v[210:211], v[158:159], v[158:159]
    v_exp_f32 v231, v231
    v_pk_fma_f32 v[208:209], v[208:209], v[226:227], v[224:225]
    v_pk_fma_f32 v[210:211], v[210:211], v[226:227], v[224:225]
    v_pk_add_f32 v[228:229], v[228:229], 1.0 op_sel_hi:[1,0]
    v_pk_add_f32 v[230:231], v[230:231], 1.0 op_sel_hi:[1,0]
    v_rcp_f32 v228, v228
    v_pk_mul_f32 v[208:209], v[208:209], v[156:157]
    v_pk_mul_f32 v[210:211], v[210:211], v[158:159]
    v_rcp_f32 v229, v229
    v_rcp_f32 v230, v230
    v_rcp_f32 v231, v231
    v_exp_f32 v208, v208
    v_pk_mul_f32 v[84:85], v[84:85], v[228:229]
    v_exp_f32 v209, v209
    v_pk_mul_f32 v[86:87], v[86:87], v[230:231]
    v_exp_f32 v210, v210
    v_exp_f32 v211, v211
    v_pk_add_f32 v[208:209], v[208:209], 1.0 op_sel_hi:[1,0]
    v_pk_add_f32 v[210:211], v[210:211], 1.0 op_sel_hi:[1,0]
    v_rcp_f32 v208, v208
    v_rcp_f32 v209, v209
    v_rcp_f32 v210, v210
    v_rcp_f32 v211, v211
    v_pk_mul_f32 v[156:157], v[156:157], v[208:209]
    v_pk_mul_f32 v[158:159], v[158:159], v[210:211]
    v_lshlrev_b32 v198, 16, v198
    v_mov_b32 v160, v168
    v_mul_f32 v162, v168, v198
    v_mov_b32 v161, v168
    v_mul_f32 v163, v168, v198
    v_lshlrev_b32 v200, 16, v200
    v_mov_b32 v164, v172
    v_mul_f32 v166, v172, v200
    v_mov_b32 v165, v172
    v_mul_f32 v167, v172, v200
    s_waitcnt vmcnt(26)
    s_barrier
    ds_read_b128 a[0:3], v246 offset:0
    ds_read_b128 a[4:7], v246 offset:1024
    ds_read_b128 a[8:11], v246 offset:2048
    ds_read_b128 a[12:15], v246 offset:3072
    ds_read_b128 a[16:19], v246 offset:4096
    ds_read_b128 a[20:23], v246 offset:5120
    s_waitcnt lgkmcnt(5)
    v_mfma_f32_16x16x32_bf16 v[16:19], a[0:3], a[176:179], 0
    ds_read_b128 a[24:27], v246 offset:6144
    v_mfma_f32_16x16x32_bf16 v[88:91], a[0:3], a[180:183], 0
    s_waitcnt lgkmcnt(5)
    v_mfma_f32_16x16x32_bf16 v[20:23], a[4:7], a[176:179], 0
    ds_read_b128 a[28:31], v246 offset:7168
    v_mfma_f32_16x16x32_bf16 v[92:95], a[4:7], a[180:183], 0
    s_waitcnt lgkmcnt(5)
    v_mfma_f32_16x16x32_bf16 v[24:27], a[8:11], a[176:179], 0
    ds_read_b128 a[0:3], v246 offset:8192
    v_mfma_f32_16x16x32_bf16 v[96:99], a[8:11], a[180:183], 0
    s_add_u32 m0, s80, 77824
    s_nop 0
    buffer_load_dwordx4 v5, s[20:23], s82 offen offset:1024 sc1 lds
    s_waitcnt vmcnt(12)
    ds_read_b128 a[224:227], v195 offset:0
    ds_read_b128 a[228:231], v195 offset:512
    s_waitcnt lgkmcnt(7)
    v_mfma_f32_16x16x32_bf16 v[28:31], a[12:15], a[176:179], 0
    ds_read_b128 a[4:7], v246 offset:9216
    v_mfma_f32_16x16x32_bf16 v[100:103], a[12:15], a[180:183], 0
    s_waitcnt lgkmcnt(7)
    v_mfma_f32_16x16x32_bf16 v[32:35], a[16:19], a[176:179], 0
    ds_read_b128 a[8:11], v246 offset:10240
    v_mfma_f32_16x16x32_bf16 v[104:107], a[16:19], a[180:183], 0
    s_waitcnt lgkmcnt(7)
    v_mfma_f32_16x16x32_bf16 v[36:39], a[20:23], a[176:179], 0
    ds_read_b128 a[12:15], v246 offset:11264
    v_mfma_f32_16x16x32_bf16 v[108:111], a[20:23], a[180:183], 0
    s_waitcnt lgkmcnt(7)
    v_mfma_f32_16x16x32_bf16 v[40:43], a[24:27], a[176:179], 0
    ds_read_b128 a[16:19], v246 offset:12288
    v_mfma_f32_16x16x32_bf16 v[112:115], a[24:27], a[180:183], 0
    s_waitcnt lgkmcnt(7)
    v_mfma_f32_16x16x32_bf16 v[44:47], a[28:31], a[176:179], 0
    ds_read_b128 a[20:23], v246 offset:13312
    v_mfma_f32_16x16x32_bf16 v[116:119], a[28:31], a[180:183], 0
    s_waitcnt lgkmcnt(5)
    v_mfma_f32_16x16x32_bf16 v[48:51], a[0:3], a[176:179], 0
    ds_read_b128 a[24:27], v246 offset:14336
    v_mfma_f32_16x16x32_bf16 v[120:123], a[0:3], a[180:183], 0
    s_waitcnt lgkmcnt(5)
    v_mfma_f32_16x16x32_bf16 v[16:19], a[4:7], a[184:187], v[16:19]
    ds_read_b128 a[28:31], v246 offset:15360
    v_mfma_f32_16x16x32_bf16 v[88:91], a[4:7], a[188:191], v[88:91]
    s_add_u32 m0, s80, 77824
    s_nop 0
    buffer_load_dwordx4 v5, s[20:23], s82 offen offset:2048 sc1 lds
    s_waitcnt lgkmcnt(5)
    v_mfma_f32_16x16x32_bf16 v[20:23], a[8:11], a[184:187], v[20:23]
    ds_read_b128 a[0:3], v246 offset:16384
    v_mfma_f32_16x16x32_bf16 v[92:95], a[8:11], a[188:191], v[92:95]
    s_waitcnt lgkmcnt(5)
    v_mfma_f32_16x16x32_bf16 v[24:27], a[12:15], a[184:187], v[24:27]
    ds_read_b128 a[4:7], v246 offset:17408
    v_mfma_f32_16x16x32_bf16 v[96:99], a[12:15], a[188:191], v[96:99]
    ds_read_b128 a[232:235], v196 offset:0
    ds_read_b128 a[236:239], v196 offset:512
    s_waitcnt lgkmcnt(7)
    v_mfma_f32_16x16x32_bf16 v[28:31], a[16:19], a[184:187], v[28:31]
    ds_read_b128 a[8:11], v246 offset:18432
    v_mfma_f32_16x16x32_bf16 v[100:103], a[16:19], a[188:191], v[100:103]
    s_waitcnt lgkmcnt(7)
    v_mfma_f32_16x16x32_bf16 v[32:35], a[20:23], a[184:187], v[32:35]
    ds_read_b128 a[12:15], v246 offset:19456
    v_mfma_f32_16x16x32_bf16 v[104:107], a[20:23], a[188:191], v[104:107]
    s_waitcnt lgkmcnt(7)
    v_mfma_f32_16x16x32_bf16 v[36:39], a[24:27], a[184:187], v[36:39]
    ds_read_b128 a[16:19], v246 offset:20480
    v_mfma_f32_16x16x32_bf16 v[108:111], a[24:27], a[188:191], v[108:111]
    s_waitcnt lgkmcnt(7)
    v_mfma_f32_16x16x32_bf16 v[40:43], a[28:31], a[184:187], v[40:43]
    ds_read_b128 a[20:23], v246 offset:21504
    v_mfma_f32_16x16x32_bf16 v[112:115], a[28:31], a[188:191], v[112:115]
    s_waitcnt lgkmcnt(7)
    v_mfma_f32_16x16x32_bf16 v[44:47], a[0:3], a[184:187], v[44:47]
    ds_read_b128 a[24:27], v246 offset:22528
    v_mfma_f32_16x16x32_bf16 v[116:119], a[0:3], a[188:191], v[116:119]
    s_waitcnt lgkmcnt(5)
    v_mfma_f32_16x16x32_bf16 v[48:51], a[4:7], a[184:187], v[48:51]
    ds_read_b128 a[28:31], v246 offset:23552
    v_mfma_f32_16x16x32_bf16 v[120:123], a[4:7], a[188:191], v[120:123]
    s_add_u32 m0, s80, 77824
    s_nop 0
    buffer_load_dwordx4 v5, s[20:23], s82 offen offset:3072 sc1 lds
    s_waitcnt lgkmcnt(5)
    v_mfma_f32_16x16x32_bf16 v[16:19], a[8:11], a[192:195], v[16:19]
    ds_read_b128 a[0:3], v246 offset:24576
    v_mfma_f32_16x16x32_bf16 v[88:91], a[8:11], a[196:199], v[88:91]
    s_add_u32 m0, s73, 0
    s_add_u32 s72, s72, 128
    buffer_load_dwordx4 v191, s[64:67], s72 offen lds
    s_waitcnt lgkmcnt(5)
    v_mfma_f32_16x16x32_bf16 v[20:23], a[12:15], a[192:195], v[20:23]
    ds_read_b128 a[4:7], v246 offset:25600
    v_mfma_f32_16x16x32_bf16 v[92:95], a[12:15], a[196:199], v[92:95]
    s_waitcnt lgkmcnt(5)
    v_mfma_f32_16x16x32_bf16 v[24:27], a[16:19], a[192:195], v[24:27]
    ds_read_b128 a[8:11], v246 offset:26624
    v_mfma_f32_16x16x32_bf16 v[96:99], a[16:19], a[196:199], v[96:99]
    s_waitcnt vmcnt(11)
    ds_read_b128 a[240:243], v195 offset:4096
    ds_read_b128 a[244:247], v195 offset:4608
    s_waitcnt lgkmcnt(7)
    v_mfma_f32_16x16x32_bf16 v[28:31], a[20:23], a[192:195], v[28:31]
    ds_read_b128 a[12:15], v246 offset:27648
    v_mfma_f32_16x16x32_bf16 v[100:103], a[20:23], a[196:199], v[100:103]
    s_add_u32 m0, s73, 1024
    s_nop 0
    buffer_load_dwordx4 v192, s[64:67], s72 offen lds
    s_waitcnt lgkmcnt(7)
    v_mfma_f32_16x16x32_bf16 v[32:35], a[24:27], a[192:195], v[32:35]
    ds_read_b128 a[16:19], v246 offset:28672
    v_mfma_f32_16x16x32_bf16 v[104:107], a[24:27], a[196:199], v[104:107]
    s_waitcnt lgkmcnt(7)
    v_mfma_f32_16x16x32_bf16 v[36:39], a[28:31], a[192:195], v[36:39]
    ds_read_b128 a[20:23], v246 offset:29696
    v_mfma_f32_16x16x32_bf16 v[108:111], a[28:31], a[196:199], v[108:111]
    s_waitcnt lgkmcnt(7)
    v_mfma_f32_16x16x32_bf16 v[40:43], a[0:3], a[192:195], v[40:43]
    ds_read_b128 a[24:27], v246 offset:30720
    v_mfma_f32_16x16x32_bf16 v[112:115], a[0:3], a[196:199], v[112:115]
    s_add_u32 m0, s80, 81920
    s_add_u32 s82, s81, 81920
    buffer_load_dwordx4 v5, s[20:23], s82 offen offset:0 sc1 lds
    s_waitcnt lgkmcnt(7)
    v_mfma_f32_16x16x32_bf16 v[44:47], a[4:7], a[192:195], v[44:47]
    ds_read_b128 a[28:31], v246 offset:31744
    v_mfma_f32_16x16x32_bf16 v[116:119], a[4:7], a[196:199], v[116:119]
    s_waitcnt lgkmcnt(5)
    v_mfma_f32_16x16x32_bf16 v[48:51], a[8:11], a[192:195], v[48:51]
    ds_read_b128 a[0:3], v246 offset:32768
    v_mfma_f32_16x16x32_bf16 v[120:123], a[8:11], a[196:199], v[120:123]
    s_add_u32 m0, s73, 2048
    s_nop 0
    buffer_load_dwordx4 v193, s[64:67], s72 offen lds
    s_waitcnt lgkmcnt(5)
    v_mfma_f32_16x16x32_bf16 v[16:19], a[12:15], a[200:203], v[16:19]
    ds_read_b128 a[4:7], v246 offset:33792
    v_mfma_f32_16x16x32_bf16 v[88:91], a[12:15], a[204:207], v[88:91]
    s_waitcnt lgkmcnt(5)
    v_mfma_f32_16x16x32_bf16 v[20:23], a[16:19], a[200:203], v[20:23]
    ds_read_b128 a[8:11], v246 offset:34816
    v_mfma_f32_16x16x32_bf16 v[92:95], a[16:19], a[204:207], v[92:95]
    s_waitcnt lgkmcnt(5)
    v_mfma_f32_16x16x32_bf16 v[24:27], a[20:23], a[200:203], v[24:27]
    ds_read_b128 a[12:15], v246 offset:35840
    v_mfma_f32_16x16x32_bf16 v[96:99], a[20:23], a[204:207], v[96:99]
    ds_read_b128 a[248:251], v196 offset:4096
    ds_read_b128 a[252:255], v196 offset:4608
    s_waitcnt lgkmcnt(7)
    v_mfma_f32_16x16x32_bf16 v[28:31], a[24:27], a[200:203], v[28:31]
    v_mfma_f32_16x16x32_bf16 v[100:103], a[24:27], a[204:207], v[100:103]
    s_add_u32 m0, s73, 3072
    s_nop 0
    buffer_load_dwordx4 v194, s[64:67], s72 offen lds
    s_waitcnt lgkmcnt(6)
    v_mfma_f32_16x16x32_bf16 v[32:35], a[28:31], a[200:203], v[32:35]
    v_mfma_f32_16x16x32_bf16 v[104:107], a[28:31], a[204:207], v[104:107]
    s_waitcnt lgkmcnt(5)
    v_mfma_f32_16x16x32_bf16 v[36:39], a[0:3], a[200:203], v[36:39]
    v_mfma_f32_16x16x32_bf16 v[108:111], a[0:3], a[204:207], v[108:111]
    s_waitcnt lgkmcnt(0)
    s_barrier
    ds_read_b128 a[16:19], v246 offset:36864
    s_add_u32 m0, s80, 0
    s_add_u32 s82, s81, 110592
    buffer_load_dwordx4 v5, s[20:23], s82 offen offset:0 sc1 lds
    v_mfma_f32_16x16x32_bf16 v[40:43], a[4:7], a[200:203], v[40:43]
    ds_read_b128 a[20:23], v246 offset:37888
    v_mfma_f32_16x16x32_bf16 v[112:115], a[4:7], a[204:207], v[112:115]
    ds_read_b128 a[24:27], v246 offset:38912
    v_mfma_f32_16x16x32_bf16 v[44:47], a[8:11], a[200:203], v[44:47]
    ds_read_b128 a[28:31], v246 offset:39936
    v_mfma_f32_16x16x32_bf16 v[116:119], a[8:11], a[204:207], v[116:119]
    ds_read_b128 a[0:3], v246 offset:40960
    v_mfma_f32_16x16x32_bf16 v[48:51], a[12:15], a[200:203], v[48:51]
    ds_read_b128 a[4:7], v246 offset:41984
    v_mfma_f32_16x16x32_bf16 v[120:123], a[12:15], a[204:207], v[120:123]
    s_add_u32 m0, s73, 4096
    s_add_u32 s72, s72, 128
    buffer_load_dwordx4 v191, s[64:67], s72 offen lds
    s_waitcnt lgkmcnt(5)
    v_mfma_f32_16x16x32_bf16 v[16:19], a[16:19], a[208:211], v[16:19]
    ds_read_b128 a[8:11], v246 offset:43008
    v_mfma_f32_16x16x32_bf16 v[88:91], a[16:19], a[212:215], v[88:91]
    s_add_u32 m0, s80, 0
    s_nop 0
    buffer_load_dwordx4 v5, s[20:23], s82 offen offset:1024 sc1 lds
    s_waitcnt lgkmcnt(5)
    v_mfma_f32_16x16x32_bf16 v[20:23], a[20:23], a[208:211], v[20:23]
    ds_read_b128 a[12:15], v246 offset:44032
    v_mfma_f32_16x16x32_bf16 v[92:95], a[20:23], a[212:215], v[92:95]
    s_waitcnt lgkmcnt(5)
    v_mfma_f32_16x16x32_bf16 v[24:27], a[24:27], a[208:211], v[24:27]
    ds_read_b128 a[16:19], v246 offset:45056
    v_mfma_f32_16x16x32_bf16 v[96:99], a[24:27], a[212:215], v[96:99]
    s_waitcnt vmcnt(14)
    ds_read_b128 a[176:179], v195 offset:8192
    ds_read_b128 a[180:183], v195 offset:8704
    s_waitcnt lgkmcnt(7)
    v_mfma_f32_16x16x32_bf16 v[28:31], a[28:31], a[208:211], v[28:31]
    ds_read_b128 a[20:23], v246 offset:46080
    v_mfma_f32_16x16x32_bf16 v[100:103], a[28:31], a[212:215], v[100:103]
    s_add_u32 m0, s80, 0
    s_nop 0
    buffer_load_dwordx4 v5, s[20:23], s82 offen offset:2048 sc1 lds
    s_waitcnt lgkmcnt(7)
    v_mfma_f32_16x16x32_bf16 v[32:35], a[0:3], a[208:211], v[32:35]
    ds_read_b128 a[24:27], v246 offset:47104
    v_mfma_f32_16x16x32_bf16 v[104:107], a[0:3], a[212:215], v[104:107]
    s_add_u32 m0, s73, 5120
    s_nop 0
    buffer_load_dwordx4 v192, s[64:67], s72 offen lds
    s_waitcnt lgkmcnt(7)
    v_mfma_f32_16x16x32_bf16 v[36:39], a[4:7], a[208:211], v[36:39]
    ds_read_b128 a[28:31], v246 offset:48128
    v_mfma_f32_16x16x32_bf16 v[108:111], a[4:7], a[212:215], v[108:111]
    s_waitcnt lgkmcnt(7)
    v_mfma_f32_16x16x32_bf16 v[40:43], a[8:11], a[208:211], v[40:43]
    ds_read_b128 a[0:3], v246 offset:49152
    v_mfma_f32_16x16x32_bf16 v[112:115], a[8:11], a[212:215], v[112:115]
    s_waitcnt lgkmcnt(7)
    v_mfma_f32_16x16x32_bf16 v[44:47], a[12:15], a[208:211], v[44:47]
    ds_read_b128 a[4:7], v246 offset:50176
    v_mfma_f32_16x16x32_bf16 v[116:119], a[12:15], a[212:215], v[116:119]
    s_add_u32 m0, s80, 0
    s_nop 0
    buffer_load_dwordx4 v5, s[20:23], s82 offen offset:3072 sc1 lds
    s_waitcnt lgkmcnt(5)
    v_mfma_f32_16x16x32_bf16 v[48:51], a[16:19], a[208:211], v[48:51]
    ds_read_b128 a[8:11], v246 offset:51200
    v_mfma_f32_16x16x32_bf16 v[120:123], a[16:19], a[212:215], v[120:123]
    s_add_u32 m0, s73, 6144
    s_nop 0
    buffer_load_dwordx4 v193, s[64:67], s72 offen lds
    s_waitcnt lgkmcnt(5)
    v_mfma_f32_16x16x32_bf16 v[16:19], a[20:23], a[216:219], v[16:19]
    ds_read_b128 a[12:15], v246 offset:52224
    v_mfma_f32_16x16x32_bf16 v[88:91], a[20:23], a[220:223], v[88:91]
    s_waitcnt lgkmcnt(5)
    v_mfma_f32_16x16x32_bf16 v[20:23], a[24:27], a[216:219], v[20:23]
    ds_read_b128 a[16:19], v246 offset:53248
    v_mfma_f32_16x16x32_bf16 v[92:95], a[24:27], a[220:223], v[92:95]
    s_waitcnt lgkmcnt(5)
    v_mfma_f32_16x16x32_bf16 v[24:27], a[28:31], a[216:219], v[24:27]
    ds_read_b128 a[20:23], v246 offset:54272
    v_mfma_f32_16x16x32_bf16 v[96:99], a[28:31], a[220:223], v[96:99]
    s_add_u32 m0, s80, 4096
    s_add_u32 s82, s81, 114688
    buffer_load_dwordx4 v5, s[20:23], s82 offen offset:0 sc1 lds
    ds_read_b128 a[184:187], v196 offset:8192
    ds_read_b128 a[188:191], v196 offset:8704
    s_waitcnt lgkmcnt(7)
    v_mfma_f32_16x16x32_bf16 v[28:31], a[0:3], a[216:219], v[28:31]
    ds_read_b128 a[24:27], v246 offset:55296
    v_mfma_f32_16x16x32_bf16 v[100:103], a[0:3], a[220:223], v[100:103]
    s_add_u32 m0, s73, 7168
    s_nop 0
    buffer_load_dwordx4 v194, s[64:67], s72 offen lds
    s_waitcnt lgkmcnt(7)
    v_mfma_f32_16x16x32_bf16 v[32:35], a[4:7], a[216:219], v[32:35]
    ds_read_b128 a[28:31], v246 offset:56320
    v_mfma_f32_16x16x32_bf16 v[104:107], a[4:7], a[220:223], v[104:107]
    s_waitcnt lgkmcnt(7)
    v_mfma_f32_16x16x32_bf16 v[36:39], a[8:11], a[216:219], v[36:39]
    ds_read_b128 a[0:3], v246 offset:57344
    v_mfma_f32_16x16x32_bf16 v[108:111], a[8:11], a[220:223], v[108:111]
    s_waitcnt lgkmcnt(7)
    v_mfma_f32_16x16x32_bf16 v[40:43], a[12:15], a[216:219], v[40:43]
    ds_read_b128 a[4:7], v246 offset:58368
    v_mfma_f32_16x16x32_bf16 v[112:115], a[12:15], a[220:223], v[112:115]
    s_add_u32 m0, s80, 4096
    s_nop 0
    buffer_load_dwordx4 v5, s[20:23], s82 offen offset:1024 sc1 lds
    s_waitcnt lgkmcnt(7)
    v_mfma_f32_16x16x32_bf16 v[44:47], a[16:19], a[216:219], v[44:47]
    ds_read_b128 a[8:11], v246 offset:59392
    v_mfma_f32_16x16x32_bf16 v[116:119], a[16:19], a[220:223], v[116:119]
    s_waitcnt lgkmcnt(5)
    v_mfma_f32_16x16x32_bf16 v[48:51], a[20:23], a[216:219], v[48:51]
    ds_read_b128 a[12:15], v246 offset:60416
    v_mfma_f32_16x16x32_bf16 v[120:123], a[20:23], a[220:223], v[120:123]
    s_add_u32 m0, s73, 8192
    s_add_u32 s72, s72, 128
    buffer_load_dwordx4 v191, s[64:67], s72 offen lds
    s_waitcnt lgkmcnt(5)
    v_mfma_f32_16x16x32_bf16 v[16:19], a[24:27], a[224:227], v[16:19]
    ds_read_b128 a[16:19], v246 offset:61440
    v_mfma_f32_16x16x32_bf16 v[88:91], a[24:27], a[228:231], v[88:91]
    s_waitcnt lgkmcnt(5)
    v_mfma_f32_16x16x32_bf16 v[20:23], a[28:31], a[224:227], v[20:23]
    ds_read_b128 a[20:23], v246 offset:62464
    v_mfma_f32_16x16x32_bf16 v[92:95], a[28:31], a[228:231], v[92:95]
    s_add_u32 m0, s80, 4096
    s_nop 0
    buffer_load_dwordx4 v5, s[20:23], s82 offen offset:2048 sc1 lds
    s_waitcnt lgkmcnt(5)
    v_mfma_f32_16x16x32_bf16 v[24:27], a[0:3], a[224:227], v[24:27]
    ds_read_b128 a[24:27], v246 offset:63488
    v_mfma_f32_16x16x32_bf16 v[96:99], a[0:3], a[228:231], v[96:99]
    s_waitcnt vmcnt(12)
    ds_read_b128 a[192:195], v195 offset:0
    ds_read_b128 a[196:199], v195 offset:512
    s_waitcnt lgkmcnt(7)
    v_mfma_f32_16x16x32_bf16 v[28:31], a[4:7], a[224:227], v[28:31]
    ds_read_b128 a[28:31], v246 offset:64512
    v_mfma_f32_16x16x32_bf16 v[100:103], a[4:7], a[228:231], v[100:103]
    s_add_u32 m0, s73, 9216
    s_nop 0
    buffer_load_dwordx4 v192, s[64:67], s72 offen lds
    s_waitcnt lgkmcnt(7)
    v_mfma_f32_16x16x32_bf16 v[32:35], a[8:11], a[224:227], v[32:35]
    ds_read_b128 a[0:3], v247 offset:0
    v_mfma_f32_16x16x32_bf16 v[104:107], a[8:11], a[228:231], v[104:107]
    s_waitcnt lgkmcnt(7)
    v_mfma_f32_16x16x32_bf16 v[36:39], a[12:15], a[224:227], v[36:39]
    ds_read_b128 a[4:7], v247 offset:1024
    v_mfma_f32_16x16x32_bf16 v[108:111], a[12:15], a[228:231], v[108:111]
    s_add_u32 m0, s80, 4096
    s_nop 0
    buffer_load_dwordx4 v5, s[20:23], s82 offen offset:3072 sc1 lds
    s_waitcnt lgkmcnt(7)
    v_mfma_f32_16x16x32_bf16 v[40:43], a[16:19], a[224:227], v[40:43]
    ds_read_b128 a[8:11], v247 offset:2048
    v_mfma_f32_16x16x32_bf16 v[112:115], a[16:19], a[228:231], v[112:115]
    s_waitcnt lgkmcnt(7)
    v_mfma_f32_16x16x32_bf16 v[44:47], a[20:23], a[224:227], v[44:47]
    ds_read_b128 a[12:15], v247 offset:3072
    v_mfma_f32_16x16x32_bf16 v[116:119], a[20:23], a[228:231], v[116:119]
    s_waitcnt lgkmcnt(5)
    v_mfma_f32_16x16x32_bf16 v[48:51], a[24:27], a[224:227], v[48:51]
    ds_read_b128 a[16:19], v247 offset:4096
    v_mfma_f32_16x16x32_bf16 v[120:123], a[24:27], a[228:231], v[120:123]
    s_add_u32 m0, s73, 10240
    s_nop 0
    buffer_load_dwordx4 v193, s[64:67], s72 offen lds
    s_waitcnt lgkmcnt(5)
    v_mfma_f32_16x16x32_bf16 v[16:19], a[28:31], a[232:235], v[16:19]
    ds_read_b128 a[20:23], v247 offset:5120
    v_mfma_f32_16x16x32_bf16 v[88:91], a[28:31], a[236:239], v[88:91]
    s_add_u32 m0, s80, 8192
    s_add_u32 s82, s81, 118784
    buffer_load_dwordx4 v5, s[20:23], s82 offen offset:0 sc1 lds
    s_waitcnt lgkmcnt(5)
    v_mfma_f32_16x16x32_bf16 v[20:23], a[0:3], a[232:235], v[20:23]
    ds_read_b128 a[24:27], v247 offset:6144
    v_mfma_f32_16x16x32_bf16 v[92:95], a[0:3], a[236:239], v[92:95]
    s_waitcnt lgkmcnt(5)
    v_mfma_f32_16x16x32_bf16 v[24:27], a[4:7], a[232:235], v[24:27]
    ds_read_b128 a[28:31], v247 offset:7168
    v_mfma_f32_16x16x32_bf16 v[96:99], a[4:7], a[236:239], v[96:99]
    ds_read_b128 a[200:203], v196 offset:0
    ds_read_b128 a[204:207], v196 offset:512
    s_waitcnt lgkmcnt(7)
    v_mfma_f32_16x16x32_bf16 v[28:31], a[8:11], a[232:235], v[28:31]
    v_mfma_f32_16x16x32_bf16 v[100:103], a[8:11], a[236:239], v[100:103]
    s_add_u32 m0, s73, 11264
    s_nop 0
    buffer_load_dwordx4 v194, s[64:67], s72 offen lds
    s_waitcnt lgkmcnt(6)
    v_mfma_f32_16x16x32_bf16 v[32:35], a[12:15], a[232:235], v[32:35]
    v_mfma_f32_16x16x32_bf16 v[104:107], a[12:15], a[236:239], v[104:107]
    s_waitcnt lgkmcnt(5)
    v_mfma_f32_16x16x32_bf16 v[36:39], a[16:19], a[232:235], v[36:39]
    v_mfma_f32_16x16x32_bf16 v[108:111], a[16:19], a[236:239], v[108:111]
    s_waitcnt lgkmcnt(0)
    s_barrier
    ds_read_b128 a[0:3], v247 offset:8192
    s_add_u32 m0, s80, 36864
    s_add_u32 s82, s81, 147456
    buffer_load_dwordx4 v5, s[20:23], s82 offen offset:0 sc1 lds
    v_mfma_f32_16x16x32_bf16 v[40:43], a[20:23], a[232:235], v[40:43]
    ds_read_b128 a[4:7], v247 offset:9216
    v_mfma_f32_16x16x32_bf16 v[112:115], a[20:23], a[236:239], v[112:115]
    ds_read_b128 a[8:11], v247 offset:10240
    v_mfma_f32_16x16x32_bf16 v[44:47], a[24:27], a[232:235], v[44:47]
    ds_read_b128 a[12:15], v247 offset:11264
    v_mfma_f32_16x16x32_bf16 v[116:119], a[24:27], a[236:239], v[116:119]
    ds_read_b128 a[16:19], v247 offset:12288
    v_mfma_f32_16x16x32_bf16 v[48:51], a[28:31], a[232:235], v[48:51]
    ds_read_b128 a[20:23], v247 offset:13312
    v_mfma_f32_16x16x32_bf16 v[120:123], a[28:31], a[236:239], v[120:123]
    s_add_u32 m0, s73, 0
    s_add_u32 s72, s72, 128
    buffer_load_dwordx4 v191, s[64:67], s72 offen lds
    s_waitcnt lgkmcnt(5)
    v_mfma_f32_16x16x32_bf16 v[16:19], a[0:3], a[240:243], v[16:19]
    ds_read_b128 a[24:27], v247 offset:14336
    v_mfma_f32_16x16x32_bf16 v[88:91], a[0:3], a[244:247], v[88:91]
    s_add_u32 m0, s80, 36864
    s_nop 0
    buffer_load_dwordx4 v5, s[20:23], s82 offen offset:1024 sc1 lds
    s_waitcnt lgkmcnt(5)
    v_mfma_f32_16x16x32_bf16 v[20:23], a[4:7], a[240:243], v[20:23]
    ds_read_b128 a[28:31], v247 offset:15360
    v_mfma_f32_16x16x32_bf16 v[92:95], a[4:7], a[244:247], v[92:95]
    s_waitcnt lgkmcnt(5)
    v_mfma_f32_16x16x32_bf16 v[24:27], a[8:11], a[240:243], v[24:27]
    ds_read_b128 a[0:3], v247 offset:16384
    v_mfma_f32_16x16x32_bf16 v[96:99], a[8:11], a[244:247], v[96:99]
    s_waitcnt vmcnt(11)
    ds_read_b128 a[208:211], v195 offset:4096
    ds_read_b128 a[212:215], v195 offset:4608
    s_waitcnt lgkmcnt(7)
    v_mfma_f32_16x16x32_bf16 v[28:31], a[12:15], a[240:243], v[28:31]
    ds_read_b128 a[4:7], v247 offset:17408
    v_mfma_f32_16x16x32_bf16 v[100:103], a[12:15], a[244:247], v[100:103]
    s_add_u32 m0, s80, 36864
    s_nop 0
    buffer_load_dwordx4 v5, s[20:23], s82 offen offset:2048 sc1 lds
    s_waitcnt lgkmcnt(7)
    v_mfma_f32_16x16x32_bf16 v[32:35], a[16:19], a[240:243], v[32:35]
    ds_read_b128 a[8:11], v247 offset:18432
    v_mfma_f32_16x16x32_bf16 v[104:107], a[16:19], a[244:247], v[104:107]
    s_add_u32 m0, s73, 1024
    s_nop 0
    buffer_load_dwordx4 v192, s[64:67], s72 offen lds
    s_waitcnt lgkmcnt(7)
    v_mfma_f32_16x16x32_bf16 v[36:39], a[20:23], a[240:243], v[36:39]
    ds_read_b128 a[12:15], v247 offset:19456
    v_mfma_f32_16x16x32_bf16 v[108:111], a[20:23], a[244:247], v[108:111]
    s_waitcnt lgkmcnt(7)
    v_mfma_f32_16x16x32_bf16 v[40:43], a[24:27], a[240:243], v[40:43]
    ds_read_b128 a[16:19], v247 offset:20480
    v_mfma_f32_16x16x32_bf16 v[112:115], a[24:27], a[244:247], v[112:115]
    s_waitcnt lgkmcnt(7)
    v_mfma_f32_16x16x32_bf16 v[44:47], a[28:31], a[240:243], v[44:47]
    ds_read_b128 a[20:23], v247 offset:21504
    v_mfma_f32_16x16x32_bf16 v[116:119], a[28:31], a[244:247], v[116:119]
    s_add_u32 m0, s80, 36864
    s_nop 0
    buffer_load_dwordx4 v5, s[20:23], s82 offen offset:3072 sc1 lds
    s_waitcnt lgkmcnt(5)
    v_mfma_f32_16x16x32_bf16 v[48:51], a[0:3], a[240:243], v[48:51]
    ds_read_b128 a[24:27], v247 offset:22528
    v_mfma_f32_16x16x32_bf16 v[120:123], a[0:3], a[244:247], v[120:123]
    s_add_u32 m0, s73, 2048
    s_nop 0
    buffer_load_dwordx4 v193, s[64:67], s72 offen lds
    s_waitcnt lgkmcnt(5)
    v_mfma_f32_16x16x32_bf16 v[16:19], a[4:7], a[248:251], v[16:19]
    ds_read_b128 a[28:31], v247 offset:23552
    v_mfma_f32_16x16x32_bf16 v[88:91], a[4:7], a[252:255], v[88:91]
    s_waitcnt lgkmcnt(5)
    v_mfma_f32_16x16x32_bf16 v[20:23], a[8:11], a[248:251], v[20:23]
    ds_read_b128 a[0:3], v247 offset:24576
    v_mfma_f32_16x16x32_bf16 v[92:95], a[8:11], a[252:255], v[92:95]
    s_waitcnt lgkmcnt(5)
    v_mfma_f32_16x16x32_bf16 v[24:27], a[12:15], a[248:251], v[24:27]
    ds_read_b128 a[4:7], v247 offset:25600
    v_mfma_f32_16x16x32_bf16 v[96:99], a[12:15], a[252:255], v[96:99]
    s_add_u32 m0, s80, 40960
    s_add_u32 s82, s81, 151552
    buffer_load_dwordx4 v5, s[20:23], s82 offen offset:0 sc1 lds
    ds_read_b128 a[216:219], v196 offset:4096
    ds_read_b128 a[220:223], v196 offset:4608
    s_waitcnt lgkmcnt(7)
    v_mfma_f32_16x16x32_bf16 v[28:31], a[16:19], a[248:251], v[28:31]
    ds_read_b128 a[8:11], v247 offset:26624
    v_mfma_f32_16x16x32_bf16 v[100:103], a[16:19], a[252:255], v[100:103]
    s_add_u32 m0, s73, 3072
    s_nop 0
    buffer_load_dwordx4 v194, s[64:67], s72 offen lds
    s_waitcnt lgkmcnt(7)
    v_mfma_f32_16x16x32_bf16 v[32:35], a[20:23], a[248:251], v[32:35]
    ds_read_b128 a[12:15], v247 offset:27648
    v_mfma_f32_16x16x32_bf16 v[104:107], a[20:23], a[252:255], v[104:107]
    s_waitcnt lgkmcnt(7)
    v_mfma_f32_16x16x32_bf16 v[36:39], a[24:27], a[248:251], v[36:39]
    ds_read_b128 a[16:19], v247 offset:28672
    v_mfma_f32_16x16x32_bf16 v[108:111], a[24:27], a[252:255], v[108:111]
    s_waitcnt lgkmcnt(7)
    v_mfma_f32_16x16x32_bf16 v[40:43], a[28:31], a[248:251], v[40:43]
    ds_read_b128 a[20:23], v247 offset:29696
    v_mfma_f32_16x16x32_bf16 v[112:115], a[28:31], a[252:255], v[112:115]
    s_add_u32 m0, s80, 40960
    s_nop 0
    buffer_load_dwordx4 v5, s[20:23], s82 offen offset:1024 sc1 lds
    s_waitcnt lgkmcnt(7)
    v_mfma_f32_16x16x32_bf16 v[44:47], a[0:3], a[248:251], v[44:47]
    ds_read_b128 a[24:27], v247 offset:30720
    v_mfma_f32_16x16x32_bf16 v[116:119], a[0:3], a[252:255], v[116:119]
    s_waitcnt lgkmcnt(5)
    v_mfma_f32_16x16x32_bf16 v[48:51], a[4:7], a[248:251], v[48:51]
    ds_read_b128 a[28:31], v247 offset:31744
    v_mfma_f32_16x16x32_bf16 v[120:123], a[4:7], a[252:255], v[120:123]
    s_add_u32 m0, s73, 4096
    s_add_u32 s72, s72, 128
    buffer_load_dwordx4 v191, s[64:67], s72 offen lds
    s_waitcnt lgkmcnt(5)
    v_mfma_f32_16x16x32_bf16 v[16:19], a[8:11], a[176:179], v[16:19]
    ds_read_b128 a[0:3], v247 offset:32768
    v_mfma_f32_16x16x32_bf16 v[88:91], a[8:11], a[180:183], v[88:91]
    s_waitcnt lgkmcnt(5)
    v_mfma_f32_16x16x32_bf16 v[20:23], a[12:15], a[176:179], v[20:23]
    ds_read_b128 a[4:7], v247 offset:33792
    v_mfma_f32_16x16x32_bf16 v[92:95], a[12:15], a[180:183], v[92:95]
    s_add_u32 m0, s80, 40960
    s_nop 0
    buffer_load_dwordx4 v5, s[20:23], s82 offen offset:2048 sc1 lds
    s_waitcnt lgkmcnt(5)
    v_mfma_f32_16x16x32_bf16 v[24:27], a[16:19], a[176:179], v[24:27]
    ds_read_b128 a[8:11], v247 offset:34816
    v_mfma_f32_16x16x32_bf16 v[96:99], a[16:19], a[180:183], v[96:99]
    s_waitcnt vmcnt(12)
    ds_read_b128 a[224:227], v195 offset:8192
    ds_read_b128 a[228:231], v195 offset:8704
    s_waitcnt lgkmcnt(7)
    v_mfma_f32_16x16x32_bf16 v[28:31], a[20:23], a[176:179], v[28:31]
    ds_read_b128 a[12:15], v247 offset:35840
    v_mfma_f32_16x16x32_bf16 v[100:103], a[20:23], a[180:183], v[100:103]
    s_add_u32 m0, s73, 5120
    s_nop 0
    buffer_load_dwordx4 v192, s[64:67], s72 offen lds
    s_waitcnt lgkmcnt(7)
    v_mfma_f32_16x16x32_bf16 v[32:35], a[24:27], a[176:179], v[32:35]
    ds_read_b128 a[16:19], v247 offset:36864
    v_mfma_f32_16x16x32_bf16 v[104:107], a[24:27], a[180:183], v[104:107]
    s_waitcnt lgkmcnt(7)
    v_mfma_f32_16x16x32_bf16 v[36:39], a[28:31], a[176:179], v[36:39]
    ds_read_b128 a[20:23], v247 offset:37888
    v_mfma_f32_16x16x32_bf16 v[108:111], a[28:31], a[180:183], v[108:111]
    s_add_u32 m0, s80, 40960
    s_nop 0
    buffer_load_dwordx4 v5, s[20:23], s82 offen offset:3072 sc1 lds
    s_waitcnt lgkmcnt(7)
    v_mfma_f32_16x16x32_bf16 v[40:43], a[0:3], a[176:179], v[40:43]
    ds_read_b128 a[24:27], v247 offset:38912
    v_mfma_f32_16x16x32_bf16 v[112:115], a[0:3], a[180:183], v[112:115]
    s_waitcnt lgkmcnt(7)
    v_mfma_f32_16x16x32_bf16 v[44:47], a[4:7], a[176:179], v[44:47]
    ds_read_b128 a[28:31], v247 offset:39936
    v_mfma_f32_16x16x32_bf16 v[116:119], a[4:7], a[180:183], v[116:119]
    s_waitcnt lgkmcnt(5)
    v_mfma_f32_16x16x32_bf16 v[48:51], a[8:11], a[176:179], v[48:51]
    ds_read_b128 a[0:3], v247 offset:40960
    v_mfma_f32_16x16x32_bf16 v[120:123], a[8:11], a[180:183], v[120:123]
    s_add_u32 m0, s73, 6144
    s_nop 0
    buffer_load_dwordx4 v193, s[64:67], s72 offen lds
    s_waitcnt lgkmcnt(5)
    v_mfma_f32_16x16x32_bf16 v[16:19], a[12:15], a[184:187], v[16:19]
    ds_read_b128 a[4:7], v247 offset:41984
    v_mfma_f32_16x16x32_bf16 v[88:91], a[12:15], a[188:191], v[88:91]
    s_add_u32 m0, s80, 45056
    s_add_u32 s82, s81, 155648
    buffer_load_dwordx4 v5, s[20:23], s82 offen offset:0 sc1 lds
    s_waitcnt lgkmcnt(5)
    v_mfma_f32_16x16x32_bf16 v[20:23], a[16:19], a[184:187], v[20:23]
    ds_read_b128 a[8:11], v247 offset:43008
    v_mfma_f32_16x16x32_bf16 v[92:95], a[16:19], a[188:191], v[92:95]
    s_waitcnt lgkmcnt(5)
    v_mfma_f32_16x16x32_bf16 v[24:27], a[20:23], a[184:187], v[24:27]
    ds_read_b128 a[12:15], v247 offset:44032
    v_mfma_f32_16x16x32_bf16 v[96:99], a[20:23], a[188:191], v[96:99]
    ds_read_b128 a[232:235], v196 offset:8192
    ds_read_b128 a[236:239], v196 offset:8704
    s_waitcnt lgkmcnt(7)
    v_mfma_f32_16x16x32_bf16 v[28:31], a[24:27], a[184:187], v[28:31]
    v_mfma_f32_16x16x32_bf16 v[100:103], a[24:27], a[188:191], v[100:103]
    s_add_u32 m0, s73, 7168
    s_nop 0
    buffer_load_dwordx4 v194, s[64:67], s72 offen lds
    s_waitcnt lgkmcnt(6)
    v_mfma_f32_16x16x32_bf16 v[32:35], a[28:31], a[184:187], v[32:35]
    v_mfma_f32_16x16x32_bf16 v[104:107], a[28:31], a[188:191], v[104:107]
    s_waitcnt lgkmcnt(5)
    v_mfma_f32_16x16x32_bf16 v[36:39], a[0:3], a[184:187], v[36:39]
    v_mfma_f32_16x16x32_bf16 v[108:111], a[0:3], a[188:191], v[108:111]
    s_waitcnt lgkmcnt(0)
    s_barrier
    ds_read_b128 a[16:19], v246 offset:0
    s_add_u32 m0, s80, 73728
    s_add_u32 s82, s81, 184320
    buffer_load_dwordx4 v5, s[20:23], s82 offen offset:0 sc1 lds
    v_mfma_f32_16x16x32_bf16 v[40:43], a[4:7], a[184:187], v[40:43]
    ds_read_b128 a[20:23], v246 offset:1024
    v_mfma_f32_16x16x32_bf16 v[112:115], a[4:7], a[188:191], v[112:115]
    ds_read_b128 a[24:27], v246 offset:2048
    v_mfma_f32_16x16x32_bf16 v[44:47], a[8:11], a[184:187], v[44:47]
    ds_read_b128 a[28:31], v246 offset:3072
    v_mfma_f32_16x16x32_bf16 v[116:119], a[8:11], a[188:191], v[116:119]
    ds_read_b128 a[0:3], v246 offset:4096
    v_mfma_f32_16x16x32_bf16 v[48:51], a[12:15], a[184:187], v[48:51]
    ds_read_b128 a[4:7], v246 offset:5120
    v_mfma_f32_16x16x32_bf16 v[120:123], a[12:15], a[188:191], v[120:123]
    s_add_u32 m0, s73, 8192
    s_add_u32 s72, s72, 128
    buffer_load_dwordx4 v191, s[64:67], s72 offen lds
    s_waitcnt lgkmcnt(5)
    v_mfma_f32_16x16x32_bf16 v[16:19], a[16:19], a[192:195], v[16:19]
    ds_read_b128 a[8:11], v246 offset:6144
    v_mfma_f32_16x16x32_bf16 v[88:91], a[16:19], a[196:199], v[88:91]
    s_add_u32 m0, s80, 73728
    s_nop 0
    buffer_load_dwordx4 v5, s[20:23], s82 offen offset:1024 sc1 lds
    s_waitcnt lgkmcnt(5)
    v_mfma_f32_16x16x32_bf16 v[20:23], a[20:23], a[192:195], v[20:23]
    ds_read_b128 a[12:15], v246 offset:7168
    v_mfma_f32_16x16x32_bf16 v[92:95], a[20:23], a[196:199], v[92:95]
    s_waitcnt lgkmcnt(5)
    v_mfma_f32_16x16x32_bf16 v[24:27], a[24:27], a[192:195], v[24:27]
    ds_read_b128 a[16:19], v246 offset:8192
    v_mfma_f32_16x16x32_bf16 v[96:99], a[24:27], a[196:199], v[96:99]
    s_waitcnt vmcnt(11)
    ds_read_b128 a[240:243], v195 offset:0
    ds_read_b128 a[244:247], v195 offset:512
    s_waitcnt lgkmcnt(7)
    v_mfma_f32_16x16x32_bf16 v[28:31], a[28:31], a[192:195], v[28:31]
    ds_read_b128 a[20:23], v246 offset:9216
    v_mfma_f32_16x16x32_bf16 v[100:103], a[28:31], a[196:199], v[100:103]
    s_add_u32 m0, s80, 73728
    s_nop 0
    buffer_load_dwordx4 v5, s[20:23], s82 offen offset:2048 sc1 lds
    s_waitcnt lgkmcnt(7)
    v_mfma_f32_16x16x32_bf16 v[32:35], a[0:3], a[192:195], v[32:35]
    ds_read_b128 a[24:27], v246 offset:10240
    v_mfma_f32_16x16x32_bf16 v[104:107], a[0:3], a[196:199], v[104:107]
    s_add_u32 m0, s73, 9216
    s_nop 0
    buffer_load_dwordx4 v192, s[64:67], s72 offen lds
    s_waitcnt lgkmcnt(7)
    v_mfma_f32_16x16x32_bf16 v[36:39], a[4:7], a[192:195], v[36:39]
    ds_read_b128 a[28:31], v246 offset:11264
    v_mfma_f32_16x16x32_bf16 v[108:111], a[4:7], a[196:199], v[108:111]
    s_waitcnt lgkmcnt(7)
    v_mfma_f32_16x16x32_bf16 v[40:43], a[8:11], a[192:195], v[40:43]
    ds_read_b128 a[0:3], v246 offset:12288
    v_mfma_f32_16x16x32_bf16 v[112:115], a[8:11], a[196:199], v[112:115]
    s_waitcnt lgkmcnt(7)
    v_mfma_f32_16x16x32_bf16 v[44:47], a[12:15], a[192:195], v[44:47]
    ds_read_b128 a[4:7], v246 offset:13312
    v_mfma_f32_16x16x32_bf16 v[116:119], a[12:15], a[196:199], v[116:119]
    s_add_u32 m0, s80, 73728
    s_nop 0
    buffer_load_dwordx4 v5, s[20:23], s82 offen offset:3072 sc1 lds
    s_waitcnt lgkmcnt(5)
    v_mfma_f32_16x16x32_bf16 v[48:51], a[16:19], a[192:195], v[48:51]
    ds_read_b128 a[8:11], v246 offset:14336
    v_mfma_f32_16x16x32_bf16 v[120:123], a[16:19], a[196:199], v[120:123]
    s_add_u32 m0, s73, 10240
    s_nop 0
    buffer_load_dwordx4 v193, s[64:67], s72 offen lds
    s_waitcnt lgkmcnt(5)
    v_mfma_f32_16x16x32_bf16 v[16:19], a[20:23], a[200:203], v[16:19]
    ds_read_b128 a[12:15], v246 offset:15360
    v_mfma_f32_16x16x32_bf16 v[88:91], a[20:23], a[204:207], v[88:91]
    s_waitcnt lgkmcnt(5)
    v_mfma_f32_16x16x32_bf16 v[20:23], a[24:27], a[200:203], v[20:23]
    ds_read_b128 a[16:19], v246 offset:16384
    v_mfma_f32_16x16x32_bf16 v[92:95], a[24:27], a[204:207], v[92:95]
    s_waitcnt lgkmcnt(5)
    v_mfma_f32_16x16x32_bf16 v[24:27], a[28:31], a[200:203], v[24:27]
    ds_read_b128 a[20:23], v246 offset:17408
    v_mfma_f32_16x16x32_bf16 v[96:99], a[28:31], a[204:207], v[96:99]
    s_add_u32 m0, s80, 77824
    s_add_u32 s82, s81, 188416
    buffer_load_dwordx4 v5, s[20:23], s82 offen offset:0 sc1 lds
    ds_read_b128 a[248:251], v196 offset:0
    ds_read_b128 a[252:255], v196 offset:512
    s_waitcnt lgkmcnt(7)
    v_mfma_f32_16x16x32_bf16 v[28:31], a[0:3], a[200:203], v[28:31]
    ds_read_b128 a[24:27], v246 offset:18432
    v_mfma_f32_16x16x32_bf16 v[100:103], a[0:3], a[204:207], v[100:103]
    s_add_u32 m0, s73, 11264
    s_nop 0
    buffer_load_dwordx4 v194, s[64:67], s72 offen lds
    s_waitcnt lgkmcnt(7)
    v_mfma_f32_16x16x32_bf16 v[32:35], a[4:7], a[200:203], v[32:35]
    ds_read_b128 a[28:31], v246 offset:19456
    v_mfma_f32_16x16x32_bf16 v[104:107], a[4:7], a[204:207], v[104:107]
    s_waitcnt lgkmcnt(7)
    v_mfma_f32_16x16x32_bf16 v[36:39], a[8:11], a[200:203], v[36:39]
    ds_read_b128 a[0:3], v246 offset:20480
    v_mfma_f32_16x16x32_bf16 v[108:111], a[8:11], a[204:207], v[108:111]
    s_waitcnt lgkmcnt(7)
    v_mfma_f32_16x16x32_bf16 v[40:43], a[12:15], a[200:203], v[40:43]
    ds_read_b128 a[4:7], v246 offset:21504
    v_mfma_f32_16x16x32_bf16 v[112:115], a[12:15], a[204:207], v[112:115]
    s_add_u32 m0, s80, 77824
    s_nop 0
    buffer_load_dwordx4 v5, s[20:23], s82 offen offset:1024 sc1 lds
    s_waitcnt lgkmcnt(7)
    v_mfma_f32_16x16x32_bf16 v[44:47], a[16:19], a[200:203], v[44:47]
    ds_read_b128 a[8:11], v246 offset:22528
    v_mfma_f32_16x16x32_bf16 v[116:119], a[16:19], a[204:207], v[116:119]
    s_waitcnt lgkmcnt(5)
    v_mfma_f32_16x16x32_bf16 v[48:51], a[20:23], a[200:203], v[48:51]
    ds_read_b128 a[12:15], v246 offset:23552
    v_mfma_f32_16x16x32_bf16 v[120:123], a[20:23], a[204:207], v[120:123]
    s_add_u32 m0, s73, 0
    s_add_u32 s72, s72, 128
    buffer_load_dwordx4 v191, s[64:67], s72 offen lds
    s_waitcnt lgkmcnt(5)
    v_mfma_f32_16x16x32_bf16 v[16:19], a[24:27], a[208:211], v[16:19]
    ds_read_b128 a[16:19], v246 offset:24576
    v_mfma_f32_16x16x32_bf16 v[88:91], a[24:27], a[212:215], v[88:91]
    s_waitcnt lgkmcnt(5)
    v_mfma_f32_16x16x32_bf16 v[20:23], a[28:31], a[208:211], v[20:23]
    ds_read_b128 a[20:23], v246 offset:25600
    v_mfma_f32_16x16x32_bf16 v[92:95], a[28:31], a[212:215], v[92:95]
    s_add_u32 m0, s80, 77824
    s_nop 0
    buffer_load_dwordx4 v5, s[20:23], s82 offen offset:2048 sc1 lds
    s_waitcnt lgkmcnt(5)
    v_mfma_f32_16x16x32_bf16 v[24:27], a[0:3], a[208:211], v[24:27]
    ds_read_b128 a[24:27], v246 offset:26624
    v_mfma_f32_16x16x32_bf16 v[96:99], a[0:3], a[212:215], v[96:99]
    s_waitcnt vmcnt(12)
    ds_read_b128 a[176:179], v195 offset:4096
    ds_read_b128 a[180:183], v195 offset:4608
    s_waitcnt lgkmcnt(7)
    v_mfma_f32_16x16x32_bf16 v[28:31], a[4:7], a[208:211], v[28:31]
    ds_read_b128 a[28:31], v246 offset:27648
    v_mfma_f32_16x16x32_bf16 v[100:103], a[4:7], a[212:215], v[100:103]
    s_add_u32 m0, s73, 1024
    s_nop 0
    buffer_load_dwordx4 v192, s[64:67], s72 offen lds
    s_waitcnt lgkmcnt(7)
    v_mfma_f32_16x16x32_bf16 v[32:35], a[8:11], a[208:211], v[32:35]
    ds_read_b128 a[0:3], v246 offset:28672
    v_mfma_f32_16x16x32_bf16 v[104:107], a[8:11], a[212:215], v[104:107]
    s_waitcnt lgkmcnt(7)
    v_mfma_f32_16x16x32_bf16 v[36:39], a[12:15], a[208:211], v[36:39]
    ds_read_b128 a[4:7], v246 offset:29696
    v_mfma_f32_16x16x32_bf16 v[108:111], a[12:15], a[212:215], v[108:111]
    s_add_u32 m0, s80, 77824
    s_nop 0
    buffer_load_dwordx4 v5, s[20:23], s82 offen offset:3072 sc1 lds
    s_waitcnt lgkmcnt(7)
    v_mfma_f32_16x16x32_bf16 v[40:43], a[16:19], a[208:211], v[40:43]
    ds_read_b128 a[8:11], v246 offset:30720
    v_mfma_f32_16x16x32_bf16 v[112:115], a[16:19], a[212:215], v[112:115]
    s_waitcnt lgkmcnt(7)
    v_mfma_f32_16x16x32_bf16 v[44:47], a[20:23], a[208:211], v[44:47]
    ds_read_b128 a[12:15], v246 offset:31744
    v_mfma_f32_16x16x32_bf16 v[116:119], a[20:23], a[212:215], v[116:119]
    s_waitcnt lgkmcnt(5)
    v_mfma_f32_16x16x32_bf16 v[48:51], a[24:27], a[208:211], v[48:51]
    ds_read_b128 a[16:19], v246 offset:32768
    v_mfma_f32_16x16x32_bf16 v[120:123], a[24:27], a[212:215], v[120:123]
    s_add_u32 m0, s73, 2048
    s_nop 0
    buffer_load_dwordx4 v193, s[64:67], s72 offen lds
    s_waitcnt lgkmcnt(5)
    v_mfma_f32_16x16x32_bf16 v[16:19], a[28:31], a[216:219], v[16:19]
    ds_read_b128 a[20:23], v246 offset:33792
    v_mfma_f32_16x16x32_bf16 v[88:91], a[28:31], a[220:223], v[88:91]
    s_add_u32 m0, s80, 81920
    s_add_u32 s82, s81, 192512
    buffer_load_dwordx4 v5, s[20:23], s82 offen offset:0 sc1 lds
    s_waitcnt lgkmcnt(5)
    v_mfma_f32_16x16x32_bf16 v[20:23], a[0:3], a[216:219], v[20:23]
    ds_read_b128 a[24:27], v246 offset:34816
    v_mfma_f32_16x16x32_bf16 v[92:95], a[0:3], a[220:223], v[92:95]
    s_waitcnt lgkmcnt(5)
    v_mfma_f32_16x16x32_bf16 v[24:27], a[4:7], a[216:219], v[24:27]
    ds_read_b128 a[28:31], v246 offset:35840
    v_mfma_f32_16x16x32_bf16 v[96:99], a[4:7], a[220:223], v[96:99]
    ds_read_b128 a[184:187], v196 offset:4096
    ds_read_b128 a[188:191], v196 offset:4608
    s_waitcnt lgkmcnt(7)
    v_mfma_f32_16x16x32_bf16 v[28:31], a[8:11], a[216:219], v[28:31]
    v_mfma_f32_16x16x32_bf16 v[100:103], a[8:11], a[220:223], v[100:103]
    s_add_u32 m0, s73, 3072
    s_nop 0
    buffer_load_dwordx4 v194, s[64:67], s72 offen lds
    s_waitcnt lgkmcnt(6)
    v_mfma_f32_16x16x32_bf16 v[32:35], a[12:15], a[216:219], v[32:35]
    v_mfma_f32_16x16x32_bf16 v[104:107], a[12:15], a[220:223], v[104:107]
    s_waitcnt lgkmcnt(5)
    v_mfma_f32_16x16x32_bf16 v[36:39], a[16:19], a[216:219], v[36:39]
    v_mfma_f32_16x16x32_bf16 v[108:111], a[16:19], a[220:223], v[108:111]
    s_waitcnt lgkmcnt(0)
    s_barrier
    ds_read_b128 a[0:3], v246 offset:36864
    s_add_u32 m0, s80, 0
    s_add_u32 s82, s81, 221184
    buffer_load_dwordx4 v5, s[20:23], s82 offen offset:0 sc1 lds
    v_mfma_f32_16x16x32_bf16 v[40:43], a[20:23], a[216:219], v[40:43]
    ds_read_b128 a[4:7], v246 offset:37888
    v_mfma_f32_16x16x32_bf16 v[112:115], a[20:23], a[220:223], v[112:115]
    ds_read_b128 a[8:11], v246 offset:38912
    v_mfma_f32_16x16x32_bf16 v[44:47], a[24:27], a[216:219], v[44:47]
    ds_read_b128 a[12:15], v246 offset:39936
    v_mfma_f32_16x16x32_bf16 v[116:119], a[24:27], a[220:223], v[116:119]
    ds_read_b128 a[16:19], v246 offset:40960
    v_mfma_f32_16x16x32_bf16 v[48:51], a[28:31], a[216:219], v[48:51]
    ds_read_b128 a[20:23], v246 offset:41984
    v_mfma_f32_16x16x32_bf16 v[120:123], a[28:31], a[220:223], v[120:123]
    s_add_u32 m0, s73, 4096
    s_add_u32 s72, s72, 128
    buffer_load_dwordx4 v191, s[64:67], s72 offen lds
    s_waitcnt lgkmcnt(5)
    v_mfma_f32_16x16x32_bf16 v[16:19], a[0:3], a[224:227], v[16:19]
    ds_read_b128 a[24:27], v246 offset:43008
    v_mfma_f32_16x16x32_bf16 v[88:91], a[0:3], a[228:231], v[88:91]
    s_add_u32 m0, s80, 0
    s_nop 0
    buffer_load_dwordx4 v5, s[20:23], s82 offen offset:1024 sc1 lds
    s_waitcnt lgkmcnt(5)
    v_mfma_f32_16x16x32_bf16 v[20:23], a[4:7], a[224:227], v[20:23]
    ds_read_b128 a[28:31], v246 offset:44032
    v_mfma_f32_16x16x32_bf16 v[92:95], a[4:7], a[228:231], v[92:95]
    s_waitcnt lgkmcnt(5)
    v_mfma_f32_16x16x32_bf16 v[24:27], a[8:11], a[224:227], v[24:27]
    ds_read_b128 a[0:3], v246 offset:45056
    v_mfma_f32_16x16x32_bf16 v[96:99], a[8:11], a[228:231], v[96:99]
    s_waitcnt vmcnt(11)
    ds_read_b128 a[192:195], v195 offset:8192
    ds_read_b128 a[196:199], v195 offset:8704
    s_waitcnt lgkmcnt(7)
    v_mfma_f32_16x16x32_bf16 v[28:31], a[12:15], a[224:227], v[28:31]
    ds_read_b128 a[4:7], v246 offset:46080
    v_mfma_f32_16x16x32_bf16 v[100:103], a[12:15], a[228:231], v[100:103]
    s_add_u32 m0, s80, 0
    s_nop 0
    buffer_load_dwordx4 v5, s[20:23], s82 offen offset:2048 sc1 lds
    s_waitcnt lgkmcnt(7)
    v_mfma_f32_16x16x32_bf16 v[32:35], a[16:19], a[224:227], v[32:35]
    ds_read_b128 a[8:11], v246 offset:47104
    v_mfma_f32_16x16x32_bf16 v[104:107], a[16:19], a[228:231], v[104:107]
    s_add_u32 m0, s73, 5120
    s_nop 0
    buffer_load_dwordx4 v192, s[64:67], s72 offen lds
    s_waitcnt lgkmcnt(7)
    v_mfma_f32_16x16x32_bf16 v[36:39], a[20:23], a[224:227], v[36:39]
    ds_read_b128 a[12:15], v246 offset:48128
    v_mfma_f32_16x16x32_bf16 v[108:111], a[20:23], a[228:231], v[108:111]
    s_waitcnt lgkmcnt(7)
    v_mfma_f32_16x16x32_bf16 v[40:43], a[24:27], a[224:227], v[40:43]
    ds_read_b128 a[16:19], v246 offset:49152
    v_mfma_f32_16x16x32_bf16 v[112:115], a[24:27], a[228:231], v[112:115]
    s_waitcnt lgkmcnt(7)
    v_mfma_f32_16x16x32_bf16 v[44:47], a[28:31], a[224:227], v[44:47]
    ds_read_b128 a[20:23], v246 offset:50176
    v_mfma_f32_16x16x32_bf16 v[116:119], a[28:31], a[228:231], v[116:119]
    s_add_u32 m0, s80, 0
    s_nop 0
    buffer_load_dwordx4 v5, s[20:23], s82 offen offset:3072 sc1 lds
    s_waitcnt lgkmcnt(5)
    v_mfma_f32_16x16x32_bf16 v[48:51], a[0:3], a[224:227], v[48:51]
    ds_read_b128 a[24:27], v246 offset:51200
    v_mfma_f32_16x16x32_bf16 v[120:123], a[0:3], a[228:231], v[120:123]
    s_add_u32 m0, s73, 6144
    s_nop 0
    buffer_load_dwordx4 v193, s[64:67], s72 offen lds
    s_waitcnt lgkmcnt(5)
    v_mfma_f32_16x16x32_bf16 v[16:19], a[4:7], a[232:235], v[16:19]
    ds_read_b128 a[28:31], v246 offset:52224
    v_mfma_f32_16x16x32_bf16 v[88:91], a[4:7], a[236:239], v[88:91]
    s_waitcnt lgkmcnt(5)
    v_mfma_f32_16x16x32_bf16 v[20:23], a[8:11], a[232:235], v[20:23]
    ds_read_b128 a[0:3], v246 offset:53248
    v_mfma_f32_16x16x32_bf16 v[92:95], a[8:11], a[236:239], v[92:95]
    s_waitcnt lgkmcnt(5)
    v_mfma_f32_16x16x32_bf16 v[24:27], a[12:15], a[232:235], v[24:27]
    ds_read_b128 a[4:7], v246 offset:54272
    v_mfma_f32_16x16x32_bf16 v[96:99], a[12:15], a[236:239], v[96:99]
    s_add_u32 m0, s80, 4096
    s_add_u32 s82, s81, 225280
    buffer_load_dwordx4 v5, s[20:23], s82 offen offset:0 sc1 lds
    ds_read_b128 a[200:203], v196 offset:8192
    ds_read_b128 a[204:207], v196 offset:8704
    s_waitcnt lgkmcnt(7)
    v_mfma_f32_16x16x32_bf16 v[28:31], a[16:19], a[232:235], v[28:31]
    ds_read_b128 a[8:11], v246 offset:55296
    v_mfma_f32_16x16x32_bf16 v[100:103], a[16:19], a[236:239], v[100:103]
    s_add_u32 m0, s73, 7168
    s_nop 0
    buffer_load_dwordx4 v194, s[64:67], s72 offen lds
    s_waitcnt lgkmcnt(7)
    v_mfma_f32_16x16x32_bf16 v[32:35], a[20:23], a[232:235], v[32:35]
    ds_read_b128 a[12:15], v246 offset:56320
    v_mfma_f32_16x16x32_bf16 v[104:107], a[20:23], a[236:239], v[104:107]
    s_waitcnt lgkmcnt(7)
    v_mfma_f32_16x16x32_bf16 v[36:39], a[24:27], a[232:235], v[36:39]
    ds_read_b128 a[16:19], v246 offset:57344
    v_mfma_f32_16x16x32_bf16 v[108:111], a[24:27], a[236:239], v[108:111]
    s_waitcnt lgkmcnt(7)
    v_mfma_f32_16x16x32_bf16 v[40:43], a[28:31], a[232:235], v[40:43]
    ds_read_b128 a[20:23], v246 offset:58368
    v_mfma_f32_16x16x32_bf16 v[112:115], a[28:31], a[236:239], v[112:115]
    s_add_u32 m0, s80, 4096
    s_nop 0
    buffer_load_dwordx4 v5, s[20:23], s82 offen offset:1024 sc1 lds
    s_waitcnt lgkmcnt(7)
    v_mfma_f32_16x16x32_bf16 v[44:47], a[0:3], a[232:235], v[44:47]
    ds_read_b128 a[24:27], v246 offset:59392
    v_mfma_f32_16x16x32_bf16 v[116:119], a[0:3], a[236:239], v[116:119]
    s_waitcnt lgkmcnt(5)
    v_mfma_f32_16x16x32_bf16 v[48:51], a[4:7], a[232:235], v[48:51]
    ds_read_b128 a[28:31], v246 offset:60416
    v_mfma_f32_16x16x32_bf16 v[120:123], a[4:7], a[236:239], v[120:123]
    s_add_u32 m0, s73, 8192
    s_add_u32 s72, s72, 128
    buffer_load_dwordx4 v191, s[64:67], s72 offen lds
    s_waitcnt lgkmcnt(5)
    v_mfma_f32_16x16x32_bf16 v[16:19], a[8:11], a[240:243], v[16:19]
    ds_read_b128 a[0:3], v246 offset:61440
    v_mfma_f32_16x16x32_bf16 v[88:91], a[8:11], a[244:247], v[88:91]
    s_waitcnt lgkmcnt(5)
    v_mfma_f32_16x16x32_bf16 v[20:23], a[12:15], a[240:243], v[20:23]
    ds_read_b128 a[4:7], v246 offset:62464
    v_mfma_f32_16x16x32_bf16 v[92:95], a[12:15], a[244:247], v[92:95]
    s_add_u32 m0, s80, 4096
    s_nop 0
    buffer_load_dwordx4 v5, s[20:23], s82 offen offset:2048 sc1 lds
    s_waitcnt lgkmcnt(5)
    v_mfma_f32_16x16x32_bf16 v[24:27], a[16:19], a[240:243], v[24:27]
    ds_read_b128 a[8:11], v246 offset:63488
    v_mfma_f32_16x16x32_bf16 v[96:99], a[16:19], a[244:247], v[96:99]
    s_waitcnt vmcnt(12)
    ds_read_b128 a[208:211], v195 offset:0
    ds_read_b128 a[212:215], v195 offset:512
    s_waitcnt lgkmcnt(7)
    v_mfma_f32_16x16x32_bf16 v[28:31], a[20:23], a[240:243], v[28:31]
    ds_read_b128 a[12:15], v246 offset:64512
    v_mfma_f32_16x16x32_bf16 v[100:103], a[20:23], a[244:247], v[100:103]
    s_add_u32 m0, s73, 9216
    s_nop 0
    buffer_load_dwordx4 v192, s[64:67], s72 offen lds
    s_waitcnt lgkmcnt(7)
    v_mfma_f32_16x16x32_bf16 v[32:35], a[24:27], a[240:243], v[32:35]
    ds_read_b128 a[16:19], v247 offset:0
    v_mfma_f32_16x16x32_bf16 v[104:107], a[24:27], a[244:247], v[104:107]
    s_waitcnt lgkmcnt(7)
    v_mfma_f32_16x16x32_bf16 v[36:39], a[28:31], a[240:243], v[36:39]
    ds_read_b128 a[20:23], v247 offset:1024
    v_mfma_f32_16x16x32_bf16 v[108:111], a[28:31], a[244:247], v[108:111]
    s_add_u32 m0, s80, 4096
    s_nop 0
    buffer_load_dwordx4 v5, s[20:23], s82 offen offset:3072 sc1 lds
    s_waitcnt lgkmcnt(7)
    v_mfma_f32_16x16x32_bf16 v[40:43], a[0:3], a[240:243], v[40:43]
    ds_read_b128 a[24:27], v247 offset:2048
    v_mfma_f32_16x16x32_bf16 v[112:115], a[0:3], a[244:247], v[112:115]
    s_waitcnt lgkmcnt(7)
    v_mfma_f32_16x16x32_bf16 v[44:47], a[4:7], a[240:243], v[44:47]
    ds_read_b128 a[28:31], v247 offset:3072
    v_mfma_f32_16x16x32_bf16 v[116:119], a[4:7], a[244:247], v[116:119]
    s_waitcnt lgkmcnt(5)
    v_mfma_f32_16x16x32_bf16 v[48:51], a[8:11], a[240:243], v[48:51]
    ds_read_b128 a[0:3], v247 offset:4096
    v_mfma_f32_16x16x32_bf16 v[120:123], a[8:11], a[244:247], v[120:123]
    s_add_u32 m0, s73, 10240
    s_nop 0
    buffer_load_dwordx4 v193, s[64:67], s72 offen lds
    s_waitcnt lgkmcnt(5)
    v_mfma_f32_16x16x32_bf16 v[16:19], a[12:15], a[248:251], v[16:19]
    ds_read_b128 a[4:7], v247 offset:5120
    v_mfma_f32_16x16x32_bf16 v[88:91], a[12:15], a[252:255], v[88:91]
    s_add_u32 m0, s80, 8192
    s_add_u32 s82, s81, 229376
    buffer_load_dwordx4 v5, s[20:23], s82 offen offset:0 sc1 lds
    s_waitcnt lgkmcnt(5)
    v_mfma_f32_16x16x32_bf16 v[20:23], a[16:19], a[248:251], v[20:23]
    ds_read_b128 a[8:11], v247 offset:6144
    v_mfma_f32_16x16x32_bf16 v[92:95], a[16:19], a[252:255], v[92:95]
    s_waitcnt lgkmcnt(5)
    v_mfma_f32_16x16x32_bf16 v[24:27], a[20:23], a[248:251], v[24:27]
    ds_read_b128 a[12:15], v247 offset:7168
    v_mfma_f32_16x16x32_bf16 v[96:99], a[20:23], a[252:255], v[96:99]
    ds_read_b128 a[216:219], v196 offset:0
    ds_read_b128 a[220:223], v196 offset:512
    s_waitcnt lgkmcnt(7)
    v_mfma_f32_16x16x32_bf16 v[28:31], a[24:27], a[248:251], v[28:31]
    v_mfma_f32_16x16x32_bf16 v[100:103], a[24:27], a[252:255], v[100:103]
    s_add_u32 m0, s73, 11264
    s_nop 0
    buffer_load_dwordx4 v194, s[64:67], s72 offen lds
    s_waitcnt lgkmcnt(6)
    v_mfma_f32_16x16x32_bf16 v[32:35], a[28:31], a[248:251], v[32:35]
    v_mfma_f32_16x16x32_bf16 v[104:107], a[28:31], a[252:255], v[104:107]
    s_waitcnt lgkmcnt(5)
    v_mfma_f32_16x16x32_bf16 v[36:39], a[0:3], a[248:251], v[36:39]
    v_mfma_f32_16x16x32_bf16 v[108:111], a[0:3], a[252:255], v[108:111]
    s_waitcnt lgkmcnt(0)
    s_barrier
    ds_read_b128 a[16:19], v247 offset:8192
    s_add_u32 m0, s80, 36864
    s_add_u32 s82, s81, 258048
    buffer_load_dwordx4 v5, s[20:23], s82 offen offset:0 sc1 lds
    v_mfma_f32_16x16x32_bf16 v[40:43], a[4:7], a[248:251], v[40:43]
    ds_read_b128 a[20:23], v247 offset:9216
    v_mfma_f32_16x16x32_bf16 v[112:115], a[4:7], a[252:255], v[112:115]
    ds_read_b128 a[24:27], v247 offset:10240
    v_mfma_f32_16x16x32_bf16 v[44:47], a[8:11], a[248:251], v[44:47]
    ds_read_b128 a[28:31], v247 offset:11264
    v_mfma_f32_16x16x32_bf16 v[116:119], a[8:11], a[252:255], v[116:119]
    ds_read_b128 a[0:3], v247 offset:12288
    v_mfma_f32_16x16x32_bf16 v[48:51], a[12:15], a[248:251], v[48:51]
    ds_read_b128 a[4:7], v247 offset:13312
    v_mfma_f32_16x16x32_bf16 v[120:123], a[12:15], a[252:255], v[120:123]
    s_add_u32 m0, s73, 0
    s_add_u32 s72, s72, 128
    buffer_load_dwordx4 v191, s[64:67], s72 offen lds
    s_waitcnt lgkmcnt(5)
    v_mfma_f32_16x16x32_bf16 v[16:19], a[16:19], a[176:179], v[16:19]
    ds_read_b128 a[8:11], v247 offset:14336
    v_mfma_f32_16x16x32_bf16 v[88:91], a[16:19], a[180:183], v[88:91]
    s_add_u32 m0, s80, 36864
    s_nop 0
    buffer_load_dwordx4 v5, s[20:23], s82 offen offset:1024 sc1 lds
    s_waitcnt lgkmcnt(5)
    v_mfma_f32_16x16x32_bf16 v[20:23], a[20:23], a[176:179], v[20:23]
    ds_read_b128 a[12:15], v247 offset:15360
    v_mfma_f32_16x16x32_bf16 v[92:95], a[20:23], a[180:183], v[92:95]
    s_waitcnt lgkmcnt(5)
    v_mfma_f32_16x16x32_bf16 v[24:27], a[24:27], a[176:179], v[24:27]
    ds_read_b128 a[16:19], v247 offset:16384
    v_mfma_f32_16x16x32_bf16 v[96:99], a[24:27], a[180:183], v[96:99]
    s_waitcnt vmcnt(11)
    ds_read_b128 a[224:227], v195 offset:4096
    ds_read_b128 a[228:231], v195 offset:4608
    s_waitcnt lgkmcnt(7)
    v_mfma_f32_16x16x32_bf16 v[28:31], a[28:31], a[176:179], v[28:31]
    ds_read_b128 a[20:23], v247 offset:17408
    v_mfma_f32_16x16x32_bf16 v[100:103], a[28:31], a[180:183], v[100:103]
    s_add_u32 m0, s80, 36864
    s_nop 0
    buffer_load_dwordx4 v5, s[20:23], s82 offen offset:2048 sc1 lds
    s_waitcnt lgkmcnt(7)
    v_mfma_f32_16x16x32_bf16 v[32:35], a[0:3], a[176:179], v[32:35]
    ds_read_b128 a[24:27], v247 offset:18432
    v_mfma_f32_16x16x32_bf16 v[104:107], a[0:3], a[180:183], v[104:107]
    s_add_u32 m0, s73, 1024
    s_nop 0
    buffer_load_dwordx4 v192, s[64:67], s72 offen lds
    s_waitcnt lgkmcnt(7)
    v_mfma_f32_16x16x32_bf16 v[36:39], a[4:7], a[176:179], v[36:39]
    ds_read_b128 a[28:31], v247 offset:19456
    v_mfma_f32_16x16x32_bf16 v[108:111], a[4:7], a[180:183], v[108:111]
    s_waitcnt lgkmcnt(7)
    v_mfma_f32_16x16x32_bf16 v[40:43], a[8:11], a[176:179], v[40:43]
    ds_read_b128 a[0:3], v247 offset:20480
    v_mfma_f32_16x16x32_bf16 v[112:115], a[8:11], a[180:183], v[112:115]
    s_waitcnt lgkmcnt(7)
    v_mfma_f32_16x16x32_bf16 v[44:47], a[12:15], a[176:179], v[44:47]
    ds_read_b128 a[4:7], v247 offset:21504
    v_mfma_f32_16x16x32_bf16 v[116:119], a[12:15], a[180:183], v[116:119]
    s_add_u32 m0, s80, 36864
    s_nop 0
    buffer_load_dwordx4 v5, s[20:23], s82 offen offset:3072 sc1 lds
    s_waitcnt lgkmcnt(5)
    v_mfma_f32_16x16x32_bf16 v[48:51], a[16:19], a[176:179], v[48:51]
    ds_read_b128 a[8:11], v247 offset:22528
    v_mfma_f32_16x16x32_bf16 v[120:123], a[16:19], a[180:183], v[120:123]
    s_add_u32 m0, s73, 2048
    s_nop 0
    buffer_load_dwordx4 v193, s[64:67], s72 offen lds
    s_waitcnt lgkmcnt(5)
    v_mfma_f32_16x16x32_bf16 v[16:19], a[20:23], a[184:187], v[16:19]
    ds_read_b128 a[12:15], v247 offset:23552
    v_mfma_f32_16x16x32_bf16 v[88:91], a[20:23], a[188:191], v[88:91]
    s_waitcnt lgkmcnt(5)
    v_mfma_f32_16x16x32_bf16 v[20:23], a[24:27], a[184:187], v[20:23]
    ds_read_b128 a[16:19], v247 offset:24576
    v_mfma_f32_16x16x32_bf16 v[92:95], a[24:27], a[188:191], v[92:95]
    s_waitcnt lgkmcnt(5)
    v_mfma_f32_16x16x32_bf16 v[24:27], a[28:31], a[184:187], v[24:27]
    ds_read_b128 a[20:23], v247 offset:25600
    v_mfma_f32_16x16x32_bf16 v[96:99], a[28:31], a[188:191], v[96:99]
    s_add_u32 m0, s80, 40960
    s_add_u32 s82, s81, 262144
    buffer_load_dwordx4 v5, s[20:23], s82 offen offset:0 sc1 lds
    ds_read_b128 a[232:235], v196 offset:4096
    ds_read_b128 a[236:239], v196 offset:4608
    s_waitcnt lgkmcnt(7)
    v_mfma_f32_16x16x32_bf16 v[28:31], a[0:3], a[184:187], v[28:31]
    ds_read_b128 a[24:27], v247 offset:26624
    v_mfma_f32_16x16x32_bf16 v[100:103], a[0:3], a[188:191], v[100:103]
    s_add_u32 m0, s73, 3072
    s_nop 0
    buffer_load_dwordx4 v194, s[64:67], s72 offen lds
    s_waitcnt lgkmcnt(7)
    v_mfma_f32_16x16x32_bf16 v[32:35], a[4:7], a[184:187], v[32:35]
    ds_read_b128 a[28:31], v247 offset:27648
    v_mfma_f32_16x16x32_bf16 v[104:107], a[4:7], a[188:191], v[104:107]
    s_waitcnt lgkmcnt(7)
    v_mfma_f32_16x16x32_bf16 v[36:39], a[8:11], a[184:187], v[36:39]
    ds_read_b128 a[0:3], v247 offset:28672
    v_mfma_f32_16x16x32_bf16 v[108:111], a[8:11], a[188:191], v[108:111]
    s_waitcnt lgkmcnt(7)
    v_mfma_f32_16x16x32_bf16 v[40:43], a[12:15], a[184:187], v[40:43]
    ds_read_b128 a[4:7], v247 offset:29696
    v_mfma_f32_16x16x32_bf16 v[112:115], a[12:15], a[188:191], v[112:115]
    s_add_u32 m0, s80, 40960
    s_nop 0
    buffer_load_dwordx4 v5, s[20:23], s82 offen offset:1024 sc1 lds
    s_waitcnt lgkmcnt(7)
    v_mfma_f32_16x16x32_bf16 v[44:47], a[16:19], a[184:187], v[44:47]
    ds_read_b128 a[8:11], v247 offset:30720
    v_mfma_f32_16x16x32_bf16 v[116:119], a[16:19], a[188:191], v[116:119]
    s_waitcnt lgkmcnt(5)
    v_mfma_f32_16x16x32_bf16 v[48:51], a[20:23], a[184:187], v[48:51]
    ds_read_b128 a[12:15], v247 offset:31744
    v_mfma_f32_16x16x32_bf16 v[120:123], a[20:23], a[188:191], v[120:123]
    s_add_u32 m0, s73, 4096
    s_add_u32 s72, s72, 128
    buffer_load_dwordx4 v191, s[64:67], s72 offen lds
    s_waitcnt lgkmcnt(5)
    v_mfma_f32_16x16x32_bf16 v[16:19], a[24:27], a[192:195], v[16:19]
    ds_read_b128 a[16:19], v247 offset:32768
    v_mfma_f32_16x16x32_bf16 v[88:91], a[24:27], a[196:199], v[88:91]
    s_waitcnt lgkmcnt(5)
    v_mfma_f32_16x16x32_bf16 v[20:23], a[28:31], a[192:195], v[20:23]
    ds_read_b128 a[20:23], v247 offset:33792
    v_mfma_f32_16x16x32_bf16 v[92:95], a[28:31], a[196:199], v[92:95]
    s_add_u32 m0, s80, 40960
    s_nop 0
    buffer_load_dwordx4 v5, s[20:23], s82 offen offset:2048 sc1 lds
    s_waitcnt lgkmcnt(5)
    v_mfma_f32_16x16x32_bf16 v[24:27], a[0:3], a[192:195], v[24:27]
    ds_read_b128 a[24:27], v247 offset:34816
    v_mfma_f32_16x16x32_bf16 v[96:99], a[0:3], a[196:199], v[96:99]
    s_waitcnt vmcnt(12)
    ds_read_b128 a[240:243], v195 offset:8192
    ds_read_b128 a[244:247], v195 offset:8704
    s_waitcnt lgkmcnt(7)
    v_mfma_f32_16x16x32_bf16 v[28:31], a[4:7], a[192:195], v[28:31]
    ds_read_b128 a[28:31], v247 offset:35840
    v_mfma_f32_16x16x32_bf16 v[100:103], a[4:7], a[196:199], v[100:103]
    s_add_u32 m0, s73, 5120
    s_nop 0
    buffer_load_dwordx4 v192, s[64:67], s72 offen lds
    s_waitcnt lgkmcnt(7)
    v_mfma_f32_16x16x32_bf16 v[32:35], a[8:11], a[192:195], v[32:35]
    ds_read_b128 a[0:3], v247 offset:36864
    v_mfma_f32_16x16x32_bf16 v[104:107], a[8:11], a[196:199], v[104:107]
    s_waitcnt lgkmcnt(7)
    v_mfma_f32_16x16x32_bf16 v[36:39], a[12:15], a[192:195], v[36:39]
    ds_read_b128 a[4:7], v247 offset:37888
    v_mfma_f32_16x16x32_bf16 v[108:111], a[12:15], a[196:199], v[108:111]
    s_add_u32 m0, s80, 40960
    s_nop 0
    buffer_load_dwordx4 v5, s[20:23], s82 offen offset:3072 sc1 lds
    s_waitcnt lgkmcnt(7)
    v_mfma_f32_16x16x32_bf16 v[40:43], a[16:19], a[192:195], v[40:43]
    ds_read_b128 a[8:11], v247 offset:38912
    v_mfma_f32_16x16x32_bf16 v[112:115], a[16:19], a[196:199], v[112:115]
    s_waitcnt lgkmcnt(7)
    v_mfma_f32_16x16x32_bf16 v[44:47], a[20:23], a[192:195], v[44:47]
    ds_read_b128 a[12:15], v247 offset:39936
    v_mfma_f32_16x16x32_bf16 v[116:119], a[20:23], a[196:199], v[116:119]
    s_waitcnt lgkmcnt(5)
    v_mfma_f32_16x16x32_bf16 v[48:51], a[24:27], a[192:195], v[48:51]
    ds_read_b128 a[16:19], v247 offset:40960
    v_mfma_f32_16x16x32_bf16 v[120:123], a[24:27], a[196:199], v[120:123]
    s_add_u32 m0, s73, 6144
    s_nop 0
    buffer_load_dwordx4 v193, s[64:67], s72 offen lds
    s_waitcnt lgkmcnt(5)
    v_mfma_f32_16x16x32_bf16 v[16:19], a[28:31], a[200:203], v[16:19]
    ds_read_b128 a[20:23], v247 offset:41984
    v_mfma_f32_16x16x32_bf16 v[88:91], a[28:31], a[204:207], v[88:91]
    s_add_u32 m0, s80, 45056
    s_add_u32 s82, s81, 266240
    buffer_load_dwordx4 v5, s[20:23], s82 offen offset:0 sc1 lds
    s_waitcnt lgkmcnt(5)
    v_mfma_f32_16x16x32_bf16 v[20:23], a[0:3], a[200:203], v[20:23]
    ds_read_b128 a[24:27], v247 offset:43008
    v_mfma_f32_16x16x32_bf16 v[92:95], a[0:3], a[204:207], v[92:95]
    s_waitcnt lgkmcnt(5)
    v_mfma_f32_16x16x32_bf16 v[24:27], a[4:7], a[200:203], v[24:27]
    ds_read_b128 a[28:31], v247 offset:44032
    v_mfma_f32_16x16x32_bf16 v[96:99], a[4:7], a[204:207], v[96:99]
    ds_read_b128 a[248:251], v196 offset:8192
    ds_read_b128 a[252:255], v196 offset:8704
    s_waitcnt lgkmcnt(7)
    v_mfma_f32_16x16x32_bf16 v[28:31], a[8:11], a[200:203], v[28:31]
    v_mfma_f32_16x16x32_bf16 v[100:103], a[8:11], a[204:207], v[100:103]
    s_add_u32 m0, s73, 7168
    s_nop 0
    buffer_load_dwordx4 v194, s[64:67], s72 offen lds
    s_waitcnt lgkmcnt(6)
    v_mfma_f32_16x16x32_bf16 v[32:35], a[12:15], a[200:203], v[32:35]
    v_mfma_f32_16x16x32_bf16 v[104:107], a[12:15], a[204:207], v[104:107]
    s_waitcnt lgkmcnt(5)
    v_mfma_f32_16x16x32_bf16 v[36:39], a[16:19], a[200:203], v[36:39]
    v_mfma_f32_16x16x32_bf16 v[108:111], a[16:19], a[204:207], v[108:111]
    s_waitcnt lgkmcnt(0)
    s_barrier
    ds_read_b128 a[0:3], v246 offset:0
    s_add_u32 m0, s80, 73728
    s_add_u32 s82, s81, 294912
    buffer_load_dwordx4 v5, s[20:23], s82 offen offset:0 sc1 lds
    v_mfma_f32_16x16x32_bf16 v[40:43], a[20:23], a[200:203], v[40:43]
    ds_read_b128 a[4:7], v246 offset:1024
    v_mfma_f32_16x16x32_bf16 v[112:115], a[20:23], a[204:207], v[112:115]
    ds_read_b128 a[8:11], v246 offset:2048
    v_mfma_f32_16x16x32_bf16 v[44:47], a[24:27], a[200:203], v[44:47]
    ds_read_b128 a[12:15], v246 offset:3072
    v_mfma_f32_16x16x32_bf16 v[116:119], a[24:27], a[204:207], v[116:119]
    ds_read_b128 a[16:19], v246 offset:4096
    v_mfma_f32_16x16x32_bf16 v[48:51], a[28:31], a[200:203], v[48:51]
    ds_read_b128 a[20:23], v246 offset:5120
    v_mfma_f32_16x16x32_bf16 v[120:123], a[28:31], a[204:207], v[120:123]
    s_add_u32 m0, s73, 8192
    s_add_u32 s72, s72, 128
    buffer_load_dwordx4 v191, s[64:67], s72 offen lds
    s_waitcnt lgkmcnt(5)
    v_mfma_f32_16x16x32_bf16 v[16:19], a[0:3], a[208:211], v[16:19]
    ds_read_b128 a[24:27], v246 offset:6144
    v_mfma_f32_16x16x32_bf16 v[88:91], a[0:3], a[212:215], v[88:91]
    s_add_u32 m0, s80, 73728
    s_nop 0
    buffer_load_dwordx4 v5, s[20:23], s82 offen offset:1024 sc1 lds
    s_waitcnt lgkmcnt(5)
    v_mfma_f32_16x16x32_bf16 v[20:23], a[4:7], a[208:211], v[20:23]
    ds_read_b128 a[28:31], v246 offset:7168
    v_mfma_f32_16x16x32_bf16 v[92:95], a[4:7], a[212:215], v[92:95]
    s_waitcnt lgkmcnt(5)
    v_mfma_f32_16x16x32_bf16 v[24:27], a[8:11], a[208:211], v[24:27]
    ds_read_b128 a[0:3], v246 offset:8192
    v_mfma_f32_16x16x32_bf16 v[96:99], a[8:11], a[212:215], v[96:99]
    s_waitcnt vmcnt(11)
    ds_read_b128 a[176:179], v195 offset:0
    ds_read_b128 a[180:183], v195 offset:512
    s_waitcnt lgkmcnt(7)
    v_mfma_f32_16x16x32_bf16 v[28:31], a[12:15], a[208:211], v[28:31]
    ds_read_b128 a[4:7], v246 offset:9216
    v_mfma_f32_16x16x32_bf16 v[100:103], a[12:15], a[212:215], v[100:103]
    s_add_u32 m0, s80, 73728
    s_nop 0
    buffer_load_dwordx4 v5, s[20:23], s82 offen offset:2048 sc1 lds
    s_waitcnt lgkmcnt(7)
    v_mfma_f32_16x16x32_bf16 v[32:35], a[16:19], a[208:211], v[32:35]
    ds_read_b128 a[8:11], v246 offset:10240
    v_mfma_f32_16x16x32_bf16 v[104:107], a[16:19], a[212:215], v[104:107]
    s_add_u32 m0, s73, 9216
    s_nop 0
    buffer_load_dwordx4 v192, s[64:67], s72 offen lds
    s_waitcnt lgkmcnt(7)
    v_mfma_f32_16x16x32_bf16 v[36:39], a[20:23], a[208:211], v[36:39]
    ds_read_b128 a[12:15], v246 offset:11264
    v_mfma_f32_16x16x32_bf16 v[108:111], a[20:23], a[212:215], v[108:111]
    s_waitcnt lgkmcnt(7)
    v_mfma_f32_16x16x32_bf16 v[40:43], a[24:27], a[208:211], v[40:43]
    ds_read_b128 a[16:19], v246 offset:12288
    v_mfma_f32_16x16x32_bf16 v[112:115], a[24:27], a[212:215], v[112:115]
    s_waitcnt lgkmcnt(7)
    v_mfma_f32_16x16x32_bf16 v[44:47], a[28:31], a[208:211], v[44:47]
    ds_read_b128 a[20:23], v246 offset:13312
    v_mfma_f32_16x16x32_bf16 v[116:119], a[28:31], a[212:215], v[116:119]
    s_add_u32 m0, s80, 73728
    s_nop 0
    buffer_load_dwordx4 v5, s[20:23], s82 offen offset:3072 sc1 lds
    s_waitcnt lgkmcnt(5)
    v_mfma_f32_16x16x32_bf16 v[48:51], a[0:3], a[208:211], v[48:51]
    ds_read_b128 a[24:27], v246 offset:14336
    v_mfma_f32_16x16x32_bf16 v[120:123], a[0:3], a[212:215], v[120:123]
    s_add_u32 m0, s73, 10240
    s_nop 0
    buffer_load_dwordx4 v193, s[64:67], s72 offen lds
    s_waitcnt lgkmcnt(5)
    v_mfma_f32_16x16x32_bf16 v[16:19], a[4:7], a[216:219], v[16:19]
    ds_read_b128 a[28:31], v246 offset:15360
    v_mfma_f32_16x16x32_bf16 v[88:91], a[4:7], a[220:223], v[88:91]
    s_waitcnt lgkmcnt(5)
    v_mfma_f32_16x16x32_bf16 v[20:23], a[8:11], a[216:219], v[20:23]
    ds_read_b128 a[0:3], v246 offset:16384
    v_mfma_f32_16x16x32_bf16 v[92:95], a[8:11], a[220:223], v[92:95]
    s_waitcnt lgkmcnt(5)
    v_mfma_f32_16x16x32_bf16 v[24:27], a[12:15], a[216:219], v[24:27]
    ds_read_b128 a[4:7], v246 offset:17408
    v_mfma_f32_16x16x32_bf16 v[96:99], a[12:15], a[220:223], v[96:99]
    s_add_u32 m0, s80, 77824
    s_add_u32 s82, s81, 299008
    buffer_load_dwordx4 v5, s[20:23], s82 offen offset:0 sc1 lds
    ds_read_b128 a[184:187], v196 offset:0
    ds_read_b128 a[188:191], v196 offset:512
    s_waitcnt lgkmcnt(7)
    v_mfma_f32_16x16x32_bf16 v[28:31], a[16:19], a[216:219], v[28:31]
    ds_read_b128 a[8:11], v246 offset:18432
    v_mfma_f32_16x16x32_bf16 v[100:103], a[16:19], a[220:223], v[100:103]
    s_add_u32 m0, s73, 11264
    s_nop 0
    buffer_load_dwordx4 v194, s[64:67], s72 offen lds
    s_waitcnt lgkmcnt(7)
    v_mfma_f32_16x16x32_bf16 v[32:35], a[20:23], a[216:219], v[32:35]
    ds_read_b128 a[12:15], v246 offset:19456
    v_mfma_f32_16x16x32_bf16 v[104:107], a[20:23], a[220:223], v[104:107]
    s_waitcnt lgkmcnt(7)
    v_mfma_f32_16x16x32_bf16 v[36:39], a[24:27], a[216:219], v[36:39]
    ds_read_b128 a[16:19], v246 offset:20480
    v_mfma_f32_16x16x32_bf16 v[108:111], a[24:27], a[220:223], v[108:111]
    s_waitcnt lgkmcnt(7)
    v_mfma_f32_16x16x32_bf16 v[40:43], a[28:31], a[216:219], v[40:43]
    ds_read_b128 a[20:23], v246 offset:21504
    v_mfma_f32_16x16x32_bf16 v[112:115], a[28:31], a[220:223], v[112:115]
    s_add_u32 m0, s80, 77824
    s_nop 0
    buffer_load_dwordx4 v5, s[20:23], s82 offen offset:1024 sc1 lds
    s_waitcnt lgkmcnt(7)
    v_mfma_f32_16x16x32_bf16 v[44:47], a[0:3], a[216:219], v[44:47]
    ds_read_b128 a[24:27], v246 offset:22528
    v_mfma_f32_16x16x32_bf16 v[116:119], a[0:3], a[220:223], v[116:119]
    s_waitcnt lgkmcnt(5)
    v_mfma_f32_16x16x32_bf16 v[48:51], a[4:7], a[216:219], v[48:51]
    ds_read_b128 a[28:31], v246 offset:23552
    v_mfma_f32_16x16x32_bf16 v[120:123], a[4:7], a[220:223], v[120:123]
    s_add_u32 m0, s73, 0
    s_add_u32 s72, s72, 128
    buffer_load_dwordx4 v191, s[64:67], s72 offen lds
    s_waitcnt lgkmcnt(5)
    v_mfma_f32_16x16x32_bf16 v[16:19], a[8:11], a[224:227], v[16:19]
    ds_read_b128 a[0:3], v246 offset:24576
    v_mfma_f32_16x16x32_bf16 v[88:91], a[8:11], a[228:231], v[88:91]
    s_waitcnt lgkmcnt(5)
    v_mfma_f32_16x16x32_bf16 v[20:23], a[12:15], a[224:227], v[20:23]
    ds_read_b128 a[4:7], v246 offset:25600
    v_mfma_f32_16x16x32_bf16 v[92:95], a[12:15], a[228:231], v[92:95]
    s_add_u32 m0, s80, 77824
    s_nop 0
    buffer_load_dwordx4 v5, s[20:23], s82 offen offset:2048 sc1 lds
    s_waitcnt lgkmcnt(5)
    v_mfma_f32_16x16x32_bf16 v[24:27], a[16:19], a[224:227], v[24:27]
    ds_read_b128 a[8:11], v246 offset:26624
    v_mfma_f32_16x16x32_bf16 v[96:99], a[16:19], a[228:231], v[96:99]
    s_waitcnt vmcnt(12)
    ds_read_b128 a[192:195], v195 offset:4096
    ds_read_b128 a[196:199], v195 offset:4608
    s_waitcnt lgkmcnt(7)
    v_mfma_f32_16x16x32_bf16 v[28:31], a[20:23], a[224:227], v[28:31]
    ds_read_b128 a[12:15], v246 offset:27648
    v_mfma_f32_16x16x32_bf16 v[100:103], a[20:23], a[228:231], v[100:103]
    s_add_u32 m0, s73, 1024
    s_nop 0
    buffer_load_dwordx4 v192, s[64:67], s72 offen lds
    s_waitcnt lgkmcnt(7)
    v_mfma_f32_16x16x32_bf16 v[32:35], a[24:27], a[224:227], v[32:35]
    ds_read_b128 a[16:19], v246 offset:28672
    v_mfma_f32_16x16x32_bf16 v[104:107], a[24:27], a[228:231], v[104:107]
    s_waitcnt lgkmcnt(7)
    v_mfma_f32_16x16x32_bf16 v[36:39], a[28:31], a[224:227], v[36:39]
    ds_read_b128 a[20:23], v246 offset:29696
    v_mfma_f32_16x16x32_bf16 v[108:111], a[28:31], a[228:231], v[108:111]
    s_add_u32 m0, s80, 77824
    s_nop 0
    buffer_load_dwordx4 v5, s[20:23], s82 offen offset:3072 sc1 lds
    s_waitcnt lgkmcnt(7)
    v_mfma_f32_16x16x32_bf16 v[40:43], a[0:3], a[224:227], v[40:43]
    ds_read_b128 a[24:27], v246 offset:30720
    v_mfma_f32_16x16x32_bf16 v[112:115], a[0:3], a[228:231], v[112:115]
    s_waitcnt lgkmcnt(7)
    v_mfma_f32_16x16x32_bf16 v[44:47], a[4:7], a[224:227], v[44:47]
    ds_read_b128 a[28:31], v246 offset:31744
    v_mfma_f32_16x16x32_bf16 v[116:119], a[4:7], a[228:231], v[116:119]
    s_waitcnt lgkmcnt(5)
    v_mfma_f32_16x16x32_bf16 v[48:51], a[8:11], a[224:227], v[48:51]
    ds_read_b128 a[0:3], v246 offset:32768
    v_mfma_f32_16x16x32_bf16 v[120:123], a[8:11], a[228:231], v[120:123]
    s_add_u32 m0, s73, 2048
    s_nop 0
    buffer_load_dwordx4 v193, s[64:67], s72 offen lds
    s_waitcnt lgkmcnt(5)
    v_mfma_f32_16x16x32_bf16 v[16:19], a[12:15], a[232:235], v[16:19]
    ds_read_b128 a[4:7], v246 offset:33792
    v_mfma_f32_16x16x32_bf16 v[88:91], a[12:15], a[236:239], v[88:91]
    s_add_u32 m0, s80, 81920
    s_add_u32 s82, s81, 303104
    buffer_load_dwordx4 v5, s[20:23], s82 offen offset:0 sc1 lds
    s_waitcnt lgkmcnt(5)
    v_mfma_f32_16x16x32_bf16 v[20:23], a[16:19], a[232:235], v[20:23]
    ds_read_b128 a[8:11], v246 offset:34816
    v_mfma_f32_16x16x32_bf16 v[92:95], a[16:19], a[236:239], v[92:95]
    s_waitcnt lgkmcnt(5)
    v_mfma_f32_16x16x32_bf16 v[24:27], a[20:23], a[232:235], v[24:27]
    ds_read_b128 a[12:15], v246 offset:35840
    v_mfma_f32_16x16x32_bf16 v[96:99], a[20:23], a[236:239], v[96:99]
    ds_read_b128 a[200:203], v196 offset:4096
    ds_read_b128 a[204:207], v196 offset:4608
    s_waitcnt lgkmcnt(7)
    v_mfma_f32_16x16x32_bf16 v[28:31], a[24:27], a[232:235], v[28:31]
    v_mfma_f32_16x16x32_bf16 v[100:103], a[24:27], a[236:239], v[100:103]
    s_add_u32 m0, s73, 3072
    s_nop 0
    buffer_load_dwordx4 v194, s[64:67], s72 offen lds
    s_waitcnt lgkmcnt(6)
    v_mfma_f32_16x16x32_bf16 v[32:35], a[28:31], a[232:235], v[32:35]
    v_mfma_f32_16x16x32_bf16 v[104:107], a[28:31], a[236:239], v[104:107]
    s_waitcnt lgkmcnt(5)
    v_mfma_f32_16x16x32_bf16 v[36:39], a[0:3], a[232:235], v[36:39]
    v_mfma_f32_16x16x32_bf16 v[108:111], a[0:3], a[236:239], v[108:111]
    s_waitcnt lgkmcnt(0)
    s_barrier
    ds_read_b128 a[16:19], v246 offset:36864
    s_add_u32 m0, s80, 0
    s_add_u32 s82, s81, 331776
    buffer_load_dwordx4 v5, s[20:23], s82 offen offset:0 sc1 lds
    v_mfma_f32_16x16x32_bf16 v[40:43], a[4:7], a[232:235], v[40:43]
    ds_read_b128 a[20:23], v246 offset:37888
    v_mfma_f32_16x16x32_bf16 v[112:115], a[4:7], a[236:239], v[112:115]
    ds_read_b128 a[24:27], v246 offset:38912
    v_mfma_f32_16x16x32_bf16 v[44:47], a[8:11], a[232:235], v[44:47]
    ds_read_b128 a[28:31], v246 offset:39936
    v_mfma_f32_16x16x32_bf16 v[116:119], a[8:11], a[236:239], v[116:119]
    ds_read_b128 a[0:3], v246 offset:40960
    v_mfma_f32_16x16x32_bf16 v[48:51], a[12:15], a[232:235], v[48:51]
    ds_read_b128 a[4:7], v246 offset:41984
    v_mfma_f32_16x16x32_bf16 v[120:123], a[12:15], a[236:239], v[120:123]
    s_add_u32 m0, s73, 4096
    s_add_u32 s72, s72, 128
    buffer_load_dwordx4 v191, s[64:67], s72 offen lds
    s_waitcnt lgkmcnt(5)
    v_mfma_f32_16x16x32_bf16 v[16:19], a[16:19], a[240:243], v[16:19]
    ds_read_b128 a[8:11], v246 offset:43008
    v_mfma_f32_16x16x32_bf16 v[88:91], a[16:19], a[244:247], v[88:91]
    s_add_u32 m0, s80, 0
    s_nop 0
    buffer_load_dwordx4 v5, s[20:23], s82 offen offset:1024 sc1 lds
    s_waitcnt lgkmcnt(5)
    v_mfma_f32_16x16x32_bf16 v[20:23], a[20:23], a[240:243], v[20:23]
    ds_read_b128 a[12:15], v246 offset:44032
    v_mfma_f32_16x16x32_bf16 v[92:95], a[20:23], a[244:247], v[92:95]
    s_waitcnt lgkmcnt(5)
    v_mfma_f32_16x16x32_bf16 v[24:27], a[24:27], a[240:243], v[24:27]
    ds_read_b128 a[16:19], v246 offset:45056
    v_mfma_f32_16x16x32_bf16 v[96:99], a[24:27], a[244:247], v[96:99]
    s_waitcnt vmcnt(11)
    ds_read_b128 a[208:211], v195 offset:8192
    ds_read_b128 a[212:215], v195 offset:8704
    s_waitcnt lgkmcnt(7)
    v_mfma_f32_16x16x32_bf16 v[28:31], a[28:31], a[240:243], v[28:31]
    ds_read_b128 a[20:23], v246 offset:46080
    v_mfma_f32_16x16x32_bf16 v[100:103], a[28:31], a[244:247], v[100:103]
    s_add_u32 m0, s80, 0
    s_nop 0
    buffer_load_dwordx4 v5, s[20:23], s82 offen offset:2048 sc1 lds
    s_waitcnt lgkmcnt(7)
    v_mfma_f32_16x16x32_bf16 v[32:35], a[0:3], a[240:243], v[32:35]
    ds_read_b128 a[24:27], v246 offset:47104
    v_mfma_f32_16x16x32_bf16 v[104:107], a[0:3], a[244:247], v[104:107]
    s_add_u32 m0, s73, 5120
    s_nop 0
    buffer_load_dwordx4 v192, s[64:67], s72 offen lds
    s_waitcnt lgkmcnt(7)
    v_mfma_f32_16x16x32_bf16 v[36:39], a[4:7], a[240:243], v[36:39]
    ds_read_b128 a[28:31], v246 offset:48128
    v_mfma_f32_16x16x32_bf16 v[108:111], a[4:7], a[244:247], v[108:111]
    s_waitcnt lgkmcnt(7)
    v_mfma_f32_16x16x32_bf16 v[40:43], a[8:11], a[240:243], v[40:43]
    ds_read_b128 a[0:3], v246 offset:49152
    v_mfma_f32_16x16x32_bf16 v[112:115], a[8:11], a[244:247], v[112:115]
    s_waitcnt lgkmcnt(7)
    v_mfma_f32_16x16x32_bf16 v[44:47], a[12:15], a[240:243], v[44:47]
    ds_read_b128 a[4:7], v246 offset:50176
    v_mfma_f32_16x16x32_bf16 v[116:119], a[12:15], a[244:247], v[116:119]
    s_add_u32 m0, s80, 0
    s_nop 0
    buffer_load_dwordx4 v5, s[20:23], s82 offen offset:3072 sc1 lds
    s_waitcnt lgkmcnt(5)
    v_mfma_f32_16x16x32_bf16 v[48:51], a[16:19], a[240:243], v[48:51]
    ds_read_b128 a[8:11], v246 offset:51200
    v_mfma_f32_16x16x32_bf16 v[120:123], a[16:19], a[244:247], v[120:123]
    s_add_u32 m0, s73, 6144
    s_nop 0
    buffer_load_dwordx4 v193, s[64:67], s72 offen lds
    s_waitcnt lgkmcnt(5)
    v_mfma_f32_16x16x32_bf16 v[16:19], a[20:23], a[248:251], v[16:19]
    ds_read_b128 a[12:15], v246 offset:52224
    v_mfma_f32_16x16x32_bf16 v[88:91], a[20:23], a[252:255], v[88:91]
    s_waitcnt lgkmcnt(5)
    v_mfma_f32_16x16x32_bf16 v[20:23], a[24:27], a[248:251], v[20:23]
    ds_read_b128 a[16:19], v246 offset:53248
    v_mfma_f32_16x16x32_bf16 v[92:95], a[24:27], a[252:255], v[92:95]
    s_waitcnt lgkmcnt(5)
    v_mfma_f32_16x16x32_bf16 v[24:27], a[28:31], a[248:251], v[24:27]
    ds_read_b128 a[20:23], v246 offset:54272
    v_mfma_f32_16x16x32_bf16 v[96:99], a[28:31], a[252:255], v[96:99]
    s_add_u32 m0, s80, 4096
    s_add_u32 s82, s81, 335872
    buffer_load_dwordx4 v5, s[20:23], s82 offen offset:0 sc1 lds
    ds_read_b128 a[216:219], v196 offset:8192
    ds_read_b128 a[220:223], v196 offset:8704
    s_waitcnt lgkmcnt(7)
    v_mfma_f32_16x16x32_bf16 v[28:31], a[0:3], a[248:251], v[28:31]
    ds_read_b128 a[24:27], v246 offset:55296
    v_mfma_f32_16x16x32_bf16 v[100:103], a[0:3], a[252:255], v[100:103]
    s_add_u32 m0, s73, 7168
    s_nop 0
    buffer_load_dwordx4 v194, s[64:67], s72 offen lds
    s_waitcnt lgkmcnt(7)
    v_mfma_f32_16x16x32_bf16 v[32:35], a[4:7], a[248:251], v[32:35]
    ds_read_b128 a[28:31], v246 offset:56320
    v_mfma_f32_16x16x32_bf16 v[104:107], a[4:7], a[252:255], v[104:107]
    s_waitcnt lgkmcnt(7)
    v_mfma_f32_16x16x32_bf16 v[36:39], a[8:11], a[248:251], v[36:39]
    ds_read_b128 a[0:3], v246 offset:57344
    v_mfma_f32_16x16x32_bf16 v[108:111], a[8:11], a[252:255], v[108:111]
    s_waitcnt lgkmcnt(7)
    v_mfma_f32_16x16x32_bf16 v[40:43], a[12:15], a[248:251], v[40:43]
    ds_read_b128 a[4:7], v246 offset:58368
    v_mfma_f32_16x16x32_bf16 v[112:115], a[12:15], a[252:255], v[112:115]
    s_add_u32 m0, s80, 4096
    s_nop 0
    buffer_load_dwordx4 v5, s[20:23], s82 offen offset:1024 sc1 lds
    s_waitcnt lgkmcnt(7)
    v_mfma_f32_16x16x32_bf16 v[44:47], a[16:19], a[248:251], v[44:47]
    ds_read_b128 a[8:11], v246 offset:59392
    v_mfma_f32_16x16x32_bf16 v[116:119], a[16:19], a[252:255], v[116:119]
    s_waitcnt lgkmcnt(5)
    v_mfma_f32_16x16x32_bf16 v[48:51], a[20:23], a[248:251], v[48:51]
    ds_read_b128 a[12:15], v246 offset:60416
    v_mfma_f32_16x16x32_bf16 v[120:123], a[20:23], a[252:255], v[120:123]
    s_add_u32 m0, s73, 8192
    s_add_u32 s72, s72, 128
    buffer_load_dwordx4 v191, s[64:67], s72 offen lds
    s_waitcnt lgkmcnt(5)
    v_mfma_f32_16x16x32_bf16 v[16:19], a[24:27], a[176:179], v[16:19]
    ds_read_b128 a[16:19], v246 offset:61440
    v_mfma_f32_16x16x32_bf16 v[88:91], a[24:27], a[180:183], v[88:91]
    s_waitcnt lgkmcnt(5)
    v_mfma_f32_16x16x32_bf16 v[20:23], a[28:31], a[176:179], v[20:23]
    ds_read_b128 a[20:23], v246 offset:62464
    v_mfma_f32_16x16x32_bf16 v[92:95], a[28:31], a[180:183], v[92:95]
    s_add_u32 m0, s80, 4096
    s_nop 0
    buffer_load_dwordx4 v5, s[20:23], s82 offen offset:2048 sc1 lds
    s_waitcnt lgkmcnt(5)
    v_mfma_f32_16x16x32_bf16 v[24:27], a[0:3], a[176:179], v[24:27]
    ds_read_b128 a[24:27], v246 offset:63488
    v_mfma_f32_16x16x32_bf16 v[96:99], a[0:3], a[180:183], v[96:99]
    s_waitcnt vmcnt(12)
    ds_read_b128 a[224:227], v195 offset:0
    ds_read_b128 a[228:231], v195 offset:512
    s_waitcnt lgkmcnt(7)
    v_mfma_f32_16x16x32_bf16 v[28:31], a[4:7], a[176:179], v[28:31]
    ds_read_b128 a[28:31], v246 offset:64512
    v_mfma_f32_16x16x32_bf16 v[100:103], a[4:7], a[180:183], v[100:103]
    s_add_u32 m0, s73, 9216
    s_nop 0
    buffer_load_dwordx4 v192, s[64:67], s72 offen lds
    s_waitcnt lgkmcnt(7)
    v_mfma_f32_16x16x32_bf16 v[32:35], a[8:11], a[176:179], v[32:35]
    ds_read_b128 a[0:3], v247 offset:0
    v_mfma_f32_16x16x32_bf16 v[104:107], a[8:11], a[180:183], v[104:107]
    s_waitcnt lgkmcnt(7)
    v_mfma_f32_16x16x32_bf16 v[36:39], a[12:15], a[176:179], v[36:39]
    ds_read_b128 a[4:7], v247 offset:1024
    v_mfma_f32_16x16x32_bf16 v[108:111], a[12:15], a[180:183], v[108:111]
    s_add_u32 m0, s80, 4096
    s_nop 0
    buffer_load_dwordx4 v5, s[20:23], s82 offen offset:3072 sc1 lds
    s_waitcnt lgkmcnt(7)
    v_mfma_f32_16x16x32_bf16 v[40:43], a[16:19], a[176:179], v[40:43]
    ds_read_b128 a[8:11], v247 offset:2048
    v_mfma_f32_16x16x32_bf16 v[112:115], a[16:19], a[180:183], v[112:115]
    s_waitcnt lgkmcnt(7)
    v_mfma_f32_16x16x32_bf16 v[44:47], a[20:23], a[176:179], v[44:47]
    ds_read_b128 a[12:15], v247 offset:3072
    v_mfma_f32_16x16x32_bf16 v[116:119], a[20:23], a[180:183], v[116:119]
    s_waitcnt lgkmcnt(5)
    v_mfma_f32_16x16x32_bf16 v[48:51], a[24:27], a[176:179], v[48:51]
    ds_read_b128 a[16:19], v247 offset:4096
    v_mfma_f32_16x16x32_bf16 v[120:123], a[24:27], a[180:183], v[120:123]
    s_add_u32 m0, s73, 10240
    s_nop 0
    buffer_load_dwordx4 v193, s[64:67], s72 offen lds
    s_waitcnt lgkmcnt(5)
    v_mfma_f32_16x16x32_bf16 v[16:19], a[28:31], a[184:187], v[16:19]
    ds_read_b128 a[20:23], v247 offset:5120
    v_mfma_f32_16x16x32_bf16 v[88:91], a[28:31], a[188:191], v[88:91]
    s_add_u32 m0, s80, 8192
    s_add_u32 s82, s81, 339968
    buffer_load_dwordx4 v5, s[20:23], s82 offen offset:0 sc1 lds
    s_waitcnt lgkmcnt(5)
    v_mfma_f32_16x16x32_bf16 v[20:23], a[0:3], a[184:187], v[20:23]
    ds_read_b128 a[24:27], v247 offset:6144
    v_mfma_f32_16x16x32_bf16 v[92:95], a[0:3], a[188:191], v[92:95]
    s_waitcnt lgkmcnt(5)
    v_mfma_f32_16x16x32_bf16 v[24:27], a[4:7], a[184:187], v[24:27]
    ds_read_b128 a[28:31], v247 offset:7168
    v_mfma_f32_16x16x32_bf16 v[96:99], a[4:7], a[188:191], v[96:99]
    ds_read_b128 a[232:235], v196 offset:0
    ds_read_b128 a[236:239], v196 offset:512
    s_waitcnt lgkmcnt(7)
    v_mfma_f32_16x16x32_bf16 v[28:31], a[8:11], a[184:187], v[28:31]
    v_mfma_f32_16x16x32_bf16 v[100:103], a[8:11], a[188:191], v[100:103]
    s_add_u32 m0, s73, 11264
    s_nop 0
    buffer_load_dwordx4 v194, s[64:67], s72 offen lds
    s_waitcnt lgkmcnt(6)
    v_mfma_f32_16x16x32_bf16 v[32:35], a[12:15], a[184:187], v[32:35]
    v_mfma_f32_16x16x32_bf16 v[104:107], a[12:15], a[188:191], v[104:107]
    s_waitcnt lgkmcnt(5)
    v_mfma_f32_16x16x32_bf16 v[36:39], a[16:19], a[184:187], v[36:39]
    v_mfma_f32_16x16x32_bf16 v[108:111], a[16:19], a[188:191], v[108:111]
    s_waitcnt lgkmcnt(0)
    s_barrier
    ds_read_b128 a[0:3], v247 offset:8192
    s_add_u32 m0, s80, 36864
    s_add_u32 s82, s81, 368640
    buffer_load_dwordx4 v5, s[20:23], s82 offen offset:0 sc1 lds
    v_mfma_f32_16x16x32_bf16 v[40:43], a[20:23], a[184:187], v[40:43]
    ds_read_b128 a[4:7], v247 offset:9216
    v_mfma_f32_16x16x32_bf16 v[112:115], a[20:23], a[188:191], v[112:115]
    ds_read_b128 a[8:11], v247 offset:10240
    v_mfma_f32_16x16x32_bf16 v[44:47], a[24:27], a[184:187], v[44:47]
    ds_read_b128 a[12:15], v247 offset:11264
    v_mfma_f32_16x16x32_bf16 v[116:119], a[24:27], a[188:191], v[116:119]
    ds_read_b128 a[16:19], v247 offset:12288
    v_mfma_f32_16x16x32_bf16 v[48:51], a[28:31], a[184:187], v[48:51]
    ds_read_b128 a[20:23], v247 offset:13312
    v_mfma_f32_16x16x32_bf16 v[120:123], a[28:31], a[188:191], v[120:123]
    s_add_u32 m0, s73, 0
    s_add_u32 s72, s72, 128
    buffer_load_dwordx4 v191, s[64:67], s72 offen lds
    s_waitcnt lgkmcnt(5)
    v_mfma_f32_16x16x32_bf16 v[16:19], a[0:3], a[192:195], v[16:19]
    ds_read_b128 a[24:27], v247 offset:14336
    v_mfma_f32_16x16x32_bf16 v[88:91], a[0:3], a[196:199], v[88:91]
    s_add_u32 m0, s80, 36864
    s_nop 0
    buffer_load_dwordx4 v5, s[20:23], s82 offen offset:1024 sc1 lds
    s_waitcnt lgkmcnt(5)
    v_mfma_f32_16x16x32_bf16 v[20:23], a[4:7], a[192:195], v[20:23]
    ds_read_b128 a[28:31], v247 offset:15360
    v_mfma_f32_16x16x32_bf16 v[92:95], a[4:7], a[196:199], v[92:95]
    s_waitcnt lgkmcnt(5)
    v_mfma_f32_16x16x32_bf16 v[24:27], a[8:11], a[192:195], v[24:27]
    ds_read_b128 a[0:3], v247 offset:16384
    v_mfma_f32_16x16x32_bf16 v[96:99], a[8:11], a[196:199], v[96:99]
    s_waitcnt vmcnt(11)
    ds_read_b128 a[240:243], v195 offset:4096
    ds_read_b128 a[244:247], v195 offset:4608
    s_waitcnt lgkmcnt(7)
    v_mfma_f32_16x16x32_bf16 v[28:31], a[12:15], a[192:195], v[28:31]
    ds_read_b128 a[4:7], v247 offset:17408
    v_mfma_f32_16x16x32_bf16 v[100:103], a[12:15], a[196:199], v[100:103]
    s_add_u32 m0, s80, 36864
    s_nop 0
    buffer_load_dwordx4 v5, s[20:23], s82 offen offset:2048 sc1 lds
    s_waitcnt lgkmcnt(7)
    v_mfma_f32_16x16x32_bf16 v[32:35], a[16:19], a[192:195], v[32:35]
    ds_read_b128 a[8:11], v247 offset:18432
    v_mfma_f32_16x16x32_bf16 v[104:107], a[16:19], a[196:199], v[104:107]
    s_add_u32 m0, s73, 1024
    s_nop 0
    buffer_load_dwordx4 v192, s[64:67], s72 offen lds
    s_waitcnt lgkmcnt(7)
    v_mfma_f32_16x16x32_bf16 v[36:39], a[20:23], a[192:195], v[36:39]
    ds_read_b128 a[12:15], v247 offset:19456
    v_mfma_f32_16x16x32_bf16 v[108:111], a[20:23], a[196:199], v[108:111]
    s_waitcnt lgkmcnt(7)
    v_mfma_f32_16x16x32_bf16 v[40:43], a[24:27], a[192:195], v[40:43]
    ds_read_b128 a[16:19], v247 offset:20480
    v_mfma_f32_16x16x32_bf16 v[112:115], a[24:27], a[196:199], v[112:115]
    s_waitcnt lgkmcnt(7)
    v_mfma_f32_16x16x32_bf16 v[44:47], a[28:31], a[192:195], v[44:47]
    ds_read_b128 a[20:23], v247 offset:21504
    v_mfma_f32_16x16x32_bf16 v[116:119], a[28:31], a[196:199], v[116:119]
    s_add_u32 m0, s80, 36864
    s_nop 0
    buffer_load_dwordx4 v5, s[20:23], s82 offen offset:3072 sc1 lds
    s_waitcnt lgkmcnt(5)
    v_mfma_f32_16x16x32_bf16 v[48:51], a[0:3], a[192:195], v[48:51]
    ds_read_b128 a[24:27], v247 offset:22528
    v_mfma_f32_16x16x32_bf16 v[120:123], a[0:3], a[196:199], v[120:123]
    s_add_u32 m0, s73, 2048
    s_nop 0
    buffer_load_dwordx4 v193, s[64:67], s72 offen lds
    s_waitcnt lgkmcnt(5)
    v_mfma_f32_16x16x32_bf16 v[16:19], a[4:7], a[200:203], v[16:19]
    ds_read_b128 a[28:31], v247 offset:23552
    v_mfma_f32_16x16x32_bf16 v[88:91], a[4:7], a[204:207], v[88:91]
    s_waitcnt lgkmcnt(5)
    v_mfma_f32_16x16x32_bf16 v[20:23], a[8:11], a[200:203], v[20:23]
    ds_read_b128 a[0:3], v247 offset:24576
    v_mfma_f32_16x16x32_bf16 v[92:95], a[8:11], a[204:207], v[92:95]
    s_waitcnt lgkmcnt(5)
    v_mfma_f32_16x16x32_bf16 v[24:27], a[12:15], a[200:203], v[24:27]
    ds_read_b128 a[4:7], v247 offset:25600
    v_mfma_f32_16x16x32_bf16 v[96:99], a[12:15], a[204:207], v[96:99]
    s_add_u32 m0, s80, 40960
    s_add_u32 s82, s81, 372736
    buffer_load_dwordx4 v5, s[20:23], s82 offen offset:0 sc1 lds
    ds_read_b128 a[248:251], v196 offset:4096
    ds_read_b128 a[252:255], v196 offset:4608
    s_waitcnt lgkmcnt(7)
    v_mfma_f32_16x16x32_bf16 v[28:31], a[16:19], a[200:203], v[28:31]
    ds_read_b128 a[8:11], v247 offset:26624
    v_mfma_f32_16x16x32_bf16 v[100:103], a[16:19], a[204:207], v[100:103]
    s_add_u32 m0, s73, 3072
    s_nop 0
    buffer_load_dwordx4 v194, s[64:67], s72 offen lds
    s_waitcnt lgkmcnt(7)
    v_mfma_f32_16x16x32_bf16 v[32:35], a[20:23], a[200:203], v[32:35]
    ds_read_b128 a[12:15], v247 offset:27648
    v_mfma_f32_16x16x32_bf16 v[104:107], a[20:23], a[204:207], v[104:107]
    s_waitcnt lgkmcnt(7)
    v_mfma_f32_16x16x32_bf16 v[36:39], a[24:27], a[200:203], v[36:39]
    ds_read_b128 a[16:19], v247 offset:28672
    v_mfma_f32_16x16x32_bf16 v[108:111], a[24:27], a[204:207], v[108:111]
    s_waitcnt lgkmcnt(7)
    v_mfma_f32_16x16x32_bf16 v[40:43], a[28:31], a[200:203], v[40:43]
    ds_read_b128 a[20:23], v247 offset:29696
    v_mfma_f32_16x16x32_bf16 v[112:115], a[28:31], a[204:207], v[112:115]
    s_add_u32 m0, s80, 40960
    s_nop 0
    buffer_load_dwordx4 v5, s[20:23], s82 offen offset:1024 sc1 lds
    s_waitcnt lgkmcnt(7)
    v_mfma_f32_16x16x32_bf16 v[44:47], a[0:3], a[200:203], v[44:47]
    ds_read_b128 a[24:27], v247 offset:30720
    v_mfma_f32_16x16x32_bf16 v[116:119], a[0:3], a[204:207], v[116:119]
    s_waitcnt lgkmcnt(5)
    v_mfma_f32_16x16x32_bf16 v[48:51], a[4:7], a[200:203], v[48:51]
    ds_read_b128 a[28:31], v247 offset:31744
    v_mfma_f32_16x16x32_bf16 v[120:123], a[4:7], a[204:207], v[120:123]
    s_add_u32 m0, s73, 4096
    s_add_u32 s72, s72, 128
    buffer_load_dwordx4 v191, s[64:67], s72 offen lds
    s_waitcnt lgkmcnt(5)
    v_mfma_f32_16x16x32_bf16 v[16:19], a[8:11], a[208:211], v[16:19]
    ds_read_b128 a[0:3], v247 offset:32768
    v_mfma_f32_16x16x32_bf16 v[88:91], a[8:11], a[212:215], v[88:91]
    s_waitcnt lgkmcnt(5)
    v_mfma_f32_16x16x32_bf16 v[20:23], a[12:15], a[208:211], v[20:23]
    ds_read_b128 a[4:7], v247 offset:33792
    v_mfma_f32_16x16x32_bf16 v[92:95], a[12:15], a[212:215], v[92:95]
    s_add_u32 m0, s80, 40960
    s_nop 0
    buffer_load_dwordx4 v5, s[20:23], s82 offen offset:2048 sc1 lds
    s_waitcnt lgkmcnt(5)
    v_mfma_f32_16x16x32_bf16 v[24:27], a[16:19], a[208:211], v[24:27]
    ds_read_b128 a[8:11], v247 offset:34816
    v_mfma_f32_16x16x32_bf16 v[96:99], a[16:19], a[212:215], v[96:99]
    s_waitcnt vmcnt(12)
    ds_read_b128 a[176:179], v195 offset:8192
    ds_read_b128 a[180:183], v195 offset:8704
    s_waitcnt lgkmcnt(7)
    v_mfma_f32_16x16x32_bf16 v[28:31], a[20:23], a[208:211], v[28:31]
    ds_read_b128 a[12:15], v247 offset:35840
    v_mfma_f32_16x16x32_bf16 v[100:103], a[20:23], a[212:215], v[100:103]
    s_add_u32 m0, s73, 5120
    s_nop 0
    buffer_load_dwordx4 v192, s[64:67], s72 offen lds
    s_waitcnt lgkmcnt(7)
    v_mfma_f32_16x16x32_bf16 v[32:35], a[24:27], a[208:211], v[32:35]
    ds_read_b128 a[16:19], v247 offset:36864
    v_mfma_f32_16x16x32_bf16 v[104:107], a[24:27], a[212:215], v[104:107]
    s_waitcnt lgkmcnt(7)
    v_mfma_f32_16x16x32_bf16 v[36:39], a[28:31], a[208:211], v[36:39]
    ds_read_b128 a[20:23], v247 offset:37888
    v_mfma_f32_16x16x32_bf16 v[108:111], a[28:31], a[212:215], v[108:111]
    s_add_u32 m0, s80, 40960
    s_nop 0
    buffer_load_dwordx4 v5, s[20:23], s82 offen offset:3072 sc1 lds
    s_waitcnt lgkmcnt(7)
    v_mfma_f32_16x16x32_bf16 v[40:43], a[0:3], a[208:211], v[40:43]
    ds_read_b128 a[24:27], v247 offset:38912
    v_mfma_f32_16x16x32_bf16 v[112:115], a[0:3], a[212:215], v[112:115]
    s_waitcnt lgkmcnt(7)
    v_mfma_f32_16x16x32_bf16 v[44:47], a[4:7], a[208:211], v[44:47]
    ds_read_b128 a[28:31], v247 offset:39936
    v_mfma_f32_16x16x32_bf16 v[116:119], a[4:7], a[212:215], v[116:119]
    s_waitcnt lgkmcnt(5)
    v_mfma_f32_16x16x32_bf16 v[48:51], a[8:11], a[208:211], v[48:51]
    ds_read_b128 a[0:3], v247 offset:40960
    v_mfma_f32_16x16x32_bf16 v[120:123], a[8:11], a[212:215], v[120:123]
    s_add_u32 m0, s73, 6144
    s_nop 0
    buffer_load_dwordx4 v193, s[64:67], s72 offen lds
    s_waitcnt lgkmcnt(5)
    v_mfma_f32_16x16x32_bf16 v[16:19], a[12:15], a[216:219], v[16:19]
    ds_read_b128 a[4:7], v247 offset:41984
    v_mfma_f32_16x16x32_bf16 v[88:91], a[12:15], a[220:223], v[88:91]
    s_add_u32 m0, s80, 45056
    s_add_u32 s82, s81, 376832
    buffer_load_dwordx4 v5, s[20:23], s82 offen offset:0 sc1 lds
    s_waitcnt lgkmcnt(5)
    v_mfma_f32_16x16x32_bf16 v[20:23], a[16:19], a[216:219], v[20:23]
    ds_read_b128 a[8:11], v247 offset:43008
    v_mfma_f32_16x16x32_bf16 v[92:95], a[16:19], a[220:223], v[92:95]
    s_waitcnt lgkmcnt(5)
    v_mfma_f32_16x16x32_bf16 v[24:27], a[20:23], a[216:219], v[24:27]
    ds_read_b128 a[12:15], v247 offset:44032
    v_mfma_f32_16x16x32_bf16 v[96:99], a[20:23], a[220:223], v[96:99]
    ds_read_b128 a[184:187], v196 offset:8192
    ds_read_b128 a[188:191], v196 offset:8704
    s_waitcnt lgkmcnt(7)
    v_mfma_f32_16x16x32_bf16 v[28:31], a[24:27], a[216:219], v[28:31]
    v_mfma_f32_16x16x32_bf16 v[100:103], a[24:27], a[220:223], v[100:103]
    s_add_u32 m0, s73, 7168
    s_nop 0
    buffer_load_dwordx4 v194, s[64:67], s72 offen lds
    s_waitcnt lgkmcnt(6)
    v_mfma_f32_16x16x32_bf16 v[32:35], a[28:31], a[216:219], v[32:35]
    v_mfma_f32_16x16x32_bf16 v[104:107], a[28:31], a[220:223], v[104:107]
    s_waitcnt lgkmcnt(5)
    v_mfma_f32_16x16x32_bf16 v[36:39], a[0:3], a[216:219], v[36:39]
    v_mfma_f32_16x16x32_bf16 v[108:111], a[0:3], a[220:223], v[108:111]
    s_waitcnt lgkmcnt(0)
    s_barrier
    ds_read_b128 a[16:19], v246 offset:0
    s_add_u32 m0, s80, 73728
    s_add_u32 s82, s81, 405504
    buffer_load_dwordx4 v5, s[20:23], s82 offen offset:0 sc1 lds
    v_mfma_f32_16x16x32_bf16 v[40:43], a[4:7], a[216:219], v[40:43]
    ds_read_b128 a[20:23], v246 offset:1024
    v_mfma_f32_16x16x32_bf16 v[112:115], a[4:7], a[220:223], v[112:115]
    ds_read_b128 a[24:27], v246 offset:2048
    v_mfma_f32_16x16x32_bf16 v[44:47], a[8:11], a[216:219], v[44:47]
    ds_read_b128 a[28:31], v246 offset:3072
    v_mfma_f32_16x16x32_bf16 v[116:119], a[8:11], a[220:223], v[116:119]
    ds_read_b128 a[0:3], v246 offset:4096
    v_mfma_f32_16x16x32_bf16 v[48:51], a[12:15], a[216:219], v[48:51]
    ds_read_b128 a[4:7], v246 offset:5120
    v_mfma_f32_16x16x32_bf16 v[120:123], a[12:15], a[220:223], v[120:123]
    s_add_u32 m0, s73, 8192
    s_add_u32 s72, s72, 128
    buffer_load_dwordx4 v191, s[64:67], s72 offen lds
    s_waitcnt lgkmcnt(5)
    v_mfma_f32_16x16x32_bf16 v[16:19], a[16:19], a[224:227], v[16:19]
    ds_read_b128 a[8:11], v246 offset:6144
    v_mfma_f32_16x16x32_bf16 v[88:91], a[16:19], a[228:231], v[88:91]
    s_add_u32 m0, s80, 73728
    s_nop 0
    buffer_load_dwordx4 v5, s[20:23], s82 offen offset:1024 sc1 lds
    s_waitcnt lgkmcnt(5)
    v_mfma_f32_16x16x32_bf16 v[20:23], a[20:23], a[224:227], v[20:23]
    ds_read_b128 a[12:15], v246 offset:7168
    v_mfma_f32_16x16x32_bf16 v[92:95], a[20:23], a[228:231], v[92:95]
    s_waitcnt lgkmcnt(5)
    v_mfma_f32_16x16x32_bf16 v[24:27], a[24:27], a[224:227], v[24:27]
    ds_read_b128 a[16:19], v246 offset:8192
    v_mfma_f32_16x16x32_bf16 v[96:99], a[24:27], a[228:231], v[96:99]
    s_waitcnt vmcnt(11)
    ds_read_b128 a[192:195], v195 offset:0
    ds_read_b128 a[196:199], v195 offset:512
    s_waitcnt lgkmcnt(7)
    v_mfma_f32_16x16x32_bf16 v[28:31], a[28:31], a[224:227], v[28:31]
    ds_read_b128 a[20:23], v246 offset:9216
    v_mfma_f32_16x16x32_bf16 v[100:103], a[28:31], a[228:231], v[100:103]
    s_add_u32 m0, s80, 73728
    s_nop 0
    buffer_load_dwordx4 v5, s[20:23], s82 offen offset:2048 sc1 lds
    s_waitcnt lgkmcnt(7)
    v_mfma_f32_16x16x32_bf16 v[32:35], a[0:3], a[224:227], v[32:35]
    ds_read_b128 a[24:27], v246 offset:10240
    v_mfma_f32_16x16x32_bf16 v[104:107], a[0:3], a[228:231], v[104:107]
    s_add_u32 m0, s73, 9216
    s_nop 0
    buffer_load_dwordx4 v192, s[64:67], s72 offen lds
    s_waitcnt lgkmcnt(7)
    v_mfma_f32_16x16x32_bf16 v[36:39], a[4:7], a[224:227], v[36:39]
    ds_read_b128 a[28:31], v246 offset:11264
    v_mfma_f32_16x16x32_bf16 v[108:111], a[4:7], a[228:231], v[108:111]
    s_waitcnt lgkmcnt(7)
    v_mfma_f32_16x16x32_bf16 v[40:43], a[8:11], a[224:227], v[40:43]
    ds_read_b128 a[0:3], v246 offset:12288
    v_mfma_f32_16x16x32_bf16 v[112:115], a[8:11], a[228:231], v[112:115]
    s_waitcnt lgkmcnt(7)
    v_mfma_f32_16x16x32_bf16 v[44:47], a[12:15], a[224:227], v[44:47]
    ds_read_b128 a[4:7], v246 offset:13312
    v_mfma_f32_16x16x32_bf16 v[116:119], a[12:15], a[228:231], v[116:119]
    s_add_u32 m0, s80, 73728
    s_nop 0
    buffer_load_dwordx4 v5, s[20:23], s82 offen offset:3072 sc1 lds
    s_waitcnt lgkmcnt(5)
    v_mfma_f32_16x16x32_bf16 v[48:51], a[16:19], a[224:227], v[48:51]
    ds_read_b128 a[8:11], v246 offset:14336
    v_mfma_f32_16x16x32_bf16 v[120:123], a[16:19], a[228:231], v[120:123]
    s_add_u32 m0, s73, 10240
    s_nop 0
    buffer_load_dwordx4 v193, s[64:67], s72 offen lds
    s_waitcnt lgkmcnt(5)
    v_mfma_f32_16x16x32_bf16 v[16:19], a[20:23], a[232:235], v[16:19]
    ds_read_b128 a[12:15], v246 offset:15360
    v_mfma_f32_16x16x32_bf16 v[88:91], a[20:23], a[236:239], v[88:91]
    s_waitcnt lgkmcnt(5)
    v_mfma_f32_16x16x32_bf16 v[20:23], a[24:27], a[232:235], v[20:23]
    ds_read_b128 a[16:19], v246 offset:16384
    v_mfma_f32_16x16x32_bf16 v[92:95], a[24:27], a[236:239], v[92:95]
    s_waitcnt lgkmcnt(5)
    v_mfma_f32_16x16x32_bf16 v[24:27], a[28:31], a[232:235], v[24:27]
    ds_read_b128 a[20:23], v246 offset:17408
    v_mfma_f32_16x16x32_bf16 v[96:99], a[28:31], a[236:239], v[96:99]
    s_add_u32 m0, s80, 77824
    s_add_u32 s82, s81, 409600
    buffer_load_dwordx4 v5, s[20:23], s82 offen offset:0 sc1 lds
    ds_read_b128 a[200:203], v196 offset:0
    ds_read_b128 a[204:207], v196 offset:512
    s_waitcnt lgkmcnt(7)
    v_mfma_f32_16x16x32_bf16 v[28:31], a[0:3], a[232:235], v[28:31]
    ds_read_b128 a[24:27], v246 offset:18432
    v_mfma_f32_16x16x32_bf16 v[100:103], a[0:3], a[236:239], v[100:103]
    s_add_u32 m0, s73, 11264
    s_nop 0
    buffer_load_dwordx4 v194, s[64:67], s72 offen lds
    s_waitcnt lgkmcnt(7)
    v_mfma_f32_16x16x32_bf16 v[32:35], a[4:7], a[232:235], v[32:35]
    ds_read_b128 a[28:31], v246 offset:19456
    v_mfma_f32_16x16x32_bf16 v[104:107], a[4:7], a[236:239], v[104:107]
    s_waitcnt lgkmcnt(7)
    v_mfma_f32_16x16x32_bf16 v[36:39], a[8:11], a[232:235], v[36:39]
    ds_read_b128 a[0:3], v246 offset:20480
    v_mfma_f32_16x16x32_bf16 v[108:111], a[8:11], a[236:239], v[108:111]
    s_waitcnt lgkmcnt(7)
    v_mfma_f32_16x16x32_bf16 v[40:43], a[12:15], a[232:235], v[40:43]
    ds_read_b128 a[4:7], v246 offset:21504
    v_mfma_f32_16x16x32_bf16 v[112:115], a[12:15], a[236:239], v[112:115]
    s_add_u32 m0, s80, 77824
    s_nop 0
    buffer_load_dwordx4 v5, s[20:23], s82 offen offset:1024 sc1 lds
    s_waitcnt lgkmcnt(7)
    v_mfma_f32_16x16x32_bf16 v[44:47], a[16:19], a[232:235], v[44:47]
    ds_read_b128 a[8:11], v246 offset:22528
    v_mfma_f32_16x16x32_bf16 v[116:119], a[16:19], a[236:239], v[116:119]
    s_waitcnt lgkmcnt(5)
    v_mfma_f32_16x16x32_bf16 v[48:51], a[20:23], a[232:235], v[48:51]
    ds_read_b128 a[12:15], v246 offset:23552
    v_mfma_f32_16x16x32_bf16 v[120:123], a[20:23], a[236:239], v[120:123]
    s_add_u32 m0, s73, 0
    s_add_u32 s72, s72, 128
    buffer_load_dwordx4 v191, s[64:67], s72 offen lds
    s_waitcnt lgkmcnt(5)
    v_mfma_f32_16x16x32_bf16 v[16:19], a[24:27], a[240:243], v[16:19]
    ds_read_b128 a[16:19], v246 offset:24576
    v_mfma_f32_16x16x32_bf16 v[88:91], a[24:27], a[244:247], v[88:91]
    s_waitcnt lgkmcnt(5)
    v_mfma_f32_16x16x32_bf16 v[20:23], a[28:31], a[240:243], v[20:23]
    ds_read_b128 a[20:23], v246 offset:25600
    v_mfma_f32_16x16x32_bf16 v[92:95], a[28:31], a[244:247], v[92:95]
    s_add_u32 m0, s80, 77824
    s_nop 0
    buffer_load_dwordx4 v5, s[20:23], s82 offen offset:2048 sc1 lds
    s_waitcnt lgkmcnt(5)
    v_mfma_f32_16x16x32_bf16 v[24:27], a[0:3], a[240:243], v[24:27]
    ds_read_b128 a[24:27], v246 offset:26624
    v_mfma_f32_16x16x32_bf16 v[96:99], a[0:3], a[244:247], v[96:99]
    s_waitcnt vmcnt(12)
    ds_read_b128 a[208:211], v195 offset:4096
    ds_read_b128 a[212:215], v195 offset:4608
    s_waitcnt lgkmcnt(7)
    v_mfma_f32_16x16x32_bf16 v[28:31], a[4:7], a[240:243], v[28:31]
    ds_read_b128 a[28:31], v246 offset:27648
    v_mfma_f32_16x16x32_bf16 v[100:103], a[4:7], a[244:247], v[100:103]
    s_add_u32 m0, s73, 1024
    s_nop 0
    buffer_load_dwordx4 v192, s[64:67], s72 offen lds
    s_waitcnt lgkmcnt(7)
    v_mfma_f32_16x16x32_bf16 v[32:35], a[8:11], a[240:243], v[32:35]
    ds_read_b128 a[0:3], v246 offset:28672
    v_mfma_f32_16x16x32_bf16 v[104:107], a[8:11], a[244:247], v[104:107]
    s_waitcnt lgkmcnt(7)
    v_mfma_f32_16x16x32_bf16 v[36:39], a[12:15], a[240:243], v[36:39]
    ds_read_b128 a[4:7], v246 offset:29696
    v_mfma_f32_16x16x32_bf16 v[108:111], a[12:15], a[244:247], v[108:111]
    s_add_u32 m0, s80, 77824
    s_nop 0
    buffer_load_dwordx4 v5, s[20:23], s82 offen offset:3072 sc1 lds
    s_waitcnt lgkmcnt(7)
    v_mfma_f32_16x16x32_bf16 v[40:43], a[16:19], a[240:243], v[40:43]
    ds_read_b128 a[8:11], v246 offset:30720
    v_mfma_f32_16x16x32_bf16 v[112:115], a[16:19], a[244:247], v[112:115]
    s_waitcnt lgkmcnt(7)
    v_mfma_f32_16x16x32_bf16 v[44:47], a[20:23], a[240:243], v[44:47]
    ds_read_b128 a[12:15], v246 offset:31744
    v_mfma_f32_16x16x32_bf16 v[116:119], a[20:23], a[244:247], v[116:119]
    s_waitcnt lgkmcnt(5)
    v_mfma_f32_16x16x32_bf16 v[48:51], a[24:27], a[240:243], v[48:51]
    ds_read_b128 a[16:19], v246 offset:32768
    v_mfma_f32_16x16x32_bf16 v[120:123], a[24:27], a[244:247], v[120:123]
    s_add_u32 m0, s73, 2048
    s_nop 0
    buffer_load_dwordx4 v193, s[64:67], s72 offen lds
    s_waitcnt lgkmcnt(5)
    v_mfma_f32_16x16x32_bf16 v[16:19], a[28:31], a[248:251], v[16:19]
    ds_read_b128 a[20:23], v246 offset:33792
    v_mfma_f32_16x16x32_bf16 v[88:91], a[28:31], a[252:255], v[88:91]
    s_add_u32 m0, s80, 81920
    s_add_u32 s82, s81, 413696
    buffer_load_dwordx4 v5, s[20:23], s82 offen offset:0 sc1 lds
    s_waitcnt lgkmcnt(5)
    v_mfma_f32_16x16x32_bf16 v[20:23], a[0:3], a[248:251], v[20:23]
    ds_read_b128 a[24:27], v246 offset:34816
    v_mfma_f32_16x16x32_bf16 v[92:95], a[0:3], a[252:255], v[92:95]
    s_waitcnt lgkmcnt(5)
    v_mfma_f32_16x16x32_bf16 v[24:27], a[4:7], a[248:251], v[24:27]
    ds_read_b128 a[28:31], v246 offset:35840
    v_mfma_f32_16x16x32_bf16 v[96:99], a[4:7], a[252:255], v[96:99]
    ds_read_b128 a[216:219], v196 offset:4096
    ds_read_b128 a[220:223], v196 offset:4608
    s_waitcnt lgkmcnt(7)
    v_mfma_f32_16x16x32_bf16 v[28:31], a[8:11], a[248:251], v[28:31]
    v_mfma_f32_16x16x32_bf16 v[100:103], a[8:11], a[252:255], v[100:103]
    s_add_u32 m0, s73, 3072
    s_nop 0
    buffer_load_dwordx4 v194, s[64:67], s72 offen lds
    s_waitcnt lgkmcnt(6)
    v_mfma_f32_16x16x32_bf16 v[32:35], a[12:15], a[248:251], v[32:35]
    v_mfma_f32_16x16x32_bf16 v[104:107], a[12:15], a[252:255], v[104:107]
    s_waitcnt lgkmcnt(5)
    v_mfma_f32_16x16x32_bf16 v[36:39], a[16:19], a[248:251], v[36:39]
    v_mfma_f32_16x16x32_bf16 v[108:111], a[16:19], a[252:255], v[108:111]
    s_waitcnt lgkmcnt(0)
    s_barrier
    ds_read_b128 a[0:3], v246 offset:36864
    s_add_u32 m0, s80, 0
    s_add_u32 s82, s81, 442368
    buffer_load_dwordx4 v5, s[20:23], s82 offen offset:0 sc1 lds
    v_mfma_f32_16x16x32_bf16 v[40:43], a[20:23], a[248:251], v[40:43]
    ds_read_b128 a[4:7], v246 offset:37888
    v_mfma_f32_16x16x32_bf16 v[112:115], a[20:23], a[252:255], v[112:115]
    ds_read_b128 a[8:11], v246 offset:38912
    v_mfma_f32_16x16x32_bf16 v[44:47], a[24:27], a[248:251], v[44:47]
    ds_read_b128 a[12:15], v246 offset:39936
    v_mfma_f32_16x16x32_bf16 v[116:119], a[24:27], a[252:255], v[116:119]
    ds_read_b128 a[16:19], v246 offset:40960
    v_mfma_f32_16x16x32_bf16 v[48:51], a[28:31], a[248:251], v[48:51]
    ds_read_b128 a[20:23], v246 offset:41984
    v_mfma_f32_16x16x32_bf16 v[120:123], a[28:31], a[252:255], v[120:123]
    s_add_u32 m0, s73, 4096
    s_add_u32 s72, s72, 128
    buffer_load_dwordx4 v191, s[64:67], s72 offen lds
    s_waitcnt lgkmcnt(5)
    v_mfma_f32_16x16x32_bf16 v[16:19], a[0:3], a[176:179], v[16:19]
    ds_read_b128 a[24:27], v246 offset:43008
    v_mfma_f32_16x16x32_bf16 v[88:91], a[0:3], a[180:183], v[88:91]
    s_add_u32 m0, s80, 0
    s_nop 0
    buffer_load_dwordx4 v5, s[20:23], s82 offen offset:1024 sc1 lds
    s_waitcnt lgkmcnt(5)
    v_mfma_f32_16x16x32_bf16 v[20:23], a[4:7], a[176:179], v[20:23]
    ds_read_b128 a[28:31], v246 offset:44032
    v_mfma_f32_16x16x32_bf16 v[92:95], a[4:7], a[180:183], v[92:95]
    s_waitcnt lgkmcnt(5)
    v_mfma_f32_16x16x32_bf16 v[24:27], a[8:11], a[176:179], v[24:27]
    ds_read_b128 a[0:3], v246 offset:45056
    v_mfma_f32_16x16x32_bf16 v[96:99], a[8:11], a[180:183], v[96:99]
    s_waitcnt vmcnt(11)
    ds_read_b128 a[224:227], v195 offset:8192
    ds_read_b128 a[228:231], v195 offset:8704
    s_waitcnt lgkmcnt(7)
    v_mfma_f32_16x16x32_bf16 v[28:31], a[12:15], a[176:179], v[28:31]
    ds_read_b128 a[4:7], v246 offset:46080
    v_mfma_f32_16x16x32_bf16 v[100:103], a[12:15], a[180:183], v[100:103]
    s_add_u32 m0, s80, 0
    s_nop 0
    buffer_load_dwordx4 v5, s[20:23], s82 offen offset:2048 sc1 lds
    s_waitcnt lgkmcnt(7)
    v_mfma_f32_16x16x32_bf16 v[32:35], a[16:19], a[176:179], v[32:35]
    ds_read_b128 a[8:11], v246 offset:47104
    v_mfma_f32_16x16x32_bf16 v[104:107], a[16:19], a[180:183], v[104:107]
    s_add_u32 m0, s73, 5120
    s_nop 0
    buffer_load_dwordx4 v192, s[64:67], s72 offen lds
    s_waitcnt lgkmcnt(7)
    v_mfma_f32_16x16x32_bf16 v[36:39], a[20:23], a[176:179], v[36:39]
    ds_read_b128 a[12:15], v246 offset:48128
    v_mfma_f32_16x16x32_bf16 v[108:111], a[20:23], a[180:183], v[108:111]
    s_waitcnt lgkmcnt(7)
    v_mfma_f32_16x16x32_bf16 v[40:43], a[24:27], a[176:179], v[40:43]
    ds_read_b128 a[16:19], v246 offset:49152
    v_mfma_f32_16x16x32_bf16 v[112:115], a[24:27], a[180:183], v[112:115]
    s_waitcnt lgkmcnt(7)
    v_mfma_f32_16x16x32_bf16 v[44:47], a[28:31], a[176:179], v[44:47]
    ds_read_b128 a[20:23], v246 offset:50176
    v_mfma_f32_16x16x32_bf16 v[116:119], a[28:31], a[180:183], v[116:119]
    s_add_u32 m0, s80, 0
    s_nop 0
    buffer_load_dwordx4 v5, s[20:23], s82 offen offset:3072 sc1 lds
    s_waitcnt lgkmcnt(5)
    v_mfma_f32_16x16x32_bf16 v[48:51], a[0:3], a[176:179], v[48:51]
    ds_read_b128 a[24:27], v246 offset:51200
    v_mfma_f32_16x16x32_bf16 v[120:123], a[0:3], a[180:183], v[120:123]
    s_add_u32 m0, s73, 6144
    s_nop 0
    buffer_load_dwordx4 v193, s[64:67], s72 offen lds
    s_waitcnt lgkmcnt(5)
    v_mfma_f32_16x16x32_bf16 v[16:19], a[4:7], a[184:187], v[16:19]
    ds_read_b128 a[28:31], v246 offset:52224
    v_mfma_f32_16x16x32_bf16 v[88:91], a[4:7], a[188:191], v[88:91]
    s_waitcnt lgkmcnt(5)
    v_mfma_f32_16x16x32_bf16 v[20:23], a[8:11], a[184:187], v[20:23]
    ds_read_b128 a[0:3], v246 offset:53248
    v_mfma_f32_16x16x32_bf16 v[92:95], a[8:11], a[188:191], v[92:95]
    s_waitcnt lgkmcnt(5)
    v_mfma_f32_16x16x32_bf16 v[24:27], a[12:15], a[184:187], v[24:27]
    ds_read_b128 a[4:7], v246 offset:54272
    v_mfma_f32_16x16x32_bf16 v[96:99], a[12:15], a[188:191], v[96:99]
    s_add_u32 m0, s80, 4096
    s_add_u32 s82, s81, 446464
    buffer_load_dwordx4 v5, s[20:23], s82 offen offset:0 sc1 lds
    ds_read_b128 a[232:235], v196 offset:8192
    ds_read_b128 a[236:239], v196 offset:8704
    s_waitcnt lgkmcnt(7)
    v_mfma_f32_16x16x32_bf16 v[28:31], a[16:19], a[184:187], v[28:31]
    ds_read_b128 a[8:11], v246 offset:55296
    v_mfma_f32_16x16x32_bf16 v[100:103], a[16:19], a[188:191], v[100:103]
    s_add_u32 m0, s73, 7168
    s_nop 0
    buffer_load_dwordx4 v194, s[64:67], s72 offen lds
    s_waitcnt lgkmcnt(7)
    v_mfma_f32_16x16x32_bf16 v[32:35], a[20:23], a[184:187], v[32:35]
    ds_read_b128 a[12:15], v246 offset:56320
    v_mfma_f32_16x16x32_bf16 v[104:107], a[20:23], a[188:191], v[104:107]
    s_waitcnt lgkmcnt(7)
    v_mfma_f32_16x16x32_bf16 v[36:39], a[24:27], a[184:187], v[36:39]
    ds_read_b128 a[16:19], v246 offset:57344
    v_mfma_f32_16x16x32_bf16 v[108:111], a[24:27], a[188:191], v[108:111]
    s_waitcnt lgkmcnt(7)
    v_mfma_f32_16x16x32_bf16 v[40:43], a[28:31], a[184:187], v[40:43]
    ds_read_b128 a[20:23], v246 offset:58368
    v_mfma_f32_16x16x32_bf16 v[112:115], a[28:31], a[188:191], v[112:115]
    s_add_u32 m0, s80, 4096
    s_nop 0
    buffer_load_dwordx4 v5, s[20:23], s82 offen offset:1024 sc1 lds
    s_waitcnt lgkmcnt(7)
    v_mfma_f32_16x16x32_bf16 v[44:47], a[0:3], a[184:187], v[44:47]
    ds_read_b128 a[24:27], v246 offset:59392
    v_mfma_f32_16x16x32_bf16 v[116:119], a[0:3], a[188:191], v[116:119]
    s_waitcnt lgkmcnt(5)
    v_mfma_f32_16x16x32_bf16 v[48:51], a[4:7], a[184:187], v[48:51]
    ds_read_b128 a[28:31], v246 offset:60416
    v_mfma_f32_16x16x32_bf16 v[120:123], a[4:7], a[188:191], v[120:123]
    s_add_u32 m0, s73, 8192
    s_add_u32 s72, s72, 128
    buffer_load_dwordx4 v191, s[64:67], s72 offen lds
    s_waitcnt lgkmcnt(5)
    v_mfma_f32_16x16x32_bf16 v[16:19], a[8:11], a[192:195], v[16:19]
    ds_read_b128 a[0:3], v246 offset:61440
    v_mfma_f32_16x16x32_bf16 v[88:91], a[8:11], a[196:199], v[88:91]
    s_waitcnt lgkmcnt(5)
    v_mfma_f32_16x16x32_bf16 v[20:23], a[12:15], a[192:195], v[20:23]
    ds_read_b128 a[4:7], v246 offset:62464
    v_mfma_f32_16x16x32_bf16 v[92:95], a[12:15], a[196:199], v[92:95]
    s_add_u32 m0, s80, 4096
    s_nop 0
    buffer_load_dwordx4 v5, s[20:23], s82 offen offset:2048 sc1 lds
    s_waitcnt lgkmcnt(5)
    v_mfma_f32_16x16x32_bf16 v[24:27], a[16:19], a[192:195], v[24:27]
    ds_read_b128 a[8:11], v246 offset:63488
    v_mfma_f32_16x16x32_bf16 v[96:99], a[16:19], a[196:199], v[96:99]
    s_waitcnt vmcnt(12)
    ds_read_b128 a[240:243], v195 offset:0
    ds_read_b128 a[244:247], v195 offset:512
    s_waitcnt lgkmcnt(7)
    v_mfma_f32_16x16x32_bf16 v[28:31], a[20:23], a[192:195], v[28:31]
    ds_read_b128 a[12:15], v246 offset:64512
    v_mfma_f32_16x16x32_bf16 v[100:103], a[20:23], a[196:199], v[100:103]
    s_add_u32 m0, s73, 9216
    s_nop 0
    buffer_load_dwordx4 v192, s[64:67], s72 offen lds
    s_waitcnt lgkmcnt(7)
    v_mfma_f32_16x16x32_bf16 v[32:35], a[24:27], a[192:195], v[32:35]
    ds_read_b128 a[16:19], v247 offset:0
    v_mfma_f32_16x16x32_bf16 v[104:107], a[24:27], a[196:199], v[104:107]
    s_waitcnt lgkmcnt(7)
    v_mfma_f32_16x16x32_bf16 v[36:39], a[28:31], a[192:195], v[36:39]
    ds_read_b128 a[20:23], v247 offset:1024
    v_mfma_f32_16x16x32_bf16 v[108:111], a[28:31], a[196:199], v[108:111]
    s_add_u32 m0, s80, 4096
    s_nop 0
    buffer_load_dwordx4 v5, s[20:23], s82 offen offset:3072 sc1 lds
    s_waitcnt lgkmcnt(7)
    v_mfma_f32_16x16x32_bf16 v[40:43], a[0:3], a[192:195], v[40:43]
    ds_read_b128 a[24:27], v247 offset:2048
    v_mfma_f32_16x16x32_bf16 v[112:115], a[0:3], a[196:199], v[112:115]
    s_waitcnt lgkmcnt(7)
    v_mfma_f32_16x16x32_bf16 v[44:47], a[4:7], a[192:195], v[44:47]
    ds_read_b128 a[28:31], v247 offset:3072
    v_mfma_f32_16x16x32_bf16 v[116:119], a[4:7], a[196:199], v[116:119]
    s_waitcnt lgkmcnt(5)
    v_mfma_f32_16x16x32_bf16 v[48:51], a[8:11], a[192:195], v[48:51]
    ds_read_b128 a[0:3], v247 offset:4096
    v_mfma_f32_16x16x32_bf16 v[120:123], a[8:11], a[196:199], v[120:123]
    s_add_u32 m0, s73, 10240
    s_nop 0
    buffer_load_dwordx4 v193, s[64:67], s72 offen lds
    s_waitcnt lgkmcnt(5)
    v_mfma_f32_16x16x32_bf16 v[16:19], a[12:15], a[200:203], v[16:19]
    ds_read_b128 a[4:7], v247 offset:5120
    v_mfma_f32_16x16x32_bf16 v[88:91], a[12:15], a[204:207], v[88:91]
    s_add_u32 m0, s80, 8192
    s_add_u32 s82, s81, 450560
    buffer_load_dwordx4 v5, s[20:23], s82 offen offset:0 sc1 lds
    s_waitcnt lgkmcnt(5)
    v_mfma_f32_16x16x32_bf16 v[20:23], a[16:19], a[200:203], v[20:23]
    ds_read_b128 a[8:11], v247 offset:6144
    v_mfma_f32_16x16x32_bf16 v[92:95], a[16:19], a[204:207], v[92:95]
    s_waitcnt lgkmcnt(5)
    v_mfma_f32_16x16x32_bf16 v[24:27], a[20:23], a[200:203], v[24:27]
    ds_read_b128 a[12:15], v247 offset:7168
    v_mfma_f32_16x16x32_bf16 v[96:99], a[20:23], a[204:207], v[96:99]
    ds_read_b128 a[248:251], v196 offset:0
    ds_read_b128 a[252:255], v196 offset:512
    s_waitcnt lgkmcnt(7)
    v_mfma_f32_16x16x32_bf16 v[28:31], a[24:27], a[200:203], v[28:31]
    v_mfma_f32_16x16x32_bf16 v[100:103], a[24:27], a[204:207], v[100:103]
    s_add_u32 m0, s73, 11264
    s_nop 0
    buffer_load_dwordx4 v194, s[64:67], s72 offen lds
    s_waitcnt lgkmcnt(6)
    v_mfma_f32_16x16x32_bf16 v[32:35], a[28:31], a[200:203], v[32:35]
    v_mfma_f32_16x16x32_bf16 v[104:107], a[28:31], a[204:207], v[104:107]
    s_waitcnt lgkmcnt(5)
    v_mfma_f32_16x16x32_bf16 v[36:39], a[0:3], a[200:203], v[36:39]
    v_mfma_f32_16x16x32_bf16 v[108:111], a[0:3], a[204:207], v[108:111]
    s_waitcnt lgkmcnt(0)
    s_barrier
    ds_read_b128 a[16:19], v247 offset:8192
    s_add_u32 m0, s80, 36864
    s_add_u32 s82, s81, 479232
    buffer_load_dwordx4 v5, s[20:23], s82 offen offset:0 sc1 lds
    v_mfma_f32_16x16x32_bf16 v[40:43], a[4:7], a[200:203], v[40:43]
    ds_read_b128 a[20:23], v247 offset:9216
    v_mfma_f32_16x16x32_bf16 v[112:115], a[4:7], a[204:207], v[112:115]
    ds_read_b128 a[24:27], v247 offset:10240
    v_mfma_f32_16x16x32_bf16 v[44:47], a[8:11], a[200:203], v[44:47]
    ds_read_b128 a[28:31], v247 offset:11264
    v_mfma_f32_16x16x32_bf16 v[116:119], a[8:11], a[204:207], v[116:119]
    ds_read_b128 a[0:3], v247 offset:12288
    v_mfma_f32_16x16x32_bf16 v[48:51], a[12:15], a[200:203], v[48:51]
    ds_read_b128 a[4:7], v247 offset:13312
    v_mfma_f32_16x16x32_bf16 v[120:123], a[12:15], a[204:207], v[120:123]
    s_add_u32 m0, s73, 0
    s_add_u32 s72, s72, 128
    buffer_load_dwordx4 v191, s[64:67], s72 offen lds
    s_waitcnt lgkmcnt(5)
    v_mfma_f32_16x16x32_bf16 v[16:19], a[16:19], a[208:211], v[16:19]
    ds_read_b128 a[8:11], v247 offset:14336
    v_mfma_f32_16x16x32_bf16 v[88:91], a[16:19], a[212:215], v[88:91]
    s_add_u32 m0, s80, 36864
    s_nop 0
    buffer_load_dwordx4 v5, s[20:23], s82 offen offset:1024 sc1 lds
    s_waitcnt lgkmcnt(5)
    v_mfma_f32_16x16x32_bf16 v[20:23], a[20:23], a[208:211], v[20:23]
    ds_read_b128 a[12:15], v247 offset:15360
    v_mfma_f32_16x16x32_bf16 v[92:95], a[20:23], a[212:215], v[92:95]
    s_waitcnt lgkmcnt(5)
    v_mfma_f32_16x16x32_bf16 v[24:27], a[24:27], a[208:211], v[24:27]
    ds_read_b128 a[16:19], v247 offset:16384
    v_mfma_f32_16x16x32_bf16 v[96:99], a[24:27], a[212:215], v[96:99]
    s_waitcnt vmcnt(11)
    ds_read_b128 a[176:179], v195 offset:4096
    ds_read_b128 a[180:183], v195 offset:4608
    s_waitcnt lgkmcnt(7)
    v_mfma_f32_16x16x32_bf16 v[28:31], a[28:31], a[208:211], v[28:31]
    ds_read_b128 a[20:23], v247 offset:17408
    v_mfma_f32_16x16x32_bf16 v[100:103], a[28:31], a[212:215], v[100:103]
    s_add_u32 m0, s80, 36864
    s_nop 0
    buffer_load_dwordx4 v5, s[20:23], s82 offen offset:2048 sc1 lds
    s_waitcnt lgkmcnt(7)
    v_mfma_f32_16x16x32_bf16 v[32:35], a[0:3], a[208:211], v[32:35]
    ds_read_b128 a[24:27], v247 offset:18432
    v_mfma_f32_16x16x32_bf16 v[104:107], a[0:3], a[212:215], v[104:107]
    s_add_u32 m0, s73, 1024
    s_nop 0
    buffer_load_dwordx4 v192, s[64:67], s72 offen lds
    s_waitcnt lgkmcnt(7)
    v_mfma_f32_16x16x32_bf16 v[36:39], a[4:7], a[208:211], v[36:39]
    ds_read_b128 a[28:31], v247 offset:19456
    v_mfma_f32_16x16x32_bf16 v[108:111], a[4:7], a[212:215], v[108:111]
    s_waitcnt lgkmcnt(7)
    v_mfma_f32_16x16x32_bf16 v[40:43], a[8:11], a[208:211], v[40:43]
    ds_read_b128 a[0:3], v247 offset:20480
    v_mfma_f32_16x16x32_bf16 v[112:115], a[8:11], a[212:215], v[112:115]
    s_waitcnt lgkmcnt(7)
    v_mfma_f32_16x16x32_bf16 v[44:47], a[12:15], a[208:211], v[44:47]
    ds_read_b128 a[4:7], v247 offset:21504
    v_mfma_f32_16x16x32_bf16 v[116:119], a[12:15], a[212:215], v[116:119]
    s_add_u32 m0, s80, 36864
    s_nop 0
    buffer_load_dwordx4 v5, s[20:23], s82 offen offset:3072 sc1 lds
    s_waitcnt lgkmcnt(5)
    v_mfma_f32_16x16x32_bf16 v[48:51], a[16:19], a[208:211], v[48:51]
    ds_read_b128 a[8:11], v247 offset:22528
    v_mfma_f32_16x16x32_bf16 v[120:123], a[16:19], a[212:215], v[120:123]
    s_add_u32 m0, s73, 2048
    s_nop 0
    buffer_load_dwordx4 v193, s[64:67], s72 offen lds
    s_waitcnt lgkmcnt(5)
    v_mfma_f32_16x16x32_bf16 v[16:19], a[20:23], a[216:219], v[16:19]
    ds_read_b128 a[12:15], v247 offset:23552
    v_mfma_f32_16x16x32_bf16 v[88:91], a[20:23], a[220:223], v[88:91]
    s_waitcnt lgkmcnt(5)
    v_mfma_f32_16x16x32_bf16 v[20:23], a[24:27], a[216:219], v[20:23]
    ds_read_b128 a[16:19], v247 offset:24576
    v_mfma_f32_16x16x32_bf16 v[92:95], a[24:27], a[220:223], v[92:95]
    s_waitcnt lgkmcnt(5)
    v_mfma_f32_16x16x32_bf16 v[24:27], a[28:31], a[216:219], v[24:27]
    ds_read_b128 a[20:23], v247 offset:25600
    v_mfma_f32_16x16x32_bf16 v[96:99], a[28:31], a[220:223], v[96:99]
    s_add_u32 m0, s80, 40960
    s_add_u32 s82, s81, 483328
    buffer_load_dwordx4 v5, s[20:23], s82 offen offset:0 sc1 lds
    ds_read_b128 a[184:187], v196 offset:4096
    ds_read_b128 a[188:191], v196 offset:4608
    s_waitcnt lgkmcnt(7)
    v_mfma_f32_16x16x32_bf16 v[28:31], a[0:3], a[216:219], v[28:31]
    ds_read_b128 a[24:27], v247 offset:26624
    v_mfma_f32_16x16x32_bf16 v[100:103], a[0:3], a[220:223], v[100:103]
    s_add_u32 m0, s73, 3072
    s_nop 0
    buffer_load_dwordx4 v194, s[64:67], s72 offen lds
    s_waitcnt lgkmcnt(7)
    v_mfma_f32_16x16x32_bf16 v[32:35], a[4:7], a[216:219], v[32:35]
    ds_read_b128 a[28:31], v247 offset:27648
    v_mfma_f32_16x16x32_bf16 v[104:107], a[4:7], a[220:223], v[104:107]
    s_waitcnt lgkmcnt(7)
    v_mfma_f32_16x16x32_bf16 v[36:39], a[8:11], a[216:219], v[36:39]
    ds_read_b128 a[0:3], v247 offset:28672
    v_mfma_f32_16x16x32_bf16 v[108:111], a[8:11], a[220:223], v[108:111]
    s_waitcnt lgkmcnt(7)
    v_mfma_f32_16x16x32_bf16 v[40:43], a[12:15], a[216:219], v[40:43]
    ds_read_b128 a[4:7], v247 offset:29696
    v_mfma_f32_16x16x32_bf16 v[112:115], a[12:15], a[220:223], v[112:115]
    s_add_u32 m0, s80, 40960
    s_nop 0
    buffer_load_dwordx4 v5, s[20:23], s82 offen offset:1024 sc1 lds
    s_waitcnt lgkmcnt(7)
    v_mfma_f32_16x16x32_bf16 v[44:47], a[16:19], a[216:219], v[44:47]
    ds_read_b128 a[8:11], v247 offset:30720
    v_mfma_f32_16x16x32_bf16 v[116:119], a[16:19], a[220:223], v[116:119]
    s_waitcnt lgkmcnt(5)
    v_mfma_f32_16x16x32_bf16 v[48:51], a[20:23], a[216:219], v[48:51]
    ds_read_b128 a[12:15], v247 offset:31744
    v_mfma_f32_16x16x32_bf16 v[120:123], a[20:23], a[220:223], v[120:123]
    s_add_u32 m0, s73, 4096
    s_add_u32 s72, s72, 128
    buffer_load_dwordx4 v191, s[64:67], s72 offen lds
    s_waitcnt lgkmcnt(5)
    v_mfma_f32_16x16x32_bf16 v[16:19], a[24:27], a[224:227], v[16:19]
    ds_read_b128 a[16:19], v247 offset:32768
    v_mfma_f32_16x16x32_bf16 v[88:91], a[24:27], a[228:231], v[88:91]
    s_waitcnt lgkmcnt(5)
    v_mfma_f32_16x16x32_bf16 v[20:23], a[28:31], a[224:227], v[20:23]
    ds_read_b128 a[20:23], v247 offset:33792
    v_mfma_f32_16x16x32_bf16 v[92:95], a[28:31], a[228:231], v[92:95]
    s_add_u32 m0, s80, 40960
    s_nop 0
    buffer_load_dwordx4 v5, s[20:23], s82 offen offset:2048 sc1 lds
    s_waitcnt lgkmcnt(5)
    v_mfma_f32_16x16x32_bf16 v[24:27], a[0:3], a[224:227], v[24:27]
    ds_read_b128 a[24:27], v247 offset:34816
    v_mfma_f32_16x16x32_bf16 v[96:99], a[0:3], a[228:231], v[96:99]
    s_waitcnt vmcnt(12)
    ds_read_b128 a[192:195], v195 offset:8192
    ds_read_b128 a[196:199], v195 offset:8704
    s_waitcnt lgkmcnt(7)
    v_mfma_f32_16x16x32_bf16 v[28:31], a[4:7], a[224:227], v[28:31]
    ds_read_b128 a[28:31], v247 offset:35840
    v_mfma_f32_16x16x32_bf16 v[100:103], a[4:7], a[228:231], v[100:103]
    s_add_u32 m0, s73, 5120
    s_nop 0
    buffer_load_dwordx4 v192, s[64:67], s72 offen lds
    s_waitcnt lgkmcnt(7)
    v_mfma_f32_16x16x32_bf16 v[32:35], a[8:11], a[224:227], v[32:35]
    ds_read_b128 a[0:3], v247 offset:36864
    v_mfma_f32_16x16x32_bf16 v[104:107], a[8:11], a[228:231], v[104:107]
    s_waitcnt lgkmcnt(7)
    v_mfma_f32_16x16x32_bf16 v[36:39], a[12:15], a[224:227], v[36:39]
    ds_read_b128 a[4:7], v247 offset:37888
    v_mfma_f32_16x16x32_bf16 v[108:111], a[12:15], a[228:231], v[108:111]
    s_add_u32 m0, s80, 40960
    s_nop 0
    buffer_load_dwordx4 v5, s[20:23], s82 offen offset:3072 sc1 lds
    s_waitcnt lgkmcnt(7)
    v_mfma_f32_16x16x32_bf16 v[40:43], a[16:19], a[224:227], v[40:43]
    ds_read_b128 a[8:11], v247 offset:38912
    v_mfma_f32_16x16x32_bf16 v[112:115], a[16:19], a[228:231], v[112:115]
    s_waitcnt lgkmcnt(7)
    v_mfma_f32_16x16x32_bf16 v[44:47], a[20:23], a[224:227], v[44:47]
    ds_read_b128 a[12:15], v247 offset:39936
    v_mfma_f32_16x16x32_bf16 v[116:119], a[20:23], a[228:231], v[116:119]
    s_waitcnt lgkmcnt(5)
    v_mfma_f32_16x16x32_bf16 v[48:51], a[24:27], a[224:227], v[48:51]
    ds_read_b128 a[16:19], v247 offset:40960
    v_mfma_f32_16x16x32_bf16 v[120:123], a[24:27], a[228:231], v[120:123]
    s_add_u32 m0, s73, 6144
    s_nop 0
    buffer_load_dwordx4 v193, s[64:67], s72 offen lds
    s_waitcnt lgkmcnt(5)
    v_mfma_f32_16x16x32_bf16 v[16:19], a[28:31], a[232:235], v[16:19]
    ds_read_b128 a[20:23], v247 offset:41984
    v_mfma_f32_16x16x32_bf16 v[88:91], a[28:31], a[236:239], v[88:91]
    s_add_u32 m0, s80, 45056
    s_add_u32 s82, s81, 487424
    buffer_load_dwordx4 v5, s[20:23], s82 offen offset:0 sc1 lds
    s_waitcnt lgkmcnt(5)
    v_mfma_f32_16x16x32_bf16 v[20:23], a[0:3], a[232:235], v[20:23]
    ds_read_b128 a[24:27], v247 offset:43008
    v_mfma_f32_16x16x32_bf16 v[92:95], a[0:3], a[236:239], v[92:95]
    s_waitcnt lgkmcnt(5)
    v_mfma_f32_16x16x32_bf16 v[24:27], a[4:7], a[232:235], v[24:27]
    ds_read_b128 a[28:31], v247 offset:44032
    v_mfma_f32_16x16x32_bf16 v[96:99], a[4:7], a[236:239], v[96:99]
    ds_read_b128 a[200:203], v196 offset:8192
    ds_read_b128 a[204:207], v196 offset:8704
    s_waitcnt lgkmcnt(7)
    v_mfma_f32_16x16x32_bf16 v[28:31], a[8:11], a[232:235], v[28:31]
    v_mfma_f32_16x16x32_bf16 v[100:103], a[8:11], a[236:239], v[100:103]
    s_add_u32 m0, s73, 7168
    s_nop 0
    buffer_load_dwordx4 v194, s[64:67], s72 offen lds
    s_waitcnt lgkmcnt(6)
    v_mfma_f32_16x16x32_bf16 v[32:35], a[12:15], a[232:235], v[32:35]
    v_mfma_f32_16x16x32_bf16 v[104:107], a[12:15], a[236:239], v[104:107]
    s_waitcnt lgkmcnt(5)
    v_mfma_f32_16x16x32_bf16 v[36:39], a[16:19], a[232:235], v[36:39]
    v_mfma_f32_16x16x32_bf16 v[108:111], a[16:19], a[236:239], v[108:111]
    s_waitcnt lgkmcnt(0)
    s_barrier
    ds_read_b128 a[0:3], v246 offset:0
    s_add_u32 m0, s80, 73728
    s_add_u32 s82, s81, 516096
    buffer_load_dwordx4 v5, s[20:23], s82 offen offset:0 sc1 lds
    v_mfma_f32_16x16x32_bf16 v[40:43], a[20:23], a[232:235], v[40:43]
    ds_read_b128 a[4:7], v246 offset:1024
    v_mfma_f32_16x16x32_bf16 v[112:115], a[20:23], a[236:239], v[112:115]
    ds_read_b128 a[8:11], v246 offset:2048
    v_mfma_f32_16x16x32_bf16 v[44:47], a[24:27], a[232:235], v[44:47]
    ds_read_b128 a[12:15], v246 offset:3072
    v_mfma_f32_16x16x32_bf16 v[116:119], a[24:27], a[236:239], v[116:119]
    ds_read_b128 a[16:19], v246 offset:4096
    v_mfma_f32_16x16x32_bf16 v[48:51], a[28:31], a[232:235], v[48:51]
    ds_read_b128 a[20:23], v246 offset:5120
    v_mfma_f32_16x16x32_bf16 v[120:123], a[28:31], a[236:239], v[120:123]
    s_add_u32 m0, s73, 8192
    s_add_u32 s72, s72, 128
    buffer_load_dwordx4 v191, s[64:67], s72 offen lds
    s_waitcnt lgkmcnt(5)
    v_mfma_f32_16x16x32_bf16 v[16:19], a[0:3], a[240:243], v[16:19]
    ds_read_b128 a[24:27], v246 offset:6144
    v_mfma_f32_16x16x32_bf16 v[88:91], a[0:3], a[244:247], v[88:91]
    s_add_u32 m0, s80, 73728
    s_nop 0
    buffer_load_dwordx4 v5, s[20:23], s82 offen offset:1024 sc1 lds
    s_waitcnt lgkmcnt(5)
    v_mfma_f32_16x16x32_bf16 v[20:23], a[4:7], a[240:243], v[20:23]
    ds_read_b128 a[28:31], v246 offset:7168
    v_mfma_f32_16x16x32_bf16 v[92:95], a[4:7], a[244:247], v[92:95]
    s_waitcnt lgkmcnt(5)
    v_mfma_f32_16x16x32_bf16 v[24:27], a[8:11], a[240:243], v[24:27]
    ds_read_b128 a[0:3], v246 offset:8192
    v_mfma_f32_16x16x32_bf16 v[96:99], a[8:11], a[244:247], v[96:99]
    s_waitcnt vmcnt(11)
    ds_read_b128 a[208:211], v195 offset:0
    ds_read_b128 a[212:215], v195 offset:512
    s_waitcnt lgkmcnt(7)
    v_mfma_f32_16x16x32_bf16 v[28:31], a[12:15], a[240:243], v[28:31]
    ds_read_b128 a[4:7], v246 offset:9216
    v_mfma_f32_16x16x32_bf16 v[100:103], a[12:15], a[244:247], v[100:103]
    s_add_u32 m0, s80, 73728
    s_nop 0
    buffer_load_dwordx4 v5, s[20:23], s82 offen offset:2048 sc1 lds
    s_waitcnt lgkmcnt(7)
    v_mfma_f32_16x16x32_bf16 v[32:35], a[16:19], a[240:243], v[32:35]
    ds_read_b128 a[8:11], v246 offset:10240
    v_mfma_f32_16x16x32_bf16 v[104:107], a[16:19], a[244:247], v[104:107]
    s_add_u32 m0, s73, 9216
    s_nop 0
    buffer_load_dwordx4 v192, s[64:67], s72 offen lds
    s_waitcnt lgkmcnt(7)
    v_mfma_f32_16x16x32_bf16 v[36:39], a[20:23], a[240:243], v[36:39]
    ds_read_b128 a[12:15], v246 offset:11264
    v_mfma_f32_16x16x32_bf16 v[108:111], a[20:23], a[244:247], v[108:111]
    s_waitcnt lgkmcnt(7)
    v_mfma_f32_16x16x32_bf16 v[40:43], a[24:27], a[240:243], v[40:43]
    ds_read_b128 a[16:19], v246 offset:12288
    v_mfma_f32_16x16x32_bf16 v[112:115], a[24:27], a[244:247], v[112:115]
    s_waitcnt lgkmcnt(7)
    v_mfma_f32_16x16x32_bf16 v[44:47], a[28:31], a[240:243], v[44:47]
    ds_read_b128 a[20:23], v246 offset:13312
    v_mfma_f32_16x16x32_bf16 v[116:119], a[28:31], a[244:247], v[116:119]
    s_add_u32 m0, s80, 73728
    s_nop 0
    buffer_load_dwordx4 v5, s[20:23], s82 offen offset:3072 sc1 lds
    s_waitcnt lgkmcnt(5)
    v_mfma_f32_16x16x32_bf16 v[48:51], a[0:3], a[240:243], v[48:51]
    ds_read_b128 a[24:27], v246 offset:14336
    v_mfma_f32_16x16x32_bf16 v[120:123], a[0:3], a[244:247], v[120:123]
    s_add_u32 m0, s73, 10240
    s_nop 0
    buffer_load_dwordx4 v193, s[64:67], s72 offen lds
    s_waitcnt lgkmcnt(5)
    v_mfma_f32_16x16x32_bf16 v[16:19], a[4:7], a[248:251], v[16:19]
    ds_read_b128 a[28:31], v246 offset:15360
    v_mfma_f32_16x16x32_bf16 v[88:91], a[4:7], a[252:255], v[88:91]
    s_waitcnt lgkmcnt(5)
    v_mfma_f32_16x16x32_bf16 v[20:23], a[8:11], a[248:251], v[20:23]
    ds_read_b128 a[0:3], v246 offset:16384
    v_mfma_f32_16x16x32_bf16 v[92:95], a[8:11], a[252:255], v[92:95]
    s_waitcnt lgkmcnt(5)
    v_mfma_f32_16x16x32_bf16 v[24:27], a[12:15], a[248:251], v[24:27]
    ds_read_b128 a[4:7], v246 offset:17408
    v_mfma_f32_16x16x32_bf16 v[96:99], a[12:15], a[252:255], v[96:99]
    s_add_u32 m0, s80, 77824
    s_add_u32 s82, s81, 520192
    buffer_load_dwordx4 v5, s[20:23], s82 offen offset:0 sc1 lds
    ds_read_b128 a[216:219], v196 offset:0
    ds_read_b128 a[220:223], v196 offset:512
    s_waitcnt lgkmcnt(7)
    v_mfma_f32_16x16x32_bf16 v[28:31], a[16:19], a[248:251], v[28:31]
    ds_read_b128 a[8:11], v246 offset:18432
    v_mfma_f32_16x16x32_bf16 v[100:103], a[16:19], a[252:255], v[100:103]
    s_add_u32 m0, s73, 11264
    s_nop 0
    buffer_load_dwordx4 v194, s[64:67], s72 offen lds
    s_waitcnt lgkmcnt(7)
    v_mfma_f32_16x16x32_bf16 v[32:35], a[20:23], a[248:251], v[32:35]
    ds_read_b128 a[12:15], v246 offset:19456
    v_mfma_f32_16x16x32_bf16 v[104:107], a[20:23], a[252:255], v[104:107]
    s_waitcnt lgkmcnt(7)
    v_mfma_f32_16x16x32_bf16 v[36:39], a[24:27], a[248:251], v[36:39]
    ds_read_b128 a[16:19], v246 offset:20480
    v_mfma_f32_16x16x32_bf16 v[108:111], a[24:27], a[252:255], v[108:111]
    s_waitcnt lgkmcnt(7)
    v_mfma_f32_16x16x32_bf16 v[40:43], a[28:31], a[248:251], v[40:43]
    ds_read_b128 a[20:23], v246 offset:21504
    v_mfma_f32_16x16x32_bf16 v[112:115], a[28:31], a[252:255], v[112:115]
    s_add_u32 m0, s80, 77824
    s_nop 0
    buffer_load_dwordx4 v5, s[20:23], s82 offen offset:1024 sc1 lds
    s_waitcnt lgkmcnt(7)
    v_mfma_f32_16x16x32_bf16 v[44:47], a[0:3], a[248:251], v[44:47]
    ds_read_b128 a[24:27], v246 offset:22528
    v_mfma_f32_16x16x32_bf16 v[116:119], a[0:3], a[252:255], v[116:119]
    s_waitcnt lgkmcnt(5)
    v_mfma_f32_16x16x32_bf16 v[48:51], a[4:7], a[248:251], v[48:51]
    ds_read_b128 a[28:31], v246 offset:23552
    v_mfma_f32_16x16x32_bf16 v[120:123], a[4:7], a[252:255], v[120:123]
    s_add_u32 m0, s73, 0
    s_add_u32 s72, s72, 128
    buffer_load_dwordx4 v191, s[64:67], s72 offen lds
    s_waitcnt lgkmcnt(5)
    v_mfma_f32_16x16x32_bf16 v[16:19], a[8:11], a[176:179], v[16:19]
    ds_read_b128 a[0:3], v246 offset:24576
    v_mfma_f32_16x16x32_bf16 v[88:91], a[8:11], a[180:183], v[88:91]
    s_waitcnt lgkmcnt(5)
    v_mfma_f32_16x16x32_bf16 v[20:23], a[12:15], a[176:179], v[20:23]
    ds_read_b128 a[4:7], v246 offset:25600
    v_mfma_f32_16x16x32_bf16 v[92:95], a[12:15], a[180:183], v[92:95]
    s_add_u32 m0, s80, 77824
    s_nop 0
    buffer_load_dwordx4 v5, s[20:23], s82 offen offset:2048 sc1 lds
    s_waitcnt lgkmcnt(5)
    v_mfma_f32_16x16x32_bf16 v[24:27], a[16:19], a[176:179], v[24:27]
    ds_read_b128 a[8:11], v246 offset:26624
    v_mfma_f32_16x16x32_bf16 v[96:99], a[16:19], a[180:183], v[96:99]
    s_waitcnt vmcnt(12)
    ds_read_b128 a[224:227], v195 offset:4096
    ds_read_b128 a[228:231], v195 offset:4608
    s_waitcnt lgkmcnt(7)
    v_mfma_f32_16x16x32_bf16 v[28:31], a[20:23], a[176:179], v[28:31]
    ds_read_b128 a[12:15], v246 offset:27648
    v_mfma_f32_16x16x32_bf16 v[100:103], a[20:23], a[180:183], v[100:103]
    s_add_u32 m0, s73, 1024
    s_nop 0
    buffer_load_dwordx4 v192, s[64:67], s72 offen lds
    s_waitcnt lgkmcnt(7)
    v_mfma_f32_16x16x32_bf16 v[32:35], a[24:27], a[176:179], v[32:35]
    ds_read_b128 a[16:19], v246 offset:28672
    v_mfma_f32_16x16x32_bf16 v[104:107], a[24:27], a[180:183], v[104:107]
    s_waitcnt lgkmcnt(7)
    v_mfma_f32_16x16x32_bf16 v[36:39], a[28:31], a[176:179], v[36:39]
    ds_read_b128 a[20:23], v246 offset:29696
    v_mfma_f32_16x16x32_bf16 v[108:111], a[28:31], a[180:183], v[108:111]
    s_add_u32 m0, s80, 77824
    s_nop 0
    buffer_load_dwordx4 v5, s[20:23], s82 offen offset:3072 sc1 lds
    s_waitcnt lgkmcnt(7)
    v_mfma_f32_16x16x32_bf16 v[40:43], a[0:3], a[176:179], v[40:43]
    ds_read_b128 a[24:27], v246 offset:30720
    v_mfma_f32_16x16x32_bf16 v[112:115], a[0:3], a[180:183], v[112:115]
    s_waitcnt lgkmcnt(7)
    v_mfma_f32_16x16x32_bf16 v[44:47], a[4:7], a[176:179], v[44:47]
    ds_read_b128 a[28:31], v246 offset:31744
    v_mfma_f32_16x16x32_bf16 v[116:119], a[4:7], a[180:183], v[116:119]
    s_waitcnt lgkmcnt(5)
    v_mfma_f32_16x16x32_bf16 v[48:51], a[8:11], a[176:179], v[48:51]
    ds_read_b128 a[0:3], v246 offset:32768
    v_mfma_f32_16x16x32_bf16 v[120:123], a[8:11], a[180:183], v[120:123]
    s_add_u32 m0, s73, 2048
    s_nop 0
    buffer_load_dwordx4 v193, s[64:67], s72 offen lds
    s_waitcnt lgkmcnt(5)
    v_mfma_f32_16x16x32_bf16 v[16:19], a[12:15], a[184:187], v[16:19]
    ds_read_b128 a[4:7], v246 offset:33792
    v_mfma_f32_16x16x32_bf16 v[88:91], a[12:15], a[188:191], v[88:91]
    s_add_u32 m0, s80, 81920
    s_add_u32 s82, s81, 524288
    buffer_load_dwordx4 v5, s[20:23], s82 offen offset:0 sc1 lds
    s_waitcnt lgkmcnt(5)
    v_mfma_f32_16x16x32_bf16 v[20:23], a[16:19], a[184:187], v[20:23]
    ds_read_b128 a[8:11], v246 offset:34816
    v_mfma_f32_16x16x32_bf16 v[92:95], a[16:19], a[188:191], v[92:95]
    s_waitcnt lgkmcnt(5)
    v_mfma_f32_16x16x32_bf16 v[24:27], a[20:23], a[184:187], v[24:27]
    ds_read_b128 a[12:15], v246 offset:35840
    v_mfma_f32_16x16x32_bf16 v[96:99], a[20:23], a[188:191], v[96:99]
    ds_read_b128 a[232:235], v196 offset:4096
    ds_read_b128 a[236:239], v196 offset:4608
    s_waitcnt lgkmcnt(7)
    v_mfma_f32_16x16x32_bf16 v[28:31], a[24:27], a[184:187], v[28:31]
    v_mfma_f32_16x16x32_bf16 v[100:103], a[24:27], a[188:191], v[100:103]
    s_add_u32 m0, s73, 3072
    s_nop 0
    buffer_load_dwordx4 v194, s[64:67], s72 offen lds
    s_waitcnt lgkmcnt(6)
    v_mfma_f32_16x16x32_bf16 v[32:35], a[28:31], a[184:187], v[32:35]
    v_mfma_f32_16x16x32_bf16 v[104:107], a[28:31], a[188:191], v[104:107]
    s_waitcnt lgkmcnt(5)
    v_mfma_f32_16x16x32_bf16 v[36:39], a[0:3], a[184:187], v[36:39]
    v_mfma_f32_16x16x32_bf16 v[108:111], a[0:3], a[188:191], v[108:111]
    s_waitcnt lgkmcnt(0)
    s_barrier
    ds_read_b128 a[16:19], v246 offset:36864
    s_add_u32 m0, s80, 0
    s_add_u32 s83, s85, 540
    s_sub_u32 s84, s83, 540
    s_and_b32 s42, s84, 3
    s_mul_i32 s42, s42, 9
    s_lshr_b32 s84, s84, 2
    s_add_u32 s42, s42, s84
    s_add_u32 s42, s42, 540
    s_cmp_lt_u32 s83, 540
    s_cselect_b32 s42, s83, s42
    s_lshl_b32 s42, s42, 10
    s_add_u32 s42, s42, s79
    buffer_load_dwordx4 v5, s[20:23], s42 offen sc1 lds
    v_mfma_f32_16x16x32_bf16 v[40:43], a[4:7], a[184:187], v[40:43]
    ds_read_b128 a[20:23], v246 offset:37888
    v_mfma_f32_16x16x32_bf16 v[112:115], a[4:7], a[188:191], v[112:115]
    ds_read_b128 a[24:27], v246 offset:38912
    v_mfma_f32_16x16x32_bf16 v[44:47], a[8:11], a[184:187], v[44:47]
    ds_read_b128 a[28:31], v246 offset:39936
    v_mfma_f32_16x16x32_bf16 v[116:119], a[8:11], a[188:191], v[116:119]
    ds_read_b128 a[0:3], v246 offset:40960
    v_mfma_f32_16x16x32_bf16 v[48:51], a[12:15], a[184:187], v[48:51]
    ds_read_b128 a[4:7], v246 offset:41984
    v_mfma_f32_16x16x32_bf16 v[120:123], a[12:15], a[188:191], v[120:123]
    s_add_u32 m0, s73, 4096
    s_add_u32 s72, s72, 128
    buffer_load_dwordx4 v191, s[64:67], s72 offen lds
    s_waitcnt lgkmcnt(5)
    v_mfma_f32_16x16x32_bf16 v[16:19], a[16:19], a[192:195], v[16:19]
    ds_read_b128 a[8:11], v246 offset:43008
    v_mfma_f32_16x16x32_bf16 v[88:91], a[16:19], a[196:199], v[88:91]
    s_add_u32 m0, s80, 1024
    s_add_u32 s83, s85, 541
    s_sub_u32 s84, s83, 540
    s_and_b32 s42, s84, 3
    s_mul_i32 s42, s42, 9
    s_lshr_b32 s84, s84, 2
    s_add_u32 s42, s42, s84
    s_add_u32 s42, s42, 540
    s_cmp_lt_u32 s83, 540
    s_cselect_b32 s42, s83, s42
    s_lshl_b32 s42, s42, 10
    s_add_u32 s42, s42, s79
    buffer_load_dwordx4 v5, s[20:23], s42 offen sc1 lds
    s_waitcnt lgkmcnt(5)
    v_mfma_f32_16x16x32_bf16 v[20:23], a[20:23], a[192:195], v[20:23]
    ds_read_b128 a[12:15], v246 offset:44032
    v_mfma_f32_16x16x32_bf16 v[92:95], a[20:23], a[196:199], v[92:95]
    s_waitcnt lgkmcnt(5)
    v_mfma_f32_16x16x32_bf16 v[24:27], a[24:27], a[192:195], v[24:27]
    ds_read_b128 a[16:19], v246 offset:45056
    v_mfma_f32_16x16x32_bf16 v[96:99], a[24:27], a[196:199], v[96:99]
    s_waitcnt vmcnt(11)
    ds_read_b128 a[240:243], v195 offset:8192
    ds_read_b128 a[244:247], v195 offset:8704
    s_waitcnt lgkmcnt(7)
    v_mfma_f32_16x16x32_bf16 v[28:31], a[28:31], a[192:195], v[28:31]
    ds_read_b128 a[20:23], v246 offset:46080
    v_mfma_f32_16x16x32_bf16 v[100:103], a[28:31], a[196:199], v[100:103]
    s_add_u32 m0, s80, 2048
    s_add_u32 s83, s85, 542
    s_sub_u32 s84, s83, 540
    s_and_b32 s42, s84, 3
    s_mul_i32 s42, s42, 9
    s_lshr_b32 s84, s84, 2
    s_add_u32 s42, s42, s84
    s_add_u32 s42, s42, 540
    s_cmp_lt_u32 s83, 540
    s_cselect_b32 s42, s83, s42
    s_lshl_b32 s42, s42, 10
    s_add_u32 s42, s42, s79
    buffer_load_dwordx4 v5, s[20:23], s42 offen sc1 lds
    s_waitcnt lgkmcnt(7)
    v_mfma_f32_16x16x32_bf16 v[32:35], a[0:3], a[192:195], v[32:35]
    ds_read_b128 a[24:27], v246 offset:47104
    v_mfma_f32_16x16x32_bf16 v[104:107], a[0:3], a[196:199], v[104:107]
    s_add_u32 m0, s73, 5120
    s_nop 0
    buffer_load_dwordx4 v192, s[64:67], s72 offen lds
    s_waitcnt lgkmcnt(7)
    v_mfma_f32_16x16x32_bf16 v[36:39], a[4:7], a[192:195], v[36:39]
    ds_read_b128 a[28:31], v246 offset:48128
    v_mfma_f32_16x16x32_bf16 v[108:111], a[4:7], a[196:199], v[108:111]
    s_waitcnt lgkmcnt(7)
    v_mfma_f32_16x16x32_bf16 v[40:43], a[8:11], a[192:195], v[40:43]
    ds_read_b128 a[0:3], v246 offset:49152
    v_mfma_f32_16x16x32_bf16 v[112:115], a[8:11], a[196:199], v[112:115]
    s_waitcnt lgkmcnt(7)
    v_mfma_f32_16x16x32_bf16 v[44:47], a[12:15], a[192:195], v[44:47]
    ds_read_b128 a[4:7], v246 offset:50176
    v_mfma_f32_16x16x32_bf16 v[116:119], a[12:15], a[196:199], v[116:119]
    s_add_u32 m0, s80, 3072
    s_add_u32 s83, s85, 543
    s_sub_u32 s84, s83, 540
    s_and_b32 s42, s84, 3
    s_mul_i32 s42, s42, 9
    s_lshr_b32 s84, s84, 2
    s_add_u32 s42, s42, s84
    s_add_u32 s42, s42, 540
    s_cmp_lt_u32 s83, 540
    s_cselect_b32 s42, s83, s42
    s_lshl_b32 s42, s42, 10
    s_add_u32 s42, s42, s79
    buffer_load_dwordx4 v5, s[20:23], s42 offen sc1 lds
    s_waitcnt lgkmcnt(5)
    v_mfma_f32_16x16x32_bf16 v[48:51], a[16:19], a[192:195], v[48:51]
    ds_read_b128 a[8:11], v246 offset:51200
    v_mfma_f32_16x16x32_bf16 v[120:123], a[16:19], a[196:199], v[120:123]
    s_add_u32 m0, s73, 6144
    s_nop 0
    buffer_load_dwordx4 v193, s[64:67], s72 offen lds
    s_waitcnt lgkmcnt(5)
    v_mfma_f32_16x16x32_bf16 v[16:19], a[20:23], a[200:203], v[16:19]
    ds_read_b128 a[12:15], v246 offset:52224
    v_mfma_f32_16x16x32_bf16 v[88:91], a[20:23], a[204:207], v[88:91]
    s_waitcnt lgkmcnt(5)
    v_mfma_f32_16x16x32_bf16 v[20:23], a[24:27], a[200:203], v[20:23]
    ds_read_b128 a[16:19], v246 offset:53248
    v_mfma_f32_16x16x32_bf16 v[92:95], a[24:27], a[204:207], v[92:95]
    s_waitcnt lgkmcnt(5)
    v_mfma_f32_16x16x32_bf16 v[24:27], a[28:31], a[200:203], v[24:27]
    ds_read_b128 a[20:23], v246 offset:54272
    v_mfma_f32_16x16x32_bf16 v[96:99], a[28:31], a[204:207], v[96:99]
    s_add_u32 m0, s80, 4096
    s_add_u32 s83, s85, 544
    s_sub_u32 s84, s83, 540
    s_and_b32 s42, s84, 3
    s_mul_i32 s42, s42, 9
    s_lshr_b32 s84, s84, 2
    s_add_u32 s42, s42, s84
    s_add_u32 s42, s42, 540
    s_cmp_lt_u32 s83, 540
    s_cselect_b32 s42, s83, s42
    s_lshl_b32 s42, s42, 10
    s_add_u32 s42, s42, s79
    buffer_load_dwordx4 v5, s[20:23], s42 offen sc1 lds
    ds_read_b128 a[248:251], v196 offset:8192
    ds_read_b128 a[252:255], v196 offset:8704
    s_waitcnt lgkmcnt(7)
    v_mfma_f32_16x16x32_bf16 v[28:31], a[0:3], a[200:203], v[28:31]
    ds_read_b128 a[24:27], v246 offset:55296
    v_mfma_f32_16x16x32_bf16 v[100:103], a[0:3], a[204:207], v[100:103]
    s_add_u32 m0, s73, 7168
    s_nop 0
    buffer_load_dwordx4 v194, s[64:67], s72 offen lds
    s_waitcnt lgkmcnt(7)
    v_mfma_f32_16x16x32_bf16 v[32:35], a[4:7], a[200:203], v[32:35]
    ds_read_b128 a[28:31], v246 offset:56320
    v_mfma_f32_16x16x32_bf16 v[104:107], a[4:7], a[204:207], v[104:107]
    s_waitcnt lgkmcnt(7)
    v_mfma_f32_16x16x32_bf16 v[36:39], a[8:11], a[200:203], v[36:39]
    ds_read_b128 a[0:3], v246 offset:57344
    v_mfma_f32_16x16x32_bf16 v[108:111], a[8:11], a[204:207], v[108:111]
    s_waitcnt lgkmcnt(7)
    v_mfma_f32_16x16x32_bf16 v[40:43], a[12:15], a[200:203], v[40:43]
    ds_read_b128 a[4:7], v246 offset:58368
    v_mfma_f32_16x16x32_bf16 v[112:115], a[12:15], a[204:207], v[112:115]
    s_add_u32 m0, s80, 5120
    s_add_u32 s83, s85, 545
    s_sub_u32 s84, s83, 540
    s_and_b32 s42, s84, 3
    s_mul_i32 s42, s42, 9
    s_lshr_b32 s84, s84, 2
    s_add_u32 s42, s42, s84
    s_add_u32 s42, s42, 540
    s_cmp_lt_u32 s83, 540
    s_cselect_b32 s42, s83, s42
    s_lshl_b32 s42, s42, 10
    s_add_u32 s42, s42, s79
    buffer_load_dwordx4 v5, s[20:23], s42 offen sc1 lds
    s_waitcnt lgkmcnt(7)
    v_mfma_f32_16x16x32_bf16 v[44:47], a[16:19], a[200:203], v[44:47]
    ds_read_b128 a[8:11], v246 offset:59392
    v_mfma_f32_16x16x32_bf16 v[116:119], a[16:19], a[204:207], v[116:119]
    s_waitcnt lgkmcnt(5)
    v_mfma_f32_16x16x32_bf16 v[48:51], a[20:23], a[200:203], v[48:51]
    ds_read_b128 a[12:15], v246 offset:60416
    v_mfma_f32_16x16x32_bf16 v[120:123], a[20:23], a[204:207], v[120:123]
    s_waitcnt lgkmcnt(5)
    v_mfma_f32_16x16x32_bf16 v[16:19], a[24:27], a[208:211], v[16:19]
    ds_read_b128 a[16:19], v246 offset:61440
    v_mfma_f32_16x16x32_bf16 v[88:91], a[24:27], a[212:215], v[88:91]
    s_waitcnt lgkmcnt(5)
    v_mfma_f32_16x16x32_bf16 v[20:23], a[28:31], a[208:211], v[20:23]
    ds_read_b128 a[20:23], v246 offset:62464
    v_mfma_f32_16x16x32_bf16 v[92:95], a[28:31], a[212:215], v[92:95]
    s_add_u32 m0, s80, 6144
    s_add_u32 s83, s85, 546
    s_sub_u32 s84, s83, 540
    s_and_b32 s42, s84, 3
    s_mul_i32 s42, s42, 9
    s_lshr_b32 s84, s84, 2
    s_add_u32 s42, s42, s84
    s_add_u32 s42, s42, 540
    s_cmp_lt_u32 s83, 540
    s_cselect_b32 s42, s83, s42
    s_lshl_b32 s42, s42, 10
    s_add_u32 s42, s42, s79
    buffer_load_dwordx4 v5, s[20:23], s42 offen sc1 lds
    s_waitcnt lgkmcnt(5)
    v_mfma_f32_16x16x32_bf16 v[24:27], a[0:3], a[208:211], v[24:27]
    ds_read_b128 a[24:27], v246 offset:63488
    v_mfma_f32_16x16x32_bf16 v[96:99], a[0:3], a[212:215], v[96:99]
    s_waitcnt vmcnt(11)
    ds_read_b128 a[176:179], v195 offset:0
    ds_read_b128 a[180:183], v195 offset:512
    s_waitcnt lgkmcnt(7)
    v_mfma_f32_16x16x32_bf16 v[28:31], a[4:7], a[208:211], v[28:31]
    ds_read_b128 a[28:31], v246 offset:64512
    v_mfma_f32_16x16x32_bf16 v[100:103], a[4:7], a[212:215], v[100:103]
    s_mov_b32 s92, s32
    s_and_b32 s93, s33, 0xffff
    s_mov_b32 s94, mega_end1-L_pc0
    s_mov_b32 s95, 0x20000
    s_add_u32 s96, s34, L_p5-L_pc0
    buffer_load_dword v12, v11, s[92:95], s96 offen
    s_waitcnt lgkmcnt(7)
    v_mfma_f32_16x16x32_bf16 v[32:35], a[8:11], a[208:211], v[32:35]
    ds_read_b128 a[0:3], v247 offset:0
    v_mfma_f32_16x16x32_bf16 v[104:107], a[8:11], a[212:215], v[104:107]
    s_waitcnt lgkmcnt(7)
    v_mfma_f32_16x16x32_bf16 v[36:39], a[12:15], a[208:211], v[36:39]
    ds_read_b128 a[4:7], v247 offset:1024
    v_mfma_f32_16x16x32_bf16 v[108:111], a[12:15], a[212:215], v[108:111]
    s_add_u32 m0, s80, 7168
    s_add_u32 s83, s85, 547
    s_sub_u32 s84, s83, 540
    s_and_b32 s42, s84, 3
    s_mul_i32 s42, s42, 9
    s_lshr_b32 s84, s84, 2
    s_add_u32 s42, s42, s84
    s_add_u32 s42, s42, 540
    s_cmp_lt_u32 s83, 540
    s_cselect_b32 s42, s83, s42
    s_lshl_b32 s42, s42, 10
    s_add_u32 s42, s42, s79
    buffer_load_dwordx4 v5, s[20:23], s42 offen sc1 lds
    s_waitcnt lgkmcnt(7)
    v_mfma_f32_16x16x32_bf16 v[40:43], a[16:19], a[208:211], v[40:43]
    ds_read_b128 a[8:11], v247 offset:2048
    v_mfma_f32_16x16x32_bf16 v[112:115], a[16:19], a[212:215], v[112:115]
    s_waitcnt lgkmcnt(7)
    v_mfma_f32_16x16x32_bf16 v[44:47], a[20:23], a[208:211], v[44:47]
    ds_read_b128 a[12:15], v247 offset:3072
    v_mfma_f32_16x16x32_bf16 v[116:119], a[20:23], a[212:215], v[116:119]
    s_waitcnt lgkmcnt(5)
    v_mfma_f32_16x16x32_bf16 v[48:51], a[24:27], a[208:211], v[48:51]
    ds_read_b128 a[16:19], v247 offset:4096
    v_mfma_f32_16x16x32_bf16 v[120:123], a[24:27], a[212:215], v[120:123]
    s_waitcnt lgkmcnt(5)
    v_mfma_f32_16x16x32_bf16 v[16:19], a[28:31], a[216:219], v[16:19]
    ds_read_b128 a[20:23], v247 offset:5120
    v_mfma_f32_16x16x32_bf16 v[88:91], a[28:31], a[220:223], v[88:91]
    s_add_u32 m0, s80, 8192
    s_add_u32 s83, s85, 548
    s_sub_u32 s84, s83, 540
    s_and_b32 s42, s84, 3
    s_mul_i32 s42, s42, 9
    s_lshr_b32 s84, s84, 2
    s_add_u32 s42, s42, s84
    s_add_u32 s42, s42, 540
    s_cmp_lt_u32 s83, 540
    s_cselect_b32 s42, s83, s42
    s_lshl_b32 s42, s42, 10
    s_add_u32 s42, s42, s79
    buffer_load_dwordx4 v5, s[20:23], s42 offen sc1 lds
    s_waitcnt lgkmcnt(5)
    v_mfma_f32_16x16x32_bf16 v[20:23], a[0:3], a[216:219], v[20:23]
    ds_read_b128 a[24:27], v247 offset:6144
    v_mfma_f32_16x16x32_bf16 v[92:95], a[0:3], a[220:223], v[92:95]
    s_waitcnt lgkmcnt(5)
    v_mfma_f32_16x16x32_bf16 v[24:27], a[4:7], a[216:219], v[24:27]
    ds_read_b128 a[28:31], v247 offset:7168
    v_mfma_f32_16x16x32_bf16 v[96:99], a[4:7], a[220:223], v[96:99]
    ds_read_b128 a[184:187], v196 offset:0
    ds_read_b128 a[188:191], v196 offset:512
    s_waitcnt lgkmcnt(7)
    v_mfma_f32_16x16x32_bf16 v[28:31], a[8:11], a[216:219], v[28:31]
    v_mfma_f32_16x16x32_bf16 v[100:103], a[8:11], a[220:223], v[100:103]
    s_waitcnt lgkmcnt(6)
    v_mfma_f32_16x16x32_bf16 v[32:35], a[12:15], a[216:219], v[32:35]
    v_mfma_f32_16x16x32_bf16 v[104:107], a[12:15], a[220:223], v[104:107]
    buffer_load_dwordx4 a[32:35], v5, s[16:19], s26 offen offset:0 sc1
    s_waitcnt lgkmcnt(5)
    v_mfma_f32_16x16x32_bf16 v[36:39], a[16:19], a[216:219], v[36:39]
    v_mfma_f32_16x16x32_bf16 v[108:111], a[16:19], a[220:223], v[108:111]
    s_waitcnt lgkmcnt(0)
    s_barrier
    ds_read_b128 a[0:3], v247 offset:8192
    v_mfma_f32_16x16x32_bf16 v[40:43], a[20:23], a[216:219], v[40:43]
    ds_read_b128 a[4:7], v247 offset:9216
    v_mfma_f32_16x16x32_bf16 v[112:115], a[20:23], a[220:223], v[112:115]
    ds_read_b128 a[8:11], v247 offset:10240
    buffer_load_dwordx4 a[36:39], v5, s[16:19], s27 offen offset:0 sc1
    v_mfma_f32_16x16x32_bf16 v[44:47], a[24:27], a[216:219], v[44:47]
    ds_read_b128 a[12:15], v247 offset:11264
    v_mfma_f32_16x16x32_bf16 v[116:119], a[24:27], a[220:223], v[116:119]
    ds_read_b128 a[16:19], v247 offset:12288
    v_mfma_f32_16x16x32_bf16 v[48:51], a[28:31], a[216:219], v[48:51]
    ds_read_b128 a[20:23], v247 offset:13312
    v_mfma_f32_16x16x32_bf16 v[120:123], a[28:31], a[220:223], v[120:123]
    buffer_load_dwordx4 a[40:43], v5, s[16:19], s28 offen offset:0 sc1
    s_waitcnt lgkmcnt(5)
    v_mfma_f32_16x16x32_bf16 v[16:19], a[0:3], a[224:227], v[16:19]
    ds_read_b128 a[24:27], v247 offset:14336
    v_mfma_f32_16x16x32_bf16 v[88:91], a[0:3], a[228:231], v[88:91]
    s_waitcnt lgkmcnt(5)
    v_mfma_f32_16x16x32_bf16 v[20:23], a[4:7], a[224:227], v[20:23]
    ds_read_b128 a[28:31], v247 offset:15360
    v_mfma_f32_16x16x32_bf16 v[92:95], a[4:7], a[228:231], v[92:95]
    buffer_load_dwordx4 a[44:47], v5, s[16:19], s29 offen offset:0 sc1
    s_waitcnt lgkmcnt(5)
    v_mfma_f32_16x16x32_bf16 v[24:27], a[8:11], a[224:227], v[24:27]
    ds_read_b128 a[0:3], v247 offset:16384
    v_mfma_f32_16x16x32_bf16 v[96:99], a[8:11], a[228:231], v[96:99]
    s_waitcnt vmcnt(9)
    ds_read_b128 a[192:195], v195 offset:4096
    ds_read_b128 a[196:199], v195 offset:4608
    s_waitcnt lgkmcnt(7)
    v_mfma_f32_16x16x32_bf16 v[28:31], a[12:15], a[224:227], v[28:31]
    ds_read_b128 a[4:7], v247 offset:17408
    v_mfma_f32_16x16x32_bf16 v[100:103], a[12:15], a[228:231], v[100:103]
    buffer_load_dwordx4 a[48:51], v10, s[16:19], s30 offen offset:0 sc1
    s_waitcnt lgkmcnt(7)
    v_mfma_f32_16x16x32_bf16 v[32:35], a[16:19], a[224:227], v[32:35]
    ds_read_b128 a[8:11], v247 offset:18432
    v_mfma_f32_16x16x32_bf16 v[104:107], a[16:19], a[228:231], v[104:107]
    s_waitcnt lgkmcnt(7)
    v_mfma_f32_16x16x32_bf16 v[36:39], a[20:23], a[224:227], v[36:39]
    ds_read_b128 a[12:15], v247 offset:19456
    v_mfma_f32_16x16x32_bf16 v[108:111], a[20:23], a[228:231], v[108:111]
    buffer_load_dwordx4 a[52:55], v5, s[16:19], s26 offen offset:1024 sc1
    s_waitcnt lgkmcnt(7)
    v_mfma_f32_16x16x32_bf16 v[40:43], a[24:27], a[224:227], v[40:43]
    ds_read_b128 a[16:19], v247 offset:20480
    v_mfma_f32_16x16x32_bf16 v[112:115], a[24:27], a[228:231], v[112:115]
    s_waitcnt lgkmcnt(7)
    v_mfma_f32_16x16x32_bf16 v[44:47], a[28:31], a[224:227], v[44:47]
    ds_read_b128 a[20:23], v247 offset:21504
    v_mfma_f32_16x16x32_bf16 v[116:119], a[28:31], a[228:231], v[116:119]
    buffer_load_dwordx4 a[56:59], v5, s[16:19], s27 offen offset:1024 sc1
    s_waitcnt lgkmcnt(5)
    v_mfma_f32_16x16x32_bf16 v[48:51], a[0:3], a[224:227], v[48:51]
    ds_read_b128 a[24:27], v247 offset:22528
    v_mfma_f32_16x16x32_bf16 v[120:123], a[0:3], a[228:231], v[120:123]
    s_waitcnt lgkmcnt(5)
    v_mfma_f32_16x16x32_bf16 v[16:19], a[4:7], a[232:235], v[16:19]
    ds_read_b128 a[28:31], v247 offset:23552
    v_mfma_f32_16x16x32_bf16 v[88:91], a[4:7], a[236:239], v[88:91]
    buffer_load_dwordx4 a[60:63], v5, s[16:19], s28 offen offset:1024 sc1
    s_waitcnt lgkmcnt(5)
    v_mfma_f32_16x16x32_bf16 v[20:23], a[8:11], a[232:235], v[20:23]
    ds_read_b128 a[0:3], v247 offset:24576
    v_mfma_f32_16x16x32_bf16 v[92:95], a[8:11], a[236:239], v[92:95]
    s_waitcnt lgkmcnt(5)
    v_mfma_f32_16x16x32_bf16 v[24:27], a[12:15], a[232:235], v[24:27]
    ds_read_b128 a[4:7], v247 offset:25600
    v_mfma_f32_16x16x32_bf16 v[96:99], a[12:15], a[236:239], v[96:99]
    buffer_load_dwordx4 a[64:67], v5, s[16:19], s29 offen offset:1024 sc1
    ds_read_b128 a[200:203], v196 offset:4096
    ds_read_b128 a[204:207], v196 offset:4608
    s_waitcnt lgkmcnt(7)
    v_mfma_f32_16x16x32_bf16 v[28:31], a[16:19], a[232:235], v[28:31]
    ds_read_b128 a[8:11], v247 offset:26624
    v_mfma_f32_16x16x32_bf16 v[100:103], a[16:19], a[236:239], v[100:103]
    s_waitcnt lgkmcnt(7)
    v_mfma_f32_16x16x32_bf16 v[32:35], a[20:23], a[232:235], v[32:35]
    ds_read_b128 a[12:15], v247 offset:27648
    v_mfma_f32_16x16x32_bf16 v[104:107], a[20:23], a[236:239], v[104:107]
    buffer_load_dwordx4 a[68:71], v10, s[16:19], s30 offen offset:1024 sc1
    s_waitcnt lgkmcnt(7)
    v_mfma_f32_16x16x32_bf16 v[36:39], a[24:27], a[232:235], v[36:39]
    ds_read_b128 a[16:19], v247 offset:28672
    v_mfma_f32_16x16x32_bf16 v[108:111], a[24:27], a[236:239], v[108:111]
    s_waitcnt lgkmcnt(7)
    v_mfma_f32_16x16x32_bf16 v[40:43], a[28:31], a[232:235], v[40:43]
    ds_read_b128 a[20:23], v247 offset:29696
    v_mfma_f32_16x16x32_bf16 v[112:115], a[28:31], a[236:239], v[112:115]
    buffer_load_dwordx4 a[72:75], v5, s[16:19], s26 offen offset:2048 sc1
    s_waitcnt lgkmcnt(7)
    v_mfma_f32_16x16x32_bf16 v[44:47], a[0:3], a[232:235], v[44:47]
    ds_read_b128 a[24:27], v247 offset:30720
    v_mfma_f32_16x16x32_bf16 v[116:119], a[0:3], a[236:239], v[116:119]
    s_waitcnt lgkmcnt(5)
    v_mfma_f32_16x16x32_bf16 v[48:51], a[4:7], a[232:235], v[48:51]
    ds_read_b128 a[28:31], v247 offset:31744
    v_mfma_f32_16x16x32_bf16 v[120:123], a[4:7], a[236:239], v[120:123]
    buffer_load_dwordx4 a[76:79], v5, s[16:19], s27 offen offset:2048 sc1
    s_waitcnt lgkmcnt(5)
    v_mfma_f32_16x16x32_bf16 v[16:19], a[8:11], a[240:243], v[16:19]
    ds_read_b128 a[0:3], v247 offset:32768
    v_mfma_f32_16x16x32_bf16 v[88:91], a[8:11], a[244:247], v[88:91]
    s_waitcnt lgkmcnt(5)
    v_mfma_f32_16x16x32_bf16 v[20:23], a[12:15], a[240:243], v[20:23]
    ds_read_b128 a[4:7], v247 offset:33792
    v_mfma_f32_16x16x32_bf16 v[92:95], a[12:15], a[244:247], v[92:95]
    buffer_load_dwordx4 a[80:83], v5, s[16:19], s28 offen offset:2048 sc1
    s_waitcnt lgkmcnt(5)
    v_mfma_f32_16x16x32_bf16 v[24:27], a[16:19], a[240:243], v[24:27]
    ds_read_b128 a[8:11], v247 offset:34816
    v_mfma_f32_16x16x32_bf16 v[96:99], a[16:19], a[244:247], v[96:99]
    s_waitcnt lgkmcnt(5)
    v_mfma_f32_16x16x32_bf16 v[28:31], a[20:23], a[240:243], v[28:31]
    ds_read_b128 a[12:15], v247 offset:35840
    v_mfma_f32_16x16x32_bf16 v[100:103], a[20:23], a[244:247], v[100:103]
    buffer_load_dwordx4 a[84:87], v5, s[16:19], s29 offen offset:2048 sc1
    s_waitcnt lgkmcnt(5)
    v_mfma_f32_16x16x32_bf16 v[32:35], a[24:27], a[240:243], v[32:35]
    ds_read_b128 a[16:19], v247 offset:36864
    v_mfma_f32_16x16x32_bf16 v[104:107], a[24:27], a[244:247], v[104:107]
    s_waitcnt lgkmcnt(5)
    v_mfma_f32_16x16x32_bf16 v[36:39], a[28:31], a[240:243], v[36:39]
    ds_read_b128 a[20:23], v247 offset:37888
    v_mfma_f32_16x16x32_bf16 v[108:111], a[28:31], a[244:247], v[108:111]
    buffer_load_dwordx4 a[88:91], v10, s[16:19], s30 offen offset:2048 sc1
    s_waitcnt lgkmcnt(5)
    v_mfma_f32_16x16x32_bf16 v[40:43], a[0:3], a[240:243], v[40:43]
    ds_read_b128 a[24:27], v247 offset:38912
    v_mfma_f32_16x16x32_bf16 v[112:115], a[0:3], a[244:247], v[112:115]
    s_waitcnt lgkmcnt(5)
    v_mfma_f32_16x16x32_bf16 v[44:47], a[4:7], a[240:243], v[44:47]
    ds_read_b128 a[28:31], v247 offset:39936
    v_mfma_f32_16x16x32_bf16 v[116:119], a[4:7], a[244:247], v[116:119]
    buffer_load_dwordx4 a[92:95], v5, s[16:19], s26 offen offset:3072 sc1
    s_waitcnt lgkmcnt(5)
    v_mfma_f32_16x16x32_bf16 v[48:51], a[8:11], a[240:243], v[48:51]
    ds_read_b128 a[0:3], v247 offset:40960
    v_mfma_f32_16x16x32_bf16 v[120:123], a[8:11], a[244:247], v[120:123]
    s_waitcnt lgkmcnt(5)
    v_mfma_f32_16x16x32_bf16 v[16:19], a[12:15], a[248:251], v[16:19]
    ds_read_b128 a[4:7], v247 offset:41984
    v_mfma_f32_16x16x32_bf16 v[88:91], a[12:15], a[252:255], v[88:91]
    buffer_load_dwordx4 a[96:99], v5, s[16:19], s27 offen offset:3072 sc1
    s_waitcnt lgkmcnt(5)
    v_mfma_f32_16x16x32_bf16 v[20:23], a[16:19], a[248:251], v[20:23]
    ds_read_b128 a[8:11], v247 offset:43008
    v_mfma_f32_16x16x32_bf16 v[92:95], a[16:19], a[252:255], v[92:95]
    s_waitcnt lgkmcnt(5)
    v_mfma_f32_16x16x32_bf16 v[24:27], a[20:23], a[248:251], v[24:27]
    ds_read_b128 a[12:15], v247 offset:44032
    v_mfma_f32_16x16x32_bf16 v[96:99], a[20:23], a[252:255], v[96:99]
    buffer_load_dwordx4 a[100:103], v5, s[16:19], s28 offen offset:3072 sc1
    s_waitcnt lgkmcnt(5)
    v_mfma_f32_16x16x32_bf16 v[28:31], a[24:27], a[248:251], v[28:31]
    v_mfma_f32_16x16x32_bf16 v[100:103], a[24:27], a[252:255], v[100:103]
    s_waitcnt lgkmcnt(4)
    v_mfma_f32_16x16x32_bf16 v[32:35], a[28:31], a[248:251], v[32:35]
    v_mfma_f32_16x16x32_bf16 v[104:107], a[28:31], a[252:255], v[104:107]
    buffer_load_dwordx4 a[104:107], v5, s[16:19], s29 offen offset:3072 sc1
    s_waitcnt lgkmcnt(3)
    v_mfma_f32_16x16x32_bf16 v[36:39], a[0:3], a[248:251], v[36:39]
    v_mfma_f32_16x16x32_bf16 v[108:111], a[0:3], a[252:255], v[108:111]
    s_waitcnt lgkmcnt(0)
    s_waitcnt vmcnt(19)
    s_barrier
    ds_read_b128 a[16:19], v246 offset:0
    v_mfma_f32_16x16x32_bf16 v[40:43], a[4:7], a[248:251], v[40:43]
    ds_read_b128 a[20:23], v246 offset:1024
    v_mfma_f32_16x16x32_bf16 v[112:115], a[4:7], a[252:255], v[112:115]
    ds_read_b128 a[24:27], v246 offset:2048
    buffer_load_dwordx4 a[108:111], v10, s[16:19], s30 offen offset:3072 sc1
    v_mfma_f32_16x16x32_bf16 v[44:47], a[8:11], a[248:251], v[44:47]
    ds_read_b128 a[28:31], v246 offset:3072
    v_mfma_f32_16x16x32_bf16 v[116:119], a[8:11], a[252:255], v[116:119]
    ds_read_b128 a[0:3], v246 offset:4096
    v_mfma_f32_16x16x32_bf16 v[48:51], a[12:15], a[248:251], v[48:51]
    ds_read_b128 a[4:7], v246 offset:5120
    v_mfma_f32_16x16x32_bf16 v[120:123], a[12:15], a[252:255], v[120:123]
    s_add_u32 s26, s26, 4096
    buffer_load_dwordx4 a[112:115], v5, s[16:19], s26 offen offset:0 sc1
    s_waitcnt lgkmcnt(5)
    v_mfma_f32_16x16x32_bf16 v[16:19], a[16:19], a[176:179], v[16:19]
    ds_read_b128 a[8:11], v246 offset:6144
    v_mfma_f32_16x16x32_bf16 v[88:91], a[16:19], a[180:183], v[88:91]
    s_waitcnt lgkmcnt(5)
    v_mfma_f32_16x16x32_bf16 v[16:19], a[20:23], a[184:187], v[16:19]
    ds_read_b128 a[12:15], v246 offset:7168
    v_mfma_f32_16x16x32_bf16 v[88:91], a[20:23], a[188:191], v[88:91]
    s_add_u32 s27, s27, 4096
    buffer_load_dwordx4 a[116:119], v5, s[16:19], s27 offen offset:0 sc1
    s_waitcnt lgkmcnt(5)
    v_mfma_f32_16x16x32_bf16 v[16:19], a[24:27], a[192:195], v[16:19]
    ds_read_b128 a[16:19], v246 offset:8192
    v_mfma_f32_16x16x32_bf16 v[88:91], a[24:27], a[196:199], v[88:91]
    s_waitcnt lgkmcnt(5)
    v_mfma_f32_16x16x32_bf16 v[16:19], a[28:31], a[200:203], v[16:19]
    ds_read_b128 a[20:23], v246 offset:9216
    v_mfma_f32_16x16x32_bf16 v[88:91], a[28:31], a[204:207], v[88:91]
    s_add_u32 s28, s28, 4096
    buffer_load_dwordx4 a[120:123], v5, s[16:19], s28 offen offset:0 sc1
    s_waitcnt lgkmcnt(5)
    v_mfma_f32_16x16x32_bf16 v[20:23], a[0:3], a[176:179], v[20:23]
    ds_read_b128 a[24:27], v246 offset:10240
    v_mfma_f32_16x16x32_bf16 v[92:95], a[0:3], a[180:183], v[92:95]
    s_waitcnt lgkmcnt(5)
    v_mfma_f32_16x16x32_bf16 v[20:23], a[4:7], a[184:187], v[20:23]
    ds_read_b128 a[28:31], v246 offset:11264
    v_mfma_f32_16x16x32_bf16 v[92:95], a[4:7], a[188:191], v[92:95]
    s_add_u32 s29, s29, 4096
    buffer_load_dwordx4 a[124:127], v5, s[16:19], s29 offen offset:0 sc1
    s_waitcnt lgkmcnt(5)
    v_mfma_f32_16x16x32_bf16 v[20:23], a[8:11], a[192:195], v[20:23]
    ds_read_b128 a[0:3], v246 offset:12288
    v_fma_f32 v16, v16, v160, v162
    v_fma_f32 v17, v17, v160, v162
    v_mfma_f32_16x16x32_bf16 v[92:95], a[8:11], a[196:199], v[92:95]
    v_fma_f32 v18, v18, v160, v162
    v_fma_f32 v19, v19, v160, v162
    s_waitcnt lgkmcnt(5)
    v_mfma_f32_16x16x32_bf16 v[20:23], a[12:15], a[200:203], v[20:23]
    ds_read_b128 a[4:7], v246 offset:13312
    v_mul_f32 v16, v16, v52
    v_mul_f32 v17, v17, v53
    v_mfma_f32_16x16x32_bf16 v[92:95], a[12:15], a[204:207], v[92:95]
    s_add_u32 s30, s30, 4096
    buffer_load_dwordx4 a[128:131], v10, s[16:19], s30 offen offset:0 sc1
    v_mul_f32 v18, v18, v54
    v_mul_f32 v19, v19, v55
    s_waitcnt lgkmcnt(5)
    v_mfma_f32_16x16x32_bf16 v[24:27], a[16:19], a[176:179], v[24:27]
    ds_read_b128 a[8:11], v246 offset:14336
    v_cvt_pk_bf16_f32 v236, v16, v17
    v_cvt_pk_bf16_f32 v237, v18, v19
    v_mfma_f32_16x16x32_bf16 v[96:99], a[16:19], a[180:183], v[96:99]
    v_fma_f32 v88, v88, v164, v166
    v_fma_f32 v89, v89, v164, v166
    s_waitcnt lgkmcnt(5)
    v_mfma_f32_16x16x32_bf16 v[24:27], a[20:23], a[184:187], v[24:27]
    ds_read_b128 a[12:15], v246 offset:15360
    v_fma_f32 v90, v90, v164, v166
    v_fma_f32 v91, v91, v164, v166
    v_mfma_f32_16x16x32_bf16 v[96:99], a[20:23], a[188:191], v[96:99]
    buffer_load_dwordx4 a[132:135], v5, s[16:19], s26 offen offset:1024 sc1
    v_mul_f32 v88, v88, v124
    v_mul_f32 v89, v89, v125
    s_waitcnt lgkmcnt(5)
    v_mfma_f32_16x16x32_bf16 v[24:27], a[24:27], a[192:195], v[24:27]
    ds_read_b128 a[16:19], v246 offset:16384
    v_mul_f32 v90, v90, v126
    v_mul_f32 v91, v91, v127
    v_mfma_f32_16x16x32_bf16 v[96:99], a[24:27], a[196:199], v[96:99]
    v_cvt_pk_bf16_f32 v238, v88, v89
    v_cvt_pk_bf16_f32 v239, v90, v91
    s_waitcnt lgkmcnt(5)
    v_mfma_f32_16x16x32_bf16 v[24:27], a[28:31], a[200:203], v[24:27]
    ds_read_b128 a[20:23], v246 offset:17408
    v_permlane16_swap_b32 v236, v238
    v_permlane16_swap_b32 v237, v239
    v_mfma_f32_16x16x32_bf16 v[96:99], a[28:31], a[204:207], v[96:99]
    buffer_load_dwordx4 a[136:139], v5, s[16:19], s27 offen offset:1024 sc1
    buffer_store_dwordx4 v[236:239], v202, s[20:23], s75 offen offset:0 sc1
    v_fma_f32 v20, v20, v160, v162
    s_waitcnt lgkmcnt(5)
    v_mfma_f32_16x16x32_bf16 v[28:31], a[0:3], a[176:179], v[28:31]
    ds_read_b128 a[24:27], v246 offset:18432
    v_fma_f32 v21, v21, v160, v162
    v_fma_f32 v22, v22, v160, v162
    v_mfma_f32_16x16x32_bf16 v[100:103], a[0:3], a[180:183], v[100:103]
    v_fma_f32 v23, v23, v160, v162
    v_mul_f32 v20, v20, v56
    s_waitcnt lgkmcnt(5)
    v_mfma_f32_16x16x32_bf16 v[28:31], a[4:7], a[184:187], v[28:31]
    ds_read_b128 a[28:31], v246 offset:19456
    v_mul_f32 v21, v21, v57
    v_mul_f32 v22, v22, v58
    v_mfma_f32_16x16x32_bf16 v[100:103], a[4:7], a[188:191], v[100:103]
    buffer_load_dwordx4 a[140:143], v5, s[16:19], s28 offen offset:1024 sc1
    v_mul_f32 v23, v23, v59
    v_cvt_pk_bf16_f32 v240, v20, v21
    s_waitcnt lgkmcnt(5)
    v_mfma_f32_16x16x32_bf16 v[28:31], a[8:11], a[192:195], v[28:31]
    ds_read_b128 a[0:3], v246 offset:20480
    v_cvt_pk_bf16_f32 v241, v22, v23
    v_fma_f32 v92, v92, v164, v166
    v_mfma_f32_16x16x32_bf16 v[100:103], a[8:11], a[196:199], v[100:103]
    v_fma_f32 v93, v93, v164, v166
    v_fma_f32 v94, v94, v164, v166
    s_waitcnt lgkmcnt(5)
    v_mfma_f32_16x16x32_bf16 v[28:31], a[12:15], a[200:203], v[28:31]
    ds_read_b128 a[4:7], v246 offset:21504
    v_fma_f32 v95, v95, v164, v166
    v_mul_f32 v92, v92, v128
    v_mfma_f32_16x16x32_bf16 v[100:103], a[12:15], a[204:207], v[100:103]
    buffer_load_dwordx4 a[144:147], v5, s[16:19], s29 offen offset:1024 sc1
    v_mul_f32 v93, v93, v129
    v_mul_f32 v94, v94, v130
    s_waitcnt lgkmcnt(5)
    v_mfma_f32_16x16x32_bf16 v[32:35], a[16:19], a[176:179], v[32:35]
    ds_read_b128 a[8:11], v246 offset:22528
    v_mul_f32 v95, v95, v131
    v_cvt_pk_bf16_f32 v242, v92, v93
    v_mfma_f32_16x16x32_bf16 v[104:107], a[16:19], a[180:183], v[104:107]
    v_cvt_pk_bf16_f32 v243, v94, v95
    v_permlane16_swap_b32 v240, v242
    s_waitcnt lgkmcnt(5)
    v_mfma_f32_16x16x32_bf16 v[32:35], a[20:23], a[184:187], v[32:35]
    ds_read_b128 a[12:15], v246 offset:23552
    v_permlane16_swap_b32 v241, v243
    buffer_store_dwordx4 v[240:243], v202, s[20:23], s75 offen offset:512 sc1
    v_mfma_f32_16x16x32_bf16 v[104:107], a[20:23], a[188:191], v[104:107]
    buffer_load_dwordx4 a[148:151], v10, s[16:19], s30 offen offset:1024 sc1
    v_fma_f32 v24, v24, v160, v162
    v_fma_f32 v25, v25, v160, v162
    s_waitcnt lgkmcnt(5)
    v_mfma_f32_16x16x32_bf16 v[32:35], a[24:27], a[192:195], v[32:35]
    ds_read_b128 a[16:19], v246 offset:24576
    v_fma_f32 v26, v26, v160, v162
    v_fma_f32 v27, v27, v160, v162
    v_mfma_f32_16x16x32_bf16 v[104:107], a[24:27], a[196:199], v[104:107]
    v_mul_f32 v24, v24, v60
    v_mul_f32 v25, v25, v61
    s_waitcnt lgkmcnt(5)
    v_mfma_f32_16x16x32_bf16 v[32:35], a[28:31], a[200:203], v[32:35]
    ds_read_b128 a[20:23], v246 offset:25600
    v_mul_f32 v26, v26, v62
    v_mul_f32 v27, v27, v63
    v_mfma_f32_16x16x32_bf16 v[104:107], a[28:31], a[204:207], v[104:107]
    buffer_load_dwordx4 a[152:155], v5, s[16:19], s26 offen offset:2048 sc1
    v_cvt_pk_bf16_f32 v236, v24, v25
    v_cvt_pk_bf16_f32 v237, v26, v27
    s_waitcnt lgkmcnt(5)
    v_mfma_f32_16x16x32_bf16 v[36:39], a[0:3], a[176:179], v[36:39]
    ds_read_b128 a[24:27], v246 offset:26624
    v_fma_f32 v96, v96, v164, v166
    v_fma_f32 v97, v97, v164, v166
    v_mfma_f32_16x16x32_bf16 v[108:111], a[0:3], a[180:183], v[108:111]
    v_fma_f32 v98, v98, v164, v166
    v_fma_f32 v99, v99, v164, v166
    s_waitcnt lgkmcnt(5)
    v_mfma_f32_16x16x32_bf16 v[36:39], a[4:7], a[184:187], v[36:39]
    ds_read_b128 a[28:31], v246 offset:27648
    v_mul_f32 v96, v96, v132
    v_mul_f32 v97, v97, v133
    v_mfma_f32_16x16x32_bf16 v[108:111], a[4:7], a[188:191], v[108:111]
    buffer_load_dwordx4 a[156:159], v5, s[16:19], s27 offen offset:2048 sc1
    v_mul_f32 v98, v98, v134
    v_mul_f32 v99, v99, v135
    s_waitcnt lgkmcnt(5)
    v_mfma_f32_16x16x32_bf16 v[36:39], a[8:11], a[192:195], v[36:39]
    ds_read_b128 a[0:3], v246 offset:28672
    v_cvt_pk_bf16_f32 v238, v96, v97
    v_cvt_pk_bf16_f32 v239, v98, v99
    v_mfma_f32_16x16x32_bf16 v[108:111], a[8:11], a[196:199], v[108:111]
    v_permlane16_swap_b32 v236, v238
    v_permlane16_swap_b32 v237, v239
    s_waitcnt lgkmcnt(5)
    v_mfma_f32_16x16x32_bf16 v[36:39], a[12:15], a[200:203], v[36:39]
    ds_read_b128 a[4:7], v246 offset:29696
    buffer_store_dwordx4 v[236:239], v202, s[20:23], s75 offen offset:1024 sc1
    v_fma_f32 v28, v28, v160, v162
    v_mfma_f32_16x16x32_bf16 v[108:111], a[12:15], a[204:207], v[108:111]
    buffer_load_dwordx4 a[160:163], v5, s[16:19], s28 offen offset:2048 sc1
    v_fma_f32 v29, v29, v160, v162
    v_fma_f32 v30, v30, v160, v162
    s_waitcnt lgkmcnt(5)
    v_mfma_f32_16x16x32_bf16 v[40:43], a[16:19], a[176:179], v[40:43]
    ds_read_b128 a[8:11], v246 offset:30720
    v_fma_f32 v31, v31, v160, v162
    v_mul_f32 v28, v28, v64
    v_mfma_f32_16x16x32_bf16 v[112:115], a[16:19], a[180:183], v[112:115]
    v_mul_f32 v29, v29, v65
    v_mul_f32 v30, v30, v66
    s_waitcnt lgkmcnt(5)
    v_mfma_f32_16x16x32_bf16 v[40:43], a[20:23], a[184:187], v[40:43]
    ds_read_b128 a[12:15], v246 offset:31744
    v_mul_f32 v31, v31, v67
    v_cvt_pk_bf16_f32 v240, v28, v29
    v_mfma_f32_16x16x32_bf16 v[112:115], a[20:23], a[188:191], v[112:115]
    buffer_load_dwordx4 a[164:167], v5, s[16:19], s29 offen offset:2048 sc1
    v_cvt_pk_bf16_f32 v241, v30, v31
    v_fma_f32 v100, v100, v164, v166
    s_waitcnt lgkmcnt(5)
    v_mfma_f32_16x16x32_bf16 v[40:43], a[24:27], a[192:195], v[40:43]
    ds_read_b128 a[16:19], v246 offset:32768
    v_fma_f32 v101, v101, v164, v166
    v_fma_f32 v102, v102, v164, v166
    v_mfma_f32_16x16x32_bf16 v[112:115], a[24:27], a[196:199], v[112:115]
    v_fma_f32 v103, v103, v164, v166
    v_mul_f32 v100, v100, v136
    s_waitcnt lgkmcnt(5)
    v_mfma_f32_16x16x32_bf16 v[40:43], a[28:31], a[200:203], v[40:43]
    ds_read_b128 a[20:23], v246 offset:33792
    v_mul_f32 v101, v101, v137
    v_mul_f32 v102, v102, v138
    v_mfma_f32_16x16x32_bf16 v[112:115], a[28:31], a[204:207], v[112:115]
    buffer_load_dwordx4 a[168:171], v10, s[16:19], s30 offen offset:2048 sc1
    v_mul_f32 v103, v103, v139
    v_cvt_pk_bf16_f32 v242, v100, v101
    s_waitcnt lgkmcnt(5)
    v_mfma_f32_16x16x32_bf16 v[44:47], a[0:3], a[176:179], v[44:47]
    ds_read_b128 a[24:27], v246 offset:34816
    v_cvt_pk_bf16_f32 v243, v102, v103
    v_permlane16_swap_b32 v240, v242
    v_mfma_f32_16x16x32_bf16 v[116:119], a[0:3], a[180:183], v[116:119]
    v_permlane16_swap_b32 v241, v243
    buffer_store_dwordx4 v[240:243], v202, s[20:23], s75 offen offset:1536 sc1
    s_waitcnt lgkmcnt(5)
    v_mfma_f32_16x16x32_bf16 v[44:47], a[4:7], a[184:187], v[44:47]
    ds_read_b128 a[28:31], v246 offset:35840
    v_fma_f32 v32, v32, v160, v162
    v_fma_f32 v33, v33, v160, v162
    v_mfma_f32_16x16x32_bf16 v[116:119], a[4:7], a[188:191], v[116:119]
    v_fma_f32 v34, v34, v160, v162
    v_fma_f32 v35, v35, v160, v162
    s_waitcnt lgkmcnt(5)
    v_mfma_f32_16x16x32_bf16 v[44:47], a[8:11], a[192:195], v[44:47]
    v_mul_f32 v32, v32, v68
    v_mul_f32 v33, v33, v69
    v_mfma_f32_16x16x32_bf16 v[116:119], a[8:11], a[196:199], v[116:119]
    v_mul_f32 v34, v34, v70
    v_mul_f32 v35, v35, v71
    s_waitcnt lgkmcnt(4)
    v_mfma_f32_16x16x32_bf16 v[44:47], a[12:15], a[200:203], v[44:47]
    v_cvt_pk_bf16_f32 v236, v32, v33
    v_cvt_pk_bf16_f32 v237, v34, v35
    v_mfma_f32_16x16x32_bf16 v[116:119], a[12:15], a[204:207], v[116:119]
    v_fma_f32 v104, v104, v164, v166
    v_fma_f32 v105, v105, v164, v166
    s_waitcnt lgkmcnt(3)
    v_mfma_f32_16x16x32_bf16 v[48:51], a[16:19], a[176:179], v[48:51]
    v_fma_f32 v106, v106, v164, v166
    v_fma_f32 v107, v107, v164, v166
    v_mfma_f32_16x16x32_bf16 v[120:123], a[16:19], a[180:183], v[120:123]
    v_mul_f32 v104, v104, v140
    v_mul_f32 v105, v105, v141
    s_waitcnt lgkmcnt(2)
    v_mfma_f32_16x16x32_bf16 v[48:51], a[20:23], a[184:187], v[48:51]
    v_mul_f32 v106, v106, v142
    v_mul_f32 v107, v107, v143
    v_mfma_f32_16x16x32_bf16 v[120:123], a[20:23], a[188:191], v[120:123]
    v_cvt_pk_bf16_f32 v238, v104, v105
    v_cvt_pk_bf16_f32 v239, v106, v107
    s_waitcnt lgkmcnt(1)
    v_mfma_f32_16x16x32_bf16 v[48:51], a[24:27], a[192:195], v[48:51]
    v_permlane16_swap_b32 v236, v238
    v_permlane16_swap_b32 v237, v239
    v_mfma_f32_16x16x32_bf16 v[120:123], a[24:27], a[196:199], v[120:123]
    buffer_store_dwordx4 v[236:239], v202, s[20:23], s75 offen offset:2048 sc1
    v_fma_f32 v36, v36, v160, v162
    s_waitcnt lgkmcnt(0)
    v_mfma_f32_16x16x32_bf16 v[48:51], a[28:31], a[200:203], v[48:51]
    v_fma_f32 v37, v37, v160, v162
    v_fma_f32 v38, v38, v160, v162
    v_mfma_f32_16x16x32_bf16 v[120:123], a[28:31], a[204:207], v[120:123]
    v_fma_f32 v39, v39, v160, v162
    v_mul_f32 v36, v36, v72
    v_mul_f32 v37, v37, v73
    v_mul_f32 v38, v38, v74
    v_mul_f32 v39, v39, v75
    v_cvt_pk_bf16_f32 v240, v36, v37
    v_cvt_pk_bf16_f32 v241, v38, v39
    v_fma_f32 v108, v108, v164, v166
    v_fma_f32 v109, v109, v164, v166
    v_fma_f32 v110, v110, v164, v166
    v_fma_f32 v111, v111, v164, v166
    v_mul_f32 v108, v108, v144
    v_mul_f32 v109, v109, v145
    v_mul_f32 v110, v110, v146
    v_mul_f32 v111, v111, v147
    v_cvt_pk_bf16_f32 v242, v108, v109
    v_cvt_pk_bf16_f32 v243, v110, v111
    s_nop 0
    v_permlane16_swap_b32 v240, v242
    v_permlane16_swap_b32 v241, v243
    buffer_store_dwordx4 v[240:243], v202, s[20:23], s75 offen offset:2560 sc1
    v_fma_f32 v40, v40, v160, v162
    v_fma_f32 v41, v41, v160, v162
    v_fma_f32 v42, v42, v160, v162
    v_fma_f32 v43, v43, v160, v162
    v_mul_f32 v40, v40, v76
    v_mul_f32 v41, v41, v77
    v_mul_f32 v42, v42, v78
    v_mul_f32 v43, v43, v79
    v_cvt_pk_bf16_f32 v236, v40, v41
    v_cvt_pk_bf16_f32 v237, v42, v43
    v_fma_f32 v112, v112, v164, v166
    v_fma_f32 v113, v113, v164, v166
    v_fma_f32 v114, v114, v164, v166
    v_fma_f32 v115, v115, v164, v166
    v_mul_f32 v112, v112, v148
    v_mul_f32 v113, v113, v149
    v_mul_f32 v114, v114, v150
    v_mul_f32 v115, v115, v151
    v_cvt_pk_bf16_f32 v238, v112, v113
    v_cvt_pk_bf16_f32 v239, v114, v115
    s_nop 0
    v_permlane16_swap_b32 v236, v238
    v_permlane16_swap_b32 v237, v239
    buffer_store_dwordx4 v[236:239], v202, s[20:23], s75 offen offset:3072 sc1
    v_fma_f32 v44, v44, v160, v162
    v_fma_f32 v45, v45, v160, v162
    v_fma_f32 v46, v46, v160, v162
    v_fma_f32 v47, v47, v160, v162
    v_mul_f32 v44, v44, v80
    v_mul_f32 v45, v45, v81
    v_mul_f32 v46, v46, v82
    v_mul_f32 v47, v47, v83
    v_cvt_pk_bf16_f32 v240, v44, v45
    v_cvt_pk_bf16_f32 v241, v46, v47
    v_fma_f32 v116, v116, v164, v166
    v_fma_f32 v117, v117, v164, v166
    v_fma_f32 v118, v118, v164, v166
    v_fma_f32 v119, v119, v164, v166
    v_mul_f32 v116, v116, v152
    v_mul_f32 v117, v117, v153
    v_mul_f32 v118, v118, v154
    v_mul_f32 v119, v119, v155
    v_cvt_pk_bf16_f32 v242, v116, v117
    v_cvt_pk_bf16_f32 v243, v118, v119
    s_nop 0
    v_permlane16_swap_b32 v240, v242
    v_permlane16_swap_b32 v241, v243
    buffer_store_dwordx4 v[240:243], v202, s[20:23], s75 offen offset:3584 sc1
    v_pk_fma_f32 v[48:49], v[48:49], v[160:161], v[162:163]
    v_pk_fma_f32 v[50:51], v[50:51], v[160:161], v[162:163]
    v_pk_mul_f32 v[48:49], v[48:49], v[84:85]
    v_pk_mul_f32 v[50:51], v[50:51], v[86:87]
    v_cvt_pk_bf16_f32 v236, v48, v49
    v_cvt_pk_bf16_f32 v237, v50, v51
    v_pk_fma_f32 v[120:121], v[120:121], v[164:165], v[166:167]
    v_pk_fma_f32 v[122:123], v[122:123], v[164:165], v[166:167]
    v_pk_mul_f32 v[120:121], v[120:121], v[156:157]
    v_pk_mul_f32 v[122:123], v[122:123], v[158:159]
    v_cvt_pk_bf16_f32 v238, v120, v121
    v_cvt_pk_bf16_f32 v239, v122, v123
    s_nop 0
    v_permlane16_swap_b32 v236, v238
    v_permlane16_swap_b32 v237, v239
    buffer_store_dwordx4 v[236:239], v202, s[20:23], s76 offen offset:0 sc1
    s_lshl_b32 s38, s35, 7
    s_lshl_b32 s39, s36, 2
    s_add_u32 s38, s38, s39
    s_add_u32 s25, s38, 993280
L_p5:
    s_and_b32 s37, s2, 3
    s_lshl_b32 s35, s37, 3
    s_bfe_u32 s37, s2, 0x30003
    s_add_u32 s35, s35, s37
    s_bfe_u32 s37, s2, 0x10002
    s_lshl_b32 s36, s37, 2
    s_lshr_b32 s37, s2, 6
    s_add_u32 s36, s36, s37
    s_waitcnt vmcnt(0)
    s_waitcnt lgkmcnt(0)
    s_barrier
    buffer_store_dword v7, v8, s[20:23], s25 offen sc1
    buffer_load_dwordx4 a[0:3], v5, s[16:19], s26 offen offset:3072 sc1
    s_mul_i32 s46, s4, 18432
    s_add_u32 s44, s4, 0
    s_and_b32 s44, s44, 3
    s_lshl_b32 s45, s35, 2
    s_add_u32 s44, s44, s45
    buffer_load_dwordx4 a[4:7], v5, s[16:19], s27 offen offset:3072 sc1
    s_mul_i32 s44, s44, 73728
    s_add_u32 s44, s44, 18862080
    s_add_u32 s47, s44, s46
    s_add_u32 s44, s4, 1
    buffer_load_dwordx4 a[8:11], v5, s[16:19], s28 offen offset:3072 sc1
    s_and_b32 s44, s44, 3
    s_lshl_b32 s45, s35, 2
    s_add_u32 s44, s44, s45
    s_mul_i32 s44, s44, 73728
    s_add_u32 s44, s44, 18862080
    buffer_load_dwordx4 a[12:15], v5, s[16:19], s29 offen offset:3072 sc1
    s_add_u32 s48, s44, s46
    s_add_u32 s44, s4, 2
    s_and_b32 s44, s44, 3
    s_lshl_b32 s45, s35, 2
    buffer_load_dwordx4 a[16:19], v10, s[16:19], s30 offen offset:3072 sc1
    s_add_u32 s44, s44, s45
    s_mul_i32 s44, s44, 73728
    s_add_u32 s44, s44, 18862080
    s_add_u32 s49, s44, s46
    s_add_u32 s26, s26, 4096
    buffer_load_dwordx4 a[20:23], v5, s[16:19], s26 offen offset:0 sc1
    s_add_u32 s44, s4, 3
    s_and_b32 s44, s44, 3
    s_lshl_b32 s45, s35, 2
    s_add_u32 s44, s44, s45
    s_mul_i32 s44, s44, 73728
    s_add_u32 s27, s27, 4096
    buffer_load_dwordx4 a[24:27], v5, s[16:19], s27 offen offset:0 sc1
    s_add_u32 s44, s44, 18862080
    s_add_u32 s50, s44, s46
    s_lshl_b32 s53, s35, 2
    s_add_u32 s53, s53, s4
    s_add_u32 s28, s28, 4096
    buffer_load_dwordx4 a[28:31], v5, s[16:19], s28 offen offset:0 sc1
    s_mul_i32 s53, s53, 18432
    s_mul_i32 s54, s36, 2304
    s_add_u32 s53, s53, s54
    v_lshrrev_b32 v13, 1, v4
    v_lshlrev_b32 v14, 8, v13
    s_add_u32 s29, s29, 4096
    buffer_load_dwordx4 a[172:175], v5, s[16:19], s29 offen offset:0 sc1
    v_lshlrev_b32 v212, 4, v3
    v_add_u32 v212, v212, v14
    v_and_b32 v14, 1, v4
    v_lshlrev_b32 v14, 3, v14
    s_add_u32 s30, s30, 4096
    buffer_load_dwordx4 a[176:179], v10, s[16:19], s30 offen offset:0 sc1
    v_add_u32 v212, v212, v14
    v_add_u32 v212, s53, v212
    v_lshlrev_b32 v13, 30, v13
    v_or_b32 v213, v212, v13
    buffer_load_dwordx4 a[180:183], v5, s[16:19], s26 offen offset:1024 sc1
    s_mov_b32 s51, 6934528
    s_mov_b32 s52, 29298688
    buffer_load_dwordx2 v[96:97], v212, s[20:23], s51 offen offset:0 sc1
    buffer_load_dwordx2 v[98:99], v212, s[20:23], s51 offen offset:512 sc1
    buffer_load_dwordx2 v[100:101], v212, s[20:23], s51 offen offset:1024 sc1
    buffer_load_dwordx4 a[184:187], v5, s[16:19], s27 offen offset:1024 sc1
    buffer_load_dwordx2 v[102:103], v212, s[20:23], s51 offen offset:1536 sc1
    buffer_load_dwordx2 v[104:105], v213, s[20:23], s51 offen offset:2048 sc1
    s_mov_b32 s40, s12
    s_and_b32 s41, s13, 0xffff
    buffer_load_dwordx4 a[188:191], v5, s[16:19], s28 offen offset:1024 sc1
    s_mov_b32 s42, 2359296
    s_mov_b32 s43, 0x20000
    s_lshl_b32 s55, s35, 6
    s_lshr_b32 s56, s4, 1
    s_lshl_b32 s56, s56, 5
    buffer_load_dwordx4 a[192:195], v5, s[16:19], s29 offen offset:1024 sc1
    s_add_u32 s55, s55, s56
    s_and_b32 s56, s4, 1
    s_lshl_b32 s56, s56, 2
    s_add_u32 s55, s55, s56
    buffer_load_dwordx4 a[196:199], v10, s[16:19], s30 offen offset:1024 sc1
    v_lshrrev_b32 v13, 2, v3
    v_lshlrev_b32 v13, 3, v13
    v_and_b32 v14, 3, v3
    v_add_u32 v13, v13, v14
    buffer_load_dwordx4 a[200:203], v5, s[16:19], s26 offen offset:2048 sc1
    v_add_u32 v13, s55, v13
    v_mul_u32_u24 v13, 1152, v13
    s_mul_i32 s56, s36, 144
    v_lshlrev_b32 v14, 3, v4
    v_add_u32 v13, v13, v14
    buffer_load_dwordx4 a[204:207], v5, s[16:19], s27 offen offset:2048 sc1
    v_add_u32 v214, s56, v13
    v_lshrrev_b32 v14, 1, v4
    v_lshlrev_b32 v14, 30, v14
    v_or_b32 v215, v214, v14
    buffer_load_dwordx4 a[208:211], v5, s[16:19], s28 offen offset:2048 sc1
    s_add_u32 s57, s4, 1
    s_and_b32 s57, s57, 3
    s_mul_i32 s57, s57, 15360
    s_add_u32 s57, s57, 98304
    v_add_u32 v216, s57, v5
    buffer_load_dwordx4 a[212:215], v5, s[16:19], s29 offen offset:2048 sc1
    s_add_u32 s57, s4, 2
    s_and_b32 s57, s57, 3
    s_mul_i32 s57, s57, 15360
    s_add_u32 s57, s57, 103424
    buffer_load_dwordx4 a[216:219], v10, s[16:19], s30 offen offset:2048 sc1
    v_add_u32 v217, s57, v5
    s_add_u32 s57, s4, 3
    s_and_b32 s57, s57, 3
    s_mul_i32 s57, s57, 15360
    buffer_load_dwordx4 a[220:223], v5, s[16:19], s26 offen offset:3072 sc1
    s_add_u32 s57, s57, 108544
    v_add_u32 v218, s57, v5
    s_mul_i32 s57, s4, 15360
    s_add_u32 s57, s57, 98304
    v_add_u32 v219, s57, v5
    buffer_load_dwordx4 a[224:227], v5, s[16:19], s27 offen offset:3072 sc1
    s_lshl_b32 s58, s35, 2
    s_add_u32 s58, s58, s4
    s_lshl_b32 s58, s58, 10
    s_lshl_b32 s59, s36, 3
    buffer_load_dwordx4 a[228:231], v5, s[16:19], s28 offen offset:3072 sc1
    s_add_u32 s58, s58, s59
    s_add_u32 s58, s58, 31657984
    v_lshlrev_b32 v220, 6, v3
    v_lshlrev_b32 v221, 28, v4
    v_or_b32 v220, v220, v221
    buffer_load_dwordx4 a[232:235], v5, s[16:19], s29 offen offset:3072 sc1
    s_lshr_b32 s60, s35, 1
    s_lshl_b32 s60, s60, 7
    s_and_b32 s61, s35, 1
    s_lshl_b32 s61, s61, 5
    buffer_load_dwordx4 a[236:239], v10, s[16:19], s30 offen offset:3072 sc1
    s_add_u32 s60, s60, s61
    s_lshl_b32 s61, s36, 2
    s_add_u32 s60, s60, s61
    s_add_u32 s60, s60, 995328
    s_mov_b32 s64, s32
    s_and_b32 s65, s33, 0xffff
    s_mov_b32 s66, L_p2-L_pc0
    s_mov_b32 s67, 0x20000
    s_add_u32 s68, s34, L_p1-L_pc0
    buffer_load_dword v12, v11, s[64:67], s68 offen
    s_lshr_b32 s44, s35, 1
    s_lshl_b32 s44, s44, 7
    s_add_u32 s44, s44, 993280
    s_mov_b32 s24, 0
    s_nop 5
mega_fp16:
    buffer_load_dword v13, v9, s[20:23], s44 offen sc1
    s_waitcnt vmcnt(0)
    v_cmp_eq_u32 vcc, 0, v13
    s_add_u32 s24, s24, 1
    s_nop 3
    s_cbranch_vccz mega_fok17
    s_sleep 1
    s_cmp_lt_u32 s24, 524288
    s_cbranch_scc1 mega_fp16
mega_fok17:
    buffer_load_dwordx4 v[116:119], v5, s[20:23], s47 offen offset:0 sc1
    buffer_load_dwordx4 v[120:123], v5, s[20:23], s48 offen offset:0 sc1
    buffer_load_dwordx4 v[124:127], v5, s[20:23], s49 offen offset:0 sc1
    buffer_load_dwordx4 v[128:131], v5, s[20:23], s50 offen offset:0 sc1
    buffer_load_dwordx4 v[132:135], v5, s[20:23], s47 offen offset:1024 sc1
    buffer_load_dwordx4 v[136:139], v5, s[20:23], s48 offen offset:1024 sc1
    buffer_load_dwordx4 v[140:143], v5, s[20:23], s49 offen offset:1024 sc1
    buffer_load_dwordx4 v[144:147], v5, s[20:23], s50 offen offset:1024 sc1
    buffer_load_dwordx4 v[148:151], v5, s[20:23], s47 offen offset:2048 sc1
    buffer_load_dwordx4 v[152:155], v5, s[20:23], s48 offen offset:2048 sc1
    buffer_load_dwordx4 v[156:159], v5, s[20:23], s49 offen offset:2048 sc1
    buffer_load_dwordx4 v[160:163], v5, s[20:23], s50 offen offset:2048 sc1
    buffer_load_dwordx4 v[164:167], v5, s[20:23], s47 offen offset:3072 sc1
    buffer_load_dwordx4 v[168:171], v5, s[20:23], s48 offen offset:3072 sc1
    buffer_load_dwordx4 v[172:175], v5, s[20:23], s49 offen offset:3072 sc1
    buffer_load_dwordx4 v[176:179], v5, s[20:23], s50 offen offset:3072 sc1
    s_waitcnt vmcnt(12)
    v_mfma_f32_16x16x32_bf16 v[20:23], a[32:35], v[120:123], 0
    s_add_u32 s47, s47, 4096
    buffer_load_dwordx4 v[180:183], v5, s[20:23], s47 offen offset:0 sc1
    v_mfma_f32_16x16x32_bf16 v[36:39], a[36:39], v[120:123], 0
    s_add_u32 s48, s48, 4096
    buffer_load_dwordx4 v[184:187], v5, s[20:23], s48 offen offset:0 sc1
    v_mfma_f32_16x16x32_bf16 v[52:55], a[40:43], v[120:123], 0
    s_add_u32 s49, s49, 4096
    buffer_load_dwordx4 v[188:191], v5, s[20:23], s49 offen offset:0 sc1
    v_mfma_f32_16x16x32_bf16 v[68:71], a[44:47], v[120:123], 0
    s_add_u32 s50, s50, 4096
    buffer_load_dwordx4 v[192:195], v5, s[20:23], s50 offen offset:0 sc1
    v_mfma_f32_16x16x32_bf16 v[84:87], a[48:51], v[120:123], 0
    buffer_load_dwordx4 v[196:199], v5, s[20:23], s47 offen offset:1024 sc1
    v_mfma_f32_16x16x32_bf16 v[24:27], a[32:35], v[124:127], 0
    buffer_load_dwordx4 v[200:203], v5, s[20:23], s48 offen offset:1024 sc1
    v_mfma_f32_16x16x32_bf16 v[40:43], a[36:39], v[124:127], 0
    buffer_load_dwordx4 v[204:207], v5, s[20:23], s49 offen offset:1024 sc1
    v_mfma_f32_16x16x32_bf16 v[56:59], a[40:43], v[124:127], 0
    buffer_load_dwordx4 v[208:211], v5, s[20:23], s50 offen offset:1024 sc1
    v_mfma_f32_16x16x32_bf16 v[72:75], a[44:47], v[124:127], 0
    v_mfma_f32_16x16x32_bf16 v[88:91], a[48:51], v[124:127], 0
    v_mfma_f32_16x16x32_bf16 v[28:31], a[32:35], v[128:131], 0
    v_mfma_f32_16x16x32_bf16 v[44:47], a[36:39], v[128:131], 0
    v_mfma_f32_16x16x32_bf16 v[60:63], a[40:43], v[128:131], 0
    v_mfma_f32_16x16x32_bf16 v[76:79], a[44:47], v[128:131], 0
    v_mfma_f32_16x16x32_bf16 v[92:95], a[48:51], v[128:131], 0
    v_mfma_f32_16x16x32_bf16 v[16:19], a[32:35], v[116:119], 0
    v_mfma_f32_16x16x32_bf16 v[32:35], a[36:39], v[116:119], 0
    v_mfma_f32_16x16x32_bf16 v[48:51], a[40:43], v[116:119], 0
    v_mfma_f32_16x16x32_bf16 v[64:67], a[44:47], v[116:119], 0
    v_mfma_f32_16x16x32_bf16 v[80:83], a[48:51], v[116:119], 0
    s_waitcnt vmcnt(16)
    v_mfma_f32_16x16x32_bf16 v[20:23], a[52:55], v[136:139], v[20:23]
    buffer_load_dwordx4 v[116:119], v5, s[20:23], s47 offen offset:2048 sc1
    v_mfma_f32_16x16x32_bf16 v[36:39], a[56:59], v[136:139], v[36:39]
    buffer_load_dwordx4 v[120:123], v5, s[20:23], s48 offen offset:2048 sc1
    v_mfma_f32_16x16x32_bf16 v[52:55], a[60:63], v[136:139], v[52:55]
    buffer_load_dwordx4 v[124:127], v5, s[20:23], s49 offen offset:2048 sc1
    v_mfma_f32_16x16x32_bf16 v[68:71], a[64:67], v[136:139], v[68:71]
    buffer_load_dwordx4 v[128:131], v5, s[20:23], s50 offen offset:2048 sc1
    v_mfma_f32_16x16x32_bf16 v[84:87], a[68:71], v[136:139], v[84:87]
    v_mfma_f32_16x16x32_bf16 v[24:27], a[52:55], v[140:143], v[24:27]
    v_mfma_f32_16x16x32_bf16 v[40:43], a[56:59], v[140:143], v[40:43]
    v_mfma_f32_16x16x32_bf16 v[56:59], a[60:63], v[140:143], v[56:59]
    v_mfma_f32_16x16x32_bf16 v[72:75], a[64:67], v[140:143], v[72:75]
    v_mfma_f32_16x16x32_bf16 v[88:91], a[68:71], v[140:143], v[88:91]
    v_mfma_f32_16x16x32_bf16 v[28:31], a[52:55], v[144:147], v[28:31]
    v_mfma_f32_16x16x32_bf16 v[44:47], a[56:59], v[144:147], v[44:47]
    v_mfma_f32_16x16x32_bf16 v[60:63], a[60:63], v[144:147], v[60:63]
    v_mfma_f32_16x16x32_bf16 v[76:79], a[64:67], v[144:147], v[76:79]
    v_mfma_f32_16x16x32_bf16 v[92:95], a[68:71], v[144:147], v[92:95]
    v_mfma_f32_16x16x32_bf16 v[16:19], a[52:55], v[132:135], v[16:19]
    v_mfma_f32_16x16x32_bf16 v[32:35], a[56:59], v[132:135], v[32:35]
    v_mfma_f32_16x16x32_bf16 v[48:51], a[60:63], v[132:135], v[48:51]
    v_mfma_f32_16x16x32_bf16 v[64:67], a[64:67], v[132:135], v[64:67]
    v_mfma_f32_16x16x32_bf16 v[80:83], a[68:71], v[132:135], v[80:83]
    s_waitcnt vmcnt(16)
    v_mfma_f32_16x16x32_bf16 v[20:23], a[72:75], v[152:155], v[20:23]
    buffer_load_dwordx4 v[132:135], v5, s[20:23], s47 offen offset:3072 sc1
    v_mfma_f32_16x16x32_bf16 v[36:39], a[76:79], v[152:155], v[36:39]
    buffer_load_dwordx4 v[136:139], v5, s[20:23], s48 offen offset:3072 sc1
    v_mfma_f32_16x16x32_bf16 v[52:55], a[80:83], v[152:155], v[52:55]
    buffer_load_dwordx4 v[140:143], v5, s[20:23], s49 offen offset:3072 sc1
    v_mfma_f32_16x16x32_bf16 v[68:71], a[84:87], v[152:155], v[68:71]
    buffer_load_dwordx4 v[144:147], v5, s[20:23], s50 offen offset:3072 sc1
    v_mfma_f32_16x16x32_bf16 v[84:87], a[88:91], v[152:155], v[84:87]
    s_add_u32 s26, s26, 4096
    buffer_load_dwordx4 a[32:35], v5, s[16:19], s26 offen offset:0 sc1
    v_mfma_f32_16x16x32_bf16 v[24:27], a[72:75], v[156:159], v[24:27]
    s_add_u32 s27, s27, 4096
    buffer_load_dwordx4 a[36:39], v5, s[16:19], s27 offen offset:0 sc1
    v_mfma_f32_16x16x32_bf16 v[40:43], a[76:79], v[156:159], v[40:43]
    s_add_u32 s28, s28, 4096
    buffer_load_dwordx4 a[40:43], v5, s[16:19], s28 offen offset:0 sc1
    v_mfma_f32_16x16x32_bf16 v[56:59], a[80:83], v[156:159], v[56:59]
    s_add_u32 s29, s29, 4096
    buffer_load_dwordx4 a[44:47], v5, s[16:19], s29 offen offset:0 sc1
    v_mfma_f32_16x16x32_bf16 v[72:75], a[84:87], v[156:159], v[72:75]
    s_add_u32 s30, s30, 4096
    buffer_load_dwordx4 a[48:51], v10, s[16:19], s30 offen offset:0 sc1
    v_mfma_f32_16x16x32_bf16 v[88:91], a[88:91], v[156:159], v[88:91]
    v_mfma_f32_16x16x32_bf16 v[28:31], a[72:75], v[160:163], v[28:31]
    v_mfma_f32_16x16x32_bf16 v[44:47], a[76:79], v[160:163], v[44:47]
    v_mfma_f32_16x16x32_bf16 v[60:63], a[80:83], v[160:163], v[60:63]
    v_mfma_f32_16x16x32_bf16 v[76:79], a[84:87], v[160:163], v[76:79]
    v_mfma_f32_16x16x32_bf16 v[92:95], a[88:91], v[160:163], v[92:95]
    v_mfma_f32_16x16x32_bf16 v[16:19], a[72:75], v[148:151], v[16:19]
    v_mfma_f32_16x16x32_bf16 v[32:35], a[76:79], v[148:151], v[32:35]
    v_mfma_f32_16x16x32_bf16 v[48:51], a[80:83], v[148:151], v[48:51]
    v_mfma_f32_16x16x32_bf16 v[64:67], a[84:87], v[148:151], v[64:67]
    v_mfma_f32_16x16x32_bf16 v[80:83], a[88:91], v[148:151], v[80:83]
    s_waitcnt vmcnt(21)
    v_mfma_f32_16x16x32_bf16 v[20:23], a[92:95], v[168:171], v[20:23]
    s_add_u32 s47, s47, 4096
    buffer_load_dwordx4 v[148:151], v5, s[20:23], s47 offen offset:0 sc1
    v_mfma_f32_16x16x32_bf16 v[36:39], a[96:99], v[168:171], v[36:39]
    s_add_u32 s48, s48, 4096
    buffer_load_dwordx4 v[152:155], v5, s[20:23], s48 offen offset:0 sc1
    v_mfma_f32_16x16x32_bf16 v[52:55], a[100:103], v[168:171], v[52:55]
    s_add_u32 s49, s49, 4096
    buffer_load_dwordx4 v[156:159], v5, s[20:23], s49 offen offset:0 sc1
    v_mfma_f32_16x16x32_bf16 v[68:71], a[104:107], v[168:171], v[68:71]
    s_add_u32 s50, s50, 4096
    buffer_load_dwordx4 v[160:163], v5, s[20:23], s50 offen offset:0 sc1
    v_mfma_f32_16x16x32_bf16 v[84:87], a[108:111], v[168:171], v[84:87]
    buffer_load_dwordx4 a[52:55], v5, s[16:19], s26 offen offset:1024 sc1
    v_mfma_f32_16x16x32_bf16 v[24:27], a[92:95], v[172:175], v[24:27]
    buffer_load_dwordx4 a[56:59], v5, s[16:19], s27 offen offset:1024 sc1
    v_mfma_f32_16x16x32_bf16 v[40:43], a[96:99], v[172:175], v[40:43]
    buffer_load_dwordx4 a[60:63], v5, s[16:19], s28 offen offset:1024 sc1
    v_mfma_f32_16x16x32_bf16 v[56:59], a[100:103], v[172:175], v[56:59]
    buffer_load_dwordx4 a[64:67], v5, s[16:19], s29 offen offset:1024 sc1
    v_mfma_f32_16x16x32_bf16 v[72:75], a[104:107], v[172:175], v[72:75]
    buffer_load_dwordx4 a[68:71], v10, s[16:19], s30 offen offset:1024 sc1
    v_mfma_f32_16x16x32_bf16 v[88:91], a[108:111], v[172:175], v[88:91]
    v_mfma_f32_16x16x32_bf16 v[28:31], a[92:95], v[176:179], v[28:31]
    v_mfma_f32_16x16x32_bf16 v[44:47], a[96:99], v[176:179], v[44:47]
    v_mfma_f32_16x16x32_bf16 v[60:63], a[100:103], v[176:179], v[60:63]
    v_mfma_f32_16x16x32_bf16 v[76:79], a[104:107], v[176:179], v[76:79]
    v_mfma_f32_16x16x32_bf16 v[92:95], a[108:111], v[176:179], v[92:95]
    v_mfma_f32_16x16x32_bf16 v[16:19], a[92:95], v[164:167], v[16:19]
    v_mfma_f32_16x16x32_bf16 v[32:35], a[96:99], v[164:167], v[32:35]
    v_mfma_f32_16x16x32_bf16 v[48:51], a[100:103], v[164:167], v[48:51]
    v_mfma_f32_16x16x32_bf16 v[64:67], a[104:107], v[164:167], v[64:67]
    v_mfma_f32_16x16x32_bf16 v[80:83], a[108:111], v[164:167], v[80:83]
    s_waitcnt vmcnt(26)
    v_mfma_f32_16x16x32_bf16 v[20:23], a[112:115], v[184:187], v[20:23]
    buffer_load_dwordx4 v[164:167], v5, s[20:23], s47 offen offset:1024 sc1
    v_mfma_f32_16x16x32_bf16 v[36:39], a[116:119], v[184:187], v[36:39]
    buffer_load_dwordx4 v[168:171], v5, s[20:23], s48 offen offset:1024 sc1
    v_mfma_f32_16x16x32_bf16 v[52:55], a[120:123], v[184:187], v[52:55]
    buffer_load_dwordx4 v[172:175], v5, s[20:23], s49 offen offset:1024 sc1
    v_mfma_f32_16x16x32_bf16 v[68:71], a[124:127], v[184:187], v[68:71]
    buffer_load_dwordx4 v[176:179], v5, s[20:23], s50 offen offset:1024 sc1
    v_mfma_f32_16x16x32_bf16 v[84:87], a[128:131], v[184:187], v[84:87]
    buffer_load_dwordx4 a[72:75], v5, s[16:19], s26 offen offset:2048 sc1
    v_mfma_f32_16x16x32_bf16 v[24:27], a[112:115], v[188:191], v[24:27]
    buffer_load_dwordx4 a[76:79], v5, s[16:19], s27 offen offset:2048 sc1
    v_mfma_f32_16x16x32_bf16 v[40:43], a[116:119], v[188:191], v[40:43]
    buffer_load_dwordx4 a[80:83], v5, s[16:19], s28 offen offset:2048 sc1
    v_mfma_f32_16x16x32_bf16 v[56:59], a[120:123], v[188:191], v[56:59]
    buffer_load_dwordx4 a[84:87], v5, s[16:19], s29 offen offset:2048 sc1
    v_mfma_f32_16x16x32_bf16 v[72:75], a[124:127], v[188:191], v[72:75]
    buffer_load_dwordx4 a[88:91], v10, s[16:19], s30 offen offset:2048 sc1
    v_mfma_f32_16x16x32_bf16 v[88:91], a[128:131], v[188:191], v[88:91]
    v_mfma_f32_16x16x32_bf16 v[28:31], a[112:115], v[192:195], v[28:31]
    v_mfma_f32_16x16x32_bf16 v[44:47], a[116:119], v[192:195], v[44:47]
    v_mfma_f32_16x16x32_bf16 v[60:63], a[120:123], v[192:195], v[60:63]
    v_mfma_f32_16x16x32_bf16 v[76:79], a[124:127], v[192:195], v[76:79]
    v_mfma_f32_16x16x32_bf16 v[92:95], a[128:131], v[192:195], v[92:95]
    v_mfma_f32_16x16x32_bf16 v[16:19], a[112:115], v[180:183], v[16:19]
    v_mfma_f32_16x16x32_bf16 v[32:35], a[116:119], v[180:183], v[32:35]
    v_mfma_f32_16x16x32_bf16 v[48:51], a[120:123], v[180:183], v[48:51]
    v_mfma_f32_16x16x32_bf16 v[64:67], a[124:127], v[180:183], v[64:67]
    v_mfma_f32_16x16x32_bf16 v[80:83], a[128:131], v[180:183], v[80:83]
    s_waitcnt vmcnt(31)
    v_mfma_f32_16x16x32_bf16 v[20:23], a[132:135], v[200:203], v[20:23]
    buffer_load_dwordx4 v[180:183], v5, s[20:23], s47 offen offset:2048 sc1
    v_mfma_f32_16x16x32_bf16 v[36:39], a[136:139], v[200:203], v[36:39]
    buffer_load_dwordx4 v[184:187], v5, s[20:23], s48 offen offset:2048 sc1
    v_mfma_f32_16x16x32_bf16 v[52:55], a[140:143], v[200:203], v[52:55]
    buffer_load_dwordx4 v[188:191], v5, s[20:23], s49 offen offset:2048 sc1
    v_mfma_f32_16x16x32_bf16 v[68:71], a[144:147], v[200:203], v[68:71]
    buffer_load_dwordx4 v[192:195], v5, s[20:23], s50 offen offset:2048 sc1
    v_mfma_f32_16x16x32_bf16 v[84:87], a[148:151], v[200:203], v[84:87]
    buffer_load_dwordx4 a[92:95], v5, s[16:19], s26 offen offset:3072 sc1
    v_mfma_f32_16x16x32_bf16 v[24:27], a[132:135], v[204:207], v[24:27]
    buffer_load_dwordx4 a[96:99], v5, s[16:19], s27 offen offset:3072 sc1
    v_mfma_f32_16x16x32_bf16 v[40:43], a[136:139], v[204:207], v[40:43]
    buffer_load_dwordx4 a[100:103], v5, s[16:19], s28 offen offset:3072 sc1
    v_mfma_f32_16x16x32_bf16 v[56:59], a[140:143], v[204:207], v[56:59]
    buffer_load_dwordx4 a[104:107], v5, s[16:19], s29 offen offset:3072 sc1
    v_mfma_f32_16x16x32_bf16 v[72:75], a[144:147], v[204:207], v[72:75]
    buffer_load_dwordx4 a[108:111], v10, s[16:19], s30 offen offset:3072 sc1
    v_mfma_f32_16x16x32_bf16 v[88:91], a[148:151], v[204:207], v[88:91]
    v_mfma_f32_16x16x32_bf16 v[28:31], a[132:135], v[208:211], v[28:31]
    v_mfma_f32_16x16x32_bf16 v[44:47], a[136:139], v[208:211], v[44:47]
    v_mfma_f32_16x16x32_bf16 v[60:63], a[140:143], v[208:211], v[60:63]
    v_mfma_f32_16x16x32_bf16 v[76:79], a[144:147], v[208:211], v[76:79]
    v_mfma_f32_16x16x32_bf16 v[92:95], a[148:151], v[208:211], v[92:95]
    v_mfma_f32_16x16x32_bf16 v[16:19], a[132:135], v[196:199], v[16:19]
    v_mfma_f32_16x16x32_bf16 v[32:35], a[136:139], v[196:199], v[32:35]
    v_mfma_f32_16x16x32_bf16 v[48:51], a[140:143], v[196:199], v[48:51]
    v_mfma_f32_16x16x32_bf16 v[64:67], a[144:147], v[196:199], v[64:67]
    v_mfma_f32_16x16x32_bf16 v[80:83], a[148:151], v[196:199], v[80:83]
    s_waitcnt vmcnt(36)
    v_mfma_f32_16x16x32_bf16 v[20:23], a[152:155], v[120:123], v[20:23]
    buffer_load_dwordx4 v[196:199], v5, s[20:23], s47 offen offset:3072 sc1
    v_mfma_f32_16x16x32_bf16 v[36:39], a[156:159], v[120:123], v[36:39]
    buffer_load_dwordx4 v[200:203], v5, s[20:23], s48 offen offset:3072 sc1
    v_mfma_f32_16x16x32_bf16 v[52:55], a[160:163], v[120:123], v[52:55]
    buffer_load_dwordx4 v[204:207], v5, s[20:23], s49 offen offset:3072 sc1
    v_mfma_f32_16x16x32_bf16 v[68:71], a[164:167], v[120:123], v[68:71]
    buffer_load_dwordx4 v[208:211], v5, s[20:23], s50 offen offset:3072 sc1
    v_mfma_f32_16x16x32_bf16 v[84:87], a[168:171], v[120:123], v[84:87]
    s_add_u32 s26, s26, 4096
    buffer_load_dwordx4 a[112:115], v5, s[16:19], s26 offen offset:0 sc1
    v_mfma_f32_16x16x32_bf16 v[24:27], a[152:155], v[124:127], v[24:27]
    s_add_u32 s27, s27, 4096
    buffer_load_dwordx4 a[116:119], v5, s[16:19], s27 offen offset:0 sc1
    v_mfma_f32_16x16x32_bf16 v[40:43], a[156:159], v[124:127], v[40:43]
    s_add_u32 s28, s28, 4096
    buffer_load_dwordx4 a[120:123], v5, s[16:19], s28 offen offset:0 sc1
    v_mfma_f32_16x16x32_bf16 v[56:59], a[160:163], v[124:127], v[56:59]
    s_add_u32 s29, s29, 4096
    buffer_load_dwordx4 a[124:127], v5, s[16:19], s29 offen offset:0 sc1
    v_mfma_f32_16x16x32_bf16 v[72:75], a[164:167], v[124:127], v[72:75]
    s_add_u32 s30, s30, 4096
    buffer_load_dwordx4 a[128:131], v10, s[16:19], s30 offen offset:0 sc1
    v_mfma_f32_16x16x32_bf16 v[88:91], a[168:171], v[124:127], v[88:91]
    v_mfma_f32_16x16x32_bf16 v[28:31], a[152:155], v[128:131], v[28:31]
    v_mfma_f32_16x16x32_bf16 v[44:47], a[156:159], v[128:131], v[44:47]
    v_mfma_f32_16x16x32_bf16 v[60:63], a[160:163], v[128:131], v[60:63]
    v_mfma_f32_16x16x32_bf16 v[76:79], a[164:167], v[128:131], v[76:79]
    v_mfma_f32_16x16x32_bf16 v[92:95], a[168:171], v[128:131], v[92:95]
    v_mfma_f32_16x16x32_bf16 v[16:19], a[152:155], v[116:119], v[16:19]
    v_mfma_f32_16x16x32_bf16 v[32:35], a[156:159], v[116:119], v[32:35]
    v_mfma_f32_16x16x32_bf16 v[48:51], a[160:163], v[116:119], v[48:51]
    v_mfma_f32_16x16x32_bf16 v[64:67], a[164:167], v[116:119], v[64:67]
    v_mfma_f32_16x16x32_bf16 v[80:83], a[168:171], v[116:119], v[80:83]
    s_waitcnt vmcnt(41)
    v_mfma_f32_16x16x32_bf16 v[20:23], a[0:3], v[136:139], v[20:23]
    s_add_u32 s47, s47, 4096
    buffer_load_dwordx4 v[116:119], v5, s[20:23], s47 offen offset:0 sc1
    v_mfma_f32_16x16x32_bf16 v[36:39], a[4:7], v[136:139], v[36:39]
    s_add_u32 s48, s48, 4096
    buffer_load_dwordx4 v[120:123], v5, s[20:23], s48 offen offset:0 sc1
    v_mfma_f32_16x16x32_bf16 v[52:55], a[8:11], v[136:139], v[52:55]
    s_add_u32 s49, s49, 4096
    buffer_load_dwordx4 v[124:127], v5, s[20:23], s49 offen offset:0 sc1
    v_mfma_f32_16x16x32_bf16 v[68:71], a[12:15], v[136:139], v[68:71]
    s_add_u32 s50, s50, 4096
    buffer_load_dwordx4 v[128:131], v5, s[20:23], s50 offen offset:0 sc1
    v_mfma_f32_16x16x32_bf16 v[84:87], a[16:19], v[136:139], v[84:87]
    buffer_load_dwordx4 a[132:135], v5, s[16:19], s26 offen offset:1024 sc1
    v_mfma_f32_16x16x32_bf16 v[24:27], a[0:3], v[140:143], v[24:27]
    buffer_load_dwordx4 a[136:139], v5, s[16:19], s27 offen offset:1024 sc1
    v_mfma_f32_16x16x32_bf16 v[40:43], a[4:7], v[140:143], v[40:43]
    buffer_load_dwordx4 a[140:143], v5, s[16:19], s28 offen offset:1024 sc1
    v_mfma_f32_16x16x32_bf16 v[56:59], a[8:11], v[140:143], v[56:59]
    buffer_load_dwordx4 a[144:147], v5, s[16:19], s29 offen offset:1024 sc1
    v_mfma_f32_16x16x32_bf16 v[72:75], a[12:15], v[140:143], v[72:75]
    buffer_load_dwordx4 a[148:151], v10, s[16:19], s30 offen offset:1024 sc1
    v_mfma_f32_16x16x32_bf16 v[88:91], a[16:19], v[140:143], v[88:91]
    v_mfma_f32_16x16x32_bf16 v[28:31], a[0:3], v[144:147], v[28:31]
    v_mfma_f32_16x16x32_bf16 v[44:47], a[4:7], v[144:147], v[44:47]
    v_mfma_f32_16x16x32_bf16 v[60:63], a[8:11], v[144:147], v[60:63]
    v_mfma_f32_16x16x32_bf16 v[76:79], a[12:15], v[144:147], v[76:79]
    v_mfma_f32_16x16x32_bf16 v[92:95], a[16:19], v[144:147], v[92:95]
    v_mfma_f32_16x16x32_bf16 v[16:19], a[0:3], v[132:135], v[16:19]
    v_mfma_f32_16x16x32_bf16 v[32:35], a[4:7], v[132:135], v[32:35]
    v_mfma_f32_16x16x32_bf16 v[48:51], a[8:11], v[132:135], v[48:51]
    v_mfma_f32_16x16x32_bf16 v[64:67], a[12:15], v[132:135], v[64:67]
    v_mfma_f32_16x16x32_bf16 v[80:83], a[16:19], v[132:135], v[80:83]
    s_waitcnt vmcnt(41)
    v_mfma_f32_16x16x32_bf16 v[20:23], a[20:23], v[152:155], v[20:23]
    buffer_load_dwordx4 v[132:135], v5, s[20:23], s47 offen offset:1024 sc1
    v_mfma_f32_16x16x32_bf16 v[36:39], a[24:27], v[152:155], v[36:39]
    buffer_load_dwordx4 v[136:139], v5, s[20:23], s48 offen offset:1024 sc1
    v_mfma_f32_16x16x32_bf16 v[52:55], a[28:31], v[152:155], v[52:55]
    buffer_load_dwordx4 v[140:143], v5, s[20:23], s49 offen offset:1024 sc1
    v_mfma_f32_16x16x32_bf16 v[68:71], a[172:175], v[152:155], v[68:71]
    buffer_load_dwordx4 v[144:147], v5, s[20:23], s50 offen offset:1024 sc1
    v_mfma_f32_16x16x32_bf16 v[84:87], a[176:179], v[152:155], v[84:87]
    v_mfma_f32_16x16x32_bf16 v[24:27], a[20:23], v[156:159], v[24:27]
    v_mfma_f32_16x16x32_bf16 v[40:43], a[24:27], v[156:159], v[40:43]
    v_mfma_f32_16x16x32_bf16 v[56:59], a[28:31], v[156:159], v[56:59]
    v_mfma_f32_16x16x32_bf16 v[72:75], a[172:175], v[156:159], v[72:75]
    v_mfma_f32_16x16x32_bf16 v[88:91], a[176:179], v[156:159], v[88:91]
    v_mfma_f32_16x16x32_bf16 v[28:31], a[20:23], v[160:163], v[28:31]
    v_mfma_f32_16x16x32_bf16 v[44:47], a[24:27], v[160:163], v[44:47]
    v_mfma_f32_16x16x32_bf16 v[60:63], a[28:31], v[160:163], v[60:63]
    v_mfma_f32_16x16x32_bf16 v[76:79], a[172:175], v[160:163], v[76:79]
    v_mfma_f32_16x16x32_bf16 v[92:95], a[176:179], v[160:163], v[92:95]
    v_mfma_f32_16x16x32_bf16 v[16:19], a[20:23], v[148:151], v[16:19]
    v_mfma_f32_16x16x32_bf16 v[32:35], a[24:27], v[148:151], v[32:35]
    v_mfma_f32_16x16x32_bf16 v[48:51], a[28:31], v[148:151], v[48:51]
    v_mfma_f32_16x16x32_bf16 v[64:67], a[172:175], v[148:151], v[64:67]
    v_mfma_f32_16x16x32_bf16 v[80:83], a[176:179], v[148:151], v[80:83]
    s_waitcnt vmcnt(36)
    v_mfma_f32_16x16x32_bf16 v[20:23], a[180:183], v[168:171], v[20:23]
    buffer_load_dwordx4 v[148:151], v5, s[20:23], s47 offen offset:2048 sc1
    v_mfma_f32_16x16x32_bf16 v[36:39], a[184:187], v[168:171], v[36:39]
    buffer_load_dwordx4 v[152:155], v5, s[20:23], s48 offen offset:2048 sc1
    v_mfma_f32_16x16x32_bf16 v[52:55], a[188:191], v[168:171], v[52:55]
    buffer_load_dwordx4 v[156:159], v5, s[20:23], s49 offen offset:2048 sc1
    v_mfma_f32_16x16x32_bf16 v[68:71], a[192:195], v[168:171], v[68:71]
    buffer_load_dwordx4 v[160:163], v5, s[20:23], s50 offen offset:2048 sc1
    v_mfma_f32_16x16x32_bf16 v[84:87], a[196:199], v[168:171], v[84:87]
    v_mfma_f32_16x16x32_bf16 v[24:27], a[180:183], v[172:175], v[24:27]
    v_mfma_f32_16x16x32_bf16 v[40:43], a[184:187], v[172:175], v[40:43]
    v_mfma_f32_16x16x32_bf16 v[56:59], a[188:191], v[172:175], v[56:59]
    v_mfma_f32_16x16x32_bf16 v[72:75], a[192:195], v[172:175], v[72:75]
    v_mfma_f32_16x16x32_bf16 v[88:91], a[196:199], v[172:175], v[88:91]
    v_mfma_f32_16x16x32_bf16 v[28:31], a[180:183], v[176:179], v[28:31]
    v_mfma_f32_16x16x32_bf16 v[44:47], a[184:187], v[176:179], v[44:47]
    v_mfma_f32_16x16x32_bf16 v[60:63], a[188:191], v[176:179], v[60:63]
    v_mfma_f32_16x16x32_bf16 v[76:79], a[192:195], v[176:179], v[76:79]
    v_mfma_f32_16x16x32_bf16 v[92:95], a[196:199], v[176:179], v[92:95]
    v_mfma_f32_16x16x32_bf16 v[16:19], a[180:183], v[164:167], v[16:19]
    v_mfma_f32_16x16x32_bf16 v[32:35], a[184:187], v[164:167], v[32:35]
    v_mfma_f32_16x16x32_bf16 v[48:51], a[188:191], v[164:167], v[48:51]
    v_mfma_f32_16x16x32_bf16 v[64:67], a[192:195], v[164:167], v[64:67]
    v_mfma_f32_16x16x32_bf16 v[80:83], a[196:199], v[164:167], v[80:83]
    s_waitcnt vmcnt(31)
    v_mfma_f32_16x16x32_bf16 v[20:23], a[200:203], v[184:187], v[20:23]
    buffer_load_dwordx4 v[164:167], v5, s[20:23], s47 offen offset:3072 sc1
    v_mfma_f32_16x16x32_bf16 v[36:39], a[204:207], v[184:187], v[36:39]
    buffer_load_dwordx4 v[168:171], v5, s[20:23], s48 offen offset:3072 sc1
    v_mfma_f32_16x16x32_bf16 v[52:55], a[208:211], v[184:187], v[52:55]
    buffer_load_dwordx4 v[172:175], v5, s[20:23], s49 offen offset:3072 sc1
    v_mfma_f32_16x16x32_bf16 v[68:71], a[212:215], v[184:187], v[68:71]
    buffer_load_dwordx4 v[176:179], v5, s[20:23], s50 offen offset:3072 sc1
    v_mfma_f32_16x16x32_bf16 v[84:87], a[216:219], v[184:187], v[84:87]
    v_mfma_f32_16x16x32_bf16 v[24:27], a[200:203], v[188:191], v[24:27]
    v_mfma_f32_16x16x32_bf16 v[40:43], a[204:207], v[188:191], v[40:43]
    v_mfma_f32_16x16x32_bf16 v[56:59], a[208:211], v[188:191], v[56:59]
    v_mfma_f32_16x16x32_bf16 v[72:75], a[212:215], v[188:191], v[72:75]
    v_mfma_f32_16x16x32_bf16 v[88:91], a[216:219], v[188:191], v[88:91]
    v_mfma_f32_16x16x32_bf16 v[28:31], a[200:203], v[192:195], v[28:31]
    v_mfma_f32_16x16x32_bf16 v[44:47], a[204:207], v[192:195], v[44:47]
    v_mfma_f32_16x16x32_bf16 v[60:63], a[208:211], v[192:195], v[60:63]
    v_mfma_f32_16x16x32_bf16 v[76:79], a[212:215], v[192:195], v[76:79]
    v_mfma_f32_16x16x32_bf16 v[92:95], a[216:219], v[192:195], v[92:95]
    v_mfma_f32_16x16x32_bf16 v[16:19], a[200:203], v[180:183], v[16:19]
    v_mfma_f32_16x16x32_bf16 v[32:35], a[204:207], v[180:183], v[32:35]
    v_mfma_f32_16x16x32_bf16 v[48:51], a[208:211], v[180:183], v[48:51]
    v_mfma_f32_16x16x32_bf16 v[64:67], a[212:215], v[180:183], v[64:67]
    v_mfma_f32_16x16x32_bf16 v[80:83], a[216:219], v[180:183], v[80:83]
    s_waitcnt vmcnt(26)
    v_mfma_f32_16x16x32_bf16 v[20:23], a[220:223], v[200:203], v[20:23]
    s_add_u32 s47, s47, 4096
    buffer_load_dwordx4 v[180:183], v5, s[20:23], s47 offen offset:0 sc1
    v_mfma_f32_16x16x32_bf16 v[36:39], a[224:227], v[200:203], v[36:39]
    s_add_u32 s48, s48, 4096
    buffer_load_dwordx4 v[184:187], v5, s[20:23], s48 offen offset:0 sc1
    v_mfma_f32_16x16x32_bf16 v[52:55], a[228:231], v[200:203], v[52:55]
    s_add_u32 s49, s49, 4096
    buffer_load_dwordx4 v[188:191], v5, s[20:23], s49 offen offset:0 sc1
    v_mfma_f32_16x16x32_bf16 v[68:71], a[232:235], v[200:203], v[68:71]
    s_add_u32 s50, s50, 4096
    buffer_load_dwordx4 v[192:195], v5, s[20:23], s50 offen offset:0 sc1
    v_mfma_f32_16x16x32_bf16 v[84:87], a[236:239], v[200:203], v[84:87]
    v_mfma_f32_16x16x32_bf16 v[24:27], a[220:223], v[204:207], v[24:27]
    v_mfma_f32_16x16x32_bf16 v[40:43], a[224:227], v[204:207], v[40:43]
    v_mfma_f32_16x16x32_bf16 v[56:59], a[228:231], v[204:207], v[56:59]
    v_mfma_f32_16x16x32_bf16 v[72:75], a[232:235], v[204:207], v[72:75]
    v_mfma_f32_16x16x32_bf16 v[88:91], a[236:239], v[204:207], v[88:91]
    v_mfma_f32_16x16x32_bf16 v[28:31], a[220:223], v[208:211], v[28:31]
    v_mfma_f32_16x16x32_bf16 v[44:47], a[224:227], v[208:211], v[44:47]
    v_mfma_f32_16x16x32_bf16 v[60:63], a[228:231], v[208:211], v[60:63]
    v_mfma_f32_16x16x32_bf16 v[76:79], a[232:235], v[208:211], v[76:79]
    v_mfma_f32_16x16x32_bf16 v[92:95], a[236:239], v[208:211], v[92:95]
    v_mfma_f32_16x16x32_bf16 v[16:19], a[220:223], v[196:199], v[16:19]
    v_mfma_f32_16x16x32_bf16 v[32:35], a[224:227], v[196:199], v[32:35]
    v_mfma_f32_16x16x32_bf16 v[48:51], a[228:231], v[196:199], v[48:51]
    v_mfma_f32_16x16x32_bf16 v[64:67], a[232:235], v[196:199], v[64:67]
    v_mfma_f32_16x16x32_bf16 v[80:83], a[236:239], v[196:199], v[80:83]
    s_waitcnt vmcnt(21)
    v_mfma_f32_16x16x32_bf16 v[20:23], a[32:35], v[120:123], v[20:23]
    buffer_load_dwordx4 v[196:199], v5, s[20:23], s47 offen offset:1024 sc1
    v_mfma_f32_16x16x32_bf16 v[36:39], a[36:39], v[120:123], v[36:39]
    buffer_load_dwordx4 v[200:203], v5, s[20:23], s48 offen offset:1024 sc1
    v_mfma_f32_16x16x32_bf16 v[52:55], a[40:43], v[120:123], v[52:55]
    buffer_load_dwordx4 v[204:207], v5, s[20:23], s49 offen offset:1024 sc1
    v_mfma_f32_16x16x32_bf16 v[68:71], a[44:47], v[120:123], v[68:71]
    buffer_load_dwordx4 v[208:211], v5, s[20:23], s50 offen offset:1024 sc1
    v_mfma_f32_16x16x32_bf16 v[84:87], a[48:51], v[120:123], v[84:87]
    v_mfma_f32_16x16x32_bf16 v[24:27], a[32:35], v[124:127], v[24:27]
    v_mfma_f32_16x16x32_bf16 v[40:43], a[36:39], v[124:127], v[40:43]
    v_mfma_f32_16x16x32_bf16 v[56:59], a[40:43], v[124:127], v[56:59]
    v_mfma_f32_16x16x32_bf16 v[72:75], a[44:47], v[124:127], v[72:75]
    v_mfma_f32_16x16x32_bf16 v[88:91], a[48:51], v[124:127], v[88:91]
    v_mfma_f32_16x16x32_bf16 v[28:31], a[32:35], v[128:131], v[28:31]
    v_mfma_f32_16x16x32_bf16 v[44:47], a[36:39], v[128:131], v[44:47]
    v_mfma_f32_16x16x32_bf16 v[60:63], a[40:43], v[128:131], v[60:63]
    v_mfma_f32_16x16x32_bf16 v[76:79], a[44:47], v[128:131], v[76:79]
    v_mfma_f32_16x16x32_bf16 v[92:95], a[48:51], v[128:131], v[92:95]
    v_mfma_f32_16x16x32_bf16 v[16:19], a[32:35], v[116:119], v[16:19]
    v_mfma_f32_16x16x32_bf16 v[32:35], a[36:39], v[116:119], v[32:35]
    v_mfma_f32_16x16x32_bf16 v[48:51], a[40:43], v[116:119], v[48:51]
    v_mfma_f32_16x16x32_bf16 v[64:67], a[44:47], v[116:119], v[64:67]
    v_mfma_f32_16x16x32_bf16 v[80:83], a[48:51], v[116:119], v[80:83]
    s_waitcnt vmcnt(16)
    v_mfma_f32_16x16x32_bf16 v[20:23], a[52:55], v[136:139], v[20:23]
    v_mfma_f32_16x16x32_bf16 v[36:39], a[56:59], v[136:139], v[36:39]
    v_mfma_f32_16x16x32_bf16 v[52:55], a[60:63], v[136:139], v[52:55]
    v_mfma_f32_16x16x32_bf16 v[68:71], a[64:67], v[136:139], v[68:71]
    v_mfma_f32_16x16x32_bf16 v[84:87], a[68:71], v[136:139], v[84:87]
    v_mfma_f32_16x16x32_bf16 v[24:27], a[52:55], v[140:143], v[24:27]
    v_mfma_f32_16x16x32_bf16 v[40:43], a[56:59], v[140:143], v[40:43]
    v_mfma_f32_16x16x32_bf16 v[56:59], a[60:63], v[140:143], v[56:59]
    v_mfma_f32_16x16x32_bf16 v[72:75], a[64:67], v[140:143], v[72:75]
    v_mfma_f32_16x16x32_bf16 v[88:91], a[68:71], v[140:143], v[88:91]
    v_mfma_f32_16x16x32_bf16 v[28:31], a[52:55], v[144:147], v[28:31]
    v_mfma_f32_16x16x32_bf16 v[44:47], a[56:59], v[144:147], v[44:47]
    v_mfma_f32_16x16x32_bf16 v[60:63], a[60:63], v[144:147], v[60:63]
    v_mfma_f32_16x16x32_bf16 v[76:79], a[64:67], v[144:147], v[76:79]
    v_mfma_f32_16x16x32_bf16 v[92:95], a[68:71], v[144:147], v[92:95]
    v_mfma_f32_16x16x32_bf16 v[16:19], a[52:55], v[132:135], v[16:19]
    v_mfma_f32_16x16x32_bf16 v[32:35], a[56:59], v[132:135], v[32:35]
    v_mfma_f32_16x16x32_bf16 v[48:51], a[60:63], v[132:135], v[48:51]
    v_mfma_f32_16x16x32_bf16 v[64:67], a[64:67], v[132:135], v[64:67]
    v_mfma_f32_16x16x32_bf16 v[80:83], a[68:71], v[132:135], v[80:83]
    s_waitcnt vmcnt(12)
    v_mfma_f32_16x16x32_bf16 v[20:23], a[72:75], v[152:155], v[20:23]
    v_mfma_f32_16x16x32_bf16 v[36:39], a[76:79], v[152:155], v[36:39]
    v_mfma_f32_16x16x32_bf16 v[52:55], a[80:83], v[152:155], v[52:55]
    v_mfma_f32_16x16x32_bf16 v[68:71], a[84:87], v[152:155], v[68:71]
    v_mfma_f32_16x16x32_bf16 v[84:87], a[88:91], v[152:155], v[84:87]
    v_mfma_f32_16x16x32_bf16 v[24:27], a[72:75], v[156:159], v[24:27]
    v_mfma_f32_16x16x32_bf16 v[40:43], a[76:79], v[156:159], v[40:43]
    v_mfma_f32_16x16x32_bf16 v[56:59], a[80:83], v[156:159], v[56:59]
    v_mfma_f32_16x16x32_bf16 v[72:75], a[84:87], v[156:159], v[72:75]
    v_mfma_f32_16x16x32_bf16 v[88:91], a[88:91], v[156:159], v[88:91]
    v_mfma_f32_16x16x32_bf16 v[28:31], a[72:75], v[160:163], v[28:31]
    v_mfma_f32_16x16x32_bf16 v[44:47], a[76:79], v[160:163], v[44:47]
    v_mfma_f32_16x16x32_bf16 v[60:63], a[80:83], v[160:163], v[60:63]
    v_mfma_f32_16x16x32_bf16 v[76:79], a[84:87], v[160:163], v[76:79]
    v_mfma_f32_16x16x32_bf16 v[92:95], a[88:91], v[160:163], v[92:95]
    v_mfma_f32_16x16x32_bf16 v[16:19], a[72:75], v[148:151], v[16:19]
    v_mfma_f32_16x16x32_bf16 v[32:35], a[76:79], v[148:151], v[32:35]
    v_mfma_f32_16x16x32_bf16 v[48:51], a[80:83], v[148:151], v[48:51]
    v_mfma_f32_16x16x32_bf16 v[64:67], a[84:87], v[148:151], v[64:67]
    v_mfma_f32_16x16x32_bf16 v[80:83], a[88:91], v[148:151], v[80:83]
    s_waitcnt vmcnt(8)
    v_mfma_f32_16x16x32_bf16 v[20:23], a[92:95], v[168:171], v[20:23]
    v_mfma_f32_16x16x32_bf16 v[36:39], a[96:99], v[168:171], v[36:39]
    v_mfma_f32_16x16x32_bf16 v[52:55], a[100:103], v[168:171], v[52:55]
    v_mfma_f32_16x16x32_bf16 v[68:71], a[104:107], v[168:171], v[68:71]
    v_mfma_f32_16x16x32_bf16 v[84:87], a[108:111], v[168:171], v[84:87]
    v_mfma_f32_16x16x32_bf16 v[24:27], a[92:95], v[172:175], v[24:27]
    v_mfma_f32_16x16x32_bf16 v[40:43], a[96:99], v[172:175], v[40:43]
    v_mfma_f32_16x16x32_bf16 v[56:59], a[100:103], v[172:175], v[56:59]
    v_mfma_f32_16x16x32_bf16 v[72:75], a[104:107], v[172:175], v[72:75]
    v_mfma_f32_16x16x32_bf16 v[88:91], a[108:111], v[172:175], v[88:91]
    v_mfma_f32_16x16x32_bf16 v[28:31], a[92:95], v[176:179], v[28:31]
    v_mfma_f32_16x16x32_bf16 v[44:47], a[96:99], v[176:179], v[44:47]
    v_mfma_f32_16x16x32_bf16 v[60:63], a[100:103], v[176:179], v[60:63]
    v_mfma_f32_16x16x32_bf16 v[76:79], a[104:107], v[176:179], v[76:79]
    v_mfma_f32_16x16x32_bf16 v[92:95], a[108:111], v[176:179], v[92:95]
    v_mfma_f32_16x16x32_bf16 v[16:19], a[92:95], v[164:167], v[16:19]
    v_mfma_f32_16x16x32_bf16 v[32:35], a[96:99], v[164:167], v[32:35]
    v_mfma_f32_16x16x32_bf16 v[48:51], a[100:103], v[164:167], v[48:51]
    v_mfma_f32_16x16x32_bf16 v[64:67], a[104:107], v[164:167], v[64:67]
    v_mfma_f32_16x16x32_bf16 v[80:83], a[108:111], v[164:167], v[80:83]
    s_waitcnt vmcnt(4)
    v_mfma_f32_16x16x32_bf16 v[20:23], a[112:115], v[184:187], v[20:23]
    v_mfma_f32_16x16x32_bf16 v[36:39], a[116:119], v[184:187], v[36:39]
    v_mfma_f32_16x16x32_bf16 v[52:55], a[120:123], v[184:187], v[52:55]
    v_mfma_f32_16x16x32_bf16 v[68:71], a[124:127], v[184:187], v[68:71]
    v_mfma_f32_16x16x32_bf16 v[84:87], a[128:131], v[184:187], v[84:87]
    v_mfma_f32_16x16x32_bf16 v[24:27], a[112:115], v[188:191], v[24:27]
    v_mfma_f32_16x16x32_bf16 v[40:43], a[116:119], v[188:191], v[40:43]
    v_mfma_f32_16x16x32_bf16 v[56:59], a[120:123], v[188:191], v[56:59]
    v_mfma_f32_16x16x32_bf16 v[72:75], a[124:127], v[188:191], v[72:75]
    v_mfma_f32_16x16x32_bf16 v[88:91], a[128:131], v[188:191], v[88:91]
    v_mfma_f32_16x16x32_bf16 v[28:31], a[112:115], v[192:195], v[28:31]
    v_mfma_f32_16x16x32_bf16 v[44:47], a[116:119], v[192:195], v[44:47]
    v_mfma_f32_16x16x32_bf16 v[60:63], a[120:123], v[192:195], v[60:63]
    v_mfma_f32_16x16x32_bf16 v[76:79], a[124:127], v[192:195], v[76:79]
    v_mfma_f32_16x16x32_bf16 v[92:95], a[128:131], v[192:195], v[92:95]
    v_mfma_f32_16x16x32_bf16 v[16:19], a[112:115], v[180:183], v[16:19]
    v_mfma_f32_16x16x32_bf16 v[32:35], a[116:119], v[180:183], v[32:35]
    v_mfma_f32_16x16x32_bf16 v[48:51], a[120:123], v[180:183], v[48:51]
    v_mfma_f32_16x16x32_bf16 v[64:67], a[124:127], v[180:183], v[64:67]
    v_mfma_f32_16x16x32_bf16 v[80:83], a[128:131], v[180:183], v[80:83]
    s_waitcnt vmcnt(0)
    v_mfma_f32_16x16x32_bf16 v[20:23], a[132:135], v[200:203], v[20:23]
    v_mfma_f32_16x16x32_bf16 v[36:39], a[136:139], v[200:203], v[36:39]
    v_mfma_f32_16x16x32_bf16 v[52:55], a[140:143], v[200:203], v[52:55]
    v_mfma_f32_16x16x32_bf16 v[68:71], a[144:147], v[200:203], v[68:71]
    v_mfma_f32_16x16x32_bf16 v[84:87], a[148:151], v[200:203], v[84:87]
    v_mfma_f32_16x16x32_bf16 v[24:27], a[132:135], v[204:207], v[24:27]
    v_mfma_f32_16x16x32_bf16 v[40:43], a[136:139], v[204:207], v[40:43]
    v_mfma_f32_16x16x32_bf16 v[56:59], a[140:143], v[204:207], v[56:59]
    v_mfma_f32_16x16x32_bf16 v[72:75], a[144:147], v[204:207], v[72:75]
    v_mfma_f32_16x16x32_bf16 v[88:91], a[148:151], v[204:207], v[88:91]
    ds_write_b128 v216, v[20:23] offset:0
    ds_write_b128 v216, v[36:39] offset:1024
    ds_write_b128 v216, v[52:55] offset:2048
    ds_write_b128 v216, v[68:71] offset:3072
    ds_write_b128 v216, v[84:87] offset:4096
    v_mfma_f32_16x16x32_bf16 v[28:31], a[132:135], v[208:211], v[28:31]
    v_mfma_f32_16x16x32_bf16 v[44:47], a[136:139], v[208:211], v[44:47]
    v_mfma_f32_16x16x32_bf16 v[60:63], a[140:143], v[208:211], v[60:63]
    v_mfma_f32_16x16x32_bf16 v[76:79], a[144:147], v[208:211], v[76:79]
    v_mfma_f32_16x16x32_bf16 v[92:95], a[148:151], v[208:211], v[92:95]
    ds_write_b128 v217, v[24:27] offset:0
    ds_write_b128 v217, v[40:43] offset:1024
    ds_write_b128 v217, v[56:59] offset:2048
    ds_write_b128 v217, v[72:75] offset:3072
    ds_write_b128 v217, v[88:91] offset:4096
    v_mfma_f32_16x16x32_bf16 v[16:19], a[132:135], v[196:199], v[16:19]
    v_mfma_f32_16x16x32_bf16 v[32:35], a[136:139], v[196:199], v[32:35]
    v_mfma_f32_16x16x32_bf16 v[48:51], a[140:143], v[196:199], v[48:51]
    v_mfma_f32_16x16x32_bf16 v[64:67], a[144:147], v[196:199], v[64:67]
    v_mfma_f32_16x16x32_bf16 v[80:83], a[148:151], v[196:199], v[80:83]
    ds_write_b128 v218, v[28:31] offset:0
    ds_write_b128 v218, v[44:47] offset:1024
    ds_write_b128 v218, v[60:63] offset:2048
    ds_write_b128 v218, v[76:79] offset:3072
    ds_write_b128 v218, v[92:95] offset:4096
    s_waitcnt lgkmcnt(0)
    s_barrier
    ds_read_b128 v[20:23], v219 offset:0
    ds_read_b128 v[24:27], v219 offset:5120
    ds_read_b128 v[28:31], v219 offset:10240
    ds_read_b128 v[36:39], v219 offset:1024
    ds_read_b128 v[40:43], v219 offset:6144
    ds_read_b128 v[44:47], v219 offset:11264
    ds_read_b128 v[52:55], v219 offset:2048
    ds_read_b128 v[56:59], v219 offset:7168
    ds_read_b128 v[60:63], v219 offset:12288
    ds_read_b128 v[68:71], v219 offset:3072
    ds_read_b128 v[72:75], v219 offset:8192
    ds_read_b128 v[76:79], v219 offset:13312
    ds_read_b128 v[84:87], v219 offset:4096
    ds_read_b128 v[88:91], v219 offset:9216
    ds_read_b128 v[92:95], v219 offset:14336
    s_nop 11
    s_cmp_eq_u32 s3, 1
    s_cbranch_scc1 mega_p5l118
    v_mov_b32 v112, 0
    v_mov_b32 v113, 0
    v_lshlrev_b32 v108, 16, v96
    v_and_b32 v109, 0xffff0000, v96
    v_lshlrev_b32 v110, 16, v97
    v_and_b32 v111, 0xffff0000, v97
    v_pk_add_f32 v[16:17], v[16:17], v[108:109]
    v_pk_add_f32 v[18:19], v[18:19], v[110:111]
    s_waitcnt lgkmcnt(12)
    v_pk_add_f32 v[20:21], v[20:21], v[24:25]
    v_pk_add_f32 v[22:23], v[22:23], v[26:27]
    v_pk_add_f32 v[16:17], v[16:17], v[28:29]
    v_pk_add_f32 v[18:19], v[18:19], v[30:31]
    v_pk_add_f32 v[16:17], v[16:17], v[20:21]
    v_pk_add_f32 v[18:19], v[18:19], v[22:23]
    v_cvt_pk_bf16_f32 v96, v16, v17
    v_cvt_pk_bf16_f32 v97, v18, v19
    buffer_store_dwordx2 v[96:97], v212, s[20:23], s52 offen offset:0 sc1
    v_lshlrev_b32 v108, 16, v96
    v_and_b32 v109, 0xffff0000, v96
    v_lshlrev_b32 v110, 16, v97
    v_and_b32 v111, 0xffff0000, v97
    v_add_f32 v112, v112, v108
    v_fmac_f32 v113, v108, v108
    v_add_f32 v112, v112, v109
    v_fmac_f32 v113, v109, v109
    v_add_f32 v112, v112, v110
    v_fmac_f32 v113, v110, v110
    v_add_f32 v112, v112, v111
    v_fmac_f32 v113, v111, v111
    v_lshlrev_b32 v108, 16, v98
    v_and_b32 v109, 0xffff0000, v98
    v_lshlrev_b32 v110, 16, v99
    v_and_b32 v111, 0xffff0000, v99
    v_pk_add_f32 v[32:33], v[32:33], v[108:109]
    v_pk_add_f32 v[34:35], v[34:35], v[110:111]
    s_waitcnt lgkmcnt(9)
    v_pk_add_f32 v[36:37], v[36:37], v[40:41]
    v_pk_add_f32 v[38:39], v[38:39], v[42:43]
    v_pk_add_f32 v[32:33], v[32:33], v[44:45]
    v_pk_add_f32 v[34:35], v[34:35], v[46:47]
    v_pk_add_f32 v[32:33], v[32:33], v[36:37]
    v_pk_add_f32 v[34:35], v[34:35], v[38:39]
    v_cvt_pk_bf16_f32 v98, v32, v33
    v_cvt_pk_bf16_f32 v99, v34, v35
    buffer_store_dwordx2 v[98:99], v212, s[20:23], s52 offen offset:512 sc1
    v_lshlrev_b32 v108, 16, v98
    v_and_b32 v109, 0xffff0000, v98
    v_lshlrev_b32 v110, 16, v99
    v_and_b32 v111, 0xffff0000, v99
    v_add_f32 v112, v112, v108
    v_fmac_f32 v113, v108, v108
    v_add_f32 v112, v112, v109
    v_fmac_f32 v113, v109, v109
    v_add_f32 v112, v112, v110
    v_fmac_f32 v113, v110, v110
    v_add_f32 v112, v112, v111
    v_fmac_f32 v113, v111, v111
    v_lshlrev_b32 v108, 16, v100
    v_and_b32 v109, 0xffff0000, v100
    v_lshlrev_b32 v110, 16, v101
    v_and_b32 v111, 0xffff0000, v101
    v_pk_add_f32 v[48:49], v[48:49], v[108:109]
    v_pk_add_f32 v[50:51], v[50:51], v[110:111]
    s_waitcnt lgkmcnt(6)
    v_pk_add_f32 v[52:53], v[52:53], v[56:57]
    v_pk_add_f32 v[54:55], v[54:55], v[58:59]
    v_pk_add_f32 v[48:49], v[48:49], v[60:61]
    v_pk_add_f32 v[50:51], v[50:51], v[62:63]
    v_pk_add_f32 v[48:49], v[48:49], v[52:53]
    v_pk_add_f32 v[50:51], v[50:51], v[54:55]
    v_cvt_pk_bf16_f32 v100, v48, v49
    v_cvt_pk_bf16_f32 v101, v50, v51
    buffer_store_dwordx2 v[100:101], v212, s[20:23], s52 offen offset:1024 sc1
    v_lshlrev_b32 v108, 16, v100
    v_and_b32 v109, 0xffff0000, v100
    v_lshlrev_b32 v110, 16, v101
    v_and_b32 v111, 0xffff0000, v101
    v_add_f32 v112, v112, v108
    v_fmac_f32 v113, v108, v108
    v_add_f32 v112, v112, v109
    v_fmac_f32 v113, v109, v109
    v_add_f32 v112, v112, v110
    v_fmac_f32 v113, v110, v110
    v_add_f32 v112, v112, v111
    v_fmac_f32 v113, v111, v111
    v_lshlrev_b32 v108, 16, v102
    v_and_b32 v109, 0xffff0000, v102
    v_lshlrev_b32 v110, 16, v103
    v_and_b32 v111, 0xffff0000, v103
    v_pk_add_f32 v[64:65], v[64:65], v[108:109]
    v_pk_add_f32 v[66:67], v[66:67], v[110:111]
    s_waitcnt lgkmcnt(3)
    v_pk_add_f32 v[68:69], v[68:69], v[72:73]
    v_pk_add_f32 v[70:71], v[70:71], v[74:75]
    v_pk_add_f32 v[64:65], v[64:65], v[76:77]
    v_pk_add_f32 v[66:67], v[66:67], v[78:79]
    v_pk_add_f32 v[64:65], v[64:65], v[68:69]
    v_pk_add_f32 v[66:67], v[66:67], v[70:71]
    v_cvt_pk_bf16_f32 v102, v64, v65
    v_cvt_pk_bf16_f32 v103, v66, v67
    buffer_store_dwordx2 v[102:103], v212, s[20:23], s52 offen offset:1536 sc1
    v_lshlrev_b32 v108, 16, v102
    v_and_b32 v109, 0xffff0000, v102
    v_lshlrev_b32 v110, 16, v103
    v_and_b32 v111, 0xffff0000, v103
    v_add_f32 v112, v112, v108
    v_fmac_f32 v113, v108, v108
    v_add_f32 v112, v112, v109
    v_fmac_f32 v113, v109, v109
    v_add_f32 v112, v112, v110
    v_fmac_f32 v113, v110, v110
    v_add_f32 v112, v112, v111
    v_fmac_f32 v113, v111, v111
    v_lshlrev_b32 v108, 16, v104
    v_and_b32 v109, 0xffff0000, v104
    v_lshlrev_b32 v110, 16, v105
    v_and_b32 v111, 0xffff0000, v105
    v_pk_add_f32 v[80:81], v[80:81], v[108:109]
    v_pk_add_f32 v[82:83], v[82:83], v[110:111]
    s_waitcnt lgkmcnt(0)
    v_pk_add_f32 v[84:85], v[84:85], v[88:89]
    v_pk_add_f32 v[86:87], v[86:87], v[90:91]
    v_pk_add_f32 v[80:81], v[80:81], v[92:93]
    v_pk_add_f32 v[82:83], v[82:83], v[94:95]
    v_pk_add_f32 v[80:81], v[80:81], v[84:85]
    v_pk_add_f32 v[82:83], v[82:83], v[86:87]
    v_cvt_pk_bf16_f32 v104, v80, v81
    v_cvt_pk_bf16_f32 v105, v82, v83
    buffer_store_dwordx2 v[104:105], v213, s[20:23], s52 offen offset:2048 sc1
    v_lshlrev_b32 v108, 16, v104
    v_and_b32 v109, 0xffff0000, v104
    v_lshlrev_b32 v110, 16, v105
    v_and_b32 v111, 0xffff0000, v105
    v_add_f32 v112, v112, v108
    v_fmac_f32 v113, v108, v108
    v_add_f32 v112, v112, v109
    v_fmac_f32 v113, v109, v109
    v_add_f32 v112, v112, v110
    v_fmac_f32 v113, v110, v110
    v_add_f32 v112, v112, v111
    v_fmac_f32 v113, v111, v111
    v_mov_b32 v13, v112
    s_nop 1
    v_permlane32_swap_b32 v112, v13
    v_add_f32 v112, v112, v13
    v_mov_b32 v13, v112
    s_nop 1
    v_permlane16_swap_b32 v112, v13
    v_add_f32 v112, v112, v13
    v_mov_b32 v14, v113
    s_nop 1
    v_permlane32_swap_b32 v113, v14
    v_add_f32 v113, v113, v14
    v_mov_b32 v14, v113
    s_nop 1
    v_permlane16_swap_b32 v113, v14
    v_add_f32 v113, v113, v14
    buffer_store_dwordx2 v[112:113], v220, s[20:23], s58 offen sc1
    s_mov_b32 s25, s60
    s_nop 11
    s_branch mega_p5end19
mega_p5l118:
    v_lshlrev_b32 v108, 16, v96
    v_and_b32 v109, 0xffff0000, v96
    v_lshlrev_b32 v110, 16, v97
    v_and_b32 v111, 0xffff0000, v97
    v_pk_add_f32 v[16:17], v[16:17], v[108:109]
    v_pk_add_f32 v[18:19], v[18:19], v[110:111]
    s_waitcnt lgkmcnt(12)
    v_pk_add_f32 v[20:21], v[20:21], v[24:25]
    v_pk_add_f32 v[22:23], v[22:23], v[26:27]
    v_pk_add_f32 v[16:17], v[16:17], v[28:29]
    v_pk_add_f32 v[18:19], v[18:19], v[30:31]
    v_pk_add_f32 v[16:17], v[16:17], v[20:21]
    v_pk_add_f32 v[18:19], v[18:19], v[22:23]
    v_cvt_pk_bf16_f32 v96, v16, v17
    v_cvt_pk_bf16_f32 v97, v18, v19
    buffer_store_dwordx2 v[96:97], v214, s[40:43], 0 offen offset:0
    v_lshlrev_b32 v108, 16, v98
    v_and_b32 v109, 0xffff0000, v98
    v_lshlrev_b32 v110, 16, v99
    v_and_b32 v111, 0xffff0000, v99
    v_pk_add_f32 v[32:33], v[32:33], v[108:109]
    v_pk_add_f32 v[34:35], v[34:35], v[110:111]
    s_waitcnt lgkmcnt(9)
    v_pk_add_f32 v[36:37], v[36:37], v[40:41]
    v_pk_add_f32 v[38:39], v[38:39], v[42:43]
    v_pk_add_f32 v[32:33], v[32:33], v[44:45]
    v_pk_add_f32 v[34:35], v[34:35], v[46:47]
    v_pk_add_f32 v[32:33], v[32:33], v[36:37]
    v_pk_add_f32 v[34:35], v[34:35], v[38:39]
    v_cvt_pk_bf16_f32 v98, v32, v33
    v_cvt_pk_bf16_f32 v99, v34, v35
    buffer_store_dwordx2 v[98:99], v214, s[40:43], 0 offen offset:32
    v_lshlrev_b32 v108, 16, v100
    v_and_b32 v109, 0xffff0000, v100
    v_lshlrev_b32 v110, 16, v101
    v_and_b32 v111, 0xffff0000, v101
    v_pk_add_f32 v[48:49], v[48:49], v[108:109]
    v_pk_add_f32 v[50:51], v[50:51], v[110:111]
    s_waitcnt lgkmcnt(6)
    v_pk_add_f32 v[52:53], v[52:53], v[56:57]
    v_pk_add_f32 v[54:55], v[54:55], v[58:59]
    v_pk_add_f32 v[48:49], v[48:49], v[60:61]
    v_pk_add_f32 v[50:51], v[50:51], v[62:63]
    v_pk_add_f32 v[48:49], v[48:49], v[52:53]
    v_pk_add_f32 v[50:51], v[50:51], v[54:55]
    v_cvt_pk_bf16_f32 v100, v48, v49
    v_cvt_pk_bf16_f32 v101, v50, v51
    buffer_store_dwordx2 v[100:101], v214, s[40:43], 0 offen offset:64
    v_lshlrev_b32 v108, 16, v102
    v_and_b32 v109, 0xffff0000, v102
    v_lshlrev_b32 v110, 16, v103
    v_and_b32 v111, 0xffff0000, v103
    v_pk_add_f32 v[64:65], v[64:65], v[108:109]
    v_pk_add_f32 v[66:67], v[66:67], v[110:111]
    s_waitcnt lgkmcnt(3)
    v_pk_add_f32 v[68:69], v[68:69], v[72:73]
    v_pk_add_f32 v[70:71], v[70:71], v[74:75]
    v_pk_add_f32 v[64:65], v[64:65], v[76:77]
    v_pk_add_f32 v[66:67], v[66:67], v[78:79]
    v_pk_add_f32 v[64:65], v[64:65], v[68:69]
    v_pk_add_f32 v[66:67], v[66:67], v[70:71]
    v_cvt_pk_bf16_f32 v102, v64, v65
    v_cvt_pk_bf16_f32 v103, v66, v67
    buffer_store_dwordx2 v[102:103], v214, s[40:43], 0 offen offset:96
    v_lshlrev_b32 v108, 16, v104
    v_and_b32 v109, 0xffff0000, v104
    v_lshlrev_b32 v110, 16, v105
    v_and_b32 v111, 0xffff0000, v105
    v_pk_add_f32 v[80:81], v[80:81], v[108:109]
    v_pk_add_f32 v[82:83], v[82:83], v[110:111]
    s_waitcnt lgkmcnt(0)
    v_pk_add_f32 v[84:85], v[84:85], v[88:89]
    v_pk_add_f32 v[86:87], v[86:87], v[90:91]
    v_pk_add_f32 v[80:81], v[80:81], v[92:93]
    v_pk_add_f32 v[82:83], v[82:83], v[94:95]
    v_pk_add_f32 v[80:81], v[80:81], v[84:85]
    v_pk_add_f32 v[82:83], v[82:83], v[86:87]
    v_cvt_pk_bf16_f32 v104, v80, v81
    v_cvt_pk_bf16_f32 v105, v82, v83
    buffer_store_dwordx2 v[104:105], v215, s[40:43], 0 offen offset:128
    s_nop 10
mega_p5end19:
    s_add_u32 s3, s3, 1
    s_cmp_lt_u32 s3, 2
    s_cbranch_scc1 mega_top2
mega_end1:
    s_endpgm
.section .rodata,"a"
.p2align 6
.amdhsa_kernel k0_kernel
  .amdhsa_next_free_vgpr 112
  .amdhsa_next_free_sgpr 66
  .amdhsa_accum_offset 112
  .amdhsa_group_segment_fixed_size 0
  .amdhsa_kernarg_size 88
  .amdhsa_user_sgpr_count 2
  .amdhsa_user_sgpr_kernarg_segment_ptr 1
  .amdhsa_system_sgpr_workgroup_id_x 1
  .amdhsa_float_denorm_mode_32 3
  .amdhsa_float_denorm_mode_16_64 3
.end_amdhsa_kernel
.section .rodata,"a"
.p2align 6
.amdhsa_kernel mega_kernel
  .amdhsa_next_free_vgpr 504
  .amdhsa_next_free_sgpr 97
  .amdhsa_accum_offset 248
  .amdhsa_group_segment_fixed_size 0
  .amdhsa_kernarg_size 88
  .amdhsa_user_sgpr_count 2
  .amdhsa_user_sgpr_kernarg_segment_ptr 1
  .amdhsa_system_sgpr_workgroup_id_x 1
  .amdhsa_float_denorm_mode_32 3
  .amdhsa_float_denorm_mode_16_64 3
.end_amdhsa_kernel
```
